```python
import torch

def _softmax(x, axis=-1):
    return torch.softmax(x, dim=axis)

def _gelu(x):
    return torch.nn.functional.gelu(x, approximate='tanh')

def _silu(x):
    return torch.nn.functional.silu(x)

def _sigmoid(x):
    return torch.sigmoid(x)

def _layernorm(x, axis=-1, eps=1e-05):
    m = x.mean(dim=axis, keepdim=True)
    v = x.var(dim=axis, keepdim=True, unbiased=False)
    return (x - m) / torch.sqrt(v + eps)

def _scatter_add(tgt, idx, src, axis=0):
    return tgt.clone().index_add_(axis, idx, src)

def _segment_sum(src, seg, n):
    out = torch.zeros((n,) + src.shape[1:], dtype=src.dtype)
    return out.index_add_(0, seg, src)

def _pad(x, pw):
    flat = tuple((v for pair in reversed(pw) for v in pair))
    return torch.nn.functional.pad(x, flat)
kernel_name = 'gated_mix__softmax_full_mha__memory_aug_recurrent_mem_tr__prompt'

def setup_inputs():

    _w = lambda a: (lambda t: t.to(torch.bfloat16) if t.is_floating_point() else t)(torch.as_tensor(a))

    def _A_setup():
        B, S, D = (1, 2048, 640)
        return {'x': _w((lambda *s: torch.randn(*s, dtype=torch.bfloat16) * 0.05)(B, S, D)), 'wqkv': _w((lambda *s: torch.randn(*s, dtype=torch.bfloat16) * 0.8)(D, 3 * D)), 'wo': _w((lambda *s: torch.randn(*s, dtype=torch.bfloat16) * 0.05)(D, D))}
    _A_in = _A_setup()

    def _B_setup():
        B, S, Dm = (1, 2048, 640)
        H, Dh = (32, 192)
        M, seg = (8, 32)
        seg = min(seg, S)
        S = S // seg * seg
        return {'x': _w((lambda *s: torch.randn(*s, dtype=torch.bfloat16) * 0.05)(B, S, Dm)), 'mem0': _w((lambda *s: torch.randn(*s, dtype=torch.bfloat16) * 0.8)(B, M, Dm)), 'Wq': _w((lambda *s: torch.randn(*s, dtype=torch.bfloat16) * 3.2)(Dm, H, Dh) * Dm ** (-0.5)), 'Wk': _w((lambda *s: torch.randn(*s, dtype=torch.bfloat16) * 3.2)(Dm, H, Dh) * Dm ** (-0.5)), 'Wv': _w((lambda *s: torch.randn(*s, dtype=torch.bfloat16) * 0.8)(Dm, H, Dh) * Dm ** (-0.5)), 'Wo': _w((lambda *s: torch.randn(*s, dtype=torch.bfloat16) * 0.8)(H, Dh, Dm) * (H * Dh) ** (-0.5)), 'seg_len': seg}
    _B_in = _B_setup()
    return {'A_x': _A_in['x'], 'A_wqkv': _A_in['wqkv'], 'A_wo': _A_in['wo'], 'B_x': _B_in['x'], 'B_mem0': _B_in['mem0'], 'B_Wq': _B_in['Wq'], 'B_Wk': _B_in['Wk'], 'B_Wv': _B_in['Wv'], 'B_Wo': _B_in['Wo'], 'B_seg_len': _B_in['seg_len'], 'gate_w': _w((lambda *s: torch.randn(*s, dtype=torch.bfloat16) * 0.05)(640) * 16.0)}

def reference(A_x, A_wqkv, A_wo, B_x, B_mem0, B_Wq, B_Wk, B_Wv, B_Wo, B_seg_len, gate_w):

    def _A_ref(x, wqkv, wo):
        B, S, D = x.shape
        H = 32
        Dh = D // H
        qkv = (lambda x, *d: x.permute(*d))((x @ wqkv).reshape(B, S, 3, H, Dh), 2, 0, 3, 1, 4)
        q, k, v = (qkv[0], qkv[1], qkv[2])
        scale = Dh ** (-0.5)
        scores = torch.einsum('bhqd,bhkd->bhqk', q, k) * scale
        p = _softmax(scores, axis=-1)
        o = torch.einsum('bhqk,bhkd->bhqd', p, v)
        return (lambda x, *d: x.permute(*d))(o, 0, 2, 1, 3).reshape(B, S, D) @ wo

    def _B_ref(x, mem0, Wq, Wk, Wv, Wo, seg_len):
        B, S, Dm = x.shape
        H, Dh = (Wq.shape[1], Wq.shape[2])
        M = mem0.shape[1]
        scale = Dh ** (-0.5)
        n_seg = S // seg_len
        L = M + seg_len
        idx = torch.arange(L)
        mask = (idx[:, None] < M) | (idx[:, None] >= idx[None, :])
        mem = mem0
        outs = []
        for s in range(n_seg):
            xs = x[:, s * seg_len:(s + 1) * seg_len, :].clone()
            h = torch.concatenate([mem, xs], axis=1)
            q = torch.einsum('btd,dhe->bhte', h, Wq)
            k = torch.einsum('btd,dhe->bhte', h, Wk)
            v = torch.einsum('btd,dhe->bhte', h, Wv)
            scores = torch.einsum('bhqe,bhke->bhqk', q, k) * scale
            scores = torch.where(mask[None, None], scores, -1000000000.0)
            p = _softmax(scores, axis=-1)
            o = torch.einsum('bhqk,bhke->bhqe', p, v)
            o = torch.einsum('bhte,hed->btd', o, Wo)
            mem = o[:, :M, :].clone()
            outs.append(o[:, M:, :])
        return torch.concatenate(outs, axis=1)
    x = A_x
    g = _sigmoid((x * gate_w).sum(-1, keepdims=True))
    a = _A_ref(x, A_wqkv, A_wo)
    b = _B_ref(x, B_mem0, B_Wq, B_Wk, B_Wv, B_Wo, B_seg_len)
    return g * a + (1 - g) * b
```

```asm
; @launch grid=(256,1,1) block=(256,1,1) lds=163840
.amdgcn_target "amdgcn-amd-amdhsa--gfx950"
.text
.globl gated_mix__softmax_full_mha__memory_aug_recurrent_mem_tr__prompt_kernel
.p2align 8
.type gated_mix__softmax_full_mha__memory_aug_recurrent_mem_tr__prompt_kernel,@function
gated_mix__softmax_full_mha__memory_aug_recurrent_mem_tr__prompt_kernel:
    s_cmp_ge_u32 s2, 256
    s_cbranch_scc0 L_go
    s_endpgm
L_go:
    s_load_dwordx16 s[36:51], s[0:1], 0
    s_load_dwordx8 s[52:59], s[0:1], 64
    s_load_dwordx4 s[60:63], s[0:1], 96
    v_lshrrev_b32 v1, 6, v0
    v_and_b32 v0, 63, v0
    v_readfirstlane_b32 s3, v1
    s_getreg_b32 s5, hwreg(HW_REG_XCC_ID)
    s_and_b32 s5, s5, 7
    s_mov_b32 s32, 0x200000
    s_waitcnt lgkmcnt(0)
    s_mov_b32 s8, s62
    s_and_b32 s9, s63, 0xffff
    s_mov_b32 s10, 268435456
    s_mov_b32 s11, 0x20000
    s_mov_b32 s12, s36
    s_and_b32 s13, s37, 0xffff
    s_mov_b32 s14, 2621440
    s_mov_b32 s15, 0x20000
    s_mov_b32 s24, s60
    s_and_b32 s25, s61, 0xffff
    s_mov_b32 s26, 256
    s_mov_b32 s27, 0x20000
    s_mov_b32 s28, s58
    s_and_b32 s29, s59, 0xffff
    s_mov_b32 s30, 2621440
    s_mov_b32 s31, 0x20000
    s_cmp_lg_u32 s3, 0
    s_cbranch_scc1 L_tk_done
    s_lshl_b32 s6, s5, 5
    v_mov_b32 v2, 1
    v_mov_b32 v3, s6
    s_mov_b64 exec, 1
    buffer_atomic_add v2, v3, s[24:27], 0 offen sc0 sc1
    s_mov_b64 exec, -1
    s_waitcnt vmcnt(0)
    v_readfirstlane_b32 s7, v2
    s_add_u32 s4, s6, s7
    s_cmp_lt_u32 s7, 32
    s_cbranch_scc1 L_tk_have
    v_and_b32 v3, 7, v0
    v_lshlrev_b32 v3, 5, v3
L_tk_wait:
    buffer_load_dword v2, v3, s[24:27], 0 offen sc1
    s_waitcnt vmcnt(0)
    s_mov_b32 s33, 0
    v_readlane_b32 s64, v2, 0
    s_add_u32 s33, s33, s64
    v_readlane_b32 s65, v2, 1
    s_add_u32 s33, s33, s65
    v_readlane_b32 s66, v2, 2
    s_add_u32 s33, s33, s66
    v_readlane_b32 s67, v2, 3
    s_add_u32 s33, s33, s67
    v_readlane_b32 s68, v2, 4
    s_add_u32 s33, s33, s68
    v_readlane_b32 s69, v2, 5
    s_add_u32 s33, s33, s69
    v_readlane_b32 s70, v2, 6
    s_add_u32 s33, s33, s70
    v_readlane_b32 s71, v2, 7
    s_add_u32 s33, s33, s71
    s_cmp_ge_u32 s33, 256
    s_cbranch_scc1 L_tk_all
    s_sleep 8
    s_sub_u32 s32, s32, 1
    s_cbranch_scc0 L_tk_wait
    s_endpgm
L_tk_all:
    s_sub_u32 s7, s7, 32
    s_max_u32 s33, s64, 32
    s_sub_u32 s33, s33, 32
    s_cmp_gt_u32 s5, 0
    s_cselect_b32 s33, s33, 0
    s_add_u32 s7, s7, s33
    s_max_u32 s33, s65, 32
    s_sub_u32 s33, s33, 32
    s_cmp_gt_u32 s5, 1
    s_cselect_b32 s33, s33, 0
    s_add_u32 s7, s7, s33
    s_max_u32 s33, s66, 32
    s_sub_u32 s33, s33, 32
    s_cmp_gt_u32 s5, 2
    s_cselect_b32 s33, s33, 0
    s_add_u32 s7, s7, s33
    s_max_u32 s33, s67, 32
    s_sub_u32 s33, s33, 32
    s_cmp_gt_u32 s5, 3
    s_cselect_b32 s33, s33, 0
    s_add_u32 s7, s7, s33
    s_max_u32 s33, s68, 32
    s_sub_u32 s33, s33, 32
    s_cmp_gt_u32 s5, 4
    s_cselect_b32 s33, s33, 0
    s_add_u32 s7, s7, s33
    s_max_u32 s33, s69, 32
    s_sub_u32 s33, s33, 32
    s_cmp_gt_u32 s5, 5
    s_cselect_b32 s33, s33, 0
    s_add_u32 s7, s7, s33
    s_max_u32 s33, s70, 32
    s_sub_u32 s33, s33, 32
    s_cmp_gt_u32 s5, 6
    s_cselect_b32 s33, s33, 0
    s_add_u32 s7, s7, s33
    s_max_u32 s33, s71, 32
    s_sub_u32 s33, s33, 32
    s_cmp_gt_u32 s5, 7
    s_cselect_b32 s33, s33, 0
    s_add_u32 s7, s7, s33
    s_min_u32 s33, s64, 32
    s_add_u32 s4, s33, 0
    s_add_u32 s4, s4, s7
    s_sub_u32 s33, 32, s33
    s_cmp_lt_u32 s7, s33
    s_cbranch_scc1 L_tk_have
    s_sub_u32 s7, s7, s33
    s_min_u32 s33, s65, 32
    s_add_u32 s4, s33, 32
    s_add_u32 s4, s4, s7
    s_sub_u32 s33, 32, s33
    s_cmp_lt_u32 s7, s33
    s_cbranch_scc1 L_tk_have
    s_sub_u32 s7, s7, s33
    s_min_u32 s33, s66, 32
    s_add_u32 s4, s33, 64
    s_add_u32 s4, s4, s7
    s_sub_u32 s33, 32, s33
    s_cmp_lt_u32 s7, s33
    s_cbranch_scc1 L_tk_have
    s_sub_u32 s7, s7, s33
    s_min_u32 s33, s67, 32
    s_add_u32 s4, s33, 96
    s_add_u32 s4, s4, s7
    s_sub_u32 s33, 32, s33
    s_cmp_lt_u32 s7, s33
    s_cbranch_scc1 L_tk_have
    s_sub_u32 s7, s7, s33
    s_min_u32 s33, s68, 32
    s_add_u32 s4, s33, 128
    s_add_u32 s4, s4, s7
    s_sub_u32 s33, 32, s33
    s_cmp_lt_u32 s7, s33
    s_cbranch_scc1 L_tk_have
    s_sub_u32 s7, s7, s33
    s_min_u32 s33, s69, 32
    s_add_u32 s4, s33, 160
    s_add_u32 s4, s4, s7
    s_sub_u32 s33, 32, s33
    s_cmp_lt_u32 s7, s33
    s_cbranch_scc1 L_tk_have
    s_sub_u32 s7, s7, s33
    s_min_u32 s33, s70, 32
    s_add_u32 s4, s33, 192
    s_add_u32 s4, s4, s7
    s_sub_u32 s33, 32, s33
    s_cmp_lt_u32 s7, s33
    s_cbranch_scc1 L_tk_have
    s_sub_u32 s7, s7, s33
    s_min_u32 s33, s71, 32
    s_add_u32 s4, s33, 224
    s_add_u32 s4, s4, s7
    s_sub_u32 s33, 32, s33
    s_cmp_lt_u32 s7, s33
    s_cbranch_scc1 L_tk_have
    s_sub_u32 s7, s7, s33
    s_endpgm
L_tk_have:
    v_mov_b32 v2, s4
    v_mov_b32 v3, 0
    ds_write_b32 v3, v2
    s_waitcnt lgkmcnt(0)
L_tk_done:
    s_barrier
    v_mov_b32 v3, 0
    ds_read_b32 v2, v3
    s_waitcnt lgkmcnt(0)
    v_readfirstlane_b32 s4, v2
    s_barrier
    s_and_b32 s4, s4, 255
    s_cmp_lt_u32 s4, 32
    s_cbranch_scc1 L_S1
    s_cmp_lt_u32 s4, 128
    s_cbranch_scc1 L_PRO
    s_cmp_lt_u32 s4, 192
    s_cbranch_scc1 L_X1
    s_branch L_PRO
L_S1:
    s_mov_b32 s5, s4
    s_mov_b32 s16, s46
    s_and_b32 s17, s47, 0xffff
    s_mov_b32 s18, 7864320
    s_mov_b32 s19, 0x20000
    s_mov_b32 s20, s48
    s_and_b32 s21, s49, 0xffff
    s_mov_b32 s22, 7864320
    s_mov_b32 s23, 0x20000
    s_mul_i32 s6, s5, 384
    s_mul_i32 s7, s3, 96
    s_add_u32 s6, s6, s7
    s_mov_b32 s7, 43691
    s_movk_i32 s33, 0x3000
    v_add_u32 v26, 0, v0
    v_mul_lo_u32 v20, v26, s7
    v_lshrrev_b32 v20, 18, v20
    v_mul_u32_u24 v2, 6, v20
    v_sub_u32 v26, v26, v2
    v_and_b32 v2, 0x33, v20
    v_and_b32 v3, 4, v20
    v_lshl_or_b32 v2, v3, 1, v2
    v_and_b32 v3, 8, v20
    v_lshrrev_b32 v3, 1, v3
    v_or_b32 v2, v2, v3
    v_mul_lo_u32 v20, v2, s33
    v_lshl_add_u32 v20, v26, 4, v20
    v_add_u32 v20, s6, v20
    v_add_u32 v26, 64, v0
    v_mul_lo_u32 v21, v26, s7
    v_lshrrev_b32 v21, 18, v21
    v_mul_u32_u24 v2, 6, v21
    v_sub_u32 v26, v26, v2
    v_and_b32 v2, 0x33, v21
    v_and_b32 v3, 4, v21
    v_lshl_or_b32 v2, v3, 1, v2
    v_and_b32 v3, 8, v21
    v_lshrrev_b32 v3, 1, v3
    v_or_b32 v2, v2, v3
    v_mul_lo_u32 v21, v2, s33
    v_lshl_add_u32 v21, v26, 4, v21
    v_add_u32 v21, s6, v21
    v_add_u32 v26, 128, v0
    v_mul_lo_u32 v22, v26, s7
    v_lshrrev_b32 v22, 18, v22
    v_mul_u32_u24 v2, 6, v22
    v_sub_u32 v26, v26, v2
    v_and_b32 v2, 0x33, v22
    v_and_b32 v3, 4, v22
    v_lshl_or_b32 v2, v3, 1, v2
    v_and_b32 v3, 8, v22
    v_lshrrev_b32 v3, 1, v3
    v_or_b32 v2, v2, v3
    v_mul_lo_u32 v22, v2, s33
    v_lshl_add_u32 v22, v26, 4, v22
    v_add_u32 v22, s6, v22
    v_add_u32 v26, 192, v0
    v_mul_lo_u32 v23, v26, s7
    v_lshrrev_b32 v23, 18, v23
    v_mul_u32_u24 v2, 6, v23
    v_sub_u32 v26, v26, v2
    v_and_b32 v2, 0x33, v23
    v_and_b32 v3, 4, v23
    v_lshl_or_b32 v2, v3, 1, v2
    v_and_b32 v3, 8, v23
    v_lshrrev_b32 v3, 1, v3
    v_or_b32 v2, v2, v3
    v_mul_lo_u32 v23, v2, s33
    v_lshl_add_u32 v23, v26, 4, v23
    v_add_u32 v23, s6, v23
    v_add_u32 v26, 256, v0
    v_mul_lo_u32 v24, v26, s7
    v_lshrrev_b32 v24, 18, v24
    v_mul_u32_u24 v2, 6, v24
    v_sub_u32 v26, v26, v2
    v_and_b32 v2, 0x33, v24
    v_and_b32 v3, 4, v24
    v_lshl_or_b32 v2, v3, 1, v2
    v_and_b32 v3, 8, v24
    v_lshrrev_b32 v3, 1, v3
    v_or_b32 v2, v2, v3
    v_mul_lo_u32 v24, v2, s33
    v_lshl_add_u32 v24, v26, 4, v24
    v_add_u32 v24, s6, v24
    v_add_u32 v26, 320, v0
    v_mul_lo_u32 v25, v26, s7
    v_lshrrev_b32 v25, 18, v25
    v_mul_u32_u24 v2, 6, v25
    v_sub_u32 v26, v26, v2
    v_and_b32 v2, 0x33, v25
    v_and_b32 v3, 4, v25
    v_lshl_or_b32 v2, v3, 1, v2
    v_and_b32 v3, 8, v25
    v_lshrrev_b32 v3, 1, v3
    v_or_b32 v2, v2, v3
    v_mul_lo_u32 v25, v2, s33
    v_lshl_add_u32 v25, v26, 4, v25
    v_add_u32 v25, s6, v25
    v_lshrrev_b32 v2, 5, v0
    v_lshlrev_b32 v2, 4, v2
    v_bfe_u32 v3, v0, 2, 3
    v_add_u32 v2, v2, v3
    v_mul_u32_u24 v2, 96, v2
    v_and_b32 v3, 3, v0
    v_lshl_add_u32 v26, v3, 3, v2
    s_mul_i32 s34, s3, 12288
    s_mov_b32 s33, 0
    s_add_u32 m0, s34, 0
    s_nop 0
    buffer_load_dwordx4 v20, s[16:19], s33 offen lds
    s_add_u32 m0, s34, 1024
    s_nop 0
    buffer_load_dwordx4 v21, s[16:19], s33 offen lds
    s_add_u32 m0, s34, 2048
    s_nop 0
    buffer_load_dwordx4 v22, s[16:19], s33 offen lds
    s_add_u32 m0, s34, 3072
    s_nop 0
    buffer_load_dwordx4 v23, s[16:19], s33 offen lds
    s_add_u32 m0, s34, 4096
    s_nop 0
    buffer_load_dwordx4 v24, s[16:19], s33 offen lds
    s_add_u32 m0, s34, 5120
    s_nop 0
    buffer_load_dwordx4 v25, s[16:19], s33 offen lds
    s_add_u32 m0, s34, 6144
    s_nop 0
    buffer_load_dwordx4 v20, s[20:23], s33 offen lds
    s_add_u32 m0, s34, 7168
    s_nop 0
    buffer_load_dwordx4 v21, s[20:23], s33 offen lds
    s_add_u32 m0, s34, 8192
    s_nop 0
    buffer_load_dwordx4 v22, s[20:23], s33 offen lds
    s_add_u32 m0, s34, 9216
    s_nop 0
    buffer_load_dwordx4 v23, s[20:23], s33 offen lds
    s_add_u32 m0, s34, 10240
    s_nop 0
    buffer_load_dwordx4 v24, s[20:23], s33 offen lds
    s_add_u32 m0, s34, 11264
    s_nop 0
    buffer_load_dwordx4 v25, s[20:23], s33 offen lds
    s_mov_b32 s33, 786432
    s_add_u32 m0, s34, 49152
    s_nop 0
    buffer_load_dwordx4 v20, s[16:19], s33 offen lds
    s_add_u32 m0, s34, 50176
    s_nop 0
    buffer_load_dwordx4 v21, s[16:19], s33 offen lds
    s_add_u32 m0, s34, 51200
    s_nop 0
    buffer_load_dwordx4 v22, s[16:19], s33 offen lds
    s_add_u32 m0, s34, 52224
    s_nop 0
    buffer_load_dwordx4 v23, s[16:19], s33 offen lds
    s_add_u32 m0, s34, 53248
    s_nop 0
    buffer_load_dwordx4 v24, s[16:19], s33 offen lds
    s_add_u32 m0, s34, 54272
    s_nop 0
    buffer_load_dwordx4 v25, s[16:19], s33 offen lds
    s_add_u32 m0, s34, 55296
    s_nop 0
    buffer_load_dwordx4 v20, s[20:23], s33 offen lds
    s_add_u32 m0, s34, 56320
    s_nop 0
    buffer_load_dwordx4 v21, s[20:23], s33 offen lds
    s_add_u32 m0, s34, 57344
    s_nop 0
    buffer_load_dwordx4 v22, s[20:23], s33 offen lds
    s_add_u32 m0, s34, 58368
    s_nop 0
    buffer_load_dwordx4 v23, s[20:23], s33 offen lds
    s_add_u32 m0, s34, 59392
    s_nop 0
    buffer_load_dwordx4 v24, s[20:23], s33 offen lds
    s_add_u32 m0, s34, 60416
    s_nop 0
    buffer_load_dwordx4 v25, s[20:23], s33 offen lds
    s_mov_b32 s33, 2359296
    s_add_u32 m0, s34, 98304
    s_nop 0
    buffer_load_dwordx4 v20, s[16:19], s33 offen lds
    s_add_u32 m0, s34, 99328
    s_nop 0
    buffer_load_dwordx4 v21, s[16:19], s33 offen lds
    s_add_u32 m0, s34, 100352
    s_nop 0
    buffer_load_dwordx4 v22, s[16:19], s33 offen lds
    s_add_u32 m0, s34, 101376
    s_nop 0
    buffer_load_dwordx4 v23, s[16:19], s33 offen lds
    s_add_u32 m0, s34, 102400
    s_nop 0
    buffer_load_dwordx4 v24, s[16:19], s33 offen lds
    s_add_u32 m0, s34, 103424
    s_nop 0
    buffer_load_dwordx4 v25, s[16:19], s33 offen lds
    s_add_u32 m0, s34, 104448
    s_nop 0
    buffer_load_dwordx4 v20, s[20:23], s33 offen lds
    s_add_u32 m0, s34, 105472
    s_nop 0
    buffer_load_dwordx4 v21, s[20:23], s33 offen lds
    s_add_u32 m0, s34, 106496
    s_nop 0
    buffer_load_dwordx4 v22, s[20:23], s33 offen lds
    s_add_u32 m0, s34, 107520
    s_nop 0
    buffer_load_dwordx4 v23, s[20:23], s33 offen lds
    s_add_u32 m0, s34, 108544
    s_nop 0
    buffer_load_dwordx4 v24, s[20:23], s33 offen lds
    s_add_u32 m0, s34, 109568
    s_nop 0
    buffer_load_dwordx4 v25, s[20:23], s33 offen lds
    s_waitcnt vmcnt(24)
    s_add_u32 s6, s34, 0
    v_add_u32 v27, s6, v26
    s_cmp_lg_u32 s3, 0
    s_cbranch_scc1 WL0_0
    ds_read_b64_tr_b16 a[0:1], v27 offset:0
    ds_read_b64_tr_b16 a[2:3], v27 offset:768
    ds_read_b64_tr_b16 a[4:5], v27 offset:3072
    ds_read_b64_tr_b16 a[6:7], v27 offset:3840
    ds_read_b64_tr_b16 a[8:9], v27 offset:32
    ds_read_b64_tr_b16 a[10:11], v27 offset:800
    ds_read_b64_tr_b16 a[12:13], v27 offset:3104
    ds_read_b64_tr_b16 a[14:15], v27 offset:3872
    ds_read_b64_tr_b16 a[16:17], v27 offset:64
    ds_read_b64_tr_b16 a[18:19], v27 offset:832
    ds_read_b64_tr_b16 a[20:21], v27 offset:3136
    ds_read_b64_tr_b16 a[22:23], v27 offset:3904
    s_waitcnt lgkmcnt(0)
    ds_read_b64_tr_b16 a[24:25], v27 offset:6144
    ds_read_b64_tr_b16 a[26:27], v27 offset:6912
    ds_read_b64_tr_b16 a[28:29], v27 offset:9216
    ds_read_b64_tr_b16 a[30:31], v27 offset:9984
    ds_read_b64_tr_b16 a[32:33], v27 offset:6176
    ds_read_b64_tr_b16 a[34:35], v27 offset:6944
    ds_read_b64_tr_b16 a[36:37], v27 offset:9248
    ds_read_b64_tr_b16 a[38:39], v27 offset:10016
    ds_read_b64_tr_b16 a[40:41], v27 offset:6208
    ds_read_b64_tr_b16 a[42:43], v27 offset:6976
    ds_read_b64_tr_b16 a[44:45], v27 offset:9280
    ds_read_b64_tr_b16 a[46:47], v27 offset:10048
    s_waitcnt lgkmcnt(0)
WL0_0:
    s_cmp_lg_u32 s3, 1
    s_cbranch_scc1 WL0_1
    ds_read_b64_tr_b16 v[160:161], v27 offset:0
    ds_read_b64_tr_b16 v[162:163], v27 offset:768
    ds_read_b64_tr_b16 v[164:165], v27 offset:3072
    ds_read_b64_tr_b16 v[166:167], v27 offset:3840
    ds_read_b64_tr_b16 v[168:169], v27 offset:32
    ds_read_b64_tr_b16 v[170:171], v27 offset:800
    ds_read_b64_tr_b16 v[172:173], v27 offset:3104
    ds_read_b64_tr_b16 v[174:175], v27 offset:3872
    ds_read_b64_tr_b16 v[176:177], v27 offset:64
    ds_read_b64_tr_b16 v[178:179], v27 offset:832
    ds_read_b64_tr_b16 v[180:181], v27 offset:3136
    ds_read_b64_tr_b16 v[182:183], v27 offset:3904
    s_waitcnt lgkmcnt(0)
    ds_read_b64_tr_b16 v[184:185], v27 offset:6144
    ds_read_b64_tr_b16 v[186:187], v27 offset:6912
    ds_read_b64_tr_b16 v[188:189], v27 offset:9216
    ds_read_b64_tr_b16 v[190:191], v27 offset:9984
    ds_read_b64_tr_b16 v[192:193], v27 offset:6176
    ds_read_b64_tr_b16 v[194:195], v27 offset:6944
    ds_read_b64_tr_b16 v[196:197], v27 offset:9248
    ds_read_b64_tr_b16 v[198:199], v27 offset:10016
    ds_read_b64_tr_b16 v[200:201], v27 offset:6208
    ds_read_b64_tr_b16 v[202:203], v27 offset:6976
    ds_read_b64_tr_b16 v[204:205], v27 offset:9280
    ds_read_b64_tr_b16 v[206:207], v27 offset:10048
    s_waitcnt lgkmcnt(0)
WL0_1:
    s_cmp_lg_u32 s3, 2
    s_cbranch_scc1 WL0_2
    ds_read_b64_tr_b16 a[192:193], v27 offset:0
    ds_read_b64_tr_b16 a[194:195], v27 offset:768
    ds_read_b64_tr_b16 a[196:197], v27 offset:3072
    ds_read_b64_tr_b16 a[198:199], v27 offset:3840
    ds_read_b64_tr_b16 a[200:201], v27 offset:32
    ds_read_b64_tr_b16 a[202:203], v27 offset:800
    ds_read_b64_tr_b16 a[204:205], v27 offset:3104
    ds_read_b64_tr_b16 a[206:207], v27 offset:3872
    ds_read_b64_tr_b16 a[208:209], v27 offset:64
    ds_read_b64_tr_b16 a[210:211], v27 offset:832
    ds_read_b64_tr_b16 a[212:213], v27 offset:3136
    ds_read_b64_tr_b16 a[214:215], v27 offset:3904
    s_waitcnt lgkmcnt(0)
    ds_read_b64_tr_b16 a[216:217], v27 offset:6144
    ds_read_b64_tr_b16 a[218:219], v27 offset:6912
    ds_read_b64_tr_b16 a[220:221], v27 offset:9216
    ds_read_b64_tr_b16 a[222:223], v27 offset:9984
    ds_read_b64_tr_b16 a[224:225], v27 offset:6176
    ds_read_b64_tr_b16 a[226:227], v27 offset:6944
    ds_read_b64_tr_b16 a[228:229], v27 offset:9248
    ds_read_b64_tr_b16 a[230:231], v27 offset:10016
    ds_read_b64_tr_b16 a[232:233], v27 offset:6208
    ds_read_b64_tr_b16 a[234:235], v27 offset:6976
    ds_read_b64_tr_b16 a[236:237], v27 offset:9280
    ds_read_b64_tr_b16 a[238:239], v27 offset:10048
    s_waitcnt lgkmcnt(0)
WL0_2:
    s_cmp_lg_u32 s3, 3
    s_cbranch_scc1 WL0_3
    ds_read_b64_tr_b16 a[96:97], v27 offset:0
    ds_read_b64_tr_b16 a[98:99], v27 offset:768
    ds_read_b64_tr_b16 a[100:101], v27 offset:3072
    ds_read_b64_tr_b16 a[102:103], v27 offset:3840
    ds_read_b64_tr_b16 a[104:105], v27 offset:32
    ds_read_b64_tr_b16 a[106:107], v27 offset:800
    ds_read_b64_tr_b16 a[108:109], v27 offset:3104
    ds_read_b64_tr_b16 a[110:111], v27 offset:3872
    ds_read_b64_tr_b16 a[112:113], v27 offset:64
    ds_read_b64_tr_b16 a[114:115], v27 offset:832
    ds_read_b64_tr_b16 a[116:117], v27 offset:3136
    ds_read_b64_tr_b16 a[118:119], v27 offset:3904
    s_waitcnt lgkmcnt(0)
    ds_read_b64_tr_b16 a[120:121], v27 offset:6144
    ds_read_b64_tr_b16 a[122:123], v27 offset:6912
    ds_read_b64_tr_b16 a[124:125], v27 offset:9216
    ds_read_b64_tr_b16 a[126:127], v27 offset:9984
    ds_read_b64_tr_b16 a[128:129], v27 offset:6176
    ds_read_b64_tr_b16 a[130:131], v27 offset:6944
    ds_read_b64_tr_b16 a[132:133], v27 offset:9248
    ds_read_b64_tr_b16 a[134:135], v27 offset:10016
    ds_read_b64_tr_b16 a[136:137], v27 offset:6208
    ds_read_b64_tr_b16 a[138:139], v27 offset:6976
    ds_read_b64_tr_b16 a[140:141], v27 offset:9280
    ds_read_b64_tr_b16 a[142:143], v27 offset:10048
    s_waitcnt lgkmcnt(0)
WL0_3:
    s_mov_b32 s33, 3145728
    s_add_u32 m0, s34, 0
    s_nop 0
    buffer_load_dwordx4 v20, s[16:19], s33 offen lds
    s_add_u32 m0, s34, 1024
    s_nop 0
    buffer_load_dwordx4 v21, s[16:19], s33 offen lds
    s_add_u32 m0, s34, 2048
    s_nop 0
    buffer_load_dwordx4 v22, s[16:19], s33 offen lds
    s_add_u32 m0, s34, 3072
    s_nop 0
    buffer_load_dwordx4 v23, s[16:19], s33 offen lds
    s_add_u32 m0, s34, 4096
    s_nop 0
    buffer_load_dwordx4 v24, s[16:19], s33 offen lds
    s_add_u32 m0, s34, 5120
    s_nop 0
    buffer_load_dwordx4 v25, s[16:19], s33 offen lds
    s_add_u32 m0, s34, 6144
    s_nop 0
    buffer_load_dwordx4 v20, s[20:23], s33 offen lds
    s_add_u32 m0, s34, 7168
    s_nop 0
    buffer_load_dwordx4 v21, s[20:23], s33 offen lds
    s_add_u32 m0, s34, 8192
    s_nop 0
    buffer_load_dwordx4 v22, s[20:23], s33 offen lds
    s_add_u32 m0, s34, 9216
    s_nop 0
    buffer_load_dwordx4 v23, s[20:23], s33 offen lds
    s_add_u32 m0, s34, 10240
    s_nop 0
    buffer_load_dwordx4 v24, s[20:23], s33 offen lds
    s_add_u32 m0, s34, 11264
    s_nop 0
    buffer_load_dwordx4 v25, s[20:23], s33 offen lds
    s_waitcnt vmcnt(24)
    s_add_u32 s6, s34, 49152
    v_add_u32 v27, s6, v26
    s_cmp_lg_u32 s3, 0
    s_cbranch_scc1 WL1_0
    ds_read_b64_tr_b16 a[48:49], v27 offset:0
    ds_read_b64_tr_b16 a[50:51], v27 offset:768
    ds_read_b64_tr_b16 a[52:53], v27 offset:3072
    ds_read_b64_tr_b16 a[54:55], v27 offset:3840
    ds_read_b64_tr_b16 a[56:57], v27 offset:32
    ds_read_b64_tr_b16 a[58:59], v27 offset:800
    ds_read_b64_tr_b16 a[60:61], v27 offset:3104
    ds_read_b64_tr_b16 a[62:63], v27 offset:3872
    ds_read_b64_tr_b16 a[64:65], v27 offset:64
    ds_read_b64_tr_b16 a[66:67], v27 offset:832
    ds_read_b64_tr_b16 a[68:69], v27 offset:3136
    ds_read_b64_tr_b16 a[70:71], v27 offset:3904
    s_waitcnt lgkmcnt(0)
    ds_read_b64_tr_b16 a[72:73], v27 offset:6144
    ds_read_b64_tr_b16 a[74:75], v27 offset:6912
    ds_read_b64_tr_b16 a[76:77], v27 offset:9216
    ds_read_b64_tr_b16 a[78:79], v27 offset:9984
    ds_read_b64_tr_b16 a[80:81], v27 offset:6176
    ds_read_b64_tr_b16 a[82:83], v27 offset:6944
    ds_read_b64_tr_b16 a[84:85], v27 offset:9248
    ds_read_b64_tr_b16 a[86:87], v27 offset:10016
    ds_read_b64_tr_b16 a[88:89], v27 offset:6208
    ds_read_b64_tr_b16 a[90:91], v27 offset:6976
    ds_read_b64_tr_b16 a[92:93], v27 offset:9280
    ds_read_b64_tr_b16 a[94:95], v27 offset:10048
    s_waitcnt lgkmcnt(0)
WL1_0:
    s_cmp_lg_u32 s3, 1
    s_cbranch_scc1 WL1_1
    ds_read_b64_tr_b16 v[208:209], v27 offset:0
    ds_read_b64_tr_b16 v[210:211], v27 offset:768
    ds_read_b64_tr_b16 v[212:213], v27 offset:3072
    ds_read_b64_tr_b16 v[214:215], v27 offset:3840
    ds_read_b64_tr_b16 v[216:217], v27 offset:32
    ds_read_b64_tr_b16 v[218:219], v27 offset:800
    ds_read_b64_tr_b16 v[220:221], v27 offset:3104
    ds_read_b64_tr_b16 v[222:223], v27 offset:3872
    ds_read_b64_tr_b16 v[224:225], v27 offset:64
    ds_read_b64_tr_b16 v[226:227], v27 offset:832
    ds_read_b64_tr_b16 v[228:229], v27 offset:3136
    ds_read_b64_tr_b16 v[230:231], v27 offset:3904
    s_waitcnt lgkmcnt(0)
    ds_read_b64_tr_b16 v[232:233], v27 offset:6144
    ds_read_b64_tr_b16 v[234:235], v27 offset:6912
    ds_read_b64_tr_b16 v[236:237], v27 offset:9216
    ds_read_b64_tr_b16 v[238:239], v27 offset:9984
    ds_read_b64_tr_b16 v[240:241], v27 offset:6176
    ds_read_b64_tr_b16 v[242:243], v27 offset:6944
    ds_read_b64_tr_b16 v[244:245], v27 offset:9248
    ds_read_b64_tr_b16 v[246:247], v27 offset:10016
    ds_read_b64_tr_b16 v[248:249], v27 offset:6208
    ds_read_b64_tr_b16 v[250:251], v27 offset:6976
    ds_read_b64_tr_b16 v[252:253], v27 offset:9280
    ds_read_b64_tr_b16 v[254:255], v27 offset:10048
    s_waitcnt lgkmcnt(0)
WL1_1:
    s_cmp_lg_u32 s3, 2
    s_cbranch_scc1 WL1_2
    ds_read_b64_tr_b16 a[240:241], v27 offset:0
    ds_read_b64_tr_b16 a[242:243], v27 offset:768
    ds_read_b64_tr_b16 a[244:245], v27 offset:3072
    ds_read_b64_tr_b16 a[246:247], v27 offset:3840
    ds_read_b64_tr_b16 a[248:249], v27 offset:32
    ds_read_b64_tr_b16 a[250:251], v27 offset:800
    ds_read_b64_tr_b16 a[252:253], v27 offset:3104
    ds_read_b64_tr_b16 a[254:255], v27 offset:3872
    ds_read_b64_tr_b16 v[128:129], v27 offset:64
    ds_read_b64_tr_b16 v[130:131], v27 offset:832
    ds_read_b64_tr_b16 v[132:133], v27 offset:3136
    ds_read_b64_tr_b16 v[134:135], v27 offset:3904
    s_waitcnt lgkmcnt(0)
    ds_read_b64_tr_b16 v[136:137], v27 offset:6144
    ds_read_b64_tr_b16 v[138:139], v27 offset:6912
    ds_read_b64_tr_b16 v[140:141], v27 offset:9216
    ds_read_b64_tr_b16 v[142:143], v27 offset:9984
    ds_read_b64_tr_b16 v[144:145], v27 offset:6176
    ds_read_b64_tr_b16 v[146:147], v27 offset:6944
    ds_read_b64_tr_b16 v[148:149], v27 offset:9248
    ds_read_b64_tr_b16 v[150:151], v27 offset:10016
    ds_read_b64_tr_b16 v[152:153], v27 offset:6208
    ds_read_b64_tr_b16 v[154:155], v27 offset:6976
    ds_read_b64_tr_b16 v[156:157], v27 offset:9280
    ds_read_b64_tr_b16 v[158:159], v27 offset:10048
    s_waitcnt lgkmcnt(0)
WL1_2:
    s_cmp_lg_u32 s3, 3
    s_cbranch_scc1 WL1_3
    ds_read_b64_tr_b16 a[144:145], v27 offset:0
    ds_read_b64_tr_b16 a[146:147], v27 offset:768
    ds_read_b64_tr_b16 a[148:149], v27 offset:3072
    ds_read_b64_tr_b16 a[150:151], v27 offset:3840
    ds_read_b64_tr_b16 a[152:153], v27 offset:32
    ds_read_b64_tr_b16 a[154:155], v27 offset:800
    ds_read_b64_tr_b16 a[156:157], v27 offset:3104
    ds_read_b64_tr_b16 a[158:159], v27 offset:3872
    ds_read_b64_tr_b16 a[160:161], v27 offset:64
    ds_read_b64_tr_b16 a[162:163], v27 offset:832
    ds_read_b64_tr_b16 a[164:165], v27 offset:3136
    ds_read_b64_tr_b16 a[166:167], v27 offset:3904
    s_waitcnt lgkmcnt(0)
    ds_read_b64_tr_b16 a[168:169], v27 offset:6144
    ds_read_b64_tr_b16 a[170:171], v27 offset:6912
    ds_read_b64_tr_b16 a[172:173], v27 offset:9216
    ds_read_b64_tr_b16 a[174:175], v27 offset:9984
    ds_read_b64_tr_b16 a[176:177], v27 offset:6176
    ds_read_b64_tr_b16 a[178:179], v27 offset:6944
    ds_read_b64_tr_b16 a[180:181], v27 offset:9248
    ds_read_b64_tr_b16 a[182:183], v27 offset:10016
    ds_read_b64_tr_b16 a[184:185], v27 offset:6208
    ds_read_b64_tr_b16 a[186:187], v27 offset:6976
    ds_read_b64_tr_b16 a[188:189], v27 offset:9280
    ds_read_b64_tr_b16 a[190:191], v27 offset:10048
    s_waitcnt lgkmcnt(0)
WL1_3:
    s_mov_b32 s33, 3932160
    s_add_u32 m0, s34, 49152
    s_nop 0
    buffer_load_dwordx4 v20, s[16:19], s33 offen lds
    s_add_u32 m0, s34, 50176
    s_nop 0
    buffer_load_dwordx4 v21, s[16:19], s33 offen lds
    s_add_u32 m0, s34, 51200
    s_nop 0
    buffer_load_dwordx4 v22, s[16:19], s33 offen lds
    s_add_u32 m0, s34, 52224
    s_nop 0
    buffer_load_dwordx4 v23, s[16:19], s33 offen lds
    s_add_u32 m0, s34, 53248
    s_nop 0
    buffer_load_dwordx4 v24, s[16:19], s33 offen lds
    s_add_u32 m0, s34, 54272
    s_nop 0
    buffer_load_dwordx4 v25, s[16:19], s33 offen lds
    s_add_u32 m0, s34, 55296
    s_nop 0
    buffer_load_dwordx4 v20, s[20:23], s33 offen lds
    s_add_u32 m0, s34, 56320
    s_nop 0
    buffer_load_dwordx4 v21, s[20:23], s33 offen lds
    s_add_u32 m0, s34, 57344
    s_nop 0
    buffer_load_dwordx4 v22, s[20:23], s33 offen lds
    s_add_u32 m0, s34, 58368
    s_nop 0
    buffer_load_dwordx4 v23, s[20:23], s33 offen lds
    s_add_u32 m0, s34, 59392
    s_nop 0
    buffer_load_dwordx4 v24, s[20:23], s33 offen lds
    s_add_u32 m0, s34, 60416
    s_nop 0
    buffer_load_dwordx4 v25, s[20:23], s33 offen lds
    s_waitcnt vmcnt(24)
    s_add_u32 s6, s34, 98304
    v_add_u32 v27, s6, v26
    s_cmp_lg_u32 s3, 0
    s_cbranch_scc1 WL2_0
    ds_read_b64_tr_b16 a[96:97], v27 offset:0
    ds_read_b64_tr_b16 a[98:99], v27 offset:768
    ds_read_b64_tr_b16 a[100:101], v27 offset:3072
    ds_read_b64_tr_b16 a[102:103], v27 offset:3840
    ds_read_b64_tr_b16 a[104:105], v27 offset:32
    ds_read_b64_tr_b16 a[106:107], v27 offset:800
    ds_read_b64_tr_b16 a[108:109], v27 offset:3104
    ds_read_b64_tr_b16 a[110:111], v27 offset:3872
    ds_read_b64_tr_b16 a[112:113], v27 offset:64
    ds_read_b64_tr_b16 a[114:115], v27 offset:832
    ds_read_b64_tr_b16 a[116:117], v27 offset:3136
    ds_read_b64_tr_b16 a[118:119], v27 offset:3904
    s_waitcnt lgkmcnt(0)
    ds_read_b64_tr_b16 a[120:121], v27 offset:6144
    ds_read_b64_tr_b16 a[122:123], v27 offset:6912
    ds_read_b64_tr_b16 a[124:125], v27 offset:9216
    ds_read_b64_tr_b16 a[126:127], v27 offset:9984
    ds_read_b64_tr_b16 a[128:129], v27 offset:6176
    ds_read_b64_tr_b16 a[130:131], v27 offset:6944
    ds_read_b64_tr_b16 a[132:133], v27 offset:9248
    ds_read_b64_tr_b16 a[134:135], v27 offset:10016
    ds_read_b64_tr_b16 a[136:137], v27 offset:6208
    ds_read_b64_tr_b16 a[138:139], v27 offset:6976
    ds_read_b64_tr_b16 a[140:141], v27 offset:9280
    ds_read_b64_tr_b16 a[142:143], v27 offset:10048
    s_waitcnt lgkmcnt(0)
WL2_0:
    s_cmp_lg_u32 s3, 1
    s_cbranch_scc1 WL2_1
    ds_read_b64_tr_b16 a[0:1], v27 offset:0
    ds_read_b64_tr_b16 a[2:3], v27 offset:768
    ds_read_b64_tr_b16 a[4:5], v27 offset:3072
    ds_read_b64_tr_b16 a[6:7], v27 offset:3840
    ds_read_b64_tr_b16 a[8:9], v27 offset:32
    ds_read_b64_tr_b16 a[10:11], v27 offset:800
    ds_read_b64_tr_b16 a[12:13], v27 offset:3104
    ds_read_b64_tr_b16 a[14:15], v27 offset:3872
    ds_read_b64_tr_b16 a[16:17], v27 offset:64
    ds_read_b64_tr_b16 a[18:19], v27 offset:832
    ds_read_b64_tr_b16 a[20:21], v27 offset:3136
    ds_read_b64_tr_b16 a[22:23], v27 offset:3904
    s_waitcnt lgkmcnt(0)
    ds_read_b64_tr_b16 a[24:25], v27 offset:6144
    ds_read_b64_tr_b16 a[26:27], v27 offset:6912
    ds_read_b64_tr_b16 a[28:29], v27 offset:9216
    ds_read_b64_tr_b16 a[30:31], v27 offset:9984
    ds_read_b64_tr_b16 a[32:33], v27 offset:6176
    ds_read_b64_tr_b16 a[34:35], v27 offset:6944
    ds_read_b64_tr_b16 a[36:37], v27 offset:9248
    ds_read_b64_tr_b16 a[38:39], v27 offset:10016
    ds_read_b64_tr_b16 a[40:41], v27 offset:6208
    ds_read_b64_tr_b16 a[42:43], v27 offset:6976
    ds_read_b64_tr_b16 a[44:45], v27 offset:9280
    ds_read_b64_tr_b16 a[46:47], v27 offset:10048
    s_waitcnt lgkmcnt(0)
WL2_1:
    s_cmp_lg_u32 s3, 2
    s_cbranch_scc1 WL2_2
    ds_read_b64_tr_b16 v[160:161], v27 offset:0
    ds_read_b64_tr_b16 v[162:163], v27 offset:768
    ds_read_b64_tr_b16 v[164:165], v27 offset:3072
    ds_read_b64_tr_b16 v[166:167], v27 offset:3840
    ds_read_b64_tr_b16 v[168:169], v27 offset:32
    ds_read_b64_tr_b16 v[170:171], v27 offset:800
    ds_read_b64_tr_b16 v[172:173], v27 offset:3104
    ds_read_b64_tr_b16 v[174:175], v27 offset:3872
    ds_read_b64_tr_b16 v[176:177], v27 offset:64
    ds_read_b64_tr_b16 v[178:179], v27 offset:832
    ds_read_b64_tr_b16 v[180:181], v27 offset:3136
    ds_read_b64_tr_b16 v[182:183], v27 offset:3904
    s_waitcnt lgkmcnt(0)
    ds_read_b64_tr_b16 v[184:185], v27 offset:6144
    ds_read_b64_tr_b16 v[186:187], v27 offset:6912
    ds_read_b64_tr_b16 v[188:189], v27 offset:9216
    ds_read_b64_tr_b16 v[190:191], v27 offset:9984
    ds_read_b64_tr_b16 v[192:193], v27 offset:6176
    ds_read_b64_tr_b16 v[194:195], v27 offset:6944
    ds_read_b64_tr_b16 v[196:197], v27 offset:9248
    ds_read_b64_tr_b16 v[198:199], v27 offset:10016
    ds_read_b64_tr_b16 v[200:201], v27 offset:6208
    ds_read_b64_tr_b16 v[202:203], v27 offset:6976
    ds_read_b64_tr_b16 v[204:205], v27 offset:9280
    ds_read_b64_tr_b16 v[206:207], v27 offset:10048
    s_waitcnt lgkmcnt(0)
WL2_2:
    s_cmp_lg_u32 s3, 3
    s_cbranch_scc1 WL2_3
    ds_read_b64_tr_b16 a[192:193], v27 offset:0
    ds_read_b64_tr_b16 a[194:195], v27 offset:768
    ds_read_b64_tr_b16 a[196:197], v27 offset:3072
    ds_read_b64_tr_b16 a[198:199], v27 offset:3840
    ds_read_b64_tr_b16 a[200:201], v27 offset:32
    ds_read_b64_tr_b16 a[202:203], v27 offset:800
    ds_read_b64_tr_b16 a[204:205], v27 offset:3104
    ds_read_b64_tr_b16 a[206:207], v27 offset:3872
    ds_read_b64_tr_b16 a[208:209], v27 offset:64
    ds_read_b64_tr_b16 a[210:211], v27 offset:832
    ds_read_b64_tr_b16 a[212:213], v27 offset:3136
    ds_read_b64_tr_b16 a[214:215], v27 offset:3904
    s_waitcnt lgkmcnt(0)
    ds_read_b64_tr_b16 a[216:217], v27 offset:6144
    ds_read_b64_tr_b16 a[218:219], v27 offset:6912
    ds_read_b64_tr_b16 a[220:221], v27 offset:9216
    ds_read_b64_tr_b16 a[222:223], v27 offset:9984
    ds_read_b64_tr_b16 a[224:225], v27 offset:6176
    ds_read_b64_tr_b16 a[226:227], v27 offset:6944
    ds_read_b64_tr_b16 a[228:229], v27 offset:9248
    ds_read_b64_tr_b16 a[230:231], v27 offset:10016
    ds_read_b64_tr_b16 a[232:233], v27 offset:6208
    ds_read_b64_tr_b16 a[234:235], v27 offset:6976
    ds_read_b64_tr_b16 a[236:237], v27 offset:9280
    ds_read_b64_tr_b16 a[238:239], v27 offset:10048
    s_waitcnt lgkmcnt(0)
WL2_3:
    s_mov_b32 s33, 4718592
    s_add_u32 m0, s34, 98304
    s_nop 0
    buffer_load_dwordx4 v20, s[16:19], s33 offen lds
    s_add_u32 m0, s34, 99328
    s_nop 0
    buffer_load_dwordx4 v21, s[16:19], s33 offen lds
    s_add_u32 m0, s34, 100352
    s_nop 0
    buffer_load_dwordx4 v22, s[16:19], s33 offen lds
    s_add_u32 m0, s34, 101376
    s_nop 0
    buffer_load_dwordx4 v23, s[16:19], s33 offen lds
    s_add_u32 m0, s34, 102400
    s_nop 0
    buffer_load_dwordx4 v24, s[16:19], s33 offen lds
    s_add_u32 m0, s34, 103424
    s_nop 0
    buffer_load_dwordx4 v25, s[16:19], s33 offen lds
    s_add_u32 m0, s34, 104448
    s_nop 0
    buffer_load_dwordx4 v20, s[20:23], s33 offen lds
    s_add_u32 m0, s34, 105472
    s_nop 0
    buffer_load_dwordx4 v21, s[20:23], s33 offen lds
    s_add_u32 m0, s34, 106496
    s_nop 0
    buffer_load_dwordx4 v22, s[20:23], s33 offen lds
    s_add_u32 m0, s34, 107520
    s_nop 0
    buffer_load_dwordx4 v23, s[20:23], s33 offen lds
    s_add_u32 m0, s34, 108544
    s_nop 0
    buffer_load_dwordx4 v24, s[20:23], s33 offen lds
    s_add_u32 m0, s34, 109568
    s_nop 0
    buffer_load_dwordx4 v25, s[20:23], s33 offen lds
    s_waitcnt vmcnt(24)
    s_add_u32 s6, s34, 0
    v_add_u32 v27, s6, v26
    s_cmp_lg_u32 s3, 0
    s_cbranch_scc1 WL3_0
    ds_read_b64_tr_b16 a[144:145], v27 offset:0
    ds_read_b64_tr_b16 a[146:147], v27 offset:768
    ds_read_b64_tr_b16 a[148:149], v27 offset:3072
    ds_read_b64_tr_b16 a[150:151], v27 offset:3840
    ds_read_b64_tr_b16 a[152:153], v27 offset:32
    ds_read_b64_tr_b16 a[154:155], v27 offset:800
    ds_read_b64_tr_b16 a[156:157], v27 offset:3104
    ds_read_b64_tr_b16 a[158:159], v27 offset:3872
    ds_read_b64_tr_b16 a[160:161], v27 offset:64
    ds_read_b64_tr_b16 a[162:163], v27 offset:832
    ds_read_b64_tr_b16 a[164:165], v27 offset:3136
    ds_read_b64_tr_b16 a[166:167], v27 offset:3904
    s_waitcnt lgkmcnt(0)
    ds_read_b64_tr_b16 a[168:169], v27 offset:6144
    ds_read_b64_tr_b16 a[170:171], v27 offset:6912
    ds_read_b64_tr_b16 a[172:173], v27 offset:9216
    ds_read_b64_tr_b16 a[174:175], v27 offset:9984
    ds_read_b64_tr_b16 a[176:177], v27 offset:6176
    ds_read_b64_tr_b16 a[178:179], v27 offset:6944
    ds_read_b64_tr_b16 a[180:181], v27 offset:9248
    ds_read_b64_tr_b16 a[182:183], v27 offset:10016
    ds_read_b64_tr_b16 a[184:185], v27 offset:6208
    ds_read_b64_tr_b16 a[186:187], v27 offset:6976
    ds_read_b64_tr_b16 a[188:189], v27 offset:9280
    ds_read_b64_tr_b16 a[190:191], v27 offset:10048
    s_waitcnt lgkmcnt(0)
WL3_0:
    s_cmp_lg_u32 s3, 1
    s_cbranch_scc1 WL3_1
    ds_read_b64_tr_b16 a[48:49], v27 offset:0
    ds_read_b64_tr_b16 a[50:51], v27 offset:768
    ds_read_b64_tr_b16 a[52:53], v27 offset:3072
    ds_read_b64_tr_b16 a[54:55], v27 offset:3840
    ds_read_b64_tr_b16 a[56:57], v27 offset:32
    ds_read_b64_tr_b16 a[58:59], v27 offset:800
    ds_read_b64_tr_b16 a[60:61], v27 offset:3104
    ds_read_b64_tr_b16 a[62:63], v27 offset:3872
    ds_read_b64_tr_b16 a[64:65], v27 offset:64
    ds_read_b64_tr_b16 a[66:67], v27 offset:832
    ds_read_b64_tr_b16 a[68:69], v27 offset:3136
    ds_read_b64_tr_b16 a[70:71], v27 offset:3904
    s_waitcnt lgkmcnt(0)
    ds_read_b64_tr_b16 a[72:73], v27 offset:6144
    ds_read_b64_tr_b16 a[74:75], v27 offset:6912
    ds_read_b64_tr_b16 a[76:77], v27 offset:9216
    ds_read_b64_tr_b16 a[78:79], v27 offset:9984
    ds_read_b64_tr_b16 a[80:81], v27 offset:6176
    ds_read_b64_tr_b16 a[82:83], v27 offset:6944
    ds_read_b64_tr_b16 a[84:85], v27 offset:9248
    ds_read_b64_tr_b16 a[86:87], v27 offset:10016
    ds_read_b64_tr_b16 a[88:89], v27 offset:6208
    ds_read_b64_tr_b16 a[90:91], v27 offset:6976
    ds_read_b64_tr_b16 a[92:93], v27 offset:9280
    ds_read_b64_tr_b16 a[94:95], v27 offset:10048
    s_waitcnt lgkmcnt(0)
WL3_1:
    s_cmp_lg_u32 s3, 2
    s_cbranch_scc1 WL3_2
    ds_read_b64_tr_b16 v[208:209], v27 offset:0
    ds_read_b64_tr_b16 v[210:211], v27 offset:768
    ds_read_b64_tr_b16 v[212:213], v27 offset:3072
    ds_read_b64_tr_b16 v[214:215], v27 offset:3840
    ds_read_b64_tr_b16 v[216:217], v27 offset:32
    ds_read_b64_tr_b16 v[218:219], v27 offset:800
    ds_read_b64_tr_b16 v[220:221], v27 offset:3104
    ds_read_b64_tr_b16 v[222:223], v27 offset:3872
    ds_read_b64_tr_b16 v[224:225], v27 offset:64
    ds_read_b64_tr_b16 v[226:227], v27 offset:832
    ds_read_b64_tr_b16 v[228:229], v27 offset:3136
    ds_read_b64_tr_b16 v[230:231], v27 offset:3904
    s_waitcnt lgkmcnt(0)
    ds_read_b64_tr_b16 v[232:233], v27 offset:6144
    ds_read_b64_tr_b16 v[234:235], v27 offset:6912
    ds_read_b64_tr_b16 v[236:237], v27 offset:9216
    ds_read_b64_tr_b16 v[238:239], v27 offset:9984
    ds_read_b64_tr_b16 v[240:241], v27 offset:6176
    ds_read_b64_tr_b16 v[242:243], v27 offset:6944
    ds_read_b64_tr_b16 v[244:245], v27 offset:9248
    ds_read_b64_tr_b16 v[246:247], v27 offset:10016
    ds_read_b64_tr_b16 v[248:249], v27 offset:6208
    ds_read_b64_tr_b16 v[250:251], v27 offset:6976
    ds_read_b64_tr_b16 v[252:253], v27 offset:9280
    ds_read_b64_tr_b16 v[254:255], v27 offset:10048
    s_waitcnt lgkmcnt(0)
WL3_2:
    s_cmp_lg_u32 s3, 3
    s_cbranch_scc1 WL3_3
    ds_read_b64_tr_b16 a[240:241], v27 offset:0
    ds_read_b64_tr_b16 a[242:243], v27 offset:768
    ds_read_b64_tr_b16 a[244:245], v27 offset:3072
    ds_read_b64_tr_b16 a[246:247], v27 offset:3840
    ds_read_b64_tr_b16 a[248:249], v27 offset:32
    ds_read_b64_tr_b16 a[250:251], v27 offset:800
    ds_read_b64_tr_b16 a[252:253], v27 offset:3104
    ds_read_b64_tr_b16 a[254:255], v27 offset:3872
    ds_read_b64_tr_b16 v[128:129], v27 offset:64
    ds_read_b64_tr_b16 v[130:131], v27 offset:832
    ds_read_b64_tr_b16 v[132:133], v27 offset:3136
    ds_read_b64_tr_b16 v[134:135], v27 offset:3904
    s_waitcnt lgkmcnt(0)
    ds_read_b64_tr_b16 v[136:137], v27 offset:6144
    ds_read_b64_tr_b16 v[138:139], v27 offset:6912
    ds_read_b64_tr_b16 v[140:141], v27 offset:9216
    ds_read_b64_tr_b16 v[142:143], v27 offset:9984
    ds_read_b64_tr_b16 v[144:145], v27 offset:6176
    ds_read_b64_tr_b16 v[146:147], v27 offset:6944
    ds_read_b64_tr_b16 v[148:149], v27 offset:9248
    ds_read_b64_tr_b16 v[150:151], v27 offset:10016
    ds_read_b64_tr_b16 v[152:153], v27 offset:6208
    ds_read_b64_tr_b16 v[154:155], v27 offset:6976
    ds_read_b64_tr_b16 v[156:157], v27 offset:9280
    ds_read_b64_tr_b16 v[158:159], v27 offset:10048
    s_waitcnt lgkmcnt(0)
WL3_3:
    s_mov_b32 s33, 6291456
    s_add_u32 m0, s34, 0
    s_nop 0
    buffer_load_dwordx4 v20, s[16:19], s33 offen lds
    s_add_u32 m0, s34, 1024
    s_nop 0
    buffer_load_dwordx4 v21, s[16:19], s33 offen lds
    s_add_u32 m0, s34, 2048
    s_nop 0
    buffer_load_dwordx4 v22, s[16:19], s33 offen lds
    s_add_u32 m0, s34, 3072
    s_nop 0
    buffer_load_dwordx4 v23, s[16:19], s33 offen lds
    s_add_u32 m0, s34, 4096
    s_nop 0
    buffer_load_dwordx4 v24, s[16:19], s33 offen lds
    s_add_u32 m0, s34, 5120
    s_nop 0
    buffer_load_dwordx4 v25, s[16:19], s33 offen lds
    s_add_u32 m0, s34, 6144
    s_nop 0
    buffer_load_dwordx4 v20, s[20:23], s33 offen lds
    s_add_u32 m0, s34, 7168
    s_nop 0
    buffer_load_dwordx4 v21, s[20:23], s33 offen lds
    s_add_u32 m0, s34, 8192
    s_nop 0
    buffer_load_dwordx4 v22, s[20:23], s33 offen lds
    s_add_u32 m0, s34, 9216
    s_nop 0
    buffer_load_dwordx4 v23, s[20:23], s33 offen lds
    s_add_u32 m0, s34, 10240
    s_nop 0
    buffer_load_dwordx4 v24, s[20:23], s33 offen lds
    s_add_u32 m0, s34, 11264
    s_nop 0
    buffer_load_dwordx4 v25, s[20:23], s33 offen lds
    s_waitcnt vmcnt(24)
    s_add_u32 s6, s34, 49152
    v_add_u32 v27, s6, v26
    s_cmp_lg_u32 s3, 0
    s_cbranch_scc1 WL4_0
    ds_read_b64_tr_b16 a[192:193], v27 offset:0
    ds_read_b64_tr_b16 a[194:195], v27 offset:768
    ds_read_b64_tr_b16 a[196:197], v27 offset:3072
    ds_read_b64_tr_b16 a[198:199], v27 offset:3840
    ds_read_b64_tr_b16 a[200:201], v27 offset:32
    ds_read_b64_tr_b16 a[202:203], v27 offset:800
    ds_read_b64_tr_b16 a[204:205], v27 offset:3104
    ds_read_b64_tr_b16 a[206:207], v27 offset:3872
    ds_read_b64_tr_b16 a[208:209], v27 offset:64
    ds_read_b64_tr_b16 a[210:211], v27 offset:832
    ds_read_b64_tr_b16 a[212:213], v27 offset:3136
    ds_read_b64_tr_b16 a[214:215], v27 offset:3904
    s_waitcnt lgkmcnt(0)
    ds_read_b64_tr_b16 a[216:217], v27 offset:6144
    ds_read_b64_tr_b16 a[218:219], v27 offset:6912
    ds_read_b64_tr_b16 a[220:221], v27 offset:9216
    ds_read_b64_tr_b16 a[222:223], v27 offset:9984
    ds_read_b64_tr_b16 a[224:225], v27 offset:6176
    ds_read_b64_tr_b16 a[226:227], v27 offset:6944
    ds_read_b64_tr_b16 a[228:229], v27 offset:9248
    ds_read_b64_tr_b16 a[230:231], v27 offset:10016
    ds_read_b64_tr_b16 a[232:233], v27 offset:6208
    ds_read_b64_tr_b16 a[234:235], v27 offset:6976
    ds_read_b64_tr_b16 a[236:237], v27 offset:9280
    ds_read_b64_tr_b16 a[238:239], v27 offset:10048
    s_waitcnt lgkmcnt(0)
WL4_0:
    s_cmp_lg_u32 s3, 1
    s_cbranch_scc1 WL4_1
    ds_read_b64_tr_b16 a[96:97], v27 offset:0
    ds_read_b64_tr_b16 a[98:99], v27 offset:768
    ds_read_b64_tr_b16 a[100:101], v27 offset:3072
    ds_read_b64_tr_b16 a[102:103], v27 offset:3840
    ds_read_b64_tr_b16 a[104:105], v27 offset:32
    ds_read_b64_tr_b16 a[106:107], v27 offset:800
    ds_read_b64_tr_b16 a[108:109], v27 offset:3104
    ds_read_b64_tr_b16 a[110:111], v27 offset:3872
    ds_read_b64_tr_b16 a[112:113], v27 offset:64
    ds_read_b64_tr_b16 a[114:115], v27 offset:832
    ds_read_b64_tr_b16 a[116:117], v27 offset:3136
    ds_read_b64_tr_b16 a[118:119], v27 offset:3904
    s_waitcnt lgkmcnt(0)
    ds_read_b64_tr_b16 a[120:121], v27 offset:6144
    ds_read_b64_tr_b16 a[122:123], v27 offset:6912
    ds_read_b64_tr_b16 a[124:125], v27 offset:9216
    ds_read_b64_tr_b16 a[126:127], v27 offset:9984
    ds_read_b64_tr_b16 a[128:129], v27 offset:6176
    ds_read_b64_tr_b16 a[130:131], v27 offset:6944
    ds_read_b64_tr_b16 a[132:133], v27 offset:9248
    ds_read_b64_tr_b16 a[134:135], v27 offset:10016
    ds_read_b64_tr_b16 a[136:137], v27 offset:6208
    ds_read_b64_tr_b16 a[138:139], v27 offset:6976
    ds_read_b64_tr_b16 a[140:141], v27 offset:9280
    ds_read_b64_tr_b16 a[142:143], v27 offset:10048
    s_waitcnt lgkmcnt(0)
WL4_1:
    s_cmp_lg_u32 s3, 2
    s_cbranch_scc1 WL4_2
    ds_read_b64_tr_b16 a[0:1], v27 offset:0
    ds_read_b64_tr_b16 a[2:3], v27 offset:768
    ds_read_b64_tr_b16 a[4:5], v27 offset:3072
    ds_read_b64_tr_b16 a[6:7], v27 offset:3840
    ds_read_b64_tr_b16 a[8:9], v27 offset:32
    ds_read_b64_tr_b16 a[10:11], v27 offset:800
    ds_read_b64_tr_b16 a[12:13], v27 offset:3104
    ds_read_b64_tr_b16 a[14:15], v27 offset:3872
    ds_read_b64_tr_b16 a[16:17], v27 offset:64
    ds_read_b64_tr_b16 a[18:19], v27 offset:832
    ds_read_b64_tr_b16 a[20:21], v27 offset:3136
    ds_read_b64_tr_b16 a[22:23], v27 offset:3904
    s_waitcnt lgkmcnt(0)
    ds_read_b64_tr_b16 a[24:25], v27 offset:6144
    ds_read_b64_tr_b16 a[26:27], v27 offset:6912
    ds_read_b64_tr_b16 a[28:29], v27 offset:9216
    ds_read_b64_tr_b16 a[30:31], v27 offset:9984
    ds_read_b64_tr_b16 a[32:33], v27 offset:6176
    ds_read_b64_tr_b16 a[34:35], v27 offset:6944
    ds_read_b64_tr_b16 a[36:37], v27 offset:9248
    ds_read_b64_tr_b16 a[38:39], v27 offset:10016
    ds_read_b64_tr_b16 a[40:41], v27 offset:6208
    ds_read_b64_tr_b16 a[42:43], v27 offset:6976
    ds_read_b64_tr_b16 a[44:45], v27 offset:9280
    ds_read_b64_tr_b16 a[46:47], v27 offset:10048
    s_waitcnt lgkmcnt(0)
WL4_2:
    s_cmp_lg_u32 s3, 3
    s_cbranch_scc1 WL4_3
    ds_read_b64_tr_b16 v[160:161], v27 offset:0
    ds_read_b64_tr_b16 v[162:163], v27 offset:768
    ds_read_b64_tr_b16 v[164:165], v27 offset:3072
    ds_read_b64_tr_b16 v[166:167], v27 offset:3840
    ds_read_b64_tr_b16 v[168:169], v27 offset:32
    ds_read_b64_tr_b16 v[170:171], v27 offset:800
    ds_read_b64_tr_b16 v[172:173], v27 offset:3104
    ds_read_b64_tr_b16 v[174:175], v27 offset:3872
    ds_read_b64_tr_b16 v[176:177], v27 offset:64
    ds_read_b64_tr_b16 v[178:179], v27 offset:832
    ds_read_b64_tr_b16 v[180:181], v27 offset:3136
    ds_read_b64_tr_b16 v[182:183], v27 offset:3904
    s_waitcnt lgkmcnt(0)
    ds_read_b64_tr_b16 v[184:185], v27 offset:6144
    ds_read_b64_tr_b16 v[186:187], v27 offset:6912
    ds_read_b64_tr_b16 v[188:189], v27 offset:9216
    ds_read_b64_tr_b16 v[190:191], v27 offset:9984
    ds_read_b64_tr_b16 v[192:193], v27 offset:6176
    ds_read_b64_tr_b16 v[194:195], v27 offset:6944
    ds_read_b64_tr_b16 v[196:197], v27 offset:9248
    ds_read_b64_tr_b16 v[198:199], v27 offset:10016
    ds_read_b64_tr_b16 v[200:201], v27 offset:6208
    ds_read_b64_tr_b16 v[202:203], v27 offset:6976
    ds_read_b64_tr_b16 v[204:205], v27 offset:9280
    ds_read_b64_tr_b16 v[206:207], v27 offset:10048
    s_waitcnt lgkmcnt(0)
WL4_3:
    s_mov_b32 s33, 7077888
    s_add_u32 m0, s34, 49152
    s_nop 0
    buffer_load_dwordx4 v20, s[16:19], s33 offen lds
    s_add_u32 m0, s34, 50176
    s_nop 0
    buffer_load_dwordx4 v21, s[16:19], s33 offen lds
    s_add_u32 m0, s34, 51200
    s_nop 0
    buffer_load_dwordx4 v22, s[16:19], s33 offen lds
    s_add_u32 m0, s34, 52224
    s_nop 0
    buffer_load_dwordx4 v23, s[16:19], s33 offen lds
    s_add_u32 m0, s34, 53248
    s_nop 0
    buffer_load_dwordx4 v24, s[16:19], s33 offen lds
    s_add_u32 m0, s34, 54272
    s_nop 0
    buffer_load_dwordx4 v25, s[16:19], s33 offen lds
    s_add_u32 m0, s34, 55296
    s_nop 0
    buffer_load_dwordx4 v20, s[20:23], s33 offen lds
    s_add_u32 m0, s34, 56320
    s_nop 0
    buffer_load_dwordx4 v21, s[20:23], s33 offen lds
    s_add_u32 m0, s34, 57344
    s_nop 0
    buffer_load_dwordx4 v22, s[20:23], s33 offen lds
    s_add_u32 m0, s34, 58368
    s_nop 0
    buffer_load_dwordx4 v23, s[20:23], s33 offen lds
    s_add_u32 m0, s34, 59392
    s_nop 0
    buffer_load_dwordx4 v24, s[20:23], s33 offen lds
    s_add_u32 m0, s34, 60416
    s_nop 0
    buffer_load_dwordx4 v25, s[20:23], s33 offen lds
    s_waitcnt vmcnt(24)
    s_add_u32 s6, s34, 98304
    v_add_u32 v27, s6, v26
    s_cmp_lg_u32 s3, 0
    s_cbranch_scc1 WL5_0
    ds_read_b64_tr_b16 a[240:241], v27 offset:0
    ds_read_b64_tr_b16 a[242:243], v27 offset:768
    ds_read_b64_tr_b16 a[244:245], v27 offset:3072
    ds_read_b64_tr_b16 a[246:247], v27 offset:3840
    ds_read_b64_tr_b16 a[248:249], v27 offset:32
    ds_read_b64_tr_b16 a[250:251], v27 offset:800
    ds_read_b64_tr_b16 a[252:253], v27 offset:3104
    ds_read_b64_tr_b16 a[254:255], v27 offset:3872
    ds_read_b64_tr_b16 v[128:129], v27 offset:64
    ds_read_b64_tr_b16 v[130:131], v27 offset:832
    ds_read_b64_tr_b16 v[132:133], v27 offset:3136
    ds_read_b64_tr_b16 v[134:135], v27 offset:3904
    s_waitcnt lgkmcnt(0)
    ds_read_b64_tr_b16 v[136:137], v27 offset:6144
    ds_read_b64_tr_b16 v[138:139], v27 offset:6912
    ds_read_b64_tr_b16 v[140:141], v27 offset:9216
    ds_read_b64_tr_b16 v[142:143], v27 offset:9984
    ds_read_b64_tr_b16 v[144:145], v27 offset:6176
    ds_read_b64_tr_b16 v[146:147], v27 offset:6944
    ds_read_b64_tr_b16 v[148:149], v27 offset:9248
    ds_read_b64_tr_b16 v[150:151], v27 offset:10016
    ds_read_b64_tr_b16 v[152:153], v27 offset:6208
    ds_read_b64_tr_b16 v[154:155], v27 offset:6976
    ds_read_b64_tr_b16 v[156:157], v27 offset:9280
    ds_read_b64_tr_b16 v[158:159], v27 offset:10048
    s_waitcnt lgkmcnt(0)
WL5_0:
    s_cmp_lg_u32 s3, 1
    s_cbranch_scc1 WL5_1
    ds_read_b64_tr_b16 a[144:145], v27 offset:0
    ds_read_b64_tr_b16 a[146:147], v27 offset:768
    ds_read_b64_tr_b16 a[148:149], v27 offset:3072
    ds_read_b64_tr_b16 a[150:151], v27 offset:3840
    ds_read_b64_tr_b16 a[152:153], v27 offset:32
    ds_read_b64_tr_b16 a[154:155], v27 offset:800
    ds_read_b64_tr_b16 a[156:157], v27 offset:3104
    ds_read_b64_tr_b16 a[158:159], v27 offset:3872
    ds_read_b64_tr_b16 a[160:161], v27 offset:64
    ds_read_b64_tr_b16 a[162:163], v27 offset:832
    ds_read_b64_tr_b16 a[164:165], v27 offset:3136
    ds_read_b64_tr_b16 a[166:167], v27 offset:3904
    s_waitcnt lgkmcnt(0)
    ds_read_b64_tr_b16 a[168:169], v27 offset:6144
    ds_read_b64_tr_b16 a[170:171], v27 offset:6912
    ds_read_b64_tr_b16 a[172:173], v27 offset:9216
    ds_read_b64_tr_b16 a[174:175], v27 offset:9984
    ds_read_b64_tr_b16 a[176:177], v27 offset:6176
    ds_read_b64_tr_b16 a[178:179], v27 offset:6944
    ds_read_b64_tr_b16 a[180:181], v27 offset:9248
    ds_read_b64_tr_b16 a[182:183], v27 offset:10016
    ds_read_b64_tr_b16 a[184:185], v27 offset:6208
    ds_read_b64_tr_b16 a[186:187], v27 offset:6976
    ds_read_b64_tr_b16 a[188:189], v27 offset:9280
    ds_read_b64_tr_b16 a[190:191], v27 offset:10048
    s_waitcnt lgkmcnt(0)
WL5_1:
    s_cmp_lg_u32 s3, 2
    s_cbranch_scc1 WL5_2
    ds_read_b64_tr_b16 a[48:49], v27 offset:0
    ds_read_b64_tr_b16 a[50:51], v27 offset:768
    ds_read_b64_tr_b16 a[52:53], v27 offset:3072
    ds_read_b64_tr_b16 a[54:55], v27 offset:3840
    ds_read_b64_tr_b16 a[56:57], v27 offset:32
    ds_read_b64_tr_b16 a[58:59], v27 offset:800
    ds_read_b64_tr_b16 a[60:61], v27 offset:3104
    ds_read_b64_tr_b16 a[62:63], v27 offset:3872
    ds_read_b64_tr_b16 a[64:65], v27 offset:64
    ds_read_b64_tr_b16 a[66:67], v27 offset:832
    ds_read_b64_tr_b16 a[68:69], v27 offset:3136
    ds_read_b64_tr_b16 a[70:71], v27 offset:3904
    s_waitcnt lgkmcnt(0)
    ds_read_b64_tr_b16 a[72:73], v27 offset:6144
    ds_read_b64_tr_b16 a[74:75], v27 offset:6912
    ds_read_b64_tr_b16 a[76:77], v27 offset:9216
    ds_read_b64_tr_b16 a[78:79], v27 offset:9984
    ds_read_b64_tr_b16 a[80:81], v27 offset:6176
    ds_read_b64_tr_b16 a[82:83], v27 offset:6944
    ds_read_b64_tr_b16 a[84:85], v27 offset:9248
    ds_read_b64_tr_b16 a[86:87], v27 offset:10016
    ds_read_b64_tr_b16 a[88:89], v27 offset:6208
    ds_read_b64_tr_b16 a[90:91], v27 offset:6976
    ds_read_b64_tr_b16 a[92:93], v27 offset:9280
    ds_read_b64_tr_b16 a[94:95], v27 offset:10048
    s_waitcnt lgkmcnt(0)
WL5_2:
    s_cmp_lg_u32 s3, 3
    s_cbranch_scc1 WL5_3
    ds_read_b64_tr_b16 v[208:209], v27 offset:0
    ds_read_b64_tr_b16 v[210:211], v27 offset:768
    ds_read_b64_tr_b16 v[212:213], v27 offset:3072
    ds_read_b64_tr_b16 v[214:215], v27 offset:3840
    ds_read_b64_tr_b16 v[216:217], v27 offset:32
    ds_read_b64_tr_b16 v[218:219], v27 offset:800
    ds_read_b64_tr_b16 v[220:221], v27 offset:3104
    ds_read_b64_tr_b16 v[222:223], v27 offset:3872
    ds_read_b64_tr_b16 v[224:225], v27 offset:64
    ds_read_b64_tr_b16 v[226:227], v27 offset:832
    ds_read_b64_tr_b16 v[228:229], v27 offset:3136
    ds_read_b64_tr_b16 v[230:231], v27 offset:3904
    s_waitcnt lgkmcnt(0)
    ds_read_b64_tr_b16 v[232:233], v27 offset:6144
    ds_read_b64_tr_b16 v[234:235], v27 offset:6912
    ds_read_b64_tr_b16 v[236:237], v27 offset:9216
    ds_read_b64_tr_b16 v[238:239], v27 offset:9984
    ds_read_b64_tr_b16 v[240:241], v27 offset:6176
    ds_read_b64_tr_b16 v[242:243], v27 offset:6944
    ds_read_b64_tr_b16 v[244:245], v27 offset:9248
    ds_read_b64_tr_b16 v[246:247], v27 offset:10016
    ds_read_b64_tr_b16 v[248:249], v27 offset:6208
    ds_read_b64_tr_b16 v[250:251], v27 offset:6976
    ds_read_b64_tr_b16 v[252:253], v27 offset:9280
    ds_read_b64_tr_b16 v[254:255], v27 offset:10048
    s_waitcnt lgkmcnt(0)
WL5_3:
    s_mov_b32 s33, 1572864
    s_add_u32 m0, s34, 98304
    s_nop 0
    buffer_load_dwordx4 v20, s[16:19], s33 offen lds
    s_add_u32 m0, s34, 99328
    s_nop 0
    buffer_load_dwordx4 v21, s[16:19], s33 offen lds
    s_add_u32 m0, s34, 100352
    s_nop 0
    buffer_load_dwordx4 v22, s[16:19], s33 offen lds
    s_add_u32 m0, s34, 101376
    s_nop 0
    buffer_load_dwordx4 v23, s[16:19], s33 offen lds
    s_add_u32 m0, s34, 102400
    s_nop 0
    buffer_load_dwordx4 v24, s[16:19], s33 offen lds
    s_add_u32 m0, s34, 103424
    s_nop 0
    buffer_load_dwordx4 v25, s[16:19], s33 offen lds
    s_add_u32 m0, s34, 104448
    s_nop 0
    buffer_load_dwordx4 v20, s[20:23], s33 offen lds
    s_add_u32 m0, s34, 105472
    s_nop 0
    buffer_load_dwordx4 v21, s[20:23], s33 offen lds
    s_add_u32 m0, s34, 106496
    s_nop 0
    buffer_load_dwordx4 v22, s[20:23], s33 offen lds
    s_add_u32 m0, s34, 107520
    s_nop 0
    buffer_load_dwordx4 v23, s[20:23], s33 offen lds
    s_add_u32 m0, s34, 108544
    s_nop 0
    buffer_load_dwordx4 v24, s[20:23], s33 offen lds
    s_add_u32 m0, s34, 109568
    s_nop 0
    buffer_load_dwordx4 v25, s[20:23], s33 offen lds
    s_waitcnt vmcnt(24)
    s_add_u32 s6, s34, 0
    v_add_u32 v27, s6, v26
    s_cmp_lg_u32 s3, 0
    s_cbranch_scc1 WL6_0
    ds_read_b64_tr_b16 v[160:161], v27 offset:0
    ds_read_b64_tr_b16 v[162:163], v27 offset:768
    ds_read_b64_tr_b16 v[164:165], v27 offset:3072
    ds_read_b64_tr_b16 v[166:167], v27 offset:3840
    ds_read_b64_tr_b16 v[168:169], v27 offset:32
    ds_read_b64_tr_b16 v[170:171], v27 offset:800
    ds_read_b64_tr_b16 v[172:173], v27 offset:3104
    ds_read_b64_tr_b16 v[174:175], v27 offset:3872
    ds_read_b64_tr_b16 v[176:177], v27 offset:64
    ds_read_b64_tr_b16 v[178:179], v27 offset:832
    ds_read_b64_tr_b16 v[180:181], v27 offset:3136
    ds_read_b64_tr_b16 v[182:183], v27 offset:3904
    s_waitcnt lgkmcnt(0)
    ds_read_b64_tr_b16 v[184:185], v27 offset:6144
    ds_read_b64_tr_b16 v[186:187], v27 offset:6912
    ds_read_b64_tr_b16 v[188:189], v27 offset:9216
    ds_read_b64_tr_b16 v[190:191], v27 offset:9984
    ds_read_b64_tr_b16 v[192:193], v27 offset:6176
    ds_read_b64_tr_b16 v[194:195], v27 offset:6944
    ds_read_b64_tr_b16 v[196:197], v27 offset:9248
    ds_read_b64_tr_b16 v[198:199], v27 offset:10016
    ds_read_b64_tr_b16 v[200:201], v27 offset:6208
    ds_read_b64_tr_b16 v[202:203], v27 offset:6976
    ds_read_b64_tr_b16 v[204:205], v27 offset:9280
    ds_read_b64_tr_b16 v[206:207], v27 offset:10048
    s_waitcnt lgkmcnt(0)
WL6_0:
    s_cmp_lg_u32 s3, 1
    s_cbranch_scc1 WL6_1
    ds_read_b64_tr_b16 a[192:193], v27 offset:0
    ds_read_b64_tr_b16 a[194:195], v27 offset:768
    ds_read_b64_tr_b16 a[196:197], v27 offset:3072
    ds_read_b64_tr_b16 a[198:199], v27 offset:3840
    ds_read_b64_tr_b16 a[200:201], v27 offset:32
    ds_read_b64_tr_b16 a[202:203], v27 offset:800
    ds_read_b64_tr_b16 a[204:205], v27 offset:3104
    ds_read_b64_tr_b16 a[206:207], v27 offset:3872
    ds_read_b64_tr_b16 a[208:209], v27 offset:64
    ds_read_b64_tr_b16 a[210:211], v27 offset:832
    ds_read_b64_tr_b16 a[212:213], v27 offset:3136
    ds_read_b64_tr_b16 a[214:215], v27 offset:3904
    s_waitcnt lgkmcnt(0)
    ds_read_b64_tr_b16 a[216:217], v27 offset:6144
    ds_read_b64_tr_b16 a[218:219], v27 offset:6912
    ds_read_b64_tr_b16 a[220:221], v27 offset:9216
    ds_read_b64_tr_b16 a[222:223], v27 offset:9984
    ds_read_b64_tr_b16 a[224:225], v27 offset:6176
    ds_read_b64_tr_b16 a[226:227], v27 offset:6944
    ds_read_b64_tr_b16 a[228:229], v27 offset:9248
    ds_read_b64_tr_b16 a[230:231], v27 offset:10016
    ds_read_b64_tr_b16 a[232:233], v27 offset:6208
    ds_read_b64_tr_b16 a[234:235], v27 offset:6976
    ds_read_b64_tr_b16 a[236:237], v27 offset:9280
    ds_read_b64_tr_b16 a[238:239], v27 offset:10048
    s_waitcnt lgkmcnt(0)
WL6_1:
    s_cmp_lg_u32 s3, 2
    s_cbranch_scc1 WL6_2
    ds_read_b64_tr_b16 a[96:97], v27 offset:0
    ds_read_b64_tr_b16 a[98:99], v27 offset:768
    ds_read_b64_tr_b16 a[100:101], v27 offset:3072
    ds_read_b64_tr_b16 a[102:103], v27 offset:3840
    ds_read_b64_tr_b16 a[104:105], v27 offset:32
    ds_read_b64_tr_b16 a[106:107], v27 offset:800
    ds_read_b64_tr_b16 a[108:109], v27 offset:3104
    ds_read_b64_tr_b16 a[110:111], v27 offset:3872
    ds_read_b64_tr_b16 a[112:113], v27 offset:64
    ds_read_b64_tr_b16 a[114:115], v27 offset:832
    ds_read_b64_tr_b16 a[116:117], v27 offset:3136
    ds_read_b64_tr_b16 a[118:119], v27 offset:3904
    s_waitcnt lgkmcnt(0)
    ds_read_b64_tr_b16 a[120:121], v27 offset:6144
    ds_read_b64_tr_b16 a[122:123], v27 offset:6912
    ds_read_b64_tr_b16 a[124:125], v27 offset:9216
    ds_read_b64_tr_b16 a[126:127], v27 offset:9984
    ds_read_b64_tr_b16 a[128:129], v27 offset:6176
    ds_read_b64_tr_b16 a[130:131], v27 offset:6944
    ds_read_b64_tr_b16 a[132:133], v27 offset:9248
    ds_read_b64_tr_b16 a[134:135], v27 offset:10016
    ds_read_b64_tr_b16 a[136:137], v27 offset:6208
    ds_read_b64_tr_b16 a[138:139], v27 offset:6976
    ds_read_b64_tr_b16 a[140:141], v27 offset:9280
    ds_read_b64_tr_b16 a[142:143], v27 offset:10048
    s_waitcnt lgkmcnt(0)
WL6_2:
    s_cmp_lg_u32 s3, 3
    s_cbranch_scc1 WL6_3
    ds_read_b64_tr_b16 a[0:1], v27 offset:0
    ds_read_b64_tr_b16 a[2:3], v27 offset:768
    ds_read_b64_tr_b16 a[4:5], v27 offset:3072
    ds_read_b64_tr_b16 a[6:7], v27 offset:3840
    ds_read_b64_tr_b16 a[8:9], v27 offset:32
    ds_read_b64_tr_b16 a[10:11], v27 offset:800
    ds_read_b64_tr_b16 a[12:13], v27 offset:3104
    ds_read_b64_tr_b16 a[14:15], v27 offset:3872
    ds_read_b64_tr_b16 a[16:17], v27 offset:64
    ds_read_b64_tr_b16 a[18:19], v27 offset:832
    ds_read_b64_tr_b16 a[20:21], v27 offset:3136
    ds_read_b64_tr_b16 a[22:23], v27 offset:3904
    s_waitcnt lgkmcnt(0)
    ds_read_b64_tr_b16 a[24:25], v27 offset:6144
    ds_read_b64_tr_b16 a[26:27], v27 offset:6912
    ds_read_b64_tr_b16 a[28:29], v27 offset:9216
    ds_read_b64_tr_b16 a[30:31], v27 offset:9984
    ds_read_b64_tr_b16 a[32:33], v27 offset:6176
    ds_read_b64_tr_b16 a[34:35], v27 offset:6944
    ds_read_b64_tr_b16 a[36:37], v27 offset:9248
    ds_read_b64_tr_b16 a[38:39], v27 offset:10016
    ds_read_b64_tr_b16 a[40:41], v27 offset:6208
    ds_read_b64_tr_b16 a[42:43], v27 offset:6976
    ds_read_b64_tr_b16 a[44:45], v27 offset:9280
    ds_read_b64_tr_b16 a[46:47], v27 offset:10048
    s_waitcnt lgkmcnt(0)
WL6_3:
    s_mov_b32 s33, 5505024
    s_add_u32 m0, s34, 0
    s_nop 0
    buffer_load_dwordx4 v20, s[16:19], s33 offen lds
    s_add_u32 m0, s34, 1024
    s_nop 0
    buffer_load_dwordx4 v21, s[16:19], s33 offen lds
    s_add_u32 m0, s34, 2048
    s_nop 0
    buffer_load_dwordx4 v22, s[16:19], s33 offen lds
    s_add_u32 m0, s34, 3072
    s_nop 0
    buffer_load_dwordx4 v23, s[16:19], s33 offen lds
    s_add_u32 m0, s34, 4096
    s_nop 0
    buffer_load_dwordx4 v24, s[16:19], s33 offen lds
    s_add_u32 m0, s34, 5120
    s_nop 0
    buffer_load_dwordx4 v25, s[16:19], s33 offen lds
    s_add_u32 m0, s34, 6144
    s_nop 0
    buffer_load_dwordx4 v20, s[20:23], s33 offen lds
    s_add_u32 m0, s34, 7168
    s_nop 0
    buffer_load_dwordx4 v21, s[20:23], s33 offen lds
    s_add_u32 m0, s34, 8192
    s_nop 0
    buffer_load_dwordx4 v22, s[20:23], s33 offen lds
    s_add_u32 m0, s34, 9216
    s_nop 0
    buffer_load_dwordx4 v23, s[20:23], s33 offen lds
    s_add_u32 m0, s34, 10240
    s_nop 0
    buffer_load_dwordx4 v24, s[20:23], s33 offen lds
    s_add_u32 m0, s34, 11264
    s_nop 0
    buffer_load_dwordx4 v25, s[20:23], s33 offen lds
    s_waitcnt vmcnt(24)
    s_add_u32 s6, s34, 49152
    v_add_u32 v27, s6, v26
    s_cmp_lg_u32 s3, 0
    s_cbranch_scc1 WL7_0
    ds_read_b64_tr_b16 v[208:209], v27 offset:0
    ds_read_b64_tr_b16 v[210:211], v27 offset:768
    ds_read_b64_tr_b16 v[212:213], v27 offset:3072
    ds_read_b64_tr_b16 v[214:215], v27 offset:3840
    ds_read_b64_tr_b16 v[216:217], v27 offset:32
    ds_read_b64_tr_b16 v[218:219], v27 offset:800
    ds_read_b64_tr_b16 v[220:221], v27 offset:3104
    ds_read_b64_tr_b16 v[222:223], v27 offset:3872
    ds_read_b64_tr_b16 v[224:225], v27 offset:64
    ds_read_b64_tr_b16 v[226:227], v27 offset:832
    ds_read_b64_tr_b16 v[228:229], v27 offset:3136
    ds_read_b64_tr_b16 v[230:231], v27 offset:3904
    s_waitcnt lgkmcnt(0)
    ds_read_b64_tr_b16 v[232:233], v27 offset:6144
    ds_read_b64_tr_b16 v[234:235], v27 offset:6912
    ds_read_b64_tr_b16 v[236:237], v27 offset:9216
    ds_read_b64_tr_b16 v[238:239], v27 offset:9984
    ds_read_b64_tr_b16 v[240:241], v27 offset:6176
    ds_read_b64_tr_b16 v[242:243], v27 offset:6944
    ds_read_b64_tr_b16 v[244:245], v27 offset:9248
    ds_read_b64_tr_b16 v[246:247], v27 offset:10016
    ds_read_b64_tr_b16 v[248:249], v27 offset:6208
    ds_read_b64_tr_b16 v[250:251], v27 offset:6976
    ds_read_b64_tr_b16 v[252:253], v27 offset:9280
    ds_read_b64_tr_b16 v[254:255], v27 offset:10048
    s_waitcnt lgkmcnt(0)
WL7_0:
    s_cmp_lg_u32 s3, 1
    s_cbranch_scc1 WL7_1
    ds_read_b64_tr_b16 a[240:241], v27 offset:0
    ds_read_b64_tr_b16 a[242:243], v27 offset:768
    ds_read_b64_tr_b16 a[244:245], v27 offset:3072
    ds_read_b64_tr_b16 a[246:247], v27 offset:3840
    ds_read_b64_tr_b16 a[248:249], v27 offset:32
    ds_read_b64_tr_b16 a[250:251], v27 offset:800
    ds_read_b64_tr_b16 a[252:253], v27 offset:3104
    ds_read_b64_tr_b16 a[254:255], v27 offset:3872
    ds_read_b64_tr_b16 v[128:129], v27 offset:64
    ds_read_b64_tr_b16 v[130:131], v27 offset:832
    ds_read_b64_tr_b16 v[132:133], v27 offset:3136
    ds_read_b64_tr_b16 v[134:135], v27 offset:3904
    s_waitcnt lgkmcnt(0)
    ds_read_b64_tr_b16 v[136:137], v27 offset:6144
    ds_read_b64_tr_b16 v[138:139], v27 offset:6912
    ds_read_b64_tr_b16 v[140:141], v27 offset:9216
    ds_read_b64_tr_b16 v[142:143], v27 offset:9984
    ds_read_b64_tr_b16 v[144:145], v27 offset:6176
    ds_read_b64_tr_b16 v[146:147], v27 offset:6944
    ds_read_b64_tr_b16 v[148:149], v27 offset:9248
    ds_read_b64_tr_b16 v[150:151], v27 offset:10016
    ds_read_b64_tr_b16 v[152:153], v27 offset:6208
    ds_read_b64_tr_b16 v[154:155], v27 offset:6976
    ds_read_b64_tr_b16 v[156:157], v27 offset:9280
    ds_read_b64_tr_b16 v[158:159], v27 offset:10048
    s_waitcnt lgkmcnt(0)
WL7_1:
    s_cmp_lg_u32 s3, 2
    s_cbranch_scc1 WL7_2
    ds_read_b64_tr_b16 a[144:145], v27 offset:0
    ds_read_b64_tr_b16 a[146:147], v27 offset:768
    ds_read_b64_tr_b16 a[148:149], v27 offset:3072
    ds_read_b64_tr_b16 a[150:151], v27 offset:3840
    ds_read_b64_tr_b16 a[152:153], v27 offset:32
    ds_read_b64_tr_b16 a[154:155], v27 offset:800
    ds_read_b64_tr_b16 a[156:157], v27 offset:3104
    ds_read_b64_tr_b16 a[158:159], v27 offset:3872
    ds_read_b64_tr_b16 a[160:161], v27 offset:64
    ds_read_b64_tr_b16 a[162:163], v27 offset:832
    ds_read_b64_tr_b16 a[164:165], v27 offset:3136
    ds_read_b64_tr_b16 a[166:167], v27 offset:3904
    s_waitcnt lgkmcnt(0)
    ds_read_b64_tr_b16 a[168:169], v27 offset:6144
    ds_read_b64_tr_b16 a[170:171], v27 offset:6912
    ds_read_b64_tr_b16 a[172:173], v27 offset:9216
    ds_read_b64_tr_b16 a[174:175], v27 offset:9984
    ds_read_b64_tr_b16 a[176:177], v27 offset:6176
    ds_read_b64_tr_b16 a[178:179], v27 offset:6944
    ds_read_b64_tr_b16 a[180:181], v27 offset:9248
    ds_read_b64_tr_b16 a[182:183], v27 offset:10016
    ds_read_b64_tr_b16 a[184:185], v27 offset:6208
    ds_read_b64_tr_b16 a[186:187], v27 offset:6976
    ds_read_b64_tr_b16 a[188:189], v27 offset:9280
    ds_read_b64_tr_b16 a[190:191], v27 offset:10048
    s_waitcnt lgkmcnt(0)
WL7_2:
    s_cmp_lg_u32 s3, 3
    s_cbranch_scc1 WL7_3
    ds_read_b64_tr_b16 a[48:49], v27 offset:0
    ds_read_b64_tr_b16 a[50:51], v27 offset:768
    ds_read_b64_tr_b16 a[52:53], v27 offset:3072
    ds_read_b64_tr_b16 a[54:55], v27 offset:3840
    ds_read_b64_tr_b16 a[56:57], v27 offset:32
    ds_read_b64_tr_b16 a[58:59], v27 offset:800
    ds_read_b64_tr_b16 a[60:61], v27 offset:3104
    ds_read_b64_tr_b16 a[62:63], v27 offset:3872
    ds_read_b64_tr_b16 a[64:65], v27 offset:64
    ds_read_b64_tr_b16 a[66:67], v27 offset:832
    ds_read_b64_tr_b16 a[68:69], v27 offset:3136
    ds_read_b64_tr_b16 a[70:71], v27 offset:3904
    s_waitcnt lgkmcnt(0)
    ds_read_b64_tr_b16 a[72:73], v27 offset:6144
    ds_read_b64_tr_b16 a[74:75], v27 offset:6912
    ds_read_b64_tr_b16 a[76:77], v27 offset:9216
    ds_read_b64_tr_b16 a[78:79], v27 offset:9984
    ds_read_b64_tr_b16 a[80:81], v27 offset:6176
    ds_read_b64_tr_b16 a[82:83], v27 offset:6944
    ds_read_b64_tr_b16 a[84:85], v27 offset:9248
    ds_read_b64_tr_b16 a[86:87], v27 offset:10016
    ds_read_b64_tr_b16 a[88:89], v27 offset:6208
    ds_read_b64_tr_b16 a[90:91], v27 offset:6976
    ds_read_b64_tr_b16 a[92:93], v27 offset:9280
    ds_read_b64_tr_b16 a[94:95], v27 offset:10048
    s_waitcnt lgkmcnt(0)
WL7_3:
    s_waitcnt vmcnt(0)
    v_add_u32 v6, s34, v26
    v_add_u32 v7, 98304, v6
    ds_read_b64_tr_b16 v[28:29], v7 offset:0
    ds_read_b64_tr_b16 v[30:31], v7 offset:768
    ds_read_b64_tr_b16 v[32:33], v7 offset:3072
    ds_read_b64_tr_b16 v[34:35], v7 offset:3840
    ds_read_b64_tr_b16 v[36:37], v7 offset:6144
    ds_read_b64_tr_b16 v[38:39], v7 offset:6912
    ds_read_b64_tr_b16 v[40:41], v7 offset:9216
    ds_read_b64_tr_b16 v[42:43], v7 offset:9984
    s_waitcnt lgkmcnt(0)
    ds_read_b64_tr_b16 v[44:45], v7 offset:32
    ds_read_b64_tr_b16 v[46:47], v7 offset:800
    ds_read_b64_tr_b16 v[48:49], v7 offset:3104
    ds_read_b64_tr_b16 v[50:51], v7 offset:3872
    ds_read_b64_tr_b16 v[52:53], v7 offset:6176
    ds_read_b64_tr_b16 v[54:55], v7 offset:6944
    ds_read_b64_tr_b16 v[56:57], v7 offset:9248
    ds_read_b64_tr_b16 v[58:59], v7 offset:10016
    s_waitcnt lgkmcnt(0)
    ds_read_b64_tr_b16 v[60:61], v7 offset:64
    ds_read_b64_tr_b16 v[62:63], v7 offset:832
    ds_read_b64_tr_b16 v[64:65], v7 offset:3136
    ds_read_b64_tr_b16 v[66:67], v7 offset:3904
    ds_read_b64_tr_b16 v[68:69], v7 offset:6208
    ds_read_b64_tr_b16 v[70:71], v7 offset:6976
    ds_read_b64_tr_b16 v[72:73], v7 offset:9280
    ds_read_b64_tr_b16 v[74:75], v7 offset:10048
    s_waitcnt lgkmcnt(0)
    ds_read_b64_tr_b16 v[76:77], v6 offset:0
    ds_read_b64_tr_b16 v[78:79], v6 offset:768
    ds_read_b64_tr_b16 v[80:81], v6 offset:3072
    ds_read_b64_tr_b16 v[82:83], v6 offset:3840
    ds_read_b64_tr_b16 v[84:85], v6 offset:6144
    ds_read_b64_tr_b16 v[86:87], v6 offset:6912
    ds_read_b64_tr_b16 v[88:89], v6 offset:9216
    ds_read_b64_tr_b16 v[90:91], v6 offset:9984
    s_waitcnt lgkmcnt(0)
    ds_read_b64_tr_b16 v[92:93], v6 offset:32
    ds_read_b64_tr_b16 v[94:95], v6 offset:800
    ds_read_b64_tr_b16 v[96:97], v6 offset:3104
    ds_read_b64_tr_b16 v[98:99], v6 offset:3872
    ds_read_b64_tr_b16 v[100:101], v6 offset:6176
    ds_read_b64_tr_b16 v[102:103], v6 offset:6944
    ds_read_b64_tr_b16 v[104:105], v6 offset:9248
    ds_read_b64_tr_b16 v[106:107], v6 offset:10016
    s_waitcnt lgkmcnt(0)
    ds_read_b64_tr_b16 v[108:109], v6 offset:64
    ds_read_b64_tr_b16 v[110:111], v6 offset:832
    ds_read_b64_tr_b16 v[112:113], v6 offset:3136
    ds_read_b64_tr_b16 v[114:115], v6 offset:3904
    ds_read_b64_tr_b16 v[116:117], v6 offset:6208
    ds_read_b64_tr_b16 v[118:119], v6 offset:6976
    ds_read_b64_tr_b16 v[120:121], v6 offset:9280
    ds_read_b64_tr_b16 v[122:123], v6 offset:10048
    s_waitcnt lgkmcnt(0)
    v_lshl_add_u32 v6, v0, 4, s34
    v_add_u32 v7, 98304, v6
    ds_write_b128 v7, v[28:31] offset:0
    ds_write_b128 v7, v[32:35] offset:1024
    ds_write_b128 v7, v[36:39] offset:2048
    ds_write_b128 v7, v[40:43] offset:3072
    ds_write_b128 v7, v[44:47] offset:4096
    ds_write_b128 v7, v[48:51] offset:5120
    ds_write_b128 v7, v[52:55] offset:6144
    ds_write_b128 v7, v[56:59] offset:7168
    ds_write_b128 v7, v[60:63] offset:8192
    ds_write_b128 v7, v[64:67] offset:9216
    ds_write_b128 v7, v[68:71] offset:10240
    ds_write_b128 v7, v[72:75] offset:11264
    s_waitcnt lgkmcnt(0)
    ds_write_b128 v6, v[76:79] offset:0
    ds_write_b128 v6, v[80:83] offset:1024
    ds_write_b128 v6, v[84:87] offset:2048
    ds_write_b128 v6, v[88:91] offset:3072
    ds_write_b128 v6, v[92:95] offset:4096
    ds_write_b128 v6, v[96:99] offset:5120
    ds_write_b128 v6, v[100:103] offset:6144
    ds_write_b128 v6, v[104:107] offset:7168
    ds_write_b128 v6, v[108:111] offset:8192
    ds_write_b128 v6, v[112:115] offset:9216
    ds_write_b128 v6, v[116:119] offset:10240
    ds_write_b128 v6, v[120:123] offset:11264
    s_waitcnt lgkmcnt(0)
    s_lshl_b32 s6, s3, 14
    s_add_u32 s6, s6, 5120
    v_lshl_add_u32 v1, v0, 4, s6
    v_and_b32 v10, 31, v0
    s_add_u32 s6, s6, 2048
    v_lshl_add_u32 v19, v10, 4, s6
    s_mul_i32 s6, s3, 2560
    s_add_u32 s6, s6, 149504
    v_lshl_add_u32 v4, v10, 4, s6
    s_sub_u32 s6, s6, 2048
    v_lshl_add_u32 v10, v0, 4, s6
    s_mov_b32 s6, 147456
    v_lshl_add_u32 v5, v0, 4, s6
    v_and_b32 v8, 8, v0
    v_cmp_eq_u32 vcc, 0, v8
    v_mov_b32 v8, 0xeeee
    v_mov_b32 v2, 0x4444
    v_cndmask_b32 v8, v8, v2, vcc
    v_lshrrev_b32 v30, 4, v0
    v_and_b32 v31, 15, v0
    v_lshrrev_b32 v32, 3, v0
    v_min_u32 v32, 4, v32
    v_and_b32 v33, 7, v0
    v_and_b32 v2, 1, v30
    v_lshlrev_b32 v2, 2, v2
    v_sub_u32 v2, v31, v2
    v_mov_b32 v3, 0x3f80
    v_mov_b32 v34, 0x3f800000
    v_cmp_eq_u32 vcc, 0, v2
    s_nop 1
    v_cndmask_b32 v20, 0, v3, vcc
    v_cmp_eq_u32 vcc, 1, v2
    s_nop 1
    v_cndmask_b32 v20, v20, v34, vcc
    v_cmp_eq_u32 vcc, 2, v2
    s_nop 1
    v_cndmask_b32 v21, 0, v3, vcc
    v_cmp_eq_u32 vcc, 3, v2
    s_nop 1
    v_cndmask_b32 v21, v21, v34, vcc
    v_cmp_eq_u32 vcc, 8, v2
    s_nop 1
    v_cndmask_b32 v22, 0, v3, vcc
    v_cmp_eq_u32 vcc, 9, v2
    s_nop 1
    v_cndmask_b32 v22, v22, v34, vcc
    v_cmp_eq_u32 vcc, 10, v2
    s_nop 1
    v_cndmask_b32 v23, 0, v3, vcc
    v_cmp_eq_u32 vcc, 11, v2
    s_nop 1
    v_cndmask_b32 v23, v23, v34, vcc
    s_mul_i32 s6, s3, 8448
    s_add_u32 s6, s6, 49152
    v_mul_u32_u24 v2, 176, v31
    v_add_u32 v2, s6, v2
    v_lshl_add_u32 v9, v30, 4, v2
    v_mov_b32 v3, 160
    v_cmp_eq_u32 vcc, 2, v30
    s_nop 1
    v_cndmask_b32 v3, v3, 64, vcc
    v_mov_b32 v34, 144
    v_cmp_eq_u32 vcc, 3, v30
    s_nop 1
    v_cndmask_b32 v3, v3, v34, vcc
    v_add_u32 v12, v2, v3
    v_mul_u32_u24 v2, 176, v33
    v_lshl_add_u32 v2, v32, 4, v2
    v_add_u32 v13, 49152, v2
    s_mul_i32 s6, s3, 1408
    s_add_u32 s6, s6, 2816
    v_add_u32 v14, s6, v13
    v_mov_b32 v38, 49152
    s_and_b32 s6, s5, 7
    s_lshr_b32 s7, s6, 1
    s_lshl_b32 s7, s7, 10
    s_and_b32 s33, s5, 1
    s_lshl_b32 s33, s33, 7
    s_add_u32 s7, s7, s33
    s_lshl_b32 s6, s6, 7
    s_add_u32 s6, s6, 4096
    v_and_b32 v35, 1, v0
    v_bfe_u32 v37, v0, 1, 2
    v_lshl_add_u32 v37, s3, 2, v37
    v_mul_u32_u24 v2, 176, v37
    v_lshl_add_u32 v2, v32, 4, v2
    v_mul_u32_u24 v3, 80, v35
    v_add3_u32 v13, v2, v3, v38
    s_and_b32 s33, s5, 7
    s_lshl_b32 s33, s33, 1
    s_add_u32 s33, s33, s3
    s_lshl_b32 s35, s33, 8
    s_lshl_b32 s33, s33, 6
    s_add_u32 s33, s33, 3840
    v_mov_b32 v2, s35
    v_mov_b32 v3, s33
    v_cmp_eq_u32 vcc, 4, v32
    s_nop 1
    v_cndmask_b32 v2, v2, v3, vcc
    v_lshl_add_u32 v2, v0, 3, v2
    v_mov_b32 v3, 1073741824
    v_cmp_gt_u32 s[56:57], 40, v0
    s_nop 1
    v_cndmask_b32 v15, v3, v2, s[56:57]
    v_lshl_add_u32 v2, v32, 8, s7
    v_mov_b32 v3, s6
    v_cmp_eq_u32 vcc, 4, v32
    s_nop 1
    v_cndmask_b32 v2, v2, v3, vcc
    v_lshl_add_u32 v2, v33, 4, v2
    v_mov_b32 v3, 1073741824
    v_cmp_gt_u32 s[72:73], 40, v0
    s_nop 1
    v_cndmask_b32 v2, v3, v2, s[72:73]
    s_lshr_b32 s6, s5, 3
    s_lshl_b32 s7, s6, 14
    v_add_u32 v15, s7, v15
    s_mul_i32 s6, s6, 5120
    s_mul_i32 s7, s3, 20480
    s_add_u32 s6, s6, s7
    v_add_u32 v16, s6, v2
    s_lshl_b32 s6, s5, 2
    s_add_u32 s6, s6, s3
    s_mul_i32 s7, s6, 3072
    v_lshl_add_u32 v17, v0, 4, s7
    s_lshl_b32 s6, s6, 8
    v_lshrrev_b32 v2, 5, v0
    v_lshl_add_u32 v18, v2, 15, s6
    s_lshl_b32 s6, s3, 3
    v_add_u32 v33, s6, v33
    v_cmp_eq_u32 s[34:35], 4, v32
    s_mul_i32 s71, s3, 3072
    s_add_u32 s71, s71, 83968
    v_lshl_add_u32 v11, v0, 4, s71
    v_mov_b32 v126, -1
    s_mov_b32 s70, 1037384597
    v_lshl_add_u32 v2, v32, 2, 0
    v_cmp_le_u32 vcc, v2, v33
    s_or_b64 vcc, vcc, s[34:35]
    s_and_b64 s[74:75], vcc, s[72:73]
    v_lshl_add_u32 v2, v32, 2, 1
    v_cmp_le_u32 vcc, v2, v33
    s_or_b64 vcc, vcc, s[34:35]
    s_and_b64 s[76:77], vcc, s[72:73]
    v_lshl_add_u32 v2, v32, 2, 2
    v_cmp_le_u32 vcc, v2, v33
    s_or_b64 vcc, vcc, s[34:35]
    s_and_b64 s[78:79], vcc, s[72:73]
    v_lshl_add_u32 v2, v32, 2, 3
    v_cmp_le_u32 vcc, v2, v33
    s_or_b64 vcc, vcc, s[34:35]
    s_and_b64 s[80:81], vcc, s[72:73]
    v_lshl_add_u32 v2, v32, 2, 16
    v_cmp_le_u32 vcc, v2, v33
    s_or_b64 vcc, vcc, s[34:35]
    s_and_b64 s[82:83], vcc, s[72:73]
    v_lshl_add_u32 v2, v32, 2, 17
    v_cmp_le_u32 vcc, v2, v33
    s_or_b64 vcc, vcc, s[34:35]
    s_and_b64 s[84:85], vcc, s[72:73]
    v_lshl_add_u32 v2, v32, 2, 18
    v_cmp_le_u32 vcc, v2, v33
    s_or_b64 vcc, vcc, s[34:35]
    s_and_b64 s[86:87], vcc, s[72:73]
    v_lshl_add_u32 v2, v32, 2, 19
    v_cmp_le_u32 vcc, v2, v33
    s_or_b64 vcc, vcc, s[34:35]
    s_and_b64 s[88:89], vcc, s[72:73]
    v_mov_b32 v3, 236
PC_1:
    buffer_load_dword v2, v3, s[24:27], 0 offen sc1
    s_waitcnt vmcnt(0)
    v_readfirstlane_b32 s6, v2
    s_and_b32 s7, s6, 255
    s_cmp_ge_u32 s7, 65
    s_cbranch_scc1 PD_2
    s_sleep 3
    s_sub_u32 s32, s32, 1
    s_cbranch_scc0 PC_1
    s_endpgm
PD_2:
    s_mov_b32 s65, s6
    s_mov_b32 s64, 0
    s_mov_b32 s67, 4358144
    s_mov_b32 s68, 50331648
    s_mov_b32 s69, 83886080
    s_mov_b32 s90, 12345344
    s_barrier
    v_bfe_u32 v2, v0, 3, 1
    v_mul_u32_u24 v2, 1328, v2
    v_sub_u32 v125, v9, v2
    s_add_u32 s6, s3, 0
    s_and_b32 s6, s6, 3
    s_mul_i32 s6, s6, 5
    s_add_u32 s6, s6, 1
    s_lshr_b32 s6, s6, 1
    s_lshl_b32 s6, s6, 10
    v_add_u32 v10, s6, v5
    s_add_u32 s6, s3, 1
    s_and_b32 s6, s6, 3
    s_mul_i32 s6, s6, 5
    s_add_u32 s6, s6, 1
    s_lshr_b32 s6, s6, 1
    s_lshl_b32 s6, s6, 10
    v_add_u32 v2, s6, v5
    s_add_u32 s6, s3, 2
    s_and_b32 s6, s6, 3
    s_mul_i32 s6, s6, 5
    s_add_u32 s6, s6, 1
    s_lshr_b32 s6, s6, 1
    s_lshl_b32 s6, s6, 10
    v_add_u32 v3, s6, v5
    s_add_u32 s6, s3, 3
    s_and_b32 s6, s6, 3
    s_mul_i32 s6, s6, 5
    s_add_u32 s6, s6, 1
    s_lshr_b32 s6, s6, 1
    s_lshl_b32 s6, s6, 10
    v_add_u32 v19, s6, v5
    s_and_b32 s6, s3, 1
    s_lshl_b32 s6, s6, 11
    v_subrev_u32 v4, s6, v4
    s_sub_u32 s60, 2048, s6
    s_lshr_b32 s61, s6, 2
    s_mul_i32 s6, s3, 2560
    s_add_u32 s6, s6, 147456
    s_add_u32 s58, s6, s60
    s_add_u32 s59, s6, s61
    v_cmp_eq_u32 vcc, -1, v126
    s_cbranch_vccz S1_FLD0
S1_FL0:
    buffer_load_dword v126, v18, s[8:11], s90 offen sc1
    s_waitcnt vmcnt(0)
    v_cmp_eq_u32 vcc, -1, v126
    s_cbranch_vccz S1_FLD0
    s_sleep 2
    s_sub_u32 s32, s32, 1
    s_cbranch_scc0 S1_FL0
    s_endpgm
S1_FLD0:
    s_mov_b32 m0, s71
    buffer_load_dwordx4 v[88:91], v17, s[8:11], s68 offen offset:0 sc1
    buffer_load_dwordx4 v17, s[8:11], s69 offen offset:0 sc1 lds
    buffer_load_dwordx4 v[92:95], v17, s[8:11], s68 offen offset:1024 sc1
    buffer_load_dwordx4 v17, s[8:11], s69 offen offset:1024 sc1 lds
    buffer_load_dwordx4 v[96:99], v17, s[8:11], s68 offen offset:2048 sc1
    buffer_load_dwordx4 v17, s[8:11], s69 offen offset:2048 sc1 lds
    buffer_load_dword v126, v18, s[8:11], s90 offen offset:4 sc1
    s_add_u32 s68, s68, 393216
    s_add_u32 s69, s69, 393216
    s_add_u32 s90, s90, 4
S1_LOOP:
    s_cmp_eq_u32 s64, 63
    s_cselect_b32 s62, 4, s3
    s_lshr_b32 s6, s64, 5
    s_add_u32 s6, s6, 8
    s_lshr_b32 s6, s65, s6
    s_and_b32 s6, s6, 1
    s_lshl_b32 s6, s6, 13
    s_lshl_b32 s66, s64, 16
    s_add_u32 s66, s66, s6
    ds_read_b128 v[100:103], v7 offset:0
    ds_read_b128 v[104:107], v7 offset:1024
    ds_read_b128 v[108:111], v7 offset:2048
    ds_read_b128 v[112:115], v7 offset:3072
    ds_read_b128 v[116:119], v7 offset:4096
    ds_read_b128 v[120:123], v7 offset:5120
    v_mov_b64 v[64:65], 0
    v_mov_b64 v[66:67], 0
    v_mov_b64 v[68:69], 0
    v_mov_b64 v[70:71], 0
    v_mov_b64 v[72:73], 0
    v_mov_b64 v[74:75], 0
    v_mov_b64 v[76:77], 0
    v_mov_b64 v[78:79], 0
    v_mov_b64 v[80:81], 0
    v_mov_b64 v[82:83], 0
    v_mov_b64 v[84:85], 0
    v_mov_b64 v[86:87], 0
    s_add_u32 s54, s66, s60
    s_add_u32 s55, s66, s61
S1_POLL:
    s_mov_b32 m0, s58
    s_mov_b32 exec_hi, 0
    buffer_load_dwordx4 v1, s[8:11], s54 offen sc1 lds
    s_mov_b32 m0, s59
    s_mov_b32 exec_hi, -1
    buffer_load_dwordx4 v1, s[8:11], s55 offen sc1 lds
    buffer_load_dwordx4 v1, s[8:11], s55 offen offset:1024 sc1 lds
    s_waitcnt vmcnt(2)
    ds_read_b128 v[32:35], v4
    s_waitcnt vmcnt(1)
    ds_read_b128 v[24:27], v10
    s_waitcnt vmcnt(0)
    ds_read_b128 v[28:31], v10 offset:1024
    s_waitcnt lgkmcnt(2)
    v_max3_u32 v127, v32, v32, v33
    v_max3_u32 v127, v127, v34, v35
    s_waitcnt lgkmcnt(1)
    v_max3_u32 v127, v127, v24, v25
    v_max3_u32 v127, v127, v26, v27
    s_waitcnt lgkmcnt(0)
    v_max3_u32 v127, v127, v28, v29
    v_max3_u32 v127, v127, v30, v31
    v_cmp_eq_u32 vcc, -1, v127
    s_cbranch_vccz S1_GOT
    s_sub_u32 s32, s32, 1
    s_cbranch_scc0 S1_POLL
    s_endpgm
S1_GOT:
    s_barrier
    v_smfmac_f32_16x16x64_bf16 v[64:67], v[24:27], a[0:7], v8
    ds_read_b128 v[56:59], v5 offset:2048
    ds_read_b128 v[32:35], v2 offset:0
    v_smfmac_f32_16x16x64_bf16 v[76:79], v[24:27], a[24:31], v8
    ds_read_b128 v[36:39], v2 offset:1024
    ds_read_b128 v[40:43], v3 offset:0
    v_smfmac_f32_16x16x64_bf16 v[68:71], v[24:27], a[8:15], v8
    ds_read_b128 v[44:47], v3 offset:1024
    ds_read_b128 v[48:51], v19 offset:0
    v_smfmac_f32_16x16x64_bf16 v[80:83], v[24:27], a[32:39], v8
    ds_read_b128 v[52:55], v19 offset:1024
    ds_read_b128 v[60:63], v5 offset:7168
    v_smfmac_f32_16x16x64_bf16 v[72:75], v[24:27], a[16:23], v8
    v_smfmac_f32_16x16x64_bf16 v[84:87], v[24:27], a[40:47], v8
    v_smfmac_f32_16x16x64_bf16 v[64:67], v[28:31], a[48:55], v8
    v_smfmac_f32_16x16x64_bf16 v[76:79], v[28:31], a[72:79], v8
    v_smfmac_f32_16x16x64_bf16 v[68:71], v[28:31], a[56:63], v8
    v_smfmac_f32_16x16x64_bf16 v[80:83], v[28:31], a[80:87], v8
    v_smfmac_f32_16x16x64_bf16 v[72:75], v[28:31], a[64:71], v8
    v_smfmac_f32_16x16x64_bf16 v[84:87], v[28:31], a[88:95], v8
    s_waitcnt lgkmcnt(0)
    v_smfmac_f32_16x16x64_bf16 v[64:67], v[56:59], v[100:107], v8
    v_smfmac_f32_16x16x64_bf16 v[76:79], v[56:59], v[108:115], v8
    v_smfmac_f32_16x16x64_bf16 v[68:71], v[56:59], v[116:123], v8
    v_smfmac_f32_16x16x64_bf16 v[64:67], v[32:35], a[96:103], v8
    v_smfmac_f32_16x16x64_bf16 v[76:79], v[32:35], a[120:127], v8
    ds_read_b128 v[100:103], v7 offset:6144
    ds_read_b128 v[104:107], v7 offset:7168
    v_smfmac_f32_16x16x64_bf16 v[68:71], v[32:35], a[104:111], v8
    ds_read_b128 v[108:111], v7 offset:8192
    ds_read_b128 v[112:115], v7 offset:9216
    v_smfmac_f32_16x16x64_bf16 v[80:83], v[32:35], a[128:135], v8
    ds_read_b128 v[116:119], v7 offset:10240
    ds_read_b128 v[120:123], v7 offset:11264
    v_smfmac_f32_16x16x64_bf16 v[72:75], v[32:35], a[112:119], v8
    ds_read_b128 v[24:27], v6 offset:6144
    ds_read_b128 v[28:31], v6 offset:7168
    v_smfmac_f32_16x16x64_bf16 v[84:87], v[32:35], a[136:143], v8
    v_smfmac_f32_16x16x64_bf16 v[64:67], v[36:39], a[144:151], v8
    v_smfmac_f32_16x16x64_bf16 v[76:79], v[36:39], a[168:175], v8
    v_smfmac_f32_16x16x64_bf16 v[68:71], v[36:39], a[152:159], v8
    v_smfmac_f32_16x16x64_bf16 v[80:83], v[36:39], a[176:183], v8
    v_smfmac_f32_16x16x64_bf16 v[72:75], v[36:39], a[160:167], v8
    v_smfmac_f32_16x16x64_bf16 v[84:87], v[36:39], a[184:191], v8
    s_waitcnt lgkmcnt(2)
    v_smfmac_f32_16x16x64_bf16 v[80:83], v[56:59], v[100:107], v8
    v_smfmac_f32_16x16x64_bf16 v[72:75], v[56:59], v[108:115], v8
    v_smfmac_f32_16x16x64_bf16 v[84:87], v[56:59], v[116:123], v8
    v_smfmac_f32_16x16x64_bf16 v[64:67], v[40:43], a[192:199], v8
    v_smfmac_f32_16x16x64_bf16 v[76:79], v[40:43], a[216:223], v8
    ds_read_b128 v[100:103], v6 offset:0
    ds_read_b128 v[104:107], v6 offset:1024
    v_smfmac_f32_16x16x64_bf16 v[68:71], v[40:43], a[200:207], v8
    ds_read_b128 v[108:111], v6 offset:2048
    ds_read_b128 v[112:115], v6 offset:3072
    v_smfmac_f32_16x16x64_bf16 v[80:83], v[40:43], a[224:231], v8
    ds_read_b128 v[116:119], v6 offset:4096
    ds_read_b128 v[120:123], v6 offset:5120
    v_smfmac_f32_16x16x64_bf16 v[72:75], v[40:43], a[208:215], v8
    ds_read_b128 v[32:35], v6 offset:8192
    ds_read_b128 v[36:39], v6 offset:9216
    v_smfmac_f32_16x16x64_bf16 v[84:87], v[40:43], a[232:239], v8
    v_smfmac_f32_16x16x64_bf16 v[64:67], v[44:47], a[240:247], v8
    v_smfmac_f32_16x16x64_bf16 v[76:79], v[44:47], v[136:143], v8
    v_smfmac_f32_16x16x64_bf16 v[68:71], v[44:47], a[248:255], v8
    v_smfmac_f32_16x16x64_bf16 v[80:83], v[44:47], v[144:151], v8
    v_smfmac_f32_16x16x64_bf16 v[72:75], v[44:47], v[128:135], v8
    v_smfmac_f32_16x16x64_bf16 v[84:87], v[44:47], v[152:159], v8
    v_smfmac_f32_16x16x64_bf16 v[64:67], v[48:51], v[160:167], v8
    v_smfmac_f32_16x16x64_bf16 v[76:79], v[48:51], v[184:191], v8
    ds_read_b128 v[40:43], v6 offset:10240
    ds_read_b128 v[44:47], v6 offset:11264
    v_smfmac_f32_16x16x64_bf16 v[68:71], v[48:51], v[168:175], v8
    v_smfmac_f32_16x16x64_bf16 v[80:83], v[48:51], v[192:199], v8
    v_smfmac_f32_16x16x64_bf16 v[72:75], v[48:51], v[176:183], v8
    v_smfmac_f32_16x16x64_bf16 v[84:87], v[48:51], v[200:207], v8
    v_smfmac_f32_16x16x64_bf16 v[64:67], v[52:55], v[208:215], v8
    v_smfmac_f32_16x16x64_bf16 v[76:79], v[52:55], v[232:239], v8
    s_waitcnt lgkmcnt(2)
    v_smfmac_f32_16x16x64_bf16 v[64:67], v[60:63], v[100:107], v8
    v_smfmac_f32_16x16x64_bf16 v[76:79], v[60:63], v[108:115], v8
    v_smfmac_f32_16x16x64_bf16 v[68:71], v[52:55], v[216:223], v8
    v_smfmac_f32_16x16x64_bf16 v[80:83], v[52:55], v[240:247], v8
    v_smfmac_f32_16x16x64_bf16 v[68:71], v[60:63], v[116:123], v8
    v_smfmac_f32_16x16x64_bf16 v[80:83], v[60:63], v[24:31], v8
    v_smfmac_f32_16x16x64_bf16 v[72:75], v[52:55], v[224:231], v8
    v_smfmac_f32_16x16x64_bf16 v[84:87], v[52:55], v[248:255], v8
    s_nop 0
    v_cvt_pk_bf16_f32 v48, v64, v65
    v_cvt_pk_bf16_f32 v49, v66, v67
    v_cvt_pk_bf16_f32 v50, v76, v77
    v_cvt_pk_bf16_f32 v51, v78, v79
    v_smfmac_f32_16x16x64_bf16 v[72:75], v[60:63], v[32:39], v8
    s_waitcnt lgkmcnt(0)
    v_smfmac_f32_16x16x64_bf16 v[84:87], v[60:63], v[40:47], v8
    v_mfma_f32_16x16x32_bf16 v[64:67], v[48:51], v[20:23], 0
    v_cvt_pk_bf16_f32 v56, v68, v69
    v_cvt_pk_bf16_f32 v57, v70, v71
    v_cvt_pk_bf16_f32 v58, v80, v81
    v_cvt_pk_bf16_f32 v59, v82, v83
    s_nop 1
    v_mfma_f32_16x16x32_bf16 v[68:71], v[56:59], v[20:23], 0
    v_cvt_pk_bf16_f32 v52, v72, v73
    v_cvt_pk_bf16_f32 v53, v74, v75
    v_cvt_pk_bf16_f32 v54, v84, v85
    v_cvt_pk_bf16_f32 v55, v86, v87
    v_cvt_pk_bf16_f32 v76, v64, v65
    v_cvt_pk_bf16_f32 v77, v66, v67
    v_mfma_f32_16x16x32_bf16 v[72:75], v[52:55], v[20:23], 0
    s_nop 0
    v_cvt_pk_bf16_f32 v78, v68, v69
    v_cvt_pk_bf16_f32 v79, v70, v71
    s_nop 1
    v_mfma_f32_16x16x32_bf16 v[108:111], v[76:79], v[76:79], 0
    v_mfma_f32_16x16x32_bf16 v[100:103], v[88:91], v[76:79], 0
    s_nop 0
    v_cvt_pk_bf16_f32 v80, v72, v73
    v_cvt_pk_bf16_f32 v81, v74, v75
    v_mfma_f32_16x16x32_bf16 v[104:107], v[92:95], v[76:79], 0
    s_nop 0
    v_mfma_f32_16x16x16_bf16 v[108:111], v[80:81], v[80:81], v[108:111]
    v_mfma_f32_16x16x16_bf16 v[100:103], v[96:97], v[80:81], v[100:103]
    v_mfma_f32_16x16x16_bf16 v[104:107], v[98:99], v[80:81], v[104:107]
    s_nop 5
    ds_write_b128 v12, v[108:111]
    s_nop 0
    v_mov_b32_dpp v100, v104 row_ror:8 row_mask:0xf bank_mask:0xc
    v_mov_b32_dpp v101, v105 row_ror:8 row_mask:0xf bank_mask:0xc
    v_mov_b32_dpp v102, v106 row_ror:8 row_mask:0xf bank_mask:0xc
    v_mov_b32_dpp v103, v107 row_ror:8 row_mask:0xf bank_mask:0xc
    ds_write_b128 v125, v[100:103]
    s_cmp_gt_u32 s62, 1
    s_waitcnt lgkmcnt(0)
    s_barrier
    s_cbranch_scc1 S1_PX
    ds_read_b128 v[24:27], v13 offset:0
    ds_read_b128 v[28:31], v13 offset:8448
    ds_read_b128 v[32:35], v13 offset:16896
    ds_read_b128 v[36:39], v13 offset:25344
    s_waitcnt lgkmcnt(2)
    v_pk_add_f32 v[24:25], v[24:25], v[28:29]
    v_pk_add_f32 v[26:27], v[26:27], v[30:31]
    s_waitcnt lgkmcnt(0)
    v_pk_add_f32 v[32:33], v[32:33], v[36:37]
    v_pk_add_f32 v[34:35], v[34:35], v[38:39]
    v_pk_add_f32 v[24:25], v[24:25], v[32:33]
    v_pk_add_f32 v[26:27], v[26:27], v[34:35]
    v_max3_f32 v28, v24, v25, v26
    v_max_f32 v28, v28, v27
    s_nop 1
    v_max_f32_dpp v28, v28, v28 quad_perm:[1,0,3,2] row_mask:0xf bank_mask:0xf
    s_nop 1
    v_max_f32_dpp v29, v28, v28 row_ror:8 row_mask:0xf bank_mask:0xf
    v_max_f32_dpp v28, v28, v28 row_ror:8 row_mask:0xf bank_mask:0xf
    s_nop 1
    v_permlane16_swap_b32 v29, v28
    v_max_f32 v30, v28, v29
    v_max_f32 v28, v28, v29
    s_nop 1
    v_permlane32_swap_b32 v30, v28
    v_max_f32 v28, v28, v30
    v_mul_f32 v28, s70, v28
    v_fma_f32 v24, v24, s70, -v28
    v_fma_f32 v25, v25, s70, -v28
    v_fma_f32 v26, v26, s70, -v28
    v_fma_f32 v27, v27, s70, -v28
    v_exp_f32 v24, v24
    v_exp_f32 v25, v25
    v_exp_f32 v26, v26
    v_exp_f32 v27, v27
    v_add_f32 v28, v24, v25
    v_add_f32 v29, v26, v27
    v_add_f32 v28, v28, v29
    v_cndmask_b32 v28, 0, v28, s[56:57]
    s_nop 1
    v_add_f32_dpp v28, v28, v28 quad_perm:[1,0,3,2] row_mask:0xf bank_mask:0xf
    s_nop 1
    v_add_f32_dpp v29, v28, v28 row_ror:8 row_mask:0xf bank_mask:0xf
    v_add_f32_dpp v28, v28, v28 row_ror:8 row_mask:0xf bank_mask:0xf
    s_nop 1
    v_permlane16_swap_b32 v29, v28
    v_add_f32 v30, v28, v29
    v_add_f32 v28, v28, v29
    s_nop 1
    v_permlane32_swap_b32 v30, v28
    v_add_f32 v28, v28, v30
    v_rcp_f32 v28, v28
    s_nop 0
    v_mul_f32 v24, v28, v24
    v_mul_f32 v25, v28, v25
    v_mul_f32 v26, v28, v26
    v_mul_f32 v27, v28, v27
    v_cvt_pk_bf16_f32 v60, |v24|, |v25|
    v_cvt_pk_bf16_f32 v61, |v26|, |v27|
    buffer_store_dwordx2 v[60:61], v15, s[8:11], s66 offen sc1
S1_PX:
    ds_read_b128 v[24:27], v11 offset:0
    ds_read_b128 v[28:31], v11 offset:1024
    ds_read_b128 v[32:35], v11 offset:2048
    s_waitcnt lgkmcnt(0)
    v_mfma_f32_16x16x32_bf16 v[36:39], v[88:91], v[24:27], 0
    v_mfma_f32_16x16x32_bf16 v[40:43], v[92:95], v[24:27], 0
    v_mfma_f32_16x16x32_bf16 v[44:47], v[76:79], v[24:27], 0
    v_mfma_f32_16x16x16_bf16 v[36:39], v[96:97], v[32:33], v[36:39]
    v_mfma_f32_16x16x16_bf16 v[40:43], v[98:99], v[32:33], v[40:43]
    v_mfma_f32_16x16x16_bf16 v[44:47], v[80:81], v[32:33], v[44:47]
    v_mfma_f32_16x16x32_bf16 v[48:51], v[88:91], v[28:31], 0
    v_mfma_f32_16x16x32_bf16 v[52:55], v[92:95], v[28:31], 0
    v_mfma_f32_16x16x32_bf16 v[56:59], v[76:79], v[28:31], 0
    v_mfma_f32_16x16x16_bf16 v[48:51], v[96:97], v[34:35], v[48:51]
    v_mfma_f32_16x16x16_bf16 v[52:55], v[98:99], v[34:35], v[52:55]
    v_mfma_f32_16x16x16_bf16 v[56:59], v[80:81], v[34:35], v[56:59]
    ds_write_b128 v9, v[36:39] offset:2816
    ds_write_b128 v9, v[40:43] offset:2896
    ds_write_b128 v12, v[44:47] offset:2816
    s_nop 2
    ds_write_b128 v9, v[48:51] offset:5632
    ds_write_b128 v9, v[52:55] offset:5712
    ds_write_b128 v12, v[56:59] offset:5632
    s_waitcnt lgkmcnt(0)
    s_barrier
    s_cmp_eq_u32 s64, 63
    s_cbranch_scc1 S1_NN
    v_cmp_eq_u32 vcc, -1, v126
    s_cbranch_vccz S1_FLD1
S1_FL1:
    buffer_load_dword v126, v18, s[8:11], s90 offen sc1
    s_waitcnt vmcnt(0)
    v_cmp_eq_u32 vcc, -1, v126
    s_cbranch_vccz S1_FLD1
    s_sleep 2
    s_sub_u32 s32, s32, 1
    s_cbranch_scc0 S1_FL1
    s_endpgm
S1_FLD1:
    s_mov_b32 m0, s71
    buffer_load_dwordx4 v[88:91], v17, s[8:11], s68 offen offset:0 sc1
    buffer_load_dwordx4 v17, s[8:11], s69 offen offset:0 sc1 lds
    buffer_load_dwordx4 v[92:95], v17, s[8:11], s68 offen offset:1024 sc1
    buffer_load_dwordx4 v17, s[8:11], s69 offen offset:1024 sc1 lds
    buffer_load_dwordx4 v[96:99], v17, s[8:11], s68 offen offset:2048 sc1
    buffer_load_dwordx4 v17, s[8:11], s69 offen offset:2048 sc1 lds
    buffer_load_dword v126, v18, s[8:11], s90 offen offset:4 sc1
    s_add_u32 s68, s68, 393216
    s_add_u32 s69, s69, 393216
    s_add_u32 s90, s90, 4
S1_NN:
    ds_read_b128 v[24:27], v14 offset:0
    ds_read_b128 v[28:31], v14 offset:80
    ds_read_b128 v[32:35], v14 offset:8448
    ds_read_b128 v[36:39], v14 offset:8528
    ds_read_b128 v[40:43], v14 offset:16896
    ds_read_b128 v[44:47], v14 offset:16976
    ds_read_b128 v[48:51], v14 offset:25344
    ds_read_b128 v[52:55], v14 offset:25424
    s_waitcnt lgkmcnt(4)
    v_pk_add_f32 v[24:25], v[24:25], v[32:33]
    v_pk_add_f32 v[26:27], v[26:27], v[34:35]
    v_pk_add_f32 v[28:29], v[28:29], v[36:37]
    v_pk_add_f32 v[30:31], v[30:31], v[38:39]
    s_waitcnt lgkmcnt(0)
    v_pk_add_f32 v[40:41], v[40:41], v[48:49]
    v_pk_add_f32 v[42:43], v[42:43], v[50:51]
    v_pk_add_f32 v[44:45], v[44:45], v[52:53]
    v_pk_add_f32 v[46:47], v[46:47], v[54:55]
    v_pk_add_f32 v[24:25], v[24:25], v[40:41]
    v_pk_add_f32 v[26:27], v[26:27], v[42:43]
    v_pk_add_f32 v[28:29], v[28:29], v[44:45]
    v_pk_add_f32 v[30:31], v[30:31], v[46:47]
    v_mov_b32 v33, 0xff800000
    v_cndmask_b32 v24, v33, v24, s[74:75]
    v_cndmask_b32 v25, v33, v25, s[76:77]
    v_cndmask_b32 v26, v33, v26, s[78:79]
    v_cndmask_b32 v27, v33, v27, s[80:81]
    v_cndmask_b32 v28, v33, v28, s[82:83]
    v_cndmask_b32 v29, v33, v29, s[84:85]
    v_cndmask_b32 v30, v33, v30, s[86:87]
    v_cndmask_b32 v31, v33, v31, s[88:89]
    v_max3_f32 v32, v24, v25, v26
    v_max3_f32 v33, v27, v28, v29
    v_max3_f32 v32, v32, v30, v31
    v_max_f32 v32, v32, v33
    s_nop 1
    v_max_f32_dpp v32, v32, v32 row_ror:8 row_mask:0xf bank_mask:0xf
    v_mov_b32 v33, v32
    s_nop 1
    v_permlane16_swap_b32 v33, v32
    v_max_f32 v32, v32, v33
    v_mov_b32 v33, v32
    s_nop 1
    v_permlane32_swap_b32 v33, v32
    v_max_f32 v32, v32, v33
    v_mul_f32 v32, s70, v32
    v_fma_f32 v24, v24, s70, -v32
    v_fma_f32 v25, v25, s70, -v32
    v_fma_f32 v26, v26, s70, -v32
    v_fma_f32 v27, v27, s70, -v32
    v_fma_f32 v28, v28, s70, -v32
    v_fma_f32 v29, v29, s70, -v32
    v_fma_f32 v30, v30, s70, -v32
    v_fma_f32 v31, v31, s70, -v32
    v_exp_f32 v24, v24
    v_exp_f32 v25, v25
    v_exp_f32 v26, v26
    v_exp_f32 v27, v27
    v_exp_f32 v28, v28
    v_exp_f32 v29, v29
    v_exp_f32 v30, v30
    v_exp_f32 v31, v31
    v_pk_add_f32 v[34:35], v[24:25], v[26:27]
    v_pk_add_f32 v[36:37], v[28:29], v[30:31]
    v_pk_add_f32 v[34:35], v[34:35], v[36:37]
    v_add_f32 v32, v34, v35
    s_nop 1
    v_add_f32_dpp v32, v32, v32 row_ror:8 row_mask:0xf bank_mask:0xf
    v_mov_b32 v33, v32
    s_nop 1
    v_permlane16_swap_b32 v33, v32
    v_add_f32 v32, v32, v33
    v_mov_b32 v33, v32
    s_nop 1
    v_permlane32_swap_b32 v33, v32
    v_add_f32 v32, v32, v33
    v_rcp_f32 v32, v32
    s_nop 0
    v_mul_f32 v24, v32, v24
    v_mul_f32 v25, v32, v25
    v_mul_f32 v26, v32, v26
    v_mul_f32 v27, v32, v27
    v_mul_f32 v28, v32, v28
    v_mul_f32 v29, v32, v29
    v_mul_f32 v30, v32, v30
    v_mul_f32 v31, v32, v31
    v_cvt_pk_bf16_f32 v36, |v24|, |v25|
    v_cvt_pk_bf16_f32 v37, |v26|, |v27|
    v_cvt_pk_bf16_f32 v38, |v28|, |v29|
    v_cvt_pk_bf16_f32 v39, |v30|, |v31|
    buffer_store_dwordx4 v[36:39], v16, s[8:11], s67 offen sc1
    s_add_u32 s64, s64, 1
    s_add_u32 s67, s67, 81920
    s_cmp_lt_u32 s64, 64
    s_cbranch_scc1 S1_LOOP
    s_endpgm
L_X1:
    s_and_b32 s5, s4, 31
    s_cmp_lt_u32 s4, 160
    s_cbranch_scc0 X1_Q
    s_mov_b32 s16, s48
    s_and_b32 s17, s49, 0xffff
    s_mov_b32 s18, 7864320
    s_mov_b32 s19, 0x20000
    s_mov_b32 s68, 50331648
    s_mov_b32 s90, 12345344
    s_cmp_lg_u32 s4, 128
    s_cbranch_scc1 X1_GO
    s_cmp_lg_u32 s3, 0
    s_cbranch_scc1 X1_CD
    v_mov_b32 v3, 7936
    s_mov_b32 s34, 4
    s_mov_b64 s[64:65], -1
    s_mov_b64 s[66:67], -1
    s_mov_b64 exec, 1
X1_CAL:
    v_add_u32 v3, 0x10000, v3
    s_mov_b32 s7, 0
    s_memtime s[72:73]
    s_waitcnt lgkmcnt(0)
    buffer_store_dword v3, v3, s[8:11], s7 offen sc1
    s_waitcnt vmcnt(0)
    s_memtime s[74:75]
    s_waitcnt lgkmcnt(0)
    s_sub_u32 s6, s74, s72
    s_min_u32 s64, s64, s6
    s_mov_b32 s7, 8192
    s_memtime s[72:73]
    s_waitcnt lgkmcnt(0)
    buffer_store_dword v3, v3, s[8:11], s7 offen sc1
    s_waitcnt vmcnt(0)
    s_memtime s[74:75]
    s_waitcnt lgkmcnt(0)
    s_sub_u32 s6, s74, s72
    s_min_u32 s65, s65, s6
    s_mov_b32 s7, 2097152
    s_memtime s[72:73]
    s_waitcnt lgkmcnt(0)
    buffer_store_dword v3, v3, s[8:11], s7 offen sc1
    s_waitcnt vmcnt(0)
    s_memtime s[74:75]
    s_waitcnt lgkmcnt(0)
    s_sub_u32 s6, s74, s72
    s_min_u32 s66, s66, s6
    s_mov_b32 s7, 2105344
    s_memtime s[72:73]
    s_waitcnt lgkmcnt(0)
    buffer_store_dword v3, v3, s[8:11], s7 offen sc1
    s_waitcnt vmcnt(0)
    s_memtime s[74:75]
    s_waitcnt lgkmcnt(0)
    s_sub_u32 s6, s74, s72
    s_min_u32 s67, s67, s6
    s_sub_u32 s34, s34, 1
    s_cmp_lg_u32 s34, 0
    s_cbranch_scc1 X1_CAL
    s_mov_b64 exec, -1
    s_cmp_gt_u32 s65, s64
    s_cselect_b32 s6, 0x101, 1
    s_cmp_gt_u32 s67, s66
    s_cselect_b32 s7, 0x200, 0
    s_add_u32 s33, s6, s7
    v_mov_b32 v3, 236
    v_mov_b32 v2, s33
    s_mov_b64 exec, 1
    buffer_atomic_add v2, v3, s[24:27], 0 offen sc1
    s_mov_b64 exec, -1
X1_CD:
    s_barrier
    s_branch X1_GO
X1_Q:
    s_mov_b32 s16, s46
    s_and_b32 s17, s47, 0xffff
    s_mov_b32 s18, 7864320
    s_mov_b32 s19, 0x20000
    s_mov_b32 s20, s44
    s_and_b32 s21, s45, 0xffff
    s_mov_b32 s22, 10240
    s_mov_b32 s23, 0x20000
    s_mov_b32 s68, 83886080
    s_mov_b32 s90, 12378112
    s_cmp_lg_u32 s4, 160
    s_cbranch_scc1 X1_GO
    s_mul_i32 s6, s3, 20
    s_lshl_b32 s7, s3, 14
    s_add_u32 s7, s7, 5120
    s_add_u32 s33, s7, 8192
    v_bfe_u32 v9, v0, 2, 3
    v_mul_u32_u24 v9, 1280, v9
    v_and_b32 v10, 3, v0
    v_lshl_add_u32 v9, v10, 3, v9
    v_lshrrev_b32 v10, 5, v0
    v_lshl_add_u32 v9, v10, 2, v9
    s_lshl_b32 s6, s6, 4
    v_add_u32 v9, s6, v9
    v_lshlrev_b32 v10, 2, v0
    buffer_load_dword v12, v9, s[20:23], 0 offen offset:0
    buffer_load_dword v13, v9, s[20:23], 0 offen offset:32
    buffer_load_dword v14, v9, s[20:23], 0 offen offset:64
    buffer_load_dword v15, v9, s[20:23], 0 offen offset:96
    buffer_load_dword v16, v9, s[20:23], 0 offen offset:128
    buffer_load_dword v17, v9, s[20:23], 0 offen offset:160
    buffer_load_dword v18, v9, s[20:23], 0 offen offset:192
    buffer_load_dword v19, v9, s[20:23], 0 offen offset:224
    buffer_load_dword v20, v9, s[20:23], 0 offen offset:256
    buffer_load_dword v21, v9, s[20:23], 0 offen offset:288
    s_waitcnt vmcnt(0)
    v_min_u32 v12, -2, v12
    buffer_store_dword v12, v10, s[8:11], s7 offen offset:0 sc1
    buffer_store_dword v12, v10, s[8:11], s33 offen offset:0 sc1
    v_min_u32 v13, -2, v13
    buffer_store_dword v13, v10, s[8:11], s7 offen offset:256 sc1
    buffer_store_dword v13, v10, s[8:11], s33 offen offset:256 sc1
    v_min_u32 v14, -2, v14
    buffer_store_dword v14, v10, s[8:11], s7 offen offset:512 sc1
    buffer_store_dword v14, v10, s[8:11], s33 offen offset:512 sc1
    v_min_u32 v15, -2, v15
    buffer_store_dword v15, v10, s[8:11], s7 offen offset:768 sc1
    buffer_store_dword v15, v10, s[8:11], s33 offen offset:768 sc1
    v_min_u32 v16, -2, v16
    buffer_store_dword v16, v10, s[8:11], s7 offen offset:1024 sc1
    buffer_store_dword v16, v10, s[8:11], s33 offen offset:1024 sc1
    v_min_u32 v17, -2, v17
    buffer_store_dword v17, v10, s[8:11], s7 offen offset:1280 sc1
    buffer_store_dword v17, v10, s[8:11], s33 offen offset:1280 sc1
    v_min_u32 v18, -2, v18
    buffer_store_dword v18, v10, s[8:11], s7 offen offset:1536 sc1
    buffer_store_dword v18, v10, s[8:11], s33 offen offset:1536 sc1
    v_min_u32 v19, -2, v19
    buffer_store_dword v19, v10, s[8:11], s7 offen offset:1792 sc1
    buffer_store_dword v19, v10, s[8:11], s33 offen offset:1792 sc1
    v_min_u32 v20, -2, v20
    buffer_store_dword v20, v10, s[8:11], s7 offen offset:2048 sc1
    buffer_store_dword v20, v10, s[8:11], s33 offen offset:2048 sc1
    v_min_u32 v21, -2, v21
    buffer_store_dword v21, v10, s[8:11], s7 offen offset:2304 sc1
    buffer_store_dword v21, v10, s[8:11], s33 offen offset:2304 sc1
    s_waitcnt vmcnt(0)
X1_GO:
    v_lshrrev_b32 v2, 3, v0
    s_lshl_b32 s6, s3, 3
    v_add_u32 v2, s6, v2
    v_bfe_u32 v3, v2, 1, 3
    v_and_b32 v8, 7, v0
    v_xor_b32 v3, v3, v8
    v_mul_u32_u24 v2, 1280, v2
    v_lshl_add_u32 v4, v3, 4, v2
    v_bfe_u32 v2, v0, 1, 3
    v_lshrrev_b32 v3, 4, v0
    v_xor_b32 v2, v2, v3
    v_lshlrev_b32 v8, 7, v8
    v_lshl_add_u32 v8, v2, 4, v8
    v_bfe_u32 v2, v0, 3, 1
    v_mul_u32_u24 v2, 10240, v2
    v_add_u32 v8, v8, v2
    v_add_u32 v8, 122880, v8
    v_xor_b32 v5, 64, v8
    s_mul_i32 s70, s3, 10240
    s_add_u32 s71, s70, 122880
    s_add_u32 s70, s70, 81920
    s_mov_b32 s69, 0
    s_add_u32 m0, s71, 0
    s_nop 0
    buffer_load_dwordx4 v4, s[12:15], s69 offen offset:0 lds
    s_add_u32 m0, s71, 896
    s_nop 0
    buffer_load_dwordx4 v4, s[12:15], s69 offen offset:128 lds
    s_add_u32 m0, s71, 1792
    s_nop 0
    buffer_load_dwordx4 v4, s[12:15], s69 offen offset:256 lds
    s_add_u32 m0, s71, 2688
    s_nop 0
    buffer_load_dwordx4 v4, s[12:15], s69 offen offset:384 lds
    s_add_u32 m0, s71, 3584
    s_nop 0
    buffer_load_dwordx4 v4, s[12:15], s69 offen offset:512 lds
    s_add_u32 m0, s71, 4480
    s_nop 0
    buffer_load_dwordx4 v4, s[12:15], s69 offen offset:640 lds
    s_add_u32 m0, s71, 5376
    s_nop 0
    buffer_load_dwordx4 v4, s[12:15], s69 offen offset:768 lds
    s_add_u32 m0, s71, 6272
    s_nop 0
    buffer_load_dwordx4 v4, s[12:15], s69 offen offset:896 lds
    s_add_u32 m0, s71, 7168
    s_nop 0
    buffer_load_dwordx4 v4, s[12:15], s69 offen offset:1024 lds
    s_add_u32 m0, s71, 8064
    s_nop 0
    buffer_load_dwordx4 v4, s[12:15], s69 offen offset:1152 lds
    s_mul_i32 s6, s5, 384
    s_mul_i32 s7, s3, 96
    s_add_u32 s6, s6, s7
    s_mov_b32 s7, 43691
    s_movk_i32 s33, 0x3000
    v_add_u32 v26, 0, v0
    v_mul_lo_u32 v20, v26, s7
    v_lshrrev_b32 v20, 18, v20
    v_mul_u32_u24 v2, 6, v20
    v_sub_u32 v26, v26, v2
    v_and_b32 v2, 0x33, v20
    v_and_b32 v3, 4, v20
    v_lshl_or_b32 v2, v3, 1, v2
    v_and_b32 v3, 8, v20
    v_lshrrev_b32 v3, 1, v3
    v_or_b32 v2, v2, v3
    v_mul_lo_u32 v20, v2, s33
    v_lshl_add_u32 v20, v26, 4, v20
    v_add_u32 v20, s6, v20
    v_add_u32 v26, 64, v0
    v_mul_lo_u32 v21, v26, s7
    v_lshrrev_b32 v21, 18, v21
    v_mul_u32_u24 v2, 6, v21
    v_sub_u32 v26, v26, v2
    v_and_b32 v2, 0x33, v21
    v_and_b32 v3, 4, v21
    v_lshl_or_b32 v2, v3, 1, v2
    v_and_b32 v3, 8, v21
    v_lshrrev_b32 v3, 1, v3
    v_or_b32 v2, v2, v3
    v_mul_lo_u32 v21, v2, s33
    v_lshl_add_u32 v21, v26, 4, v21
    v_add_u32 v21, s6, v21
    v_add_u32 v26, 128, v0
    v_mul_lo_u32 v22, v26, s7
    v_lshrrev_b32 v22, 18, v22
    v_mul_u32_u24 v2, 6, v22
    v_sub_u32 v26, v26, v2
    v_and_b32 v2, 0x33, v22
    v_and_b32 v3, 4, v22
    v_lshl_or_b32 v2, v3, 1, v2
    v_and_b32 v3, 8, v22
    v_lshrrev_b32 v3, 1, v3
    v_or_b32 v2, v2, v3
    v_mul_lo_u32 v22, v2, s33
    v_lshl_add_u32 v22, v26, 4, v22
    v_add_u32 v22, s6, v22
    v_add_u32 v26, 192, v0
    v_mul_lo_u32 v23, v26, s7
    v_lshrrev_b32 v23, 18, v23
    v_mul_u32_u24 v2, 6, v23
    v_sub_u32 v26, v26, v2
    v_and_b32 v2, 0x33, v23
    v_and_b32 v3, 4, v23
    v_lshl_or_b32 v2, v3, 1, v2
    v_and_b32 v3, 8, v23
    v_lshrrev_b32 v3, 1, v3
    v_or_b32 v2, v2, v3
    v_mul_lo_u32 v23, v2, s33
    v_lshl_add_u32 v23, v26, 4, v23
    v_add_u32 v23, s6, v23
    v_add_u32 v26, 256, v0
    v_mul_lo_u32 v24, v26, s7
    v_lshrrev_b32 v24, 18, v24
    v_mul_u32_u24 v2, 6, v24
    v_sub_u32 v26, v26, v2
    v_and_b32 v2, 0x33, v24
    v_and_b32 v3, 4, v24
    v_lshl_or_b32 v2, v3, 1, v2
    v_and_b32 v3, 8, v24
    v_lshrrev_b32 v3, 1, v3
    v_or_b32 v2, v2, v3
    v_mul_lo_u32 v24, v2, s33
    v_lshl_add_u32 v24, v26, 4, v24
    v_add_u32 v24, s6, v24
    v_add_u32 v26, 320, v0
    v_mul_lo_u32 v25, v26, s7
    v_lshrrev_b32 v25, 18, v25
    v_mul_u32_u24 v2, 6, v25
    v_sub_u32 v26, v26, v2
    v_and_b32 v2, 0x33, v25
    v_and_b32 v3, 4, v25
    v_lshl_or_b32 v2, v3, 1, v2
    v_and_b32 v3, 8, v25
    v_lshrrev_b32 v3, 1, v3
    v_or_b32 v2, v2, v3
    v_mul_lo_u32 v25, v2, s33
    v_lshl_add_u32 v25, v26, 4, v25
    v_add_u32 v25, s6, v25
    v_lshrrev_b32 v2, 5, v0
    v_lshlrev_b32 v2, 4, v2
    v_bfe_u32 v3, v0, 2, 3
    v_add_u32 v2, v2, v3
    v_mul_u32_u24 v2, 96, v2
    v_and_b32 v3, 3, v0
    v_lshl_add_u32 v26, v3, 3, v2
    s_and_b32 s72, s4, 63
    s_lshl_b32 s72, s72, 2
    s_add_u32 s72, s72, s3
    v_lshlrev_b32 v32, 4, v0
    v_mov_b64 v[28:29], -1
    v_mov_b64 v[30:31], -1
    s_lshl_b32 s6, s72, 8
    s_add_u32 s6, s6, 12345344
    v_lshlrev_b32 v33, 2, v0
    buffer_store_dword v28, v33, s[8:11], s6 offen sc1
    s_lshl_b32 s7, s72, 10
    s_and_b32 s6, s72, 0xc7
    s_sub_u32 s6, s6, 5
    s_cmp_lt_u32 s6, 3
    s_cselect_b32 s7, 4194304, s7
    buffer_store_dwordx4 v[28:31], v32, s[8:11], s7 offen sc1
    s_lshl_b32 s7, s72, 10
    s_add_u32 s7, s7, 9437184
    buffer_store_dwordx4 v[28:31], v32, s[8:11], s7 offen sc1
    s_lshl_b32 s73, s72, 8
    s_add_u32 s73, s73, 0x20000
    s_mul_i32 s74, s72, 160
    s_add_u32 s74, s74, 9723904
    v_mov_b32 v10, -1
    v_lshlrev_b32 v11, 2, v0
    v_mov_b32 v12, 1073741824
    v_cmp_gt_u32 vcc, 40, v0
    s_nop 1
    v_cndmask_b32 v12, v12, v11, vcc
    s_mov_b32 s20, s50
    s_and_b32 s21, s51, 0xffff
    s_mov_b32 s22, 7864320
    s_mov_b32 s23, 0x20000
    s_lshr_b32 s6, s72, 6
    s_mul_i32 s6, s6, 1966080
    s_and_b32 s7, s72, 63
    s_mul_i32 s7, s7, 6144
    s_add_u32 s6, s6, s7
    s_add_u32 s7, s6, 786432
    buffer_load_dwordx4 v[36:39], v32, s[20:23], s7 offen offset:0
    buffer_load_dwordx4 v[36:39], v32, s[20:23], s7 offen offset:1024
    buffer_load_dwordx4 v[36:39], v32, s[20:23], s7 offen offset:2048
    s_add_u32 s7, s6, 789504
    buffer_load_dwordx4 v[36:39], v32, s[20:23], s7 offen offset:0
    buffer_load_dwordx4 v[36:39], v32, s[20:23], s7 offen offset:1024
    buffer_load_dwordx4 v[36:39], v32, s[20:23], s7 offen offset:2048
    s_add_u32 s7, s6, 1179648
    buffer_load_dwordx4 v[36:39], v32, s[20:23], s7 offen offset:0
    buffer_load_dwordx4 v[36:39], v32, s[20:23], s7 offen offset:1024
    buffer_load_dwordx4 v[36:39], v32, s[20:23], s7 offen offset:2048
    s_add_u32 s7, s6, 1182720
    buffer_load_dwordx4 v[36:39], v32, s[20:23], s7 offen offset:0
    buffer_load_dwordx4 v[36:39], v32, s[20:23], s7 offen offset:1024
    buffer_load_dwordx4 v[36:39], v32, s[20:23], s7 offen offset:2048
    s_add_u32 s7, s6, 1572864
    buffer_load_dwordx4 v[36:39], v32, s[20:23], s7 offen offset:0
    buffer_load_dwordx4 v[36:39], v32, s[20:23], s7 offen offset:1024
    buffer_load_dwordx4 v[36:39], v32, s[20:23], s7 offen offset:2048
    s_add_u32 s7, s6, 1575936
    buffer_load_dwordx4 v[36:39], v32, s[20:23], s7 offen offset:0
    buffer_load_dwordx4 v[36:39], v32, s[20:23], s7 offen offset:1024
    buffer_load_dwordx4 v[36:39], v32, s[20:23], s7 offen offset:2048
    s_mul_i32 s34, s3, 6144
    s_mov_b32 s33, 0
    s_add_u32 m0, s34, 0
    s_nop 0
    buffer_load_dwordx4 v20, s[16:19], s33 offen lds
    s_add_u32 m0, s34, 1024
    s_nop 0
    buffer_load_dwordx4 v21, s[16:19], s33 offen lds
    s_add_u32 m0, s34, 2048
    s_nop 0
    buffer_load_dwordx4 v22, s[16:19], s33 offen lds
    s_add_u32 m0, s34, 3072
    s_nop 0
    buffer_load_dwordx4 v23, s[16:19], s33 offen lds
    s_add_u32 m0, s34, 4096
    s_nop 0
    buffer_load_dwordx4 v24, s[16:19], s33 offen lds
    s_add_u32 m0, s34, 5120
    s_nop 0
    buffer_load_dwordx4 v25, s[16:19], s33 offen lds
    s_mov_b32 s33, 786432
    s_add_u32 m0, s34, 24576
    s_nop 0
    buffer_load_dwordx4 v20, s[16:19], s33 offen lds
    s_add_u32 m0, s34, 25600
    s_nop 0
    buffer_load_dwordx4 v21, s[16:19], s33 offen lds
    s_add_u32 m0, s34, 26624
    s_nop 0
    buffer_load_dwordx4 v22, s[16:19], s33 offen lds
    s_add_u32 m0, s34, 27648
    s_nop 0
    buffer_load_dwordx4 v23, s[16:19], s33 offen lds
    s_add_u32 m0, s34, 28672
    s_nop 0
    buffer_load_dwordx4 v24, s[16:19], s33 offen lds
    s_add_u32 m0, s34, 29696
    s_nop 0
    buffer_load_dwordx4 v25, s[16:19], s33 offen lds
    s_mov_b32 s33, 1572864
    s_add_u32 m0, s34, 49152
    s_nop 0
    buffer_load_dwordx4 v20, s[16:19], s33 offen lds
    s_add_u32 m0, s34, 50176
    s_nop 0
    buffer_load_dwordx4 v21, s[16:19], s33 offen lds
    s_add_u32 m0, s34, 51200
    s_nop 0
    buffer_load_dwordx4 v22, s[16:19], s33 offen lds
    s_add_u32 m0, s34, 52224
    s_nop 0
    buffer_load_dwordx4 v23, s[16:19], s33 offen lds
    s_add_u32 m0, s34, 53248
    s_nop 0
    buffer_load_dwordx4 v24, s[16:19], s33 offen lds
    s_add_u32 m0, s34, 54272
    s_nop 0
    buffer_load_dwordx4 v25, s[16:19], s33 offen lds
    s_mov_b32 s33, 2359296
    s_add_u32 m0, s34, 73728
    s_nop 0
    buffer_load_dwordx4 v20, s[16:19], s33 offen lds
    s_add_u32 m0, s34, 74752
    s_nop 0
    buffer_load_dwordx4 v21, s[16:19], s33 offen lds
    s_add_u32 m0, s34, 75776
    s_nop 0
    buffer_load_dwordx4 v22, s[16:19], s33 offen lds
    s_add_u32 m0, s34, 76800
    s_nop 0
    buffer_load_dwordx4 v23, s[16:19], s33 offen lds
    s_add_u32 m0, s34, 77824
    s_nop 0
    buffer_load_dwordx4 v24, s[16:19], s33 offen lds
    s_add_u32 m0, s34, 78848
    s_nop 0
    buffer_load_dwordx4 v25, s[16:19], s33 offen lds
    s_mov_b32 s33, 3145728
    s_add_u32 m0, s34, 98304
    s_nop 0
    buffer_load_dwordx4 v20, s[16:19], s33 offen lds
    s_add_u32 m0, s34, 99328
    s_nop 0
    buffer_load_dwordx4 v21, s[16:19], s33 offen lds
    s_add_u32 m0, s34, 100352
    s_nop 0
    buffer_load_dwordx4 v22, s[16:19], s33 offen lds
    s_add_u32 m0, s34, 101376
    s_nop 0
    buffer_load_dwordx4 v23, s[16:19], s33 offen lds
    s_add_u32 m0, s34, 102400
    s_nop 0
    buffer_load_dwordx4 v24, s[16:19], s33 offen lds
    s_add_u32 m0, s34, 103424
    s_nop 0
    buffer_load_dwordx4 v25, s[16:19], s33 offen lds
    s_waitcnt vmcnt(24)
    s_add_u32 s6, s34, 0
    v_add_u32 v27, s6, v26
    ds_read_b64_tr_b16 a[0:1], v27 offset:0
    ds_read_b64_tr_b16 a[2:3], v27 offset:768
    ds_read_b64_tr_b16 a[4:5], v27 offset:3072
    ds_read_b64_tr_b16 a[6:7], v27 offset:3840
    ds_read_b64_tr_b16 a[8:9], v27 offset:32
    ds_read_b64_tr_b16 a[10:11], v27 offset:800
    ds_read_b64_tr_b16 a[12:13], v27 offset:3104
    ds_read_b64_tr_b16 a[14:15], v27 offset:3872
    ds_read_b64_tr_b16 a[16:17], v27 offset:64
    ds_read_b64_tr_b16 a[18:19], v27 offset:832
    ds_read_b64_tr_b16 a[20:21], v27 offset:3136
    ds_read_b64_tr_b16 a[22:23], v27 offset:3904
    s_waitcnt lgkmcnt(0)
    s_mov_b32 s33, 3932160
    s_add_u32 m0, s34, 0
    s_nop 0
    buffer_load_dwordx4 v20, s[16:19], s33 offen lds
    s_add_u32 m0, s34, 1024
    s_nop 0
    buffer_load_dwordx4 v21, s[16:19], s33 offen lds
    s_add_u32 m0, s34, 2048
    s_nop 0
    buffer_load_dwordx4 v22, s[16:19], s33 offen lds
    s_add_u32 m0, s34, 3072
    s_nop 0
    buffer_load_dwordx4 v23, s[16:19], s33 offen lds
    s_add_u32 m0, s34, 4096
    s_nop 0
    buffer_load_dwordx4 v24, s[16:19], s33 offen lds
    s_add_u32 m0, s34, 5120
    s_nop 0
    buffer_load_dwordx4 v25, s[16:19], s33 offen lds
    s_waitcnt vmcnt(24)
    s_add_u32 s6, s34, 24576
    v_add_u32 v27, s6, v26
    ds_read_b64_tr_b16 a[24:25], v27 offset:0
    ds_read_b64_tr_b16 a[26:27], v27 offset:768
    ds_read_b64_tr_b16 a[28:29], v27 offset:3072
    ds_read_b64_tr_b16 a[30:31], v27 offset:3840
    ds_read_b64_tr_b16 a[32:33], v27 offset:32
    ds_read_b64_tr_b16 a[34:35], v27 offset:800
    ds_read_b64_tr_b16 a[36:37], v27 offset:3104
    ds_read_b64_tr_b16 a[38:39], v27 offset:3872
    ds_read_b64_tr_b16 a[40:41], v27 offset:64
    ds_read_b64_tr_b16 a[42:43], v27 offset:832
    ds_read_b64_tr_b16 a[44:45], v27 offset:3136
    ds_read_b64_tr_b16 a[46:47], v27 offset:3904
    s_waitcnt lgkmcnt(0)
    s_mov_b32 s33, 4718592
    s_add_u32 m0, s34, 24576
    s_nop 0
    buffer_load_dwordx4 v20, s[16:19], s33 offen lds
    s_add_u32 m0, s34, 25600
    s_nop 0
    buffer_load_dwordx4 v21, s[16:19], s33 offen lds
    s_add_u32 m0, s34, 26624
    s_nop 0
    buffer_load_dwordx4 v22, s[16:19], s33 offen lds
    s_add_u32 m0, s34, 27648
    s_nop 0
    buffer_load_dwordx4 v23, s[16:19], s33 offen lds
    s_add_u32 m0, s34, 28672
    s_nop 0
    buffer_load_dwordx4 v24, s[16:19], s33 offen lds
    s_add_u32 m0, s34, 29696
    s_nop 0
    buffer_load_dwordx4 v25, s[16:19], s33 offen lds
    s_waitcnt vmcnt(24)
    s_add_u32 s6, s34, 49152
    v_add_u32 v27, s6, v26
    ds_read_b64_tr_b16 a[48:49], v27 offset:0
    ds_read_b64_tr_b16 a[50:51], v27 offset:768
    ds_read_b64_tr_b16 a[52:53], v27 offset:3072
    ds_read_b64_tr_b16 a[54:55], v27 offset:3840
    ds_read_b64_tr_b16 a[56:57], v27 offset:32
    ds_read_b64_tr_b16 a[58:59], v27 offset:800
    ds_read_b64_tr_b16 a[60:61], v27 offset:3104
    ds_read_b64_tr_b16 a[62:63], v27 offset:3872
    ds_read_b64_tr_b16 a[64:65], v27 offset:64
    ds_read_b64_tr_b16 a[66:67], v27 offset:832
    ds_read_b64_tr_b16 a[68:69], v27 offset:3136
    ds_read_b64_tr_b16 a[70:71], v27 offset:3904
    s_waitcnt lgkmcnt(0)
    s_mov_b32 s33, 5505024
    s_add_u32 m0, s34, 49152
    s_nop 0
    buffer_load_dwordx4 v20, s[16:19], s33 offen lds
    s_add_u32 m0, s34, 50176
    s_nop 0
    buffer_load_dwordx4 v21, s[16:19], s33 offen lds
    s_add_u32 m0, s34, 51200
    s_nop 0
    buffer_load_dwordx4 v22, s[16:19], s33 offen lds
    s_add_u32 m0, s34, 52224
    s_nop 0
    buffer_load_dwordx4 v23, s[16:19], s33 offen lds
    s_add_u32 m0, s34, 53248
    s_nop 0
    buffer_load_dwordx4 v24, s[16:19], s33 offen lds
    s_add_u32 m0, s34, 54272
    s_nop 0
    buffer_load_dwordx4 v25, s[16:19], s33 offen lds
    s_waitcnt vmcnt(24)
    s_add_u32 s6, s34, 73728
    v_add_u32 v27, s6, v26
    ds_read_b64_tr_b16 a[72:73], v27 offset:0
    ds_read_b64_tr_b16 a[74:75], v27 offset:768
    ds_read_b64_tr_b16 a[76:77], v27 offset:3072
    ds_read_b64_tr_b16 a[78:79], v27 offset:3840
    ds_read_b64_tr_b16 a[80:81], v27 offset:32
    ds_read_b64_tr_b16 a[82:83], v27 offset:800
    ds_read_b64_tr_b16 a[84:85], v27 offset:3104
    ds_read_b64_tr_b16 a[86:87], v27 offset:3872
    ds_read_b64_tr_b16 a[88:89], v27 offset:64
    ds_read_b64_tr_b16 a[90:91], v27 offset:832
    ds_read_b64_tr_b16 a[92:93], v27 offset:3136
    ds_read_b64_tr_b16 a[94:95], v27 offset:3904
    s_waitcnt lgkmcnt(0)
    s_mov_b32 s33, 6291456
    s_add_u32 m0, s34, 73728
    s_nop 0
    buffer_load_dwordx4 v20, s[16:19], s33 offen lds
    s_add_u32 m0, s34, 74752
    s_nop 0
    buffer_load_dwordx4 v21, s[16:19], s33 offen lds
    s_add_u32 m0, s34, 75776
    s_nop 0
    buffer_load_dwordx4 v22, s[16:19], s33 offen lds
    s_add_u32 m0, s34, 76800
    s_nop 0
    buffer_load_dwordx4 v23, s[16:19], s33 offen lds
    s_add_u32 m0, s34, 77824
    s_nop 0
    buffer_load_dwordx4 v24, s[16:19], s33 offen lds
    s_add_u32 m0, s34, 78848
    s_nop 0
    buffer_load_dwordx4 v25, s[16:19], s33 offen lds
    s_waitcnt vmcnt(24)
    s_add_u32 s6, s34, 98304
    v_add_u32 v27, s6, v26
    ds_read_b64_tr_b16 a[96:97], v27 offset:0
    ds_read_b64_tr_b16 a[98:99], v27 offset:768
    ds_read_b64_tr_b16 a[100:101], v27 offset:3072
    ds_read_b64_tr_b16 a[102:103], v27 offset:3840
    ds_read_b64_tr_b16 a[104:105], v27 offset:32
    ds_read_b64_tr_b16 a[106:107], v27 offset:800
    ds_read_b64_tr_b16 a[108:109], v27 offset:3104
    ds_read_b64_tr_b16 a[110:111], v27 offset:3872
    ds_read_b64_tr_b16 a[112:113], v27 offset:64
    ds_read_b64_tr_b16 a[114:115], v27 offset:832
    ds_read_b64_tr_b16 a[116:117], v27 offset:3136
    ds_read_b64_tr_b16 a[118:119], v27 offset:3904
    s_waitcnt lgkmcnt(0)
    s_mov_b32 s33, 7077888
    s_add_u32 m0, s34, 98304
    s_nop 0
    buffer_load_dwordx4 v20, s[16:19], s33 offen lds
    s_add_u32 m0, s34, 99328
    s_nop 0
    buffer_load_dwordx4 v21, s[16:19], s33 offen lds
    s_add_u32 m0, s34, 100352
    s_nop 0
    buffer_load_dwordx4 v22, s[16:19], s33 offen lds
    s_add_u32 m0, s34, 101376
    s_nop 0
    buffer_load_dwordx4 v23, s[16:19], s33 offen lds
    s_add_u32 m0, s34, 102400
    s_nop 0
    buffer_load_dwordx4 v24, s[16:19], s33 offen lds
    s_add_u32 m0, s34, 103424
    s_nop 0
    buffer_load_dwordx4 v25, s[16:19], s33 offen lds
    s_waitcnt vmcnt(24)
    s_add_u32 s6, s34, 0
    v_add_u32 v27, s6, v26
    ds_read_b64_tr_b16 a[120:121], v27 offset:0
    ds_read_b64_tr_b16 a[122:123], v27 offset:768
    ds_read_b64_tr_b16 a[124:125], v27 offset:3072
    ds_read_b64_tr_b16 a[126:127], v27 offset:3840
    ds_read_b64_tr_b16 a[128:129], v27 offset:32
    ds_read_b64_tr_b16 a[130:131], v27 offset:800
    ds_read_b64_tr_b16 a[132:133], v27 offset:3104
    ds_read_b64_tr_b16 a[134:135], v27 offset:3872
    ds_read_b64_tr_b16 a[136:137], v27 offset:64
    ds_read_b64_tr_b16 a[138:139], v27 offset:832
    ds_read_b64_tr_b16 a[140:141], v27 offset:3136
    ds_read_b64_tr_b16 a[142:143], v27 offset:3904
    s_waitcnt lgkmcnt(0)
    s_waitcnt vmcnt(18)
    s_add_u32 s6, s34, 24576
    v_add_u32 v27, s6, v26
    ds_read_b64_tr_b16 a[144:145], v27 offset:0
    ds_read_b64_tr_b16 a[146:147], v27 offset:768
    ds_read_b64_tr_b16 a[148:149], v27 offset:3072
    ds_read_b64_tr_b16 a[150:151], v27 offset:3840
    ds_read_b64_tr_b16 a[152:153], v27 offset:32
    ds_read_b64_tr_b16 a[154:155], v27 offset:800
    ds_read_b64_tr_b16 a[156:157], v27 offset:3104
    ds_read_b64_tr_b16 a[158:159], v27 offset:3872
    ds_read_b64_tr_b16 a[160:161], v27 offset:64
    ds_read_b64_tr_b16 a[162:163], v27 offset:832
    ds_read_b64_tr_b16 a[164:165], v27 offset:3136
    ds_read_b64_tr_b16 a[166:167], v27 offset:3904
    s_waitcnt lgkmcnt(0)
    s_waitcnt vmcnt(12)
    s_add_u32 s6, s34, 49152
    v_add_u32 v27, s6, v26
    ds_read_b64_tr_b16 a[168:169], v27 offset:0
    ds_read_b64_tr_b16 a[170:171], v27 offset:768
    ds_read_b64_tr_b16 a[172:173], v27 offset:3072
    ds_read_b64_tr_b16 a[174:175], v27 offset:3840
    ds_read_b64_tr_b16 a[176:177], v27 offset:32
    ds_read_b64_tr_b16 a[178:179], v27 offset:800
    ds_read_b64_tr_b16 a[180:181], v27 offset:3104
    ds_read_b64_tr_b16 a[182:183], v27 offset:3872
    ds_read_b64_tr_b16 a[184:185], v27 offset:64
    ds_read_b64_tr_b16 a[186:187], v27 offset:832
    ds_read_b64_tr_b16 a[188:189], v27 offset:3136
    ds_read_b64_tr_b16 a[190:191], v27 offset:3904
    s_waitcnt lgkmcnt(0)
    s_waitcnt vmcnt(6)
    s_add_u32 s6, s34, 73728
    v_add_u32 v27, s6, v26
    ds_read_b64_tr_b16 a[192:193], v27 offset:0
    ds_read_b64_tr_b16 a[194:195], v27 offset:768
    ds_read_b64_tr_b16 a[196:197], v27 offset:3072
    ds_read_b64_tr_b16 a[198:199], v27 offset:3840
    ds_read_b64_tr_b16 a[200:201], v27 offset:32
    ds_read_b64_tr_b16 a[202:203], v27 offset:800
    ds_read_b64_tr_b16 a[204:205], v27 offset:3104
    ds_read_b64_tr_b16 a[206:207], v27 offset:3872
    ds_read_b64_tr_b16 a[208:209], v27 offset:64
    ds_read_b64_tr_b16 a[210:211], v27 offset:832
    ds_read_b64_tr_b16 a[212:213], v27 offset:3136
    ds_read_b64_tr_b16 a[214:215], v27 offset:3904
    s_waitcnt lgkmcnt(0)
    s_waitcnt vmcnt(0)
    s_add_u32 s6, s34, 98304
    v_add_u32 v27, s6, v26
    ds_read_b64_tr_b16 a[216:217], v27 offset:0
    ds_read_b64_tr_b16 a[218:219], v27 offset:768
    ds_read_b64_tr_b16 a[220:221], v27 offset:3072
    ds_read_b64_tr_b16 a[222:223], v27 offset:3840
    ds_read_b64_tr_b16 a[224:225], v27 offset:32
    ds_read_b64_tr_b16 a[226:227], v27 offset:800
    ds_read_b64_tr_b16 a[228:229], v27 offset:3104
    ds_read_b64_tr_b16 a[230:231], v27 offset:3872
    ds_read_b64_tr_b16 a[232:233], v27 offset:64
    ds_read_b64_tr_b16 a[234:235], v27 offset:832
    ds_read_b64_tr_b16 a[236:237], v27 offset:3136
    ds_read_b64_tr_b16 a[238:239], v27 offset:3904
    s_waitcnt lgkmcnt(0)
    s_waitcnt vmcnt(0)
    s_waitcnt vmcnt(0)
    s_barrier
    s_cmp_lg_u32 s3, 0
    s_cbranch_scc1 SG_3
    v_mov_b32 v3, 236
    v_mov_b32 v2, 1
    s_mov_b64 exec, 1
    buffer_atomic_add v2, v3, s[24:27], 0 offen sc1
    s_mov_b64 exec, -1
SG_3:
    s_lshl_b32 s6, s5, 2
    s_add_u32 s6, s6, s3
    s_mul_i32 s7, s6, 3072
    v_lshl_add_u32 v6, v0, 4, s7
    s_lshl_b32 s6, s6, 8
    v_mov_b32 v7, s6
    s_mov_b32 s72, -40960
    v_mov_b32 v9, 1
    s_mov_b32 s72, -40960
    s_mov_b32 s64, 0
X1_LOOP:
    s_barrier
    s_add_u32 s69, s69, 40960
    s_mov_b32 s6, s70
    s_mov_b32 s70, s71
    s_mov_b32 s71, s6
    ds_read_b128 v[32:35], v8 offset:0
    ds_read_b128 v[36:39], v8 offset:20480
    ds_read_b128 v[40:43], v5 offset:0
    ds_read_b128 v[44:47], v5 offset:20480
    ds_read_b128 v[48:51], v8 offset:1024
    ds_read_b128 v[52:55], v8 offset:21504
    s_waitcnt lgkmcnt(4)
    v_mfma_f32_16x16x32_bf16 v[64:67], a[0:3], v[32:35], 0
    v_mfma_f32_16x16x32_bf16 v[68:71], a[0:3], v[36:39], 0
    ds_read_b128 v[56:59], v5 offset:1024
    v_mfma_f32_16x16x32_bf16 v[72:75], a[8:11], v[32:35], 0
    ds_read_b128 v[60:63], v5 offset:21504
    v_mfma_f32_16x16x32_bf16 v[76:79], a[8:11], v[36:39], 0
    v_mfma_f32_16x16x32_bf16 v[80:83], a[16:19], v[32:35], 0
    s_add_u32 m0, s71, 0
    s_nop 0
    buffer_load_dwordx4 v4, s[12:15], s69 offen offset:0 lds
    v_mfma_f32_16x16x32_bf16 v[84:87], a[16:19], v[36:39], 0
    s_waitcnt lgkmcnt(4)
    v_mfma_f32_16x16x32_bf16 v[64:67], a[4:7], v[40:43], v[64:67]
    v_mfma_f32_16x16x32_bf16 v[68:71], a[4:7], v[44:47], v[68:71]
    ds_read_b128 v[32:35], v8 offset:2048
    v_mfma_f32_16x16x32_bf16 v[72:75], a[12:15], v[40:43], v[72:75]
    ds_read_b128 v[36:39], v8 offset:22528
    v_mfma_f32_16x16x32_bf16 v[76:79], a[12:15], v[44:47], v[76:79]
    v_mfma_f32_16x16x32_bf16 v[80:83], a[20:23], v[40:43], v[80:83]
    s_add_u32 m0, s71, 896
    s_nop 0
    buffer_load_dwordx4 v4, s[12:15], s69 offen offset:128 lds
    v_mfma_f32_16x16x32_bf16 v[84:87], a[20:23], v[44:47], v[84:87]
    s_waitcnt lgkmcnt(4)
    v_mfma_f32_16x16x32_bf16 v[64:67], a[24:27], v[48:51], v[64:67]
    v_mfma_f32_16x16x32_bf16 v[68:71], a[24:27], v[52:55], v[68:71]
    ds_read_b128 v[40:43], v5 offset:2048
    v_mfma_f32_16x16x32_bf16 v[72:75], a[32:35], v[48:51], v[72:75]
    ds_read_b128 v[44:47], v5 offset:22528
    v_mfma_f32_16x16x32_bf16 v[76:79], a[32:35], v[52:55], v[76:79]
    v_mfma_f32_16x16x32_bf16 v[80:83], a[40:43], v[48:51], v[80:83]
    s_add_u32 m0, s71, 1792
    s_nop 0
    buffer_load_dwordx4 v4, s[12:15], s69 offen offset:256 lds
    v_mfma_f32_16x16x32_bf16 v[84:87], a[40:43], v[52:55], v[84:87]
    s_waitcnt lgkmcnt(4)
    v_mfma_f32_16x16x32_bf16 v[64:67], a[28:31], v[56:59], v[64:67]
    v_mfma_f32_16x16x32_bf16 v[68:71], a[28:31], v[60:63], v[68:71]
    ds_read_b128 v[48:51], v8 offset:3072
    v_mfma_f32_16x16x32_bf16 v[72:75], a[36:39], v[56:59], v[72:75]
    ds_read_b128 v[52:55], v8 offset:23552
    v_mfma_f32_16x16x32_bf16 v[76:79], a[36:39], v[60:63], v[76:79]
    v_mfma_f32_16x16x32_bf16 v[80:83], a[44:47], v[56:59], v[80:83]
    s_add_u32 m0, s71, 2688
    s_nop 0
    buffer_load_dwordx4 v4, s[12:15], s69 offen offset:384 lds
    v_mfma_f32_16x16x32_bf16 v[84:87], a[44:47], v[60:63], v[84:87]
    s_waitcnt lgkmcnt(4)
    v_mfma_f32_16x16x32_bf16 v[64:67], a[48:51], v[32:35], v[64:67]
    v_mfma_f32_16x16x32_bf16 v[68:71], a[48:51], v[36:39], v[68:71]
    ds_read_b128 v[56:59], v5 offset:3072
    v_mfma_f32_16x16x32_bf16 v[72:75], a[56:59], v[32:35], v[72:75]
    ds_read_b128 v[60:63], v5 offset:23552
    v_mfma_f32_16x16x32_bf16 v[76:79], a[56:59], v[36:39], v[76:79]
    v_mfma_f32_16x16x32_bf16 v[80:83], a[64:67], v[32:35], v[80:83]
    s_add_u32 m0, s71, 3584
    s_nop 0
    buffer_load_dwordx4 v4, s[12:15], s69 offen offset:512 lds
    v_mfma_f32_16x16x32_bf16 v[84:87], a[64:67], v[36:39], v[84:87]
    s_waitcnt lgkmcnt(4)
    v_mfma_f32_16x16x32_bf16 v[64:67], a[52:55], v[40:43], v[64:67]
    v_mfma_f32_16x16x32_bf16 v[68:71], a[52:55], v[44:47], v[68:71]
    ds_read_b128 v[32:35], v8 offset:4096
    v_mfma_f32_16x16x32_bf16 v[72:75], a[60:63], v[40:43], v[72:75]
    ds_read_b128 v[36:39], v8 offset:24576
    v_mfma_f32_16x16x32_bf16 v[76:79], a[60:63], v[44:47], v[76:79]
    v_mfma_f32_16x16x32_bf16 v[80:83], a[68:71], v[40:43], v[80:83]
    s_add_u32 m0, s71, 4480
    s_nop 0
    buffer_load_dwordx4 v4, s[12:15], s69 offen offset:640 lds
    v_mfma_f32_16x16x32_bf16 v[84:87], a[68:71], v[44:47], v[84:87]
    s_waitcnt lgkmcnt(4)
    v_mfma_f32_16x16x32_bf16 v[64:67], a[72:75], v[48:51], v[64:67]
    v_mfma_f32_16x16x32_bf16 v[68:71], a[72:75], v[52:55], v[68:71]
    ds_read_b128 v[40:43], v5 offset:4096
    v_mfma_f32_16x16x32_bf16 v[72:75], a[80:83], v[48:51], v[72:75]
    ds_read_b128 v[44:47], v5 offset:24576
    v_mfma_f32_16x16x32_bf16 v[76:79], a[80:83], v[52:55], v[76:79]
    v_mfma_f32_16x16x32_bf16 v[80:83], a[88:91], v[48:51], v[80:83]
    s_add_u32 m0, s71, 5376
    s_nop 0
    buffer_load_dwordx4 v4, s[12:15], s69 offen offset:768 lds
    v_mfma_f32_16x16x32_bf16 v[84:87], a[88:91], v[52:55], v[84:87]
    s_waitcnt lgkmcnt(4)
    v_mfma_f32_16x16x32_bf16 v[64:67], a[76:79], v[56:59], v[64:67]
    v_mfma_f32_16x16x32_bf16 v[68:71], a[76:79], v[60:63], v[68:71]
    ds_read_b128 v[48:51], v8 offset:5120
    v_mfma_f32_16x16x32_bf16 v[72:75], a[84:87], v[56:59], v[72:75]
    ds_read_b128 v[52:55], v8 offset:25600
    v_mfma_f32_16x16x32_bf16 v[76:79], a[84:87], v[60:63], v[76:79]
    v_mfma_f32_16x16x32_bf16 v[80:83], a[92:95], v[56:59], v[80:83]
    s_add_u32 m0, s71, 6272
    s_nop 0
    buffer_load_dwordx4 v4, s[12:15], s69 offen offset:896 lds
    v_mfma_f32_16x16x32_bf16 v[84:87], a[92:95], v[60:63], v[84:87]
    s_waitcnt lgkmcnt(4)
    v_mfma_f32_16x16x32_bf16 v[64:67], a[96:99], v[32:35], v[64:67]
    v_mfma_f32_16x16x32_bf16 v[68:71], a[96:99], v[36:39], v[68:71]
    ds_read_b128 v[56:59], v5 offset:5120
    v_mfma_f32_16x16x32_bf16 v[72:75], a[104:107], v[32:35], v[72:75]
    ds_read_b128 v[60:63], v5 offset:25600
    v_mfma_f32_16x16x32_bf16 v[76:79], a[104:107], v[36:39], v[76:79]
    v_mfma_f32_16x16x32_bf16 v[80:83], a[112:115], v[32:35], v[80:83]
    s_add_u32 m0, s71, 7168
    s_nop 0
    buffer_load_dwordx4 v4, s[12:15], s69 offen offset:1024 lds
    v_mfma_f32_16x16x32_bf16 v[84:87], a[112:115], v[36:39], v[84:87]
    s_waitcnt lgkmcnt(4)
    v_mfma_f32_16x16x32_bf16 v[64:67], a[100:103], v[40:43], v[64:67]
    v_mfma_f32_16x16x32_bf16 v[68:71], a[100:103], v[44:47], v[68:71]
    ds_read_b128 v[32:35], v8 offset:6144
    v_mfma_f32_16x16x32_bf16 v[72:75], a[108:111], v[40:43], v[72:75]
    ds_read_b128 v[36:39], v8 offset:26624
    v_mfma_f32_16x16x32_bf16 v[76:79], a[108:111], v[44:47], v[76:79]
    v_mfma_f32_16x16x32_bf16 v[80:83], a[116:119], v[40:43], v[80:83]
    s_add_u32 m0, s71, 8064
    s_nop 0
    buffer_load_dwordx4 v4, s[12:15], s69 offen offset:1152 lds
    v_mfma_f32_16x16x32_bf16 v[84:87], a[116:119], v[44:47], v[84:87]
    s_waitcnt lgkmcnt(4)
    v_mfma_f32_16x16x32_bf16 v[64:67], a[120:123], v[48:51], v[64:67]
    v_mfma_f32_16x16x32_bf16 v[68:71], a[120:123], v[52:55], v[68:71]
    ds_read_b128 v[40:43], v5 offset:6144
    v_mfma_f32_16x16x32_bf16 v[72:75], a[128:131], v[48:51], v[72:75]
    ds_read_b128 v[44:47], v5 offset:26624
    v_mfma_f32_16x16x32_bf16 v[76:79], a[128:131], v[52:55], v[76:79]
    v_mfma_f32_16x16x32_bf16 v[80:83], a[136:139], v[48:51], v[80:83]
    v_mfma_f32_16x16x32_bf16 v[84:87], a[136:139], v[52:55], v[84:87]
    s_waitcnt lgkmcnt(4)
    v_mfma_f32_16x16x32_bf16 v[64:67], a[124:127], v[56:59], v[64:67]
    buffer_store_dword v10, v11, s[8:11], s73 offen sc1
    v_mfma_f32_16x16x32_bf16 v[68:71], a[124:127], v[60:63], v[68:71]
    ds_read_b128 v[48:51], v8 offset:7168
    v_mfma_f32_16x16x32_bf16 v[72:75], a[132:135], v[56:59], v[72:75]
    ds_read_b128 v[52:55], v8 offset:27648
    v_mfma_f32_16x16x32_bf16 v[76:79], a[132:135], v[60:63], v[76:79]
    s_add_u32 s73, s73, 0x10000
    v_mfma_f32_16x16x32_bf16 v[80:83], a[140:143], v[56:59], v[80:83]
    v_mfma_f32_16x16x32_bf16 v[84:87], a[140:143], v[60:63], v[84:87]
    s_waitcnt lgkmcnt(4)
    v_mfma_f32_16x16x32_bf16 v[64:67], a[144:147], v[32:35], v[64:67]
    buffer_store_dword v10, v12, s[8:11], s74 offen sc1
    v_mfma_f32_16x16x32_bf16 v[68:71], a[144:147], v[36:39], v[68:71]
    ds_read_b128 v[56:59], v5 offset:7168
    v_mfma_f32_16x16x32_bf16 v[72:75], a[152:155], v[32:35], v[72:75]
    ds_read_b128 v[60:63], v5 offset:27648
    v_mfma_f32_16x16x32_bf16 v[76:79], a[152:155], v[36:39], v[76:79]
    s_add_u32 s74, s74, 40960
    v_mfma_f32_16x16x32_bf16 v[80:83], a[160:163], v[32:35], v[80:83]
    v_mfma_f32_16x16x32_bf16 v[84:87], a[160:163], v[36:39], v[84:87]
    s_waitcnt lgkmcnt(4)
    v_mfma_f32_16x16x32_bf16 v[64:67], a[148:151], v[40:43], v[64:67]
    v_mfma_f32_16x16x32_bf16 v[68:71], a[148:151], v[44:47], v[68:71]
    ds_read_b128 v[32:35], v8 offset:8192
    v_mfma_f32_16x16x32_bf16 v[72:75], a[156:159], v[40:43], v[72:75]
    ds_read_b128 v[36:39], v8 offset:28672
    v_mfma_f32_16x16x32_bf16 v[76:79], a[156:159], v[44:47], v[76:79]
    v_mfma_f32_16x16x32_bf16 v[80:83], a[164:167], v[40:43], v[80:83]
    v_mfma_f32_16x16x32_bf16 v[84:87], a[164:167], v[44:47], v[84:87]
    s_waitcnt lgkmcnt(4)
    v_mfma_f32_16x16x32_bf16 v[64:67], a[168:171], v[48:51], v[64:67]
    v_mfma_f32_16x16x32_bf16 v[68:71], a[168:171], v[52:55], v[68:71]
    ds_read_b128 v[40:43], v5 offset:8192
    v_mfma_f32_16x16x32_bf16 v[72:75], a[176:179], v[48:51], v[72:75]
    ds_read_b128 v[44:47], v5 offset:28672
    v_mfma_f32_16x16x32_bf16 v[76:79], a[176:179], v[52:55], v[76:79]
    v_mfma_f32_16x16x32_bf16 v[80:83], a[184:187], v[48:51], v[80:83]
    v_mfma_f32_16x16x32_bf16 v[84:87], a[184:187], v[52:55], v[84:87]
    s_waitcnt lgkmcnt(4)
    v_mfma_f32_16x16x32_bf16 v[64:67], a[172:175], v[56:59], v[64:67]
    v_mfma_f32_16x16x32_bf16 v[68:71], a[172:175], v[60:63], v[68:71]
    ds_read_b128 v[48:51], v8 offset:9216
    v_mfma_f32_16x16x32_bf16 v[72:75], a[180:183], v[56:59], v[72:75]
    ds_read_b128 v[52:55], v8 offset:29696
    v_mfma_f32_16x16x32_bf16 v[76:79], a[180:183], v[60:63], v[76:79]
    v_mfma_f32_16x16x32_bf16 v[80:83], a[188:191], v[56:59], v[80:83]
    v_mfma_f32_16x16x32_bf16 v[84:87], a[188:191], v[60:63], v[84:87]
    s_waitcnt lgkmcnt(4)
    v_mfma_f32_16x16x32_bf16 v[64:67], a[192:195], v[32:35], v[64:67]
    v_mfma_f32_16x16x32_bf16 v[68:71], a[192:195], v[36:39], v[68:71]
    ds_read_b128 v[56:59], v5 offset:9216
    v_mfma_f32_16x16x32_bf16 v[72:75], a[200:203], v[32:35], v[72:75]
    ds_read_b128 v[60:63], v5 offset:29696
    v_mfma_f32_16x16x32_bf16 v[76:79], a[200:203], v[36:39], v[76:79]
    v_mfma_f32_16x16x32_bf16 v[80:83], a[208:211], v[32:35], v[80:83]
    v_mfma_f32_16x16x32_bf16 v[84:87], a[208:211], v[36:39], v[84:87]
    s_waitcnt lgkmcnt(4)
    v_mfma_f32_16x16x32_bf16 v[64:67], a[196:199], v[40:43], v[64:67]
    v_mfma_f32_16x16x32_bf16 v[68:71], a[196:199], v[44:47], v[68:71]
    v_mfma_f32_16x16x32_bf16 v[72:75], a[204:207], v[40:43], v[72:75]
    v_mfma_f32_16x16x32_bf16 v[76:79], a[204:207], v[44:47], v[76:79]
    v_mfma_f32_16x16x32_bf16 v[80:83], a[212:215], v[40:43], v[80:83]
    v_mfma_f32_16x16x32_bf16 v[84:87], a[212:215], v[44:47], v[84:87]
    s_waitcnt lgkmcnt(2)
    v_mfma_f32_16x16x32_bf16 v[64:67], a[216:219], v[48:51], v[64:67]
    v_mfma_f32_16x16x32_bf16 v[68:71], a[216:219], v[52:55], v[68:71]
    v_mfma_f32_16x16x32_bf16 v[72:75], a[224:227], v[48:51], v[72:75]
    v_mfma_f32_16x16x32_bf16 v[76:79], a[224:227], v[52:55], v[76:79]
    v_mfma_f32_16x16x32_bf16 v[80:83], a[232:235], v[48:51], v[80:83]
    v_mfma_f32_16x16x32_bf16 v[84:87], a[232:235], v[52:55], v[84:87]
    s_waitcnt lgkmcnt(0)
    v_mfma_f32_16x16x32_bf16 v[64:67], a[220:223], v[56:59], v[64:67]
    v_mfma_f32_16x16x32_bf16 v[68:71], a[220:223], v[60:63], v[68:71]
    v_mfma_f32_16x16x32_bf16 v[72:75], a[228:231], v[56:59], v[72:75]
    v_mfma_f32_16x16x32_bf16 v[76:79], a[228:231], v[60:63], v[76:79]
    v_mfma_f32_16x16x32_bf16 v[80:83], a[236:239], v[56:59], v[80:83]
    v_mfma_f32_16x16x32_bf16 v[84:87], a[236:239], v[60:63], v[84:87]
    s_nop 2
    v_cvt_pk_bf16_f32 v100, v64, v65
    v_cvt_pk_bf16_f32 v101, v66, v67
    v_cvt_pk_bf16_f32 v104, v68, v69
    v_cvt_pk_bf16_f32 v105, v70, v71
    v_cvt_pk_bf16_f32 v102, v72, v73
    v_cvt_pk_bf16_f32 v103, v74, v75
    v_cvt_pk_bf16_f32 v106, v76, v77
    v_cvt_pk_bf16_f32 v107, v78, v79
    v_cvt_pk_bf16_f32 v108, v80, v81
    v_cvt_pk_bf16_f32 v109, v82, v83
    v_cvt_pk_bf16_f32 v110, v84, v85
    v_cvt_pk_bf16_f32 v111, v86, v87
    buffer_store_dwordx4 v[100:103], v6, s[8:11], s68 offen offset:0 sc1
    buffer_store_dwordx4 v[104:107], v6, s[8:11], s68 offen offset:1024 sc1
    buffer_store_dwordx4 v[108:111], v6, s[8:11], s68 offen offset:2048 sc1
    v_add_u32 v8, s72, v8
    v_add_u32 v5, s72, v5
    s_sub_u32 s72, 0, s72
    s_waitcnt vmcnt(0)
    s_mov_b64 exec, 1
    buffer_store_dword v9, v7, s[8:11], s90 offen sc1
    s_mov_b64 exec, -1
    s_add_u32 s68, s68, 393216
    s_add_u32 s90, s90, 4
    s_add_u32 s64, s64, 1
    s_cmp_lt_u32 s64, 64
    s_cbranch_scc1 X1_LOOP
    s_waitcnt vmcnt(0)
    s_barrier
    s_cmp_lg_u32 s3, 0
    s_cbranch_scc1 SG_4
    v_mov_b32 v3, 204
    v_mov_b32 v2, 1
    s_mov_b64 exec, 1
    buffer_atomic_add v2, v3, s[24:27], 0 offen sc1
    s_mov_b64 exec, -1
SG_4:
    s_endpgm
L_PRO:
    s_and_b32 s64, s4, 31
    s_lshr_b32 s5, s4, 5
    s_lshl_b32 s5, s5, 1
    s_cmp_lt_u32 s4, 128
    s_cselect_b32 s6, 2, 11
    s_sub_u32 s65, s5, s6
    s_sub_u32 s5, s4, 32
    s_cmp_lt_u32 s4, 128
    s_cselect_b32 s6, 0, 64
    s_sub_u32 s5, s5, s6
    s_mul_i32 s64, s5, 52429
    s_lshr_b32 s64, s64, 18
    s_mul_i32 s6, s64, 5
    s_sub_u32 s65, s5, s6
    s_mov_b32 s16, s50
    s_and_b32 s17, s51, 0xffff
    s_mov_b32 s18, 7864320
    s_mov_b32 s19, 0x20000
    s_mov_b32 s20, s52
    s_and_b32 s21, s53, 0xffff
    s_mov_b32 s22, 7864320
    s_mov_b32 s23, 0x20000
    v_lshrrev_b32 v4, 4, v0
    v_bfe_u32 v5, v0, 1, 3
    v_xor_b32 v5, v5, v4
    v_and_b32 v6, 1, v0
    v_lshlrev_b32 v6, 4, v6
    v_mul_u32_u24 v7, 1280, v4
    v_add_u32 v7, v7, v6
    v_lshl_add_u32 v8, v5, 5, v7
    v_xor_b32 v5, 4, v5
    v_lshl_add_u32 v9, v5, 5, v7
    s_mul_i32 s66, s64, 245760
    s_lshl_b32 s6, s65, 8
    s_add_u32 s66, s66, s6
    s_mul_i32 s6, s3, 61440
    s_add_u32 s66, s66, s6
    s_mul_i32 s67, s3, 12288
    s_add_u32 m0, s67, 0
    s_add_u32 s6, s66, 0
    buffer_load_dwordx4 v8, s[20:23], s6 offen lds
    s_add_u32 m0, s67, 1024
    s_add_u32 s6, s66, 5120
    buffer_load_dwordx4 v8, s[20:23], s6 offen lds
    s_add_u32 m0, s67, 2048
    s_add_u32 s6, s66, 10240
    buffer_load_dwordx4 v9, s[20:23], s6 offen lds
    s_add_u32 m0, s67, 3072
    s_add_u32 s6, s66, 15360
    buffer_load_dwordx4 v9, s[20:23], s6 offen lds
    s_add_u32 m0, s67, 4096
    s_add_u32 s6, s66, 20480
    buffer_load_dwordx4 v8, s[20:23], s6 offen lds
    s_add_u32 m0, s67, 5120
    s_add_u32 s6, s66, 25600
    buffer_load_dwordx4 v8, s[20:23], s6 offen lds
    s_add_u32 m0, s67, 6144
    s_add_u32 s6, s66, 30720
    buffer_load_dwordx4 v9, s[20:23], s6 offen lds
    s_add_u32 m0, s67, 7168
    s_add_u32 s6, s66, 35840
    buffer_load_dwordx4 v9, s[20:23], s6 offen lds
    s_add_u32 m0, s67, 8192
    s_add_u32 s6, s66, 40960
    buffer_load_dwordx4 v8, s[20:23], s6 offen lds
    s_add_u32 m0, s67, 9216
    s_add_u32 s6, s66, 46080
    buffer_load_dwordx4 v8, s[20:23], s6 offen lds
    s_add_u32 m0, s67, 10240
    s_add_u32 s6, s66, 51200
    buffer_load_dwordx4 v9, s[20:23], s6 offen lds
    s_add_u32 m0, s67, 11264
    s_add_u32 s6, s66, 56320
    buffer_load_dwordx4 v9, s[20:23], s6 offen lds
    v_lshrrev_b32 v5, 5, v0
    v_bfe_u32 v6, v0, 3, 2
    v_lshl_add_u32 v5, v5, 3, v6
    s_movk_i32 s6, 0x3000
    v_mul_lo_u32 v5, v5, s6
    v_and_b32 v6, 7, v0
    v_xor_b32 v7, v6, v4
    v_lshl_add_u32 v10, v7, 4, v5
    v_xor_b32 v14, 64, v10
    v_add_u32 v14, 196608, v14
    v_bfe_u32 v5, v0, 1, 3
    v_xor_b32 v5, v5, v4
    v_lshlrev_b32 v6, 7, v6
    v_lshl_add_u32 v6, v5, 4, v6
    v_bfe_u32 v5, v0, 3, 1
    v_mul_u32_u24 v5, 3072, v5
    v_add3_u32 v15, v5, v6, s67
    v_xor_b32 v48, 64, v15
    v_add_u32 v49, 98304, v15
    v_add_u32 v50, 98304, v48
    s_mul_i32 s68, s3, 1966080
    s_mul_i32 s6, s64, 384
    s_add_u32 s68, s68, s6
    s_add_u32 s6, s68, 0
    s_add_u32 m0, s67, 49152
    s_nop 0
    buffer_load_dwordx4 v10, s[16:19], s6 offen offset:0 lds
    s_add_u32 m0, s67, 50048
    s_nop 0
    buffer_load_dwordx4 v10, s[16:19], s6 offen offset:128 lds
    s_add_u32 m0, s67, 50944
    s_nop 0
    buffer_load_dwordx4 v10, s[16:19], s6 offen offset:256 lds
    s_add_u32 m0, s67, 52224
    s_nop 0
    buffer_load_dwordx4 v14, s[16:19], s6 offen offset:0 lds
    s_add_u32 m0, s67, 53120
    s_nop 0
    buffer_load_dwordx4 v14, s[16:19], s6 offen offset:128 lds
    s_add_u32 m0, s67, 54016
    s_nop 0
    buffer_load_dwordx4 v14, s[16:19], s6 offen offset:256 lds
    s_add_u32 s6, s68, 49152
    s_add_u32 m0, s67, 55296
    s_nop 0
    buffer_load_dwordx4 v10, s[16:19], s6 offen offset:0 lds
    s_add_u32 m0, s67, 56192
    s_nop 0
    buffer_load_dwordx4 v10, s[16:19], s6 offen offset:128 lds
    s_add_u32 m0, s67, 57088
    s_nop 0
    buffer_load_dwordx4 v10, s[16:19], s6 offen offset:256 lds
    s_add_u32 m0, s67, 58368
    s_nop 0
    buffer_load_dwordx4 v14, s[16:19], s6 offen offset:0 lds
    s_add_u32 m0, s67, 59264
    s_nop 0
    buffer_load_dwordx4 v14, s[16:19], s6 offen offset:128 lds
    s_add_u32 m0, s67, 60160
    s_nop 0
    buffer_load_dwordx4 v14, s[16:19], s6 offen offset:256 lds
    s_add_u32 s6, s68, 393216
    s_add_u32 m0, s67, 98304
    s_nop 0
    buffer_load_dwordx4 v10, s[16:19], s6 offen offset:0 lds
    s_add_u32 m0, s67, 99200
    s_nop 0
    buffer_load_dwordx4 v10, s[16:19], s6 offen offset:128 lds
    s_add_u32 m0, s67, 100096
    s_nop 0
    buffer_load_dwordx4 v10, s[16:19], s6 offen offset:256 lds
    s_add_u32 m0, s67, 101376
    s_nop 0
    buffer_load_dwordx4 v14, s[16:19], s6 offen offset:0 lds
    s_add_u32 m0, s67, 102272
    s_nop 0
    buffer_load_dwordx4 v14, s[16:19], s6 offen offset:128 lds
    s_add_u32 m0, s67, 103168
    s_nop 0
    buffer_load_dwordx4 v14, s[16:19], s6 offen offset:256 lds
    s_add_u32 s6, s68, 442368
    s_add_u32 m0, s67, 104448
    s_nop 0
    buffer_load_dwordx4 v10, s[16:19], s6 offen offset:0 lds
    s_add_u32 m0, s67, 105344
    s_nop 0
    buffer_load_dwordx4 v10, s[16:19], s6 offen offset:128 lds
    s_add_u32 m0, s67, 106240
    s_nop 0
    buffer_load_dwordx4 v10, s[16:19], s6 offen offset:256 lds
    s_add_u32 m0, s67, 107520
    s_nop 0
    buffer_load_dwordx4 v14, s[16:19], s6 offen offset:0 lds
    s_add_u32 m0, s67, 108416
    s_nop 0
    buffer_load_dwordx4 v14, s[16:19], s6 offen offset:128 lds
    s_add_u32 m0, s67, 109312
    s_nop 0
    buffer_load_dwordx4 v14, s[16:19], s6 offen offset:256 lds
    s_waitcnt vmcnt(24)
    s_barrier
    v_bfe_u32 v5, v0, 2, 2
    v_lshl_add_u32 v6, v4, 3, v5
    v_lshlrev_b32 v6, 8, v6
    v_and_b32 v7, 1, v4
    v_lshl_or_b32 v5, v7, 2, v5
    v_lshl_add_u32 v6, v5, 5, v6
    v_and_b32 v7, 3, v0
    v_lshl_add_u32 v11, v7, 3, v6
    v_xor_b32 v12, 0, v11
    ds_read_b64_tr_b16 v[64:65], v12 offset:0
    ds_read_b64_tr_b16 v[66:67], v12 offset:1024
    ds_read_b64_tr_b16 v[68:69], v12 offset:8192
    ds_read_b64_tr_b16 v[70:71], v12 offset:9216
    ds_read_b64_tr_b16 v[72:73], v12 offset:16384
    ds_read_b64_tr_b16 v[74:75], v12 offset:17408
    ds_read_b64_tr_b16 v[76:77], v12 offset:24576
    ds_read_b64_tr_b16 v[78:79], v12 offset:25600
    ds_read_b64_tr_b16 v[80:81], v12 offset:32768
    ds_read_b64_tr_b16 v[82:83], v12 offset:33792
    ds_read_b64_tr_b16 v[84:85], v12 offset:40960
    ds_read_b64_tr_b16 v[86:87], v12 offset:41984
    s_waitcnt lgkmcnt(0)
    v_xor_b32 v12, 32, v11
    ds_read_b64_tr_b16 v[88:89], v12 offset:0
    ds_read_b64_tr_b16 v[90:91], v12 offset:1024
    ds_read_b64_tr_b16 v[92:93], v12 offset:8192
    ds_read_b64_tr_b16 v[94:95], v12 offset:9216
    ds_read_b64_tr_b16 v[96:97], v12 offset:16384
    ds_read_b64_tr_b16 v[98:99], v12 offset:17408
    ds_read_b64_tr_b16 v[100:101], v12 offset:24576
    ds_read_b64_tr_b16 v[102:103], v12 offset:25600
    ds_read_b64_tr_b16 v[104:105], v12 offset:32768
    ds_read_b64_tr_b16 v[106:107], v12 offset:33792
    ds_read_b64_tr_b16 v[108:109], v12 offset:40960
    ds_read_b64_tr_b16 v[110:111], v12 offset:41984
    s_waitcnt lgkmcnt(0)
    v_xor_b32 v12, 64, v11
    ds_read_b64_tr_b16 v[112:113], v12 offset:0
    ds_read_b64_tr_b16 v[114:115], v12 offset:1024
    ds_read_b64_tr_b16 v[116:117], v12 offset:8192
    ds_read_b64_tr_b16 v[118:119], v12 offset:9216
    ds_read_b64_tr_b16 v[120:121], v12 offset:16384
    ds_read_b64_tr_b16 v[122:123], v12 offset:17408
    ds_read_b64_tr_b16 v[124:125], v12 offset:24576
    ds_read_b64_tr_b16 v[126:127], v12 offset:25600
    ds_read_b64_tr_b16 v[128:129], v12 offset:32768
    ds_read_b64_tr_b16 v[130:131], v12 offset:33792
    ds_read_b64_tr_b16 v[132:133], v12 offset:40960
    ds_read_b64_tr_b16 v[134:135], v12 offset:41984
    s_waitcnt lgkmcnt(0)
    v_xor_b32 v12, 96, v11
    ds_read_b64_tr_b16 v[136:137], v12 offset:0
    ds_read_b64_tr_b16 v[138:139], v12 offset:1024
    ds_read_b64_tr_b16 v[140:141], v12 offset:8192
    ds_read_b64_tr_b16 v[142:143], v12 offset:9216
    ds_read_b64_tr_b16 v[144:145], v12 offset:16384
    ds_read_b64_tr_b16 v[146:147], v12 offset:17408
    ds_read_b64_tr_b16 v[148:149], v12 offset:24576
    ds_read_b64_tr_b16 v[150:151], v12 offset:25600
    ds_read_b64_tr_b16 v[152:153], v12 offset:32768
    ds_read_b64_tr_b16 v[154:155], v12 offset:33792
    ds_read_b64_tr_b16 v[156:157], v12 offset:40960
    ds_read_b64_tr_b16 v[158:159], v12 offset:41984
    s_waitcnt lgkmcnt(0)
    v_xor_b32 v12, 128, v11
    ds_read_b64_tr_b16 v[160:161], v12 offset:0
    ds_read_b64_tr_b16 v[162:163], v12 offset:1024
    ds_read_b64_tr_b16 v[164:165], v12 offset:8192
    ds_read_b64_tr_b16 v[166:167], v12 offset:9216
    ds_read_b64_tr_b16 v[168:169], v12 offset:16384
    ds_read_b64_tr_b16 v[170:171], v12 offset:17408
    ds_read_b64_tr_b16 v[172:173], v12 offset:24576
    ds_read_b64_tr_b16 v[174:175], v12 offset:25600
    ds_read_b64_tr_b16 v[176:177], v12 offset:32768
    ds_read_b64_tr_b16 v[178:179], v12 offset:33792
    ds_read_b64_tr_b16 v[180:181], v12 offset:40960
    ds_read_b64_tr_b16 v[182:183], v12 offset:41984
    s_waitcnt lgkmcnt(0)
    v_xor_b32 v12, 160, v11
    ds_read_b64_tr_b16 v[184:185], v12 offset:0
    ds_read_b64_tr_b16 v[186:187], v12 offset:1024
    ds_read_b64_tr_b16 v[188:189], v12 offset:8192
    ds_read_b64_tr_b16 v[190:191], v12 offset:9216
    ds_read_b64_tr_b16 v[192:193], v12 offset:16384
    ds_read_b64_tr_b16 v[194:195], v12 offset:17408
    ds_read_b64_tr_b16 v[196:197], v12 offset:24576
    ds_read_b64_tr_b16 v[198:199], v12 offset:25600
    ds_read_b64_tr_b16 v[200:201], v12 offset:32768
    ds_read_b64_tr_b16 v[202:203], v12 offset:33792
    ds_read_b64_tr_b16 v[204:205], v12 offset:40960
    ds_read_b64_tr_b16 v[206:207], v12 offset:41984
    s_waitcnt lgkmcnt(0)
    v_xor_b32 v12, 192, v11
    ds_read_b64_tr_b16 v[208:209], v12 offset:0
    ds_read_b64_tr_b16 v[210:211], v12 offset:1024
    ds_read_b64_tr_b16 v[212:213], v12 offset:8192
    ds_read_b64_tr_b16 v[214:215], v12 offset:9216
    ds_read_b64_tr_b16 v[216:217], v12 offset:16384
    ds_read_b64_tr_b16 v[218:219], v12 offset:17408
    ds_read_b64_tr_b16 v[220:221], v12 offset:24576
    ds_read_b64_tr_b16 v[222:223], v12 offset:25600
    ds_read_b64_tr_b16 v[224:225], v12 offset:32768
    ds_read_b64_tr_b16 v[226:227], v12 offset:33792
    ds_read_b64_tr_b16 v[228:229], v12 offset:40960
    ds_read_b64_tr_b16 v[230:231], v12 offset:41984
    s_waitcnt lgkmcnt(0)
    v_xor_b32 v12, 224, v11
    ds_read_b64_tr_b16 v[232:233], v12 offset:0
    ds_read_b64_tr_b16 v[234:235], v12 offset:1024
    ds_read_b64_tr_b16 v[236:237], v12 offset:8192
    ds_read_b64_tr_b16 v[238:239], v12 offset:9216
    ds_read_b64_tr_b16 v[240:241], v12 offset:16384
    ds_read_b64_tr_b16 v[242:243], v12 offset:17408
    ds_read_b64_tr_b16 v[244:245], v12 offset:24576
    ds_read_b64_tr_b16 v[246:247], v12 offset:25600
    ds_read_b64_tr_b16 v[248:249], v12 offset:32768
    ds_read_b64_tr_b16 v[250:251], v12 offset:33792
    ds_read_b64_tr_b16 v[252:253], v12 offset:40960
    ds_read_b64_tr_b16 v[254:255], v12 offset:41984
    s_waitcnt lgkmcnt(0)
    s_barrier
    s_add_u32 s6, s68, 786432
    s_add_u32 m0, s67, 0
    s_nop 0
    buffer_load_dwordx4 v10, s[16:19], s6 offen offset:0 lds
    s_add_u32 m0, s67, 896
    s_nop 0
    buffer_load_dwordx4 v10, s[16:19], s6 offen offset:128 lds
    s_add_u32 m0, s67, 1792
    s_nop 0
    buffer_load_dwordx4 v10, s[16:19], s6 offen offset:256 lds
    s_add_u32 m0, s67, 3072
    s_nop 0
    buffer_load_dwordx4 v14, s[16:19], s6 offen offset:0 lds
    s_add_u32 m0, s67, 3968
    s_nop 0
    buffer_load_dwordx4 v14, s[16:19], s6 offen offset:128 lds
    s_add_u32 m0, s67, 4864
    s_nop 0
    buffer_load_dwordx4 v14, s[16:19], s6 offen offset:256 lds
    s_add_u32 s6, s68, 835584
    s_add_u32 m0, s67, 6144
    s_nop 0
    buffer_load_dwordx4 v10, s[16:19], s6 offen offset:0 lds
    s_add_u32 m0, s67, 7040
    s_nop 0
    buffer_load_dwordx4 v10, s[16:19], s6 offen offset:128 lds
    s_add_u32 m0, s67, 7936
    s_nop 0
    buffer_load_dwordx4 v10, s[16:19], s6 offen offset:256 lds
    s_add_u32 m0, s67, 9216
    s_nop 0
    buffer_load_dwordx4 v14, s[16:19], s6 offen offset:0 lds
    s_add_u32 m0, s67, 10112
    s_nop 0
    buffer_load_dwordx4 v14, s[16:19], s6 offen offset:128 lds
    s_add_u32 m0, s67, 11008
    s_nop 0
    buffer_load_dwordx4 v14, s[16:19], s6 offen offset:256 lds
    s_waitcnt vmcnt(24)
    ds_read_b128 a[0:3], v15 offset:49152
    ds_read_b128 a[4:7], v48 offset:49152
    ds_read_b128 a[8:11], v15 offset:50176
    ds_read_b128 a[12:15], v48 offset:50176
    ds_read_b128 a[16:19], v15 offset:51200
    ds_read_b128 a[20:23], v48 offset:51200
    ds_read_b128 a[24:27], v15 offset:55296
    ds_read_b128 a[28:31], v48 offset:55296
    ds_read_b128 a[32:35], v15 offset:56320
    ds_read_b128 a[36:39], v48 offset:56320
    ds_read_b128 a[40:43], v15 offset:57344
    ds_read_b128 a[44:47], v48 offset:57344
    s_waitcnt lgkmcnt(0)
    s_add_u32 s6, s68, 1179648
    s_add_u32 m0, s67, 49152
    s_nop 0
    buffer_load_dwordx4 v10, s[16:19], s6 offen offset:0 lds
    s_add_u32 m0, s67, 50048
    s_nop 0
    buffer_load_dwordx4 v10, s[16:19], s6 offen offset:128 lds
    s_add_u32 m0, s67, 50944
    s_nop 0
    buffer_load_dwordx4 v10, s[16:19], s6 offen offset:256 lds
    s_add_u32 m0, s67, 52224
    s_nop 0
    buffer_load_dwordx4 v14, s[16:19], s6 offen offset:0 lds
    s_add_u32 m0, s67, 53120
    s_nop 0
    buffer_load_dwordx4 v14, s[16:19], s6 offen offset:128 lds
    s_add_u32 m0, s67, 54016
    s_nop 0
    buffer_load_dwordx4 v14, s[16:19], s6 offen offset:256 lds
    s_add_u32 s6, s68, 1228800
    s_add_u32 m0, s67, 55296
    s_nop 0
    buffer_load_dwordx4 v10, s[16:19], s6 offen offset:0 lds
    s_add_u32 m0, s67, 56192
    s_nop 0
    buffer_load_dwordx4 v10, s[16:19], s6 offen offset:128 lds
    s_add_u32 m0, s67, 57088
    s_nop 0
    buffer_load_dwordx4 v10, s[16:19], s6 offen offset:256 lds
    s_add_u32 m0, s67, 58368
    s_nop 0
    buffer_load_dwordx4 v14, s[16:19], s6 offen offset:0 lds
    s_add_u32 m0, s67, 59264
    s_nop 0
    buffer_load_dwordx4 v14, s[16:19], s6 offen offset:128 lds
    s_add_u32 m0, s67, 60160
    s_nop 0
    buffer_load_dwordx4 v14, s[16:19], s6 offen offset:256 lds
    v_bfe_u32 v5, v0, 3, 1
    v_bfe_u32 v6, v0, 1, 2
    v_and_b32 v7, 0x31, v0
    v_lshl_add_u32 v7, v6, 2, v7
    v_lshl_add_u32 v7, v5, 1, v7
    v_lshlrev_b32 v51, 2, v7
    s_mov_b32 s6, 332032
    v_mul_lo_u32 v5, v5, s6
    v_and_b32 v6, 7, v0
    v_lshl_add_u32 v6, v4, 3, v6
    v_lshl_add_u32 v13, v6, 4, v5
    s_mul_i32 s69, s65, 5312512
    s_lshr_b32 s6, s64, 1
    s_mul_i32 s6, s6, 20480
    s_add_u32 s69, s69, s6
    s_and_b32 s6, s64, 1
    s_lshl_b32 s6, s6, 9
    s_add_u32 s69, s69, s6
    s_mul_i32 s6, s3, 5120
    s_add_u32 s69, s69, s6
    s_add_u32 s69, s69, 16777216
    v_mfma_f32_16x16x32_bf16 v[16:19], a[0:3], v[64:67], 0
    v_mfma_f32_16x16x32_bf16 v[20:23], a[24:27], v[64:67], 0
    v_mfma_f32_16x16x32_bf16 v[16:19], a[4:7], v[68:71], v[16:19]
    v_mfma_f32_16x16x32_bf16 v[20:23], a[28:31], v[68:71], v[20:23]
    v_mfma_f32_16x16x32_bf16 v[16:19], a[8:11], v[72:75], v[16:19]
    v_mfma_f32_16x16x32_bf16 v[20:23], a[32:35], v[72:75], v[20:23]
    v_mfma_f32_16x16x32_bf16 v[16:19], a[12:15], v[76:79], v[16:19]
    v_mfma_f32_16x16x32_bf16 v[20:23], a[36:39], v[76:79], v[20:23]
    v_mfma_f32_16x16x32_bf16 v[16:19], a[16:19], v[80:83], v[16:19]
    v_mfma_f32_16x16x32_bf16 v[20:23], a[40:43], v[80:83], v[20:23]
    v_mfma_f32_16x16x32_bf16 v[16:19], a[20:23], v[84:87], v[16:19]
    v_mfma_f32_16x16x32_bf16 v[20:23], a[44:47], v[84:87], v[20:23]
    v_mfma_f32_16x16x32_bf16 v[24:27], a[0:3], v[88:91], 0
    v_mfma_f32_16x16x32_bf16 v[28:31], a[24:27], v[88:91], 0
    v_mfma_f32_16x16x32_bf16 v[24:27], a[4:7], v[92:95], v[24:27]
    v_mfma_f32_16x16x32_bf16 v[28:31], a[28:31], v[92:95], v[28:31]
    v_mfma_f32_16x16x32_bf16 v[24:27], a[8:11], v[96:99], v[24:27]
    v_mfma_f32_16x16x32_bf16 v[28:31], a[32:35], v[96:99], v[28:31]
    v_mfma_f32_16x16x32_bf16 v[24:27], a[12:15], v[100:103], v[24:27]
    v_cvt_pk_bf16_f32 v32, v16, v17
    v_cvt_pk_bf16_f32 v33, v18, v19
    v_mfma_f32_16x16x32_bf16 v[28:31], a[36:39], v[100:103], v[28:31]
    v_cvt_pk_bf16_f32 v34, v20, v21
    v_cvt_pk_bf16_f32 v35, v22, v23
    v_mfma_f32_16x16x32_bf16 v[24:27], a[16:19], v[104:107], v[24:27]
    ds_bpermute_b32 v32, v51, v32
    ds_bpermute_b32 v33, v51, v33
    v_mfma_f32_16x16x32_bf16 v[28:31], a[40:43], v[104:107], v[28:31]
    ds_bpermute_b32 v34, v51, v34
    ds_bpermute_b32 v35, v51, v35
    v_mfma_f32_16x16x32_bf16 v[24:27], a[20:23], v[108:111], v[24:27]
    v_mfma_f32_16x16x32_bf16 v[28:31], a[44:47], v[108:111], v[28:31]
    v_mfma_f32_16x16x32_bf16 v[16:19], a[0:3], v[112:115], 0
    v_mfma_f32_16x16x32_bf16 v[20:23], a[24:27], v[112:115], 0
    v_mfma_f32_16x16x32_bf16 v[16:19], a[4:7], v[116:119], v[16:19]
    v_mfma_f32_16x16x32_bf16 v[20:23], a[28:31], v[116:119], v[20:23]
    s_waitcnt lgkmcnt(0)
    s_add_u32 s6, s69, 0
    v_mfma_f32_16x16x32_bf16 v[16:19], a[8:11], v[120:123], v[16:19]
    buffer_store_dwordx4 v[32:35], v13, s[8:11], s6 offen sc1
    v_mfma_f32_16x16x32_bf16 v[20:23], a[32:35], v[120:123], v[20:23]
    v_mfma_f32_16x16x32_bf16 v[16:19], a[12:15], v[124:127], v[16:19]
    v_cvt_pk_bf16_f32 v36, v24, v25
    v_cvt_pk_bf16_f32 v37, v26, v27
    v_mfma_f32_16x16x32_bf16 v[20:23], a[36:39], v[124:127], v[20:23]
    v_cvt_pk_bf16_f32 v38, v28, v29
    v_cvt_pk_bf16_f32 v39, v30, v31
    v_mfma_f32_16x16x32_bf16 v[16:19], a[16:19], v[128:131], v[16:19]
    ds_bpermute_b32 v36, v51, v36
    ds_bpermute_b32 v37, v51, v37
    v_mfma_f32_16x16x32_bf16 v[20:23], a[40:43], v[128:131], v[20:23]
    ds_bpermute_b32 v38, v51, v38
    ds_bpermute_b32 v39, v51, v39
    v_mfma_f32_16x16x32_bf16 v[16:19], a[20:23], v[132:135], v[16:19]
    v_mfma_f32_16x16x32_bf16 v[20:23], a[44:47], v[132:135], v[20:23]
    v_mfma_f32_16x16x32_bf16 v[24:27], a[0:3], v[136:139], 0
    v_mfma_f32_16x16x32_bf16 v[28:31], a[24:27], v[136:139], 0
    v_mfma_f32_16x16x32_bf16 v[24:27], a[4:7], v[140:143], v[24:27]
    v_mfma_f32_16x16x32_bf16 v[28:31], a[28:31], v[140:143], v[28:31]
    s_waitcnt lgkmcnt(0)
    s_add_u32 s6, s69, 664064
    v_mfma_f32_16x16x32_bf16 v[24:27], a[8:11], v[144:147], v[24:27]
    buffer_store_dwordx4 v[36:39], v13, s[8:11], s6 offen sc1
    v_mfma_f32_16x16x32_bf16 v[28:31], a[32:35], v[144:147], v[28:31]
    v_mfma_f32_16x16x32_bf16 v[24:27], a[12:15], v[148:151], v[24:27]
    v_cvt_pk_bf16_f32 v40, v16, v17
    v_cvt_pk_bf16_f32 v41, v18, v19
    v_mfma_f32_16x16x32_bf16 v[28:31], a[36:39], v[148:151], v[28:31]
    v_cvt_pk_bf16_f32 v42, v20, v21
    v_cvt_pk_bf16_f32 v43, v22, v23
    v_mfma_f32_16x16x32_bf16 v[24:27], a[16:19], v[152:155], v[24:27]
    ds_bpermute_b32 v40, v51, v40
    ds_bpermute_b32 v41, v51, v41
    v_mfma_f32_16x16x32_bf16 v[28:31], a[40:43], v[152:155], v[28:31]
    ds_bpermute_b32 v42, v51, v42
    ds_bpermute_b32 v43, v51, v43
    v_mfma_f32_16x16x32_bf16 v[24:27], a[20:23], v[156:159], v[24:27]
    v_mfma_f32_16x16x32_bf16 v[28:31], a[44:47], v[156:159], v[28:31]
    v_mfma_f32_16x16x32_bf16 v[16:19], a[0:3], v[160:163], 0
    v_mfma_f32_16x16x32_bf16 v[20:23], a[24:27], v[160:163], 0
    v_mfma_f32_16x16x32_bf16 v[16:19], a[4:7], v[164:167], v[16:19]
    v_mfma_f32_16x16x32_bf16 v[20:23], a[28:31], v[164:167], v[20:23]
    s_waitcnt lgkmcnt(0)
    s_add_u32 s6, s69, 1328128
    v_mfma_f32_16x16x32_bf16 v[16:19], a[8:11], v[168:171], v[16:19]
    buffer_store_dwordx4 v[40:43], v13, s[8:11], s6 offen sc1
    v_mfma_f32_16x16x32_bf16 v[20:23], a[32:35], v[168:171], v[20:23]
    v_mfma_f32_16x16x32_bf16 v[16:19], a[12:15], v[172:175], v[16:19]
    v_cvt_pk_bf16_f32 v44, v24, v25
    v_cvt_pk_bf16_f32 v45, v26, v27
    v_mfma_f32_16x16x32_bf16 v[20:23], a[36:39], v[172:175], v[20:23]
    v_cvt_pk_bf16_f32 v46, v28, v29
    v_cvt_pk_bf16_f32 v47, v30, v31
    v_mfma_f32_16x16x32_bf16 v[16:19], a[16:19], v[176:179], v[16:19]
    ds_bpermute_b32 v44, v51, v44
    ds_bpermute_b32 v45, v51, v45
    v_mfma_f32_16x16x32_bf16 v[20:23], a[40:43], v[176:179], v[20:23]
    ds_bpermute_b32 v46, v51, v46
    ds_bpermute_b32 v47, v51, v47
    v_mfma_f32_16x16x32_bf16 v[16:19], a[20:23], v[180:183], v[16:19]
    v_mfma_f32_16x16x32_bf16 v[20:23], a[44:47], v[180:183], v[20:23]
    v_mfma_f32_16x16x32_bf16 v[24:27], a[0:3], v[184:187], 0
    v_mfma_f32_16x16x32_bf16 v[28:31], a[24:27], v[184:187], 0
    v_mfma_f32_16x16x32_bf16 v[24:27], a[4:7], v[188:191], v[24:27]
    v_mfma_f32_16x16x32_bf16 v[28:31], a[28:31], v[188:191], v[28:31]
    s_waitcnt lgkmcnt(0)
    s_add_u32 s6, s69, 1992192
    v_mfma_f32_16x16x32_bf16 v[24:27], a[8:11], v[192:195], v[24:27]
    buffer_store_dwordx4 v[44:47], v13, s[8:11], s6 offen sc1
    v_mfma_f32_16x16x32_bf16 v[28:31], a[32:35], v[192:195], v[28:31]
    v_mfma_f32_16x16x32_bf16 v[24:27], a[12:15], v[196:199], v[24:27]
    v_cvt_pk_bf16_f32 v32, v16, v17
    v_cvt_pk_bf16_f32 v33, v18, v19
    v_mfma_f32_16x16x32_bf16 v[28:31], a[36:39], v[196:199], v[28:31]
    v_cvt_pk_bf16_f32 v34, v20, v21
    v_cvt_pk_bf16_f32 v35, v22, v23
    v_mfma_f32_16x16x32_bf16 v[24:27], a[16:19], v[200:203], v[24:27]
    ds_bpermute_b32 v32, v51, v32
    ds_bpermute_b32 v33, v51, v33
    v_mfma_f32_16x16x32_bf16 v[28:31], a[40:43], v[200:203], v[28:31]
    ds_bpermute_b32 v34, v51, v34
    ds_bpermute_b32 v35, v51, v35
    v_mfma_f32_16x16x32_bf16 v[24:27], a[20:23], v[204:207], v[24:27]
    v_mfma_f32_16x16x32_bf16 v[28:31], a[44:47], v[204:207], v[28:31]
    s_waitcnt vmcnt(28)
    v_mfma_f32_16x16x32_bf16 v[16:19], a[0:3], v[208:211], 0
    v_mfma_f32_16x16x32_bf16 v[20:23], a[24:27], v[208:211], 0
    v_mfma_f32_16x16x32_bf16 v[16:19], a[4:7], v[212:215], v[16:19]
    v_mfma_f32_16x16x32_bf16 v[20:23], a[28:31], v[212:215], v[20:23]
    s_waitcnt lgkmcnt(0)
    s_add_u32 s6, s69, 2656256
    v_mfma_f32_16x16x32_bf16 v[16:19], a[8:11], v[216:219], v[16:19]
    ds_read_b128 a[48:51], v49 offset:0
    buffer_store_dwordx4 v[32:35], v13, s[8:11], s6 offen sc1
    v_mfma_f32_16x16x32_bf16 v[20:23], a[32:35], v[216:219], v[20:23]
    ds_read_b128 a[52:55], v50 offset:0
    v_mfma_f32_16x16x32_bf16 v[16:19], a[12:15], v[220:223], v[16:19]
    v_cvt_pk_bf16_f32 v36, v24, v25
    v_cvt_pk_bf16_f32 v37, v26, v27
    v_mfma_f32_16x16x32_bf16 v[20:23], a[36:39], v[220:223], v[20:23]
    v_cvt_pk_bf16_f32 v38, v28, v29
    v_cvt_pk_bf16_f32 v39, v30, v31
    v_mfma_f32_16x16x32_bf16 v[16:19], a[16:19], v[224:227], v[16:19]
    ds_bpermute_b32 v36, v51, v36
    ds_bpermute_b32 v37, v51, v37
    v_mfma_f32_16x16x32_bf16 v[20:23], a[40:43], v[224:227], v[20:23]
    ds_bpermute_b32 v38, v51, v38
    ds_bpermute_b32 v39, v51, v39
    v_mfma_f32_16x16x32_bf16 v[16:19], a[20:23], v[228:231], v[16:19]
    ds_read_b128 a[56:59], v49 offset:1024
    ds_read_b128 a[60:63], v50 offset:1024
    ds_read_b128 a[64:67], v49 offset:2048
    ds_read_b128 a[68:71], v50 offset:2048
    ds_read_b128 a[72:75], v49 offset:6144
    v_mfma_f32_16x16x32_bf16 v[20:23], a[44:47], v[228:231], v[20:23]
    ds_read_b128 a[76:79], v50 offset:6144
    ds_read_b128 a[80:83], v49 offset:7168
    ds_read_b128 a[84:87], v50 offset:7168
    ds_read_b128 a[88:91], v49 offset:8192
    ds_read_b128 a[92:95], v50 offset:8192
    v_mfma_f32_16x16x32_bf16 v[24:27], a[0:3], v[232:235], 0
    v_mfma_f32_16x16x32_bf16 v[28:31], a[24:27], v[232:235], 0
    v_mfma_f32_16x16x32_bf16 v[24:27], a[4:7], v[236:239], v[24:27]
    v_mfma_f32_16x16x32_bf16 v[28:31], a[28:31], v[236:239], v[28:31]
    s_waitcnt lgkmcnt(0)
    s_add_u32 s6, s69, 3320320
    v_mfma_f32_16x16x32_bf16 v[24:27], a[8:11], v[240:243], v[24:27]
    buffer_store_dwordx4 v[36:39], v13, s[8:11], s6 offen sc1
    v_mfma_f32_16x16x32_bf16 v[28:31], a[32:35], v[240:243], v[28:31]
    v_mfma_f32_16x16x32_bf16 v[24:27], a[12:15], v[244:247], v[24:27]
    v_cvt_pk_bf16_f32 v40, v16, v17
    v_cvt_pk_bf16_f32 v41, v18, v19
    v_mfma_f32_16x16x32_bf16 v[28:31], a[36:39], v[244:247], v[28:31]
    v_cvt_pk_bf16_f32 v42, v20, v21
    v_cvt_pk_bf16_f32 v43, v22, v23
    v_mfma_f32_16x16x32_bf16 v[24:27], a[16:19], v[248:251], v[24:27]
    ds_bpermute_b32 v40, v51, v40
    ds_bpermute_b32 v41, v51, v41
    v_mfma_f32_16x16x32_bf16 v[28:31], a[40:43], v[248:251], v[28:31]
    ds_bpermute_b32 v42, v51, v42
    ds_bpermute_b32 v43, v51, v43
    v_mfma_f32_16x16x32_bf16 v[24:27], a[20:23], v[252:255], v[24:27]
    v_mfma_f32_16x16x32_bf16 v[28:31], a[44:47], v[252:255], v[28:31]
    s_add_u32 s6, s68, 1572864
    s_add_u32 m0, s67, 98304
    s_nop 0
    buffer_load_dwordx4 v10, s[16:19], s6 offen offset:0 lds
    s_add_u32 m0, s67, 99200
    s_nop 0
    buffer_load_dwordx4 v10, s[16:19], s6 offen offset:128 lds
    s_add_u32 m0, s67, 100096
    s_nop 0
    buffer_load_dwordx4 v10, s[16:19], s6 offen offset:256 lds
    s_add_u32 m0, s67, 101376
    s_nop 0
    buffer_load_dwordx4 v14, s[16:19], s6 offen offset:0 lds
    s_add_u32 m0, s67, 102272
    s_nop 0
    buffer_load_dwordx4 v14, s[16:19], s6 offen offset:128 lds
    s_add_u32 m0, s67, 103168
    s_nop 0
    buffer_load_dwordx4 v14, s[16:19], s6 offen offset:256 lds
    s_add_u32 s6, s68, 1622016
    s_add_u32 m0, s67, 104448
    s_nop 0
    buffer_load_dwordx4 v10, s[16:19], s6 offen offset:0 lds
    s_add_u32 m0, s67, 105344
    s_nop 0
    buffer_load_dwordx4 v10, s[16:19], s6 offen offset:128 lds
    s_add_u32 m0, s67, 106240
    s_nop 0
    buffer_load_dwordx4 v10, s[16:19], s6 offen offset:256 lds
    s_add_u32 m0, s67, 107520
    s_nop 0
    buffer_load_dwordx4 v14, s[16:19], s6 offen offset:0 lds
    s_add_u32 m0, s67, 108416
    s_nop 0
    buffer_load_dwordx4 v14, s[16:19], s6 offen offset:128 lds
    s_add_u32 m0, s67, 109312
    s_nop 0
    buffer_load_dwordx4 v14, s[16:19], s6 offen offset:256 lds
    v_mfma_f32_16x16x32_bf16 v[16:19], a[48:51], v[64:67], 0
    v_mfma_f32_16x16x32_bf16 v[20:23], a[72:75], v[64:67], 0
    v_mfma_f32_16x16x32_bf16 v[16:19], a[52:55], v[68:71], v[16:19]
    v_mfma_f32_16x16x32_bf16 v[20:23], a[76:79], v[68:71], v[20:23]
    s_waitcnt lgkmcnt(0)
    s_add_u32 s6, s69, 3984384
    v_mfma_f32_16x16x32_bf16 v[16:19], a[56:59], v[72:75], v[16:19]
    buffer_store_dwordx4 v[40:43], v13, s[8:11], s6 offen sc1
    v_mfma_f32_16x16x32_bf16 v[20:23], a[80:83], v[72:75], v[20:23]
    v_mfma_f32_16x16x32_bf16 v[16:19], a[60:63], v[76:79], v[16:19]
    v_cvt_pk_bf16_f32 v44, v24, v25
    v_cvt_pk_bf16_f32 v45, v26, v27
    v_mfma_f32_16x16x32_bf16 v[20:23], a[84:87], v[76:79], v[20:23]
    v_cvt_pk_bf16_f32 v46, v28, v29
    v_cvt_pk_bf16_f32 v47, v30, v31
    v_mfma_f32_16x16x32_bf16 v[16:19], a[64:67], v[80:83], v[16:19]
    ds_bpermute_b32 v44, v51, v44
    ds_bpermute_b32 v45, v51, v45
    v_mfma_f32_16x16x32_bf16 v[20:23], a[88:91], v[80:83], v[20:23]
    ds_bpermute_b32 v46, v51, v46
    ds_bpermute_b32 v47, v51, v47
    v_mfma_f32_16x16x32_bf16 v[16:19], a[68:71], v[84:87], v[16:19]
    v_mfma_f32_16x16x32_bf16 v[20:23], a[92:95], v[84:87], v[20:23]
    v_mfma_f32_16x16x32_bf16 v[24:27], a[48:51], v[88:91], 0
    v_mfma_f32_16x16x32_bf16 v[28:31], a[72:75], v[88:91], 0
    v_mfma_f32_16x16x32_bf16 v[24:27], a[52:55], v[92:95], v[24:27]
    v_mfma_f32_16x16x32_bf16 v[28:31], a[76:79], v[92:95], v[28:31]
    s_waitcnt lgkmcnt(0)
    s_add_u32 s6, s69, 4648448
    v_mfma_f32_16x16x32_bf16 v[24:27], a[56:59], v[96:99], v[24:27]
    buffer_store_dwordx4 v[44:47], v13, s[8:11], s6 offen sc1
    v_mfma_f32_16x16x32_bf16 v[28:31], a[80:83], v[96:99], v[28:31]
    v_mfma_f32_16x16x32_bf16 v[24:27], a[60:63], v[100:103], v[24:27]
    v_cvt_pk_bf16_f32 v32, v16, v17
    v_cvt_pk_bf16_f32 v33, v18, v19
    v_mfma_f32_16x16x32_bf16 v[28:31], a[84:87], v[100:103], v[28:31]
    v_cvt_pk_bf16_f32 v34, v20, v21
    v_cvt_pk_bf16_f32 v35, v22, v23
    v_mfma_f32_16x16x32_bf16 v[24:27], a[64:67], v[104:107], v[24:27]
    ds_bpermute_b32 v32, v51, v32
    ds_bpermute_b32 v33, v51, v33
    v_mfma_f32_16x16x32_bf16 v[28:31], a[88:91], v[104:107], v[28:31]
    ds_bpermute_b32 v34, v51, v34
    ds_bpermute_b32 v35, v51, v35
    v_mfma_f32_16x16x32_bf16 v[24:27], a[68:71], v[108:111], v[24:27]
    v_mfma_f32_16x16x32_bf16 v[28:31], a[92:95], v[108:111], v[28:31]
    v_mfma_f32_16x16x32_bf16 v[16:19], a[48:51], v[112:115], 0
    v_mfma_f32_16x16x32_bf16 v[20:23], a[72:75], v[112:115], 0
    v_mfma_f32_16x16x32_bf16 v[16:19], a[52:55], v[116:119], v[16:19]
    v_mfma_f32_16x16x32_bf16 v[20:23], a[76:79], v[116:119], v[20:23]
    s_waitcnt lgkmcnt(0)
    s_add_u32 s6, s69, 1024
    v_mfma_f32_16x16x32_bf16 v[16:19], a[56:59], v[120:123], v[16:19]
    buffer_store_dwordx4 v[32:35], v13, s[8:11], s6 offen sc1
    v_mfma_f32_16x16x32_bf16 v[20:23], a[80:83], v[120:123], v[20:23]
    v_mfma_f32_16x16x32_bf16 v[16:19], a[60:63], v[124:127], v[16:19]
    v_cvt_pk_bf16_f32 v36, v24, v25
    v_cvt_pk_bf16_f32 v37, v26, v27
    v_mfma_f32_16x16x32_bf16 v[20:23], a[84:87], v[124:127], v[20:23]
    v_cvt_pk_bf16_f32 v38, v28, v29
    v_cvt_pk_bf16_f32 v39, v30, v31
    v_mfma_f32_16x16x32_bf16 v[16:19], a[64:67], v[128:131], v[16:19]
    ds_bpermute_b32 v36, v51, v36
    ds_bpermute_b32 v37, v51, v37
    v_mfma_f32_16x16x32_bf16 v[20:23], a[88:91], v[128:131], v[20:23]
    ds_bpermute_b32 v38, v51, v38
    ds_bpermute_b32 v39, v51, v39
    v_mfma_f32_16x16x32_bf16 v[16:19], a[68:71], v[132:135], v[16:19]
    v_mfma_f32_16x16x32_bf16 v[20:23], a[92:95], v[132:135], v[20:23]
    v_mfma_f32_16x16x32_bf16 v[24:27], a[48:51], v[136:139], 0
    v_mfma_f32_16x16x32_bf16 v[28:31], a[72:75], v[136:139], 0
    v_mfma_f32_16x16x32_bf16 v[24:27], a[52:55], v[140:143], v[24:27]
    v_mfma_f32_16x16x32_bf16 v[28:31], a[76:79], v[140:143], v[28:31]
    s_waitcnt lgkmcnt(0)
    s_add_u32 s6, s69, 665088
    v_mfma_f32_16x16x32_bf16 v[24:27], a[56:59], v[144:147], v[24:27]
    buffer_store_dwordx4 v[36:39], v13, s[8:11], s6 offen sc1
    v_mfma_f32_16x16x32_bf16 v[28:31], a[80:83], v[144:147], v[28:31]
    v_mfma_f32_16x16x32_bf16 v[24:27], a[60:63], v[148:151], v[24:27]
    v_cvt_pk_bf16_f32 v40, v16, v17
    v_cvt_pk_bf16_f32 v41, v18, v19
    v_mfma_f32_16x16x32_bf16 v[28:31], a[84:87], v[148:151], v[28:31]
    v_cvt_pk_bf16_f32 v42, v20, v21
    v_cvt_pk_bf16_f32 v43, v22, v23
    v_mfma_f32_16x16x32_bf16 v[24:27], a[64:67], v[152:155], v[24:27]
    ds_bpermute_b32 v40, v51, v40
    ds_bpermute_b32 v41, v51, v41
    v_mfma_f32_16x16x32_bf16 v[28:31], a[88:91], v[152:155], v[28:31]
    ds_bpermute_b32 v42, v51, v42
    ds_bpermute_b32 v43, v51, v43
    v_mfma_f32_16x16x32_bf16 v[24:27], a[68:71], v[156:159], v[24:27]
    v_mfma_f32_16x16x32_bf16 v[28:31], a[92:95], v[156:159], v[28:31]
    v_mfma_f32_16x16x32_bf16 v[16:19], a[48:51], v[160:163], 0
    v_mfma_f32_16x16x32_bf16 v[20:23], a[72:75], v[160:163], 0
    v_mfma_f32_16x16x32_bf16 v[16:19], a[52:55], v[164:167], v[16:19]
    v_mfma_f32_16x16x32_bf16 v[20:23], a[76:79], v[164:167], v[20:23]
    s_waitcnt lgkmcnt(0)
    s_add_u32 s6, s69, 1329152
    v_mfma_f32_16x16x32_bf16 v[16:19], a[56:59], v[168:171], v[16:19]
    buffer_store_dwordx4 v[40:43], v13, s[8:11], s6 offen sc1
    v_mfma_f32_16x16x32_bf16 v[20:23], a[80:83], v[168:171], v[20:23]
    v_mfma_f32_16x16x32_bf16 v[16:19], a[60:63], v[172:175], v[16:19]
    v_cvt_pk_bf16_f32 v44, v24, v25
    v_cvt_pk_bf16_f32 v45, v26, v27
    v_mfma_f32_16x16x32_bf16 v[20:23], a[84:87], v[172:175], v[20:23]
    v_cvt_pk_bf16_f32 v46, v28, v29
    v_cvt_pk_bf16_f32 v47, v30, v31
    v_mfma_f32_16x16x32_bf16 v[16:19], a[64:67], v[176:179], v[16:19]
    ds_bpermute_b32 v44, v51, v44
    ds_bpermute_b32 v45, v51, v45
    v_mfma_f32_16x16x32_bf16 v[20:23], a[88:91], v[176:179], v[20:23]
    ds_bpermute_b32 v46, v51, v46
    ds_bpermute_b32 v47, v51, v47
    v_mfma_f32_16x16x32_bf16 v[16:19], a[68:71], v[180:183], v[16:19]
    v_mfma_f32_16x16x32_bf16 v[20:23], a[92:95], v[180:183], v[20:23]
    v_mfma_f32_16x16x32_bf16 v[24:27], a[48:51], v[184:187], 0
    v_mfma_f32_16x16x32_bf16 v[28:31], a[72:75], v[184:187], 0
    v_mfma_f32_16x16x32_bf16 v[24:27], a[52:55], v[188:191], v[24:27]
    v_mfma_f32_16x16x32_bf16 v[28:31], a[76:79], v[188:191], v[28:31]
    s_waitcnt lgkmcnt(0)
    s_add_u32 s6, s69, 1993216
    v_mfma_f32_16x16x32_bf16 v[24:27], a[56:59], v[192:195], v[24:27]
    buffer_store_dwordx4 v[44:47], v13, s[8:11], s6 offen sc1
    v_mfma_f32_16x16x32_bf16 v[28:31], a[80:83], v[192:195], v[28:31]
    v_mfma_f32_16x16x32_bf16 v[24:27], a[60:63], v[196:199], v[24:27]
    v_cvt_pk_bf16_f32 v32, v16, v17
    v_cvt_pk_bf16_f32 v33, v18, v19
    v_mfma_f32_16x16x32_bf16 v[28:31], a[84:87], v[196:199], v[28:31]
    v_cvt_pk_bf16_f32 v34, v20, v21
    v_cvt_pk_bf16_f32 v35, v22, v23
    v_mfma_f32_16x16x32_bf16 v[24:27], a[64:67], v[200:203], v[24:27]
    ds_bpermute_b32 v32, v51, v32
    ds_bpermute_b32 v33, v51, v33
    v_mfma_f32_16x16x32_bf16 v[28:31], a[88:91], v[200:203], v[28:31]
    ds_bpermute_b32 v34, v51, v34
    ds_bpermute_b32 v35, v51, v35
    v_mfma_f32_16x16x32_bf16 v[24:27], a[68:71], v[204:207], v[24:27]
    v_mfma_f32_16x16x32_bf16 v[28:31], a[92:95], v[204:207], v[28:31]
    s_waitcnt vmcnt(36)
    v_mfma_f32_16x16x32_bf16 v[16:19], a[48:51], v[208:211], 0
    v_mfma_f32_16x16x32_bf16 v[20:23], a[72:75], v[208:211], 0
    v_mfma_f32_16x16x32_bf16 v[16:19], a[52:55], v[212:215], v[16:19]
    v_mfma_f32_16x16x32_bf16 v[20:23], a[76:79], v[212:215], v[20:23]
    s_waitcnt lgkmcnt(0)
    s_add_u32 s6, s69, 2657280
    v_mfma_f32_16x16x32_bf16 v[16:19], a[56:59], v[216:219], v[16:19]
    ds_read_b128 a[96:99], v15 offset:0
    buffer_store_dwordx4 v[32:35], v13, s[8:11], s6 offen sc1
    v_mfma_f32_16x16x32_bf16 v[20:23], a[80:83], v[216:219], v[20:23]
    ds_read_b128 a[100:103], v48 offset:0
    v_mfma_f32_16x16x32_bf16 v[16:19], a[60:63], v[220:223], v[16:19]
    v_cvt_pk_bf16_f32 v36, v24, v25
    v_cvt_pk_bf16_f32 v37, v26, v27
    v_mfma_f32_16x16x32_bf16 v[20:23], a[84:87], v[220:223], v[20:23]
    v_cvt_pk_bf16_f32 v38, v28, v29
    v_cvt_pk_bf16_f32 v39, v30, v31
    v_mfma_f32_16x16x32_bf16 v[16:19], a[64:67], v[224:227], v[16:19]
    ds_bpermute_b32 v36, v51, v36
    ds_bpermute_b32 v37, v51, v37
    v_mfma_f32_16x16x32_bf16 v[20:23], a[88:91], v[224:227], v[20:23]
    ds_bpermute_b32 v38, v51, v38
    ds_bpermute_b32 v39, v51, v39
    v_mfma_f32_16x16x32_bf16 v[16:19], a[68:71], v[228:231], v[16:19]
    ds_read_b128 a[104:107], v15 offset:1024
    ds_read_b128 a[108:111], v48 offset:1024
    ds_read_b128 a[112:115], v15 offset:2048
    ds_read_b128 a[116:119], v48 offset:2048
    ds_read_b128 a[120:123], v15 offset:6144
    v_mfma_f32_16x16x32_bf16 v[20:23], a[92:95], v[228:231], v[20:23]
    ds_read_b128 a[124:127], v48 offset:6144
    ds_read_b128 a[128:131], v15 offset:7168
    ds_read_b128 a[132:135], v48 offset:7168
    ds_read_b128 a[136:139], v15 offset:8192
    ds_read_b128 a[140:143], v48 offset:8192
    v_mfma_f32_16x16x32_bf16 v[24:27], a[48:51], v[232:235], 0
    v_mfma_f32_16x16x32_bf16 v[28:31], a[72:75], v[232:235], 0
    v_mfma_f32_16x16x32_bf16 v[24:27], a[52:55], v[236:239], v[24:27]
    v_mfma_f32_16x16x32_bf16 v[28:31], a[76:79], v[236:239], v[28:31]
    s_waitcnt lgkmcnt(0)
    s_add_u32 s6, s69, 3321344
    v_mfma_f32_16x16x32_bf16 v[24:27], a[56:59], v[240:243], v[24:27]
    buffer_store_dwordx4 v[36:39], v13, s[8:11], s6 offen sc1
    v_mfma_f32_16x16x32_bf16 v[28:31], a[80:83], v[240:243], v[28:31]
    v_mfma_f32_16x16x32_bf16 v[24:27], a[60:63], v[244:247], v[24:27]
    v_cvt_pk_bf16_f32 v40, v16, v17
    v_cvt_pk_bf16_f32 v41, v18, v19
    v_mfma_f32_16x16x32_bf16 v[28:31], a[84:87], v[244:247], v[28:31]
    v_cvt_pk_bf16_f32 v42, v20, v21
    v_cvt_pk_bf16_f32 v43, v22, v23
    v_mfma_f32_16x16x32_bf16 v[24:27], a[64:67], v[248:251], v[24:27]
    ds_bpermute_b32 v40, v51, v40
    ds_bpermute_b32 v41, v51, v41
    v_mfma_f32_16x16x32_bf16 v[28:31], a[88:91], v[248:251], v[28:31]
    ds_bpermute_b32 v42, v51, v42
    ds_bpermute_b32 v43, v51, v43
    v_mfma_f32_16x16x32_bf16 v[24:27], a[68:71], v[252:255], v[24:27]
    v_mfma_f32_16x16x32_bf16 v[28:31], a[92:95], v[252:255], v[28:31]
    v_mfma_f32_16x16x32_bf16 v[16:19], a[96:99], v[64:67], 0
    v_mfma_f32_16x16x32_bf16 v[20:23], a[120:123], v[64:67], 0
    v_mfma_f32_16x16x32_bf16 v[16:19], a[100:103], v[68:71], v[16:19]
    v_mfma_f32_16x16x32_bf16 v[20:23], a[124:127], v[68:71], v[20:23]
    s_waitcnt lgkmcnt(0)
    s_add_u32 s6, s69, 3985408
    v_mfma_f32_16x16x32_bf16 v[16:19], a[104:107], v[72:75], v[16:19]
    buffer_store_dwordx4 v[40:43], v13, s[8:11], s6 offen sc1
    v_mfma_f32_16x16x32_bf16 v[20:23], a[128:131], v[72:75], v[20:23]
    v_mfma_f32_16x16x32_bf16 v[16:19], a[108:111], v[76:79], v[16:19]
    v_cvt_pk_bf16_f32 v44, v24, v25
    v_cvt_pk_bf16_f32 v45, v26, v27
    v_mfma_f32_16x16x32_bf16 v[20:23], a[132:135], v[76:79], v[20:23]
    v_cvt_pk_bf16_f32 v46, v28, v29
    v_cvt_pk_bf16_f32 v47, v30, v31
    v_mfma_f32_16x16x32_bf16 v[16:19], a[112:115], v[80:83], v[16:19]
    ds_bpermute_b32 v44, v51, v44
    ds_bpermute_b32 v45, v51, v45
    v_mfma_f32_16x16x32_bf16 v[20:23], a[136:139], v[80:83], v[20:23]
    ds_bpermute_b32 v46, v51, v46
    ds_bpermute_b32 v47, v51, v47
    v_mfma_f32_16x16x32_bf16 v[16:19], a[116:119], v[84:87], v[16:19]
    v_mfma_f32_16x16x32_bf16 v[20:23], a[140:143], v[84:87], v[20:23]
    v_mfma_f32_16x16x32_bf16 v[24:27], a[96:99], v[88:91], 0
    v_mfma_f32_16x16x32_bf16 v[28:31], a[120:123], v[88:91], 0
    v_mfma_f32_16x16x32_bf16 v[24:27], a[100:103], v[92:95], v[24:27]
    v_mfma_f32_16x16x32_bf16 v[28:31], a[124:127], v[92:95], v[28:31]
    s_waitcnt lgkmcnt(0)
    s_add_u32 s6, s69, 4649472
    v_mfma_f32_16x16x32_bf16 v[24:27], a[104:107], v[96:99], v[24:27]
    buffer_store_dwordx4 v[44:47], v13, s[8:11], s6 offen sc1
    v_mfma_f32_16x16x32_bf16 v[28:31], a[128:131], v[96:99], v[28:31]
    v_mfma_f32_16x16x32_bf16 v[24:27], a[108:111], v[100:103], v[24:27]
    v_cvt_pk_bf16_f32 v32, v16, v17
    v_cvt_pk_bf16_f32 v33, v18, v19
    v_mfma_f32_16x16x32_bf16 v[28:31], a[132:135], v[100:103], v[28:31]
    v_cvt_pk_bf16_f32 v34, v20, v21
    v_cvt_pk_bf16_f32 v35, v22, v23
    v_mfma_f32_16x16x32_bf16 v[24:27], a[112:115], v[104:107], v[24:27]
    ds_bpermute_b32 v32, v51, v32
    ds_bpermute_b32 v33, v51, v33
    v_mfma_f32_16x16x32_bf16 v[28:31], a[136:139], v[104:107], v[28:31]
    ds_bpermute_b32 v34, v51, v34
    ds_bpermute_b32 v35, v51, v35
    v_mfma_f32_16x16x32_bf16 v[24:27], a[116:119], v[108:111], v[24:27]
    v_mfma_f32_16x16x32_bf16 v[28:31], a[140:143], v[108:111], v[28:31]
    v_mfma_f32_16x16x32_bf16 v[16:19], a[96:99], v[112:115], 0
    v_mfma_f32_16x16x32_bf16 v[20:23], a[120:123], v[112:115], 0
    v_mfma_f32_16x16x32_bf16 v[16:19], a[100:103], v[116:119], v[16:19]
    v_mfma_f32_16x16x32_bf16 v[20:23], a[124:127], v[116:119], v[20:23]
    s_waitcnt lgkmcnt(0)
    s_add_u32 s6, s69, 2048
    v_mfma_f32_16x16x32_bf16 v[16:19], a[104:107], v[120:123], v[16:19]
    buffer_store_dwordx4 v[32:35], v13, s[8:11], s6 offen sc1
    v_mfma_f32_16x16x32_bf16 v[20:23], a[128:131], v[120:123], v[20:23]
    v_mfma_f32_16x16x32_bf16 v[16:19], a[108:111], v[124:127], v[16:19]
    v_cvt_pk_bf16_f32 v36, v24, v25
    v_cvt_pk_bf16_f32 v37, v26, v27
    v_mfma_f32_16x16x32_bf16 v[20:23], a[132:135], v[124:127], v[20:23]
    v_cvt_pk_bf16_f32 v38, v28, v29
    v_cvt_pk_bf16_f32 v39, v30, v31
    v_mfma_f32_16x16x32_bf16 v[16:19], a[112:115], v[128:131], v[16:19]
    ds_bpermute_b32 v36, v51, v36
    ds_bpermute_b32 v37, v51, v37
    v_mfma_f32_16x16x32_bf16 v[20:23], a[136:139], v[128:131], v[20:23]
    ds_bpermute_b32 v38, v51, v38
    ds_bpermute_b32 v39, v51, v39
    v_mfma_f32_16x16x32_bf16 v[16:19], a[116:119], v[132:135], v[16:19]
    v_mfma_f32_16x16x32_bf16 v[20:23], a[140:143], v[132:135], v[20:23]
    v_mfma_f32_16x16x32_bf16 v[24:27], a[96:99], v[136:139], 0
    v_mfma_f32_16x16x32_bf16 v[28:31], a[120:123], v[136:139], 0
    v_mfma_f32_16x16x32_bf16 v[24:27], a[100:103], v[140:143], v[24:27]
    v_mfma_f32_16x16x32_bf16 v[28:31], a[124:127], v[140:143], v[28:31]
    s_waitcnt lgkmcnt(0)
    s_add_u32 s6, s69, 666112
    v_mfma_f32_16x16x32_bf16 v[24:27], a[104:107], v[144:147], v[24:27]
    buffer_store_dwordx4 v[36:39], v13, s[8:11], s6 offen sc1
    v_mfma_f32_16x16x32_bf16 v[28:31], a[128:131], v[144:147], v[28:31]
    v_mfma_f32_16x16x32_bf16 v[24:27], a[108:111], v[148:151], v[24:27]
    v_cvt_pk_bf16_f32 v40, v16, v17
    v_cvt_pk_bf16_f32 v41, v18, v19
    v_mfma_f32_16x16x32_bf16 v[28:31], a[132:135], v[148:151], v[28:31]
    v_cvt_pk_bf16_f32 v42, v20, v21
    v_cvt_pk_bf16_f32 v43, v22, v23
    v_mfma_f32_16x16x32_bf16 v[24:27], a[112:115], v[152:155], v[24:27]
    ds_bpermute_b32 v40, v51, v40
    ds_bpermute_b32 v41, v51, v41
    v_mfma_f32_16x16x32_bf16 v[28:31], a[136:139], v[152:155], v[28:31]
    ds_bpermute_b32 v42, v51, v42
    ds_bpermute_b32 v43, v51, v43
    v_mfma_f32_16x16x32_bf16 v[24:27], a[116:119], v[156:159], v[24:27]
    v_mfma_f32_16x16x32_bf16 v[28:31], a[140:143], v[156:159], v[28:31]
    v_mfma_f32_16x16x32_bf16 v[16:19], a[96:99], v[160:163], 0
    v_mfma_f32_16x16x32_bf16 v[20:23], a[120:123], v[160:163], 0
    v_mfma_f32_16x16x32_bf16 v[16:19], a[100:103], v[164:167], v[16:19]
    v_mfma_f32_16x16x32_bf16 v[20:23], a[124:127], v[164:167], v[20:23]
    s_waitcnt lgkmcnt(0)
    s_add_u32 s6, s69, 1330176
    v_mfma_f32_16x16x32_bf16 v[16:19], a[104:107], v[168:171], v[16:19]
    buffer_store_dwordx4 v[40:43], v13, s[8:11], s6 offen sc1
    v_mfma_f32_16x16x32_bf16 v[20:23], a[128:131], v[168:171], v[20:23]
    v_mfma_f32_16x16x32_bf16 v[16:19], a[108:111], v[172:175], v[16:19]
    v_cvt_pk_bf16_f32 v44, v24, v25
    v_cvt_pk_bf16_f32 v45, v26, v27
    v_mfma_f32_16x16x32_bf16 v[20:23], a[132:135], v[172:175], v[20:23]
    v_cvt_pk_bf16_f32 v46, v28, v29
    v_cvt_pk_bf16_f32 v47, v30, v31
    v_mfma_f32_16x16x32_bf16 v[16:19], a[112:115], v[176:179], v[16:19]
    ds_bpermute_b32 v44, v51, v44
    ds_bpermute_b32 v45, v51, v45
    v_mfma_f32_16x16x32_bf16 v[20:23], a[136:139], v[176:179], v[20:23]
    ds_bpermute_b32 v46, v51, v46
    ds_bpermute_b32 v47, v51, v47
    v_mfma_f32_16x16x32_bf16 v[16:19], a[116:119], v[180:183], v[16:19]
    v_mfma_f32_16x16x32_bf16 v[20:23], a[140:143], v[180:183], v[20:23]
    v_mfma_f32_16x16x32_bf16 v[24:27], a[96:99], v[184:187], 0
    v_mfma_f32_16x16x32_bf16 v[28:31], a[120:123], v[184:187], 0
    v_mfma_f32_16x16x32_bf16 v[24:27], a[100:103], v[188:191], v[24:27]
    v_mfma_f32_16x16x32_bf16 v[28:31], a[124:127], v[188:191], v[28:31]
    s_waitcnt lgkmcnt(0)
    s_add_u32 s6, s69, 1994240
    v_mfma_f32_16x16x32_bf16 v[24:27], a[104:107], v[192:195], v[24:27]
    buffer_store_dwordx4 v[44:47], v13, s[8:11], s6 offen sc1
    v_mfma_f32_16x16x32_bf16 v[28:31], a[128:131], v[192:195], v[28:31]
    v_mfma_f32_16x16x32_bf16 v[24:27], a[108:111], v[196:199], v[24:27]
    v_cvt_pk_bf16_f32 v32, v16, v17
    v_cvt_pk_bf16_f32 v33, v18, v19
    v_mfma_f32_16x16x32_bf16 v[28:31], a[132:135], v[196:199], v[28:31]
    v_cvt_pk_bf16_f32 v34, v20, v21
    v_cvt_pk_bf16_f32 v35, v22, v23
    v_mfma_f32_16x16x32_bf16 v[24:27], a[112:115], v[200:203], v[24:27]
    ds_bpermute_b32 v32, v51, v32
    ds_bpermute_b32 v33, v51, v33
    v_mfma_f32_16x16x32_bf16 v[28:31], a[136:139], v[200:203], v[28:31]
    ds_bpermute_b32 v34, v51, v34
    ds_bpermute_b32 v35, v51, v35
    v_mfma_f32_16x16x32_bf16 v[24:27], a[116:119], v[204:207], v[24:27]
    v_mfma_f32_16x16x32_bf16 v[28:31], a[140:143], v[204:207], v[28:31]
    s_waitcnt vmcnt(32)
    v_mfma_f32_16x16x32_bf16 v[16:19], a[96:99], v[208:211], 0
    v_mfma_f32_16x16x32_bf16 v[20:23], a[120:123], v[208:211], 0
    v_mfma_f32_16x16x32_bf16 v[16:19], a[100:103], v[212:215], v[16:19]
    v_mfma_f32_16x16x32_bf16 v[20:23], a[124:127], v[212:215], v[20:23]
    s_waitcnt lgkmcnt(0)
    s_add_u32 s6, s69, 2658304
    v_mfma_f32_16x16x32_bf16 v[16:19], a[104:107], v[216:219], v[16:19]
    ds_read_b128 a[144:147], v15 offset:49152
    buffer_store_dwordx4 v[32:35], v13, s[8:11], s6 offen sc1
    v_mfma_f32_16x16x32_bf16 v[20:23], a[128:131], v[216:219], v[20:23]
    ds_read_b128 a[148:151], v48 offset:49152
    v_mfma_f32_16x16x32_bf16 v[16:19], a[108:111], v[220:223], v[16:19]
    v_cvt_pk_bf16_f32 v36, v24, v25
    v_cvt_pk_bf16_f32 v37, v26, v27
    v_mfma_f32_16x16x32_bf16 v[20:23], a[132:135], v[220:223], v[20:23]
    v_cvt_pk_bf16_f32 v38, v28, v29
    v_cvt_pk_bf16_f32 v39, v30, v31
    v_mfma_f32_16x16x32_bf16 v[16:19], a[112:115], v[224:227], v[16:19]
    ds_bpermute_b32 v36, v51, v36
    ds_bpermute_b32 v37, v51, v37
    v_mfma_f32_16x16x32_bf16 v[20:23], a[136:139], v[224:227], v[20:23]
    ds_bpermute_b32 v38, v51, v38
    ds_bpermute_b32 v39, v51, v39
    v_mfma_f32_16x16x32_bf16 v[16:19], a[116:119], v[228:231], v[16:19]
    ds_read_b128 a[152:155], v15 offset:50176
    ds_read_b128 a[156:159], v48 offset:50176
    ds_read_b128 a[160:163], v15 offset:51200
    ds_read_b128 a[164:167], v48 offset:51200
    ds_read_b128 a[168:171], v15 offset:55296
    v_mfma_f32_16x16x32_bf16 v[20:23], a[140:143], v[228:231], v[20:23]
    ds_read_b128 a[172:175], v48 offset:55296
    ds_read_b128 a[176:179], v15 offset:56320
    ds_read_b128 a[180:183], v48 offset:56320
    ds_read_b128 a[184:187], v15 offset:57344
    ds_read_b128 a[188:191], v48 offset:57344
    v_mfma_f32_16x16x32_bf16 v[24:27], a[96:99], v[232:235], 0
    v_mfma_f32_16x16x32_bf16 v[28:31], a[120:123], v[232:235], 0
    v_mfma_f32_16x16x32_bf16 v[24:27], a[100:103], v[236:239], v[24:27]
    v_mfma_f32_16x16x32_bf16 v[28:31], a[124:127], v[236:239], v[28:31]
    s_waitcnt lgkmcnt(0)
    s_add_u32 s6, s69, 3322368
    v_mfma_f32_16x16x32_bf16 v[24:27], a[104:107], v[240:243], v[24:27]
    buffer_store_dwordx4 v[36:39], v13, s[8:11], s6 offen sc1
    v_mfma_f32_16x16x32_bf16 v[28:31], a[128:131], v[240:243], v[28:31]
    v_mfma_f32_16x16x32_bf16 v[24:27], a[108:111], v[244:247], v[24:27]
    v_cvt_pk_bf16_f32 v40, v16, v17
    v_cvt_pk_bf16_f32 v41, v18, v19
    v_mfma_f32_16x16x32_bf16 v[28:31], a[132:135], v[244:247], v[28:31]
    v_cvt_pk_bf16_f32 v42, v20, v21
    v_cvt_pk_bf16_f32 v43, v22, v23
    v_mfma_f32_16x16x32_bf16 v[24:27], a[112:115], v[248:251], v[24:27]
    ds_bpermute_b32 v40, v51, v40
    ds_bpermute_b32 v41, v51, v41
    v_mfma_f32_16x16x32_bf16 v[28:31], a[136:139], v[248:251], v[28:31]
    ds_bpermute_b32 v42, v51, v42
    ds_bpermute_b32 v43, v51, v43
    v_mfma_f32_16x16x32_bf16 v[24:27], a[116:119], v[252:255], v[24:27]
    v_mfma_f32_16x16x32_bf16 v[28:31], a[140:143], v[252:255], v[28:31]
    v_mfma_f32_16x16x32_bf16 v[16:19], a[144:147], v[64:67], 0
    v_mfma_f32_16x16x32_bf16 v[20:23], a[168:171], v[64:67], 0
    v_mfma_f32_16x16x32_bf16 v[16:19], a[148:151], v[68:71], v[16:19]
    v_mfma_f32_16x16x32_bf16 v[20:23], a[172:175], v[68:71], v[20:23]
    s_waitcnt lgkmcnt(0)
    s_add_u32 s6, s69, 3986432
    v_mfma_f32_16x16x32_bf16 v[16:19], a[152:155], v[72:75], v[16:19]
    buffer_store_dwordx4 v[40:43], v13, s[8:11], s6 offen sc1
    v_mfma_f32_16x16x32_bf16 v[20:23], a[176:179], v[72:75], v[20:23]
    v_mfma_f32_16x16x32_bf16 v[16:19], a[156:159], v[76:79], v[16:19]
    v_cvt_pk_bf16_f32 v44, v24, v25
    v_cvt_pk_bf16_f32 v45, v26, v27
    v_mfma_f32_16x16x32_bf16 v[20:23], a[180:183], v[76:79], v[20:23]
    v_cvt_pk_bf16_f32 v46, v28, v29
    v_cvt_pk_bf16_f32 v47, v30, v31
    v_mfma_f32_16x16x32_bf16 v[16:19], a[160:163], v[80:83], v[16:19]
    ds_bpermute_b32 v44, v51, v44
    ds_bpermute_b32 v45, v51, v45
    v_mfma_f32_16x16x32_bf16 v[20:23], a[184:187], v[80:83], v[20:23]
    ds_bpermute_b32 v46, v51, v46
    ds_bpermute_b32 v47, v51, v47
    v_mfma_f32_16x16x32_bf16 v[16:19], a[164:167], v[84:87], v[16:19]
    v_mfma_f32_16x16x32_bf16 v[20:23], a[188:191], v[84:87], v[20:23]
    v_mfma_f32_16x16x32_bf16 v[24:27], a[144:147], v[88:91], 0
    v_mfma_f32_16x16x32_bf16 v[28:31], a[168:171], v[88:91], 0
    v_mfma_f32_16x16x32_bf16 v[24:27], a[148:151], v[92:95], v[24:27]
    v_mfma_f32_16x16x32_bf16 v[28:31], a[172:175], v[92:95], v[28:31]
    s_waitcnt lgkmcnt(0)
    s_add_u32 s6, s69, 4650496
    v_mfma_f32_16x16x32_bf16 v[24:27], a[152:155], v[96:99], v[24:27]
    buffer_store_dwordx4 v[44:47], v13, s[8:11], s6 offen sc1
    v_mfma_f32_16x16x32_bf16 v[28:31], a[176:179], v[96:99], v[28:31]
    v_mfma_f32_16x16x32_bf16 v[24:27], a[156:159], v[100:103], v[24:27]
    v_cvt_pk_bf16_f32 v32, v16, v17
    v_cvt_pk_bf16_f32 v33, v18, v19
    v_mfma_f32_16x16x32_bf16 v[28:31], a[180:183], v[100:103], v[28:31]
    v_cvt_pk_bf16_f32 v34, v20, v21
    v_cvt_pk_bf16_f32 v35, v22, v23
    v_mfma_f32_16x16x32_bf16 v[24:27], a[160:163], v[104:107], v[24:27]
    ds_bpermute_b32 v32, v51, v32
    ds_bpermute_b32 v33, v51, v33
    v_mfma_f32_16x16x32_bf16 v[28:31], a[184:187], v[104:107], v[28:31]
    ds_bpermute_b32 v34, v51, v34
    ds_bpermute_b32 v35, v51, v35
    v_mfma_f32_16x16x32_bf16 v[24:27], a[164:167], v[108:111], v[24:27]
    v_mfma_f32_16x16x32_bf16 v[28:31], a[188:191], v[108:111], v[28:31]
    v_mfma_f32_16x16x32_bf16 v[16:19], a[144:147], v[112:115], 0
    v_mfma_f32_16x16x32_bf16 v[20:23], a[168:171], v[112:115], 0
    v_mfma_f32_16x16x32_bf16 v[16:19], a[148:151], v[116:119], v[16:19]
    v_mfma_f32_16x16x32_bf16 v[20:23], a[172:175], v[116:119], v[20:23]
    s_waitcnt lgkmcnt(0)
    s_add_u32 s6, s69, 3072
    v_mfma_f32_16x16x32_bf16 v[16:19], a[152:155], v[120:123], v[16:19]
    buffer_store_dwordx4 v[32:35], v13, s[8:11], s6 offen sc1
    v_mfma_f32_16x16x32_bf16 v[20:23], a[176:179], v[120:123], v[20:23]
    v_mfma_f32_16x16x32_bf16 v[16:19], a[156:159], v[124:127], v[16:19]
    v_cvt_pk_bf16_f32 v36, v24, v25
    v_cvt_pk_bf16_f32 v37, v26, v27
    v_mfma_f32_16x16x32_bf16 v[20:23], a[180:183], v[124:127], v[20:23]
    v_cvt_pk_bf16_f32 v38, v28, v29
    v_cvt_pk_bf16_f32 v39, v30, v31
    v_mfma_f32_16x16x32_bf16 v[16:19], a[160:163], v[128:131], v[16:19]
    ds_bpermute_b32 v36, v51, v36
    ds_bpermute_b32 v37, v51, v37
    v_mfma_f32_16x16x32_bf16 v[20:23], a[184:187], v[128:131], v[20:23]
    ds_bpermute_b32 v38, v51, v38
    ds_bpermute_b32 v39, v51, v39
    v_mfma_f32_16x16x32_bf16 v[16:19], a[164:167], v[132:135], v[16:19]
    v_mfma_f32_16x16x32_bf16 v[20:23], a[188:191], v[132:135], v[20:23]
    v_mfma_f32_16x16x32_bf16 v[24:27], a[144:147], v[136:139], 0
    v_mfma_f32_16x16x32_bf16 v[28:31], a[168:171], v[136:139], 0
    v_mfma_f32_16x16x32_bf16 v[24:27], a[148:151], v[140:143], v[24:27]
    v_mfma_f32_16x16x32_bf16 v[28:31], a[172:175], v[140:143], v[28:31]
    s_waitcnt lgkmcnt(0)
    s_add_u32 s6, s69, 667136
    v_mfma_f32_16x16x32_bf16 v[24:27], a[152:155], v[144:147], v[24:27]
    buffer_store_dwordx4 v[36:39], v13, s[8:11], s6 offen sc1
    v_mfma_f32_16x16x32_bf16 v[28:31], a[176:179], v[144:147], v[28:31]
    v_mfma_f32_16x16x32_bf16 v[24:27], a[156:159], v[148:151], v[24:27]
    v_cvt_pk_bf16_f32 v40, v16, v17
    v_cvt_pk_bf16_f32 v41, v18, v19
    v_mfma_f32_16x16x32_bf16 v[28:31], a[180:183], v[148:151], v[28:31]
    v_cvt_pk_bf16_f32 v42, v20, v21
    v_cvt_pk_bf16_f32 v43, v22, v23
    v_mfma_f32_16x16x32_bf16 v[24:27], a[160:163], v[152:155], v[24:27]
    ds_bpermute_b32 v40, v51, v40
    ds_bpermute_b32 v41, v51, v41
    v_mfma_f32_16x16x32_bf16 v[28:31], a[184:187], v[152:155], v[28:31]
    ds_bpermute_b32 v42, v51, v42
    ds_bpermute_b32 v43, v51, v43
    v_mfma_f32_16x16x32_bf16 v[24:27], a[164:167], v[156:159], v[24:27]
    v_mfma_f32_16x16x32_bf16 v[28:31], a[188:191], v[156:159], v[28:31]
    v_mfma_f32_16x16x32_bf16 v[16:19], a[144:147], v[160:163], 0
    v_mfma_f32_16x16x32_bf16 v[20:23], a[168:171], v[160:163], 0
    v_mfma_f32_16x16x32_bf16 v[16:19], a[148:151], v[164:167], v[16:19]
    v_mfma_f32_16x16x32_bf16 v[20:23], a[172:175], v[164:167], v[20:23]
    s_waitcnt lgkmcnt(0)
    s_add_u32 s6, s69, 1331200
    v_mfma_f32_16x16x32_bf16 v[16:19], a[152:155], v[168:171], v[16:19]
    buffer_store_dwordx4 v[40:43], v13, s[8:11], s6 offen sc1
    v_mfma_f32_16x16x32_bf16 v[20:23], a[176:179], v[168:171], v[20:23]
    v_mfma_f32_16x16x32_bf16 v[16:19], a[156:159], v[172:175], v[16:19]
    v_cvt_pk_bf16_f32 v44, v24, v25
    v_cvt_pk_bf16_f32 v45, v26, v27
    v_mfma_f32_16x16x32_bf16 v[20:23], a[180:183], v[172:175], v[20:23]
    v_cvt_pk_bf16_f32 v46, v28, v29
    v_cvt_pk_bf16_f32 v47, v30, v31
    v_mfma_f32_16x16x32_bf16 v[16:19], a[160:163], v[176:179], v[16:19]
    ds_bpermute_b32 v44, v51, v44
    ds_bpermute_b32 v45, v51, v45
    v_mfma_f32_16x16x32_bf16 v[20:23], a[184:187], v[176:179], v[20:23]
    ds_bpermute_b32 v46, v51, v46
    ds_bpermute_b32 v47, v51, v47
    v_mfma_f32_16x16x32_bf16 v[16:19], a[164:167], v[180:183], v[16:19]
    v_mfma_f32_16x16x32_bf16 v[20:23], a[188:191], v[180:183], v[20:23]
    v_mfma_f32_16x16x32_bf16 v[24:27], a[144:147], v[184:187], 0
    v_mfma_f32_16x16x32_bf16 v[28:31], a[168:171], v[184:187], 0
    v_mfma_f32_16x16x32_bf16 v[24:27], a[148:151], v[188:191], v[24:27]
    v_mfma_f32_16x16x32_bf16 v[28:31], a[172:175], v[188:191], v[28:31]
    s_waitcnt lgkmcnt(0)
    s_add_u32 s6, s69, 1995264
    v_mfma_f32_16x16x32_bf16 v[24:27], a[152:155], v[192:195], v[24:27]
    buffer_store_dwordx4 v[44:47], v13, s[8:11], s6 offen sc1
    v_mfma_f32_16x16x32_bf16 v[28:31], a[176:179], v[192:195], v[28:31]
    v_mfma_f32_16x16x32_bf16 v[24:27], a[156:159], v[196:199], v[24:27]
    v_cvt_pk_bf16_f32 v32, v16, v17
    v_cvt_pk_bf16_f32 v33, v18, v19
    v_mfma_f32_16x16x32_bf16 v[28:31], a[180:183], v[196:199], v[28:31]
    v_cvt_pk_bf16_f32 v34, v20, v21
    v_cvt_pk_bf16_f32 v35, v22, v23
    v_mfma_f32_16x16x32_bf16 v[24:27], a[160:163], v[200:203], v[24:27]
    ds_bpermute_b32 v32, v51, v32
    ds_bpermute_b32 v33, v51, v33
    v_mfma_f32_16x16x32_bf16 v[28:31], a[184:187], v[200:203], v[28:31]
    ds_bpermute_b32 v34, v51, v34
    ds_bpermute_b32 v35, v51, v35
    v_mfma_f32_16x16x32_bf16 v[24:27], a[164:167], v[204:207], v[24:27]
    v_mfma_f32_16x16x32_bf16 v[28:31], a[188:191], v[204:207], v[28:31]
    s_waitcnt vmcnt(22)
    v_mfma_f32_16x16x32_bf16 v[16:19], a[144:147], v[208:211], 0
    v_mfma_f32_16x16x32_bf16 v[20:23], a[168:171], v[208:211], 0
    v_mfma_f32_16x16x32_bf16 v[16:19], a[148:151], v[212:215], v[16:19]
    v_mfma_f32_16x16x32_bf16 v[20:23], a[172:175], v[212:215], v[20:23]
    s_waitcnt lgkmcnt(0)
    s_add_u32 s6, s69, 2659328
    v_mfma_f32_16x16x32_bf16 v[16:19], a[152:155], v[216:219], v[16:19]
    ds_read_b128 a[192:195], v49 offset:0
    buffer_store_dwordx4 v[32:35], v13, s[8:11], s6 offen sc1
    v_mfma_f32_16x16x32_bf16 v[20:23], a[176:179], v[216:219], v[20:23]
    ds_read_b128 a[196:199], v50 offset:0
    v_mfma_f32_16x16x32_bf16 v[16:19], a[156:159], v[220:223], v[16:19]
    v_cvt_pk_bf16_f32 v36, v24, v25
    v_cvt_pk_bf16_f32 v37, v26, v27
    v_mfma_f32_16x16x32_bf16 v[20:23], a[180:183], v[220:223], v[20:23]
    v_cvt_pk_bf16_f32 v38, v28, v29
    v_cvt_pk_bf16_f32 v39, v30, v31
    v_mfma_f32_16x16x32_bf16 v[16:19], a[160:163], v[224:227], v[16:19]
    ds_bpermute_b32 v36, v51, v36
    ds_bpermute_b32 v37, v51, v37
    v_mfma_f32_16x16x32_bf16 v[20:23], a[184:187], v[224:227], v[20:23]
    ds_bpermute_b32 v38, v51, v38
    ds_bpermute_b32 v39, v51, v39
    v_mfma_f32_16x16x32_bf16 v[16:19], a[164:167], v[228:231], v[16:19]
    ds_read_b128 a[200:203], v49 offset:1024
    ds_read_b128 a[204:207], v50 offset:1024
    ds_read_b128 a[208:211], v49 offset:2048
    ds_read_b128 a[212:215], v50 offset:2048
    ds_read_b128 a[216:219], v49 offset:6144
    v_mfma_f32_16x16x32_bf16 v[20:23], a[188:191], v[228:231], v[20:23]
    ds_read_b128 a[220:223], v50 offset:6144
    ds_read_b128 a[224:227], v49 offset:7168
    ds_read_b128 a[228:231], v50 offset:7168
    ds_read_b128 a[232:235], v49 offset:8192
    ds_read_b128 a[236:239], v50 offset:8192
    v_mfma_f32_16x16x32_bf16 v[24:27], a[144:147], v[232:235], 0
    v_mfma_f32_16x16x32_bf16 v[28:31], a[168:171], v[232:235], 0
    v_mfma_f32_16x16x32_bf16 v[24:27], a[148:151], v[236:239], v[24:27]
    v_mfma_f32_16x16x32_bf16 v[28:31], a[172:175], v[236:239], v[28:31]
    s_waitcnt lgkmcnt(0)
    s_add_u32 s6, s69, 3323392
    v_mfma_f32_16x16x32_bf16 v[24:27], a[152:155], v[240:243], v[24:27]
    buffer_store_dwordx4 v[36:39], v13, s[8:11], s6 offen sc1
    v_mfma_f32_16x16x32_bf16 v[28:31], a[176:179], v[240:243], v[28:31]
    v_mfma_f32_16x16x32_bf16 v[24:27], a[156:159], v[244:247], v[24:27]
    v_cvt_pk_bf16_f32 v40, v16, v17
    v_cvt_pk_bf16_f32 v41, v18, v19
    v_mfma_f32_16x16x32_bf16 v[28:31], a[180:183], v[244:247], v[28:31]
    v_cvt_pk_bf16_f32 v42, v20, v21
    v_cvt_pk_bf16_f32 v43, v22, v23
    v_mfma_f32_16x16x32_bf16 v[24:27], a[160:163], v[248:251], v[24:27]
    ds_bpermute_b32 v40, v51, v40
    ds_bpermute_b32 v41, v51, v41
    v_mfma_f32_16x16x32_bf16 v[28:31], a[184:187], v[248:251], v[28:31]
    ds_bpermute_b32 v42, v51, v42
    ds_bpermute_b32 v43, v51, v43
    v_mfma_f32_16x16x32_bf16 v[24:27], a[164:167], v[252:255], v[24:27]
    v_mfma_f32_16x16x32_bf16 v[28:31], a[188:191], v[252:255], v[28:31]
    v_mfma_f32_16x16x32_bf16 v[16:19], a[192:195], v[64:67], 0
    v_mfma_f32_16x16x32_bf16 v[20:23], a[216:219], v[64:67], 0
    v_mfma_f32_16x16x32_bf16 v[16:19], a[196:199], v[68:71], v[16:19]
    v_mfma_f32_16x16x32_bf16 v[20:23], a[220:223], v[68:71], v[20:23]
    s_waitcnt lgkmcnt(0)
    s_add_u32 s6, s69, 3987456
    v_mfma_f32_16x16x32_bf16 v[16:19], a[200:203], v[72:75], v[16:19]
    buffer_store_dwordx4 v[40:43], v13, s[8:11], s6 offen sc1
    v_mfma_f32_16x16x32_bf16 v[20:23], a[224:227], v[72:75], v[20:23]
    v_mfma_f32_16x16x32_bf16 v[16:19], a[204:207], v[76:79], v[16:19]
    v_cvt_pk_bf16_f32 v44, v24, v25
    v_cvt_pk_bf16_f32 v45, v26, v27
    v_mfma_f32_16x16x32_bf16 v[20:23], a[228:231], v[76:79], v[20:23]
    v_cvt_pk_bf16_f32 v46, v28, v29
    v_cvt_pk_bf16_f32 v47, v30, v31
    v_mfma_f32_16x16x32_bf16 v[16:19], a[208:211], v[80:83], v[16:19]
    ds_bpermute_b32 v44, v51, v44
    ds_bpermute_b32 v45, v51, v45
    v_mfma_f32_16x16x32_bf16 v[20:23], a[232:235], v[80:83], v[20:23]
    ds_bpermute_b32 v46, v51, v46
    ds_bpermute_b32 v47, v51, v47
    v_mfma_f32_16x16x32_bf16 v[16:19], a[212:215], v[84:87], v[16:19]
    v_mfma_f32_16x16x32_bf16 v[20:23], a[236:239], v[84:87], v[20:23]
    v_mfma_f32_16x16x32_bf16 v[24:27], a[192:195], v[88:91], 0
    v_mfma_f32_16x16x32_bf16 v[28:31], a[216:219], v[88:91], 0
    v_mfma_f32_16x16x32_bf16 v[24:27], a[196:199], v[92:95], v[24:27]
    v_mfma_f32_16x16x32_bf16 v[28:31], a[220:223], v[92:95], v[28:31]
    s_waitcnt lgkmcnt(0)
    s_add_u32 s6, s69, 4651520
    v_mfma_f32_16x16x32_bf16 v[24:27], a[200:203], v[96:99], v[24:27]
    buffer_store_dwordx4 v[44:47], v13, s[8:11], s6 offen sc1
    v_mfma_f32_16x16x32_bf16 v[28:31], a[224:227], v[96:99], v[28:31]
    v_mfma_f32_16x16x32_bf16 v[24:27], a[204:207], v[100:103], v[24:27]
    v_cvt_pk_bf16_f32 v32, v16, v17
    v_cvt_pk_bf16_f32 v33, v18, v19
    v_mfma_f32_16x16x32_bf16 v[28:31], a[228:231], v[100:103], v[28:31]
    v_cvt_pk_bf16_f32 v34, v20, v21
    v_cvt_pk_bf16_f32 v35, v22, v23
    v_mfma_f32_16x16x32_bf16 v[24:27], a[208:211], v[104:107], v[24:27]
    ds_bpermute_b32 v32, v51, v32
    ds_bpermute_b32 v33, v51, v33
    v_mfma_f32_16x16x32_bf16 v[28:31], a[232:235], v[104:107], v[28:31]
    ds_bpermute_b32 v34, v51, v34
    ds_bpermute_b32 v35, v51, v35
    v_mfma_f32_16x16x32_bf16 v[24:27], a[212:215], v[108:111], v[24:27]
    v_mfma_f32_16x16x32_bf16 v[28:31], a[236:239], v[108:111], v[28:31]
    v_mfma_f32_16x16x32_bf16 v[16:19], a[192:195], v[112:115], 0
    v_mfma_f32_16x16x32_bf16 v[20:23], a[216:219], v[112:115], 0
    v_mfma_f32_16x16x32_bf16 v[16:19], a[196:199], v[116:119], v[16:19]
    v_mfma_f32_16x16x32_bf16 v[20:23], a[220:223], v[116:119], v[20:23]
    s_waitcnt lgkmcnt(0)
    s_add_u32 s6, s69, 4096
    v_mfma_f32_16x16x32_bf16 v[16:19], a[200:203], v[120:123], v[16:19]
    buffer_store_dwordx4 v[32:35], v13, s[8:11], s6 offen sc1
    v_mfma_f32_16x16x32_bf16 v[20:23], a[224:227], v[120:123], v[20:23]
    v_mfma_f32_16x16x32_bf16 v[16:19], a[204:207], v[124:127], v[16:19]
    v_cvt_pk_bf16_f32 v36, v24, v25
    v_cvt_pk_bf16_f32 v37, v26, v27
    v_mfma_f32_16x16x32_bf16 v[20:23], a[228:231], v[124:127], v[20:23]
    v_cvt_pk_bf16_f32 v38, v28, v29
    v_cvt_pk_bf16_f32 v39, v30, v31
    v_mfma_f32_16x16x32_bf16 v[16:19], a[208:211], v[128:131], v[16:19]
    ds_bpermute_b32 v36, v51, v36
    ds_bpermute_b32 v37, v51, v37
    v_mfma_f32_16x16x32_bf16 v[20:23], a[232:235], v[128:131], v[20:23]
    ds_bpermute_b32 v38, v51, v38
    ds_bpermute_b32 v39, v51, v39
    v_mfma_f32_16x16x32_bf16 v[16:19], a[212:215], v[132:135], v[16:19]
    v_mfma_f32_16x16x32_bf16 v[20:23], a[236:239], v[132:135], v[20:23]
    v_mfma_f32_16x16x32_bf16 v[24:27], a[192:195], v[136:139], 0
    v_mfma_f32_16x16x32_bf16 v[28:31], a[216:219], v[136:139], 0
    v_mfma_f32_16x16x32_bf16 v[24:27], a[196:199], v[140:143], v[24:27]
    v_mfma_f32_16x16x32_bf16 v[28:31], a[220:223], v[140:143], v[28:31]
    s_waitcnt lgkmcnt(0)
    s_add_u32 s6, s69, 668160
    v_mfma_f32_16x16x32_bf16 v[24:27], a[200:203], v[144:147], v[24:27]
    buffer_store_dwordx4 v[36:39], v13, s[8:11], s6 offen sc1
    v_mfma_f32_16x16x32_bf16 v[28:31], a[224:227], v[144:147], v[28:31]
    v_mfma_f32_16x16x32_bf16 v[24:27], a[204:207], v[148:151], v[24:27]
    v_cvt_pk_bf16_f32 v40, v16, v17
    v_cvt_pk_bf16_f32 v41, v18, v19
    v_mfma_f32_16x16x32_bf16 v[28:31], a[228:231], v[148:151], v[28:31]
    v_cvt_pk_bf16_f32 v42, v20, v21
    v_cvt_pk_bf16_f32 v43, v22, v23
    v_mfma_f32_16x16x32_bf16 v[24:27], a[208:211], v[152:155], v[24:27]
    ds_bpermute_b32 v40, v51, v40
    ds_bpermute_b32 v41, v51, v41
    v_mfma_f32_16x16x32_bf16 v[28:31], a[232:235], v[152:155], v[28:31]
    ds_bpermute_b32 v42, v51, v42
    ds_bpermute_b32 v43, v51, v43
    v_mfma_f32_16x16x32_bf16 v[24:27], a[212:215], v[156:159], v[24:27]
    v_mfma_f32_16x16x32_bf16 v[28:31], a[236:239], v[156:159], v[28:31]
    v_mfma_f32_16x16x32_bf16 v[16:19], a[192:195], v[160:163], 0
    v_mfma_f32_16x16x32_bf16 v[20:23], a[216:219], v[160:163], 0
    v_mfma_f32_16x16x32_bf16 v[16:19], a[196:199], v[164:167], v[16:19]
    v_mfma_f32_16x16x32_bf16 v[20:23], a[220:223], v[164:167], v[20:23]
    s_waitcnt lgkmcnt(0)
    s_add_u32 s6, s69, 1332224
    v_mfma_f32_16x16x32_bf16 v[16:19], a[200:203], v[168:171], v[16:19]
    buffer_store_dwordx4 v[40:43], v13, s[8:11], s6 offen sc1
    v_mfma_f32_16x16x32_bf16 v[20:23], a[224:227], v[168:171], v[20:23]
    v_mfma_f32_16x16x32_bf16 v[16:19], a[204:207], v[172:175], v[16:19]
    v_cvt_pk_bf16_f32 v44, v24, v25
    v_cvt_pk_bf16_f32 v45, v26, v27
    v_mfma_f32_16x16x32_bf16 v[20:23], a[228:231], v[172:175], v[20:23]
    v_cvt_pk_bf16_f32 v46, v28, v29
    v_cvt_pk_bf16_f32 v47, v30, v31
    v_mfma_f32_16x16x32_bf16 v[16:19], a[208:211], v[176:179], v[16:19]
    ds_bpermute_b32 v44, v51, v44
    ds_bpermute_b32 v45, v51, v45
    v_mfma_f32_16x16x32_bf16 v[20:23], a[232:235], v[176:179], v[20:23]
    ds_bpermute_b32 v46, v51, v46
    ds_bpermute_b32 v47, v51, v47
    v_mfma_f32_16x16x32_bf16 v[16:19], a[212:215], v[180:183], v[16:19]
    v_mfma_f32_16x16x32_bf16 v[20:23], a[236:239], v[180:183], v[20:23]
    v_mfma_f32_16x16x32_bf16 v[24:27], a[192:195], v[184:187], 0
    v_mfma_f32_16x16x32_bf16 v[28:31], a[216:219], v[184:187], 0
    v_mfma_f32_16x16x32_bf16 v[24:27], a[196:199], v[188:191], v[24:27]
    v_mfma_f32_16x16x32_bf16 v[28:31], a[220:223], v[188:191], v[28:31]
    s_waitcnt lgkmcnt(0)
    s_add_u32 s6, s69, 1996288
    v_mfma_f32_16x16x32_bf16 v[24:27], a[200:203], v[192:195], v[24:27]
    buffer_store_dwordx4 v[44:47], v13, s[8:11], s6 offen sc1
    v_mfma_f32_16x16x32_bf16 v[28:31], a[224:227], v[192:195], v[28:31]
    v_mfma_f32_16x16x32_bf16 v[24:27], a[204:207], v[196:199], v[24:27]
    v_cvt_pk_bf16_f32 v32, v16, v17
    v_cvt_pk_bf16_f32 v33, v18, v19
    v_mfma_f32_16x16x32_bf16 v[28:31], a[228:231], v[196:199], v[28:31]
    v_cvt_pk_bf16_f32 v34, v20, v21
    v_cvt_pk_bf16_f32 v35, v22, v23
    v_mfma_f32_16x16x32_bf16 v[24:27], a[208:211], v[200:203], v[24:27]
    ds_bpermute_b32 v32, v51, v32
    ds_bpermute_b32 v33, v51, v33
    v_mfma_f32_16x16x32_bf16 v[28:31], a[232:235], v[200:203], v[28:31]
    ds_bpermute_b32 v34, v51, v34
    ds_bpermute_b32 v35, v51, v35
    v_mfma_f32_16x16x32_bf16 v[24:27], a[212:215], v[204:207], v[24:27]
    v_mfma_f32_16x16x32_bf16 v[28:31], a[236:239], v[204:207], v[28:31]
    v_mfma_f32_16x16x32_bf16 v[16:19], a[192:195], v[208:211], 0
    v_mfma_f32_16x16x32_bf16 v[20:23], a[216:219], v[208:211], 0
    v_mfma_f32_16x16x32_bf16 v[16:19], a[196:199], v[212:215], v[16:19]
    v_mfma_f32_16x16x32_bf16 v[20:23], a[220:223], v[212:215], v[20:23]
    s_waitcnt lgkmcnt(0)
    s_add_u32 s6, s69, 2660352
    v_mfma_f32_16x16x32_bf16 v[16:19], a[200:203], v[216:219], v[16:19]
    buffer_store_dwordx4 v[32:35], v13, s[8:11], s6 offen sc1
    v_mfma_f32_16x16x32_bf16 v[20:23], a[224:227], v[216:219], v[20:23]
    v_mfma_f32_16x16x32_bf16 v[16:19], a[204:207], v[220:223], v[16:19]
    v_cvt_pk_bf16_f32 v36, v24, v25
    v_cvt_pk_bf16_f32 v37, v26, v27
    v_mfma_f32_16x16x32_bf16 v[20:23], a[228:231], v[220:223], v[20:23]
    v_cvt_pk_bf16_f32 v38, v28, v29
    v_cvt_pk_bf16_f32 v39, v30, v31
    v_mfma_f32_16x16x32_bf16 v[16:19], a[208:211], v[224:227], v[16:19]
    ds_bpermute_b32 v36, v51, v36
    ds_bpermute_b32 v37, v51, v37
    v_mfma_f32_16x16x32_bf16 v[20:23], a[232:235], v[224:227], v[20:23]
    ds_bpermute_b32 v38, v51, v38
    ds_bpermute_b32 v39, v51, v39
    v_mfma_f32_16x16x32_bf16 v[16:19], a[212:215], v[228:231], v[16:19]
    v_mfma_f32_16x16x32_bf16 v[20:23], a[236:239], v[228:231], v[20:23]
    v_mfma_f32_16x16x32_bf16 v[24:27], a[192:195], v[232:235], 0
    v_mfma_f32_16x16x32_bf16 v[28:31], a[216:219], v[232:235], 0
    v_mfma_f32_16x16x32_bf16 v[24:27], a[196:199], v[236:239], v[24:27]
    v_mfma_f32_16x16x32_bf16 v[28:31], a[220:223], v[236:239], v[28:31]
    s_waitcnt lgkmcnt(0)
    s_add_u32 s6, s69, 3324416
    v_mfma_f32_16x16x32_bf16 v[24:27], a[200:203], v[240:243], v[24:27]
    buffer_store_dwordx4 v[36:39], v13, s[8:11], s6 offen sc1
    v_mfma_f32_16x16x32_bf16 v[28:31], a[224:227], v[240:243], v[28:31]
    v_mfma_f32_16x16x32_bf16 v[24:27], a[204:207], v[244:247], v[24:27]
    v_cvt_pk_bf16_f32 v40, v16, v17
    v_cvt_pk_bf16_f32 v41, v18, v19
    v_mfma_f32_16x16x32_bf16 v[28:31], a[228:231], v[244:247], v[28:31]
    v_cvt_pk_bf16_f32 v42, v20, v21
    v_cvt_pk_bf16_f32 v43, v22, v23
    v_mfma_f32_16x16x32_bf16 v[24:27], a[208:211], v[248:251], v[24:27]
    ds_bpermute_b32 v40, v51, v40
    ds_bpermute_b32 v41, v51, v41
    v_mfma_f32_16x16x32_bf16 v[28:31], a[232:235], v[248:251], v[28:31]
    ds_bpermute_b32 v42, v51, v42
    ds_bpermute_b32 v43, v51, v43
    v_mfma_f32_16x16x32_bf16 v[24:27], a[212:215], v[252:255], v[24:27]
    v_mfma_f32_16x16x32_bf16 v[28:31], a[236:239], v[252:255], v[28:31]
    s_waitcnt lgkmcnt(0)
    s_add_u32 s6, s69, 3988480
    buffer_store_dwordx4 v[40:43], v13, s[8:11], s6 offen sc1
    s_nop 3
    v_cvt_pk_bf16_f32 v44, v24, v25
    v_cvt_pk_bf16_f32 v45, v26, v27
    v_cvt_pk_bf16_f32 v46, v28, v29
    v_cvt_pk_bf16_f32 v47, v30, v31
    ds_bpermute_b32 v44, v51, v44
    ds_bpermute_b32 v45, v51, v45
    ds_bpermute_b32 v46, v51, v46
    ds_bpermute_b32 v47, v51, v47
    s_waitcnt lgkmcnt(0)
    s_add_u32 s6, s69, 4652544
    buffer_store_dwordx4 v[44:47], v13, s[8:11], s6 offen sc1
    s_lshl_b32 s33, s65, 5
    s_lshr_b32 s6, s64, 3
    s_lshl_b32 s6, s6, 2
    s_add_u32 s33, s33, s6
    s_add_u32 s33, s33, 16
    s_and_b32 s6, s64, 6
    s_lshl_b32 s6, s6, 2
    s_lshl_b32 s34, 1, s6
    s_waitcnt vmcnt(0)
    s_barrier
    s_cmp_lg_u32 s3, 0
    s_cbranch_scc1 SG_5
    v_mov_b32 v3, s33
    v_mov_b32 v2, s34
    s_mov_b64 exec, 1
    buffer_atomic_add v2, v3, s[24:27], 0 offen sc1
    s_mov_b64 exec, -1
SG_5:
    s_cmp_ge_u32 s4, 192
    s_cbranch_scc1 L_A
    s_and_b32 s6, s4, 31
    s_cmp_ge_u32 s6, 27
    s_cbranch_scc1 L_END
    s_lshr_b32 s5, s4, 5
    s_mul_i32 s5, s5, 27
    s_add_u32 s5, s5, s6
    s_sub_u32 s5, s5, 27
    s_cmp_lt_u32 s5, 80
    s_cbranch_scc1 L_S2
L_END:
    s_endpgm
L_S2:
    s_barrier
    v_lshrrev_b32 v2, 3, v0
    s_lshl_b32 s6, s3, 3
    v_add_u32 v2, s6, v2
    v_bfe_u32 v3, v2, 1, 3
    v_and_b32 v11, 7, v0
    v_xor_b32 v3, v3, v11
    v_mul_u32_u24 v2, 1280, v2
    v_lshl_add_u32 v9, v3, 4, v2
    v_bfe_u32 v2, v0, 1, 3
    v_lshrrev_b32 v3, 4, v0
    v_xor_b32 v2, v2, v3
    v_lshlrev_b32 v11, 7, v11
    v_lshl_add_u32 v11, v2, 4, v11
    v_bfe_u32 v2, v0, 3, 1
    v_mul_u32_u24 v2, 10240, v2
    v_add_u32 v11, v11, v2
    v_add_u32 v11, 81920, v11
    v_xor_b32 v10, 64, v11
    s_mul_i32 s70, s3, 10240
    s_add_u32 s71, s70, 122880
    s_add_u32 s70, s70, 81920
    s_mov_b32 s69, 0
    s_add_u32 m0, s70, 0
    s_nop 0
    buffer_load_dwordx4 v9, s[12:15], s69 offen offset:0 lds
    s_add_u32 m0, s70, 896
    s_nop 0
    buffer_load_dwordx4 v9, s[12:15], s69 offen offset:128 lds
    s_add_u32 m0, s70, 1792
    s_nop 0
    buffer_load_dwordx4 v9, s[12:15], s69 offen offset:256 lds
    s_add_u32 m0, s70, 2688
    s_nop 0
    buffer_load_dwordx4 v9, s[12:15], s69 offen offset:384 lds
    s_add_u32 m0, s70, 3584
    s_nop 0
    buffer_load_dwordx4 v9, s[12:15], s69 offen offset:512 lds
    s_add_u32 m0, s70, 4480
    s_nop 0
    buffer_load_dwordx4 v9, s[12:15], s69 offen offset:640 lds
    s_add_u32 m0, s70, 5376
    s_nop 0
    buffer_load_dwordx4 v9, s[12:15], s69 offen offset:768 lds
    s_add_u32 m0, s70, 6272
    s_nop 0
    buffer_load_dwordx4 v9, s[12:15], s69 offen offset:896 lds
    s_add_u32 m0, s70, 7168
    s_nop 0
    buffer_load_dwordx4 v9, s[12:15], s69 offen offset:1024 lds
    s_add_u32 m0, s70, 8064
    s_nop 0
    buffer_load_dwordx4 v9, s[12:15], s69 offen offset:1152 lds
    s_lshl_b32 s6, s3, 14
    s_add_u32 s6, s6, 5120
    v_lshl_add_u32 v1, v0, 4, s6
    v_and_b32 v5, 31, v0
    s_add_u32 s6, s6, 2048
    v_lshl_add_u32 v4, v5, 4, s6
    s_mul_i32 s6, s3, 2560
    s_add_u32 s6, s6, 2048
    v_lshl_add_u32 v6, v5, 4, s6
    s_sub_u32 s6, s6, 2048
    v_lshl_add_u32 v5, v0, 4, s6
    s_mov_b32 s6, 0
    v_lshl_add_u32 v7, v0, 4, s6
    v_and_b32 v8, 8, v0
    v_cmp_eq_u32 vcc, 0, v8
    v_mov_b32 v8, 0xeeee
    v_mov_b32 v2, 0x4444
    v_cndmask_b32 v8, v8, v2, vcc
    v_lshlrev_b32 v2, 4, v0
    s_mov_b32 s35, 40960
    s_mul_i32 s60, s3, 10240
    s_add_u32 s60, s60, 40960
    v_add_u32 v181, s60, v2
    s_lshl_b32 s6, s3, 14
    v_add_u32 v12, s6, v2
    v_bfe_u32 v20, v0, 2, 2
    v_lshrrev_b32 v21, 4, v0
    v_lshl_add_u32 v20, v20, 2, v21
    v_and_b32 v21, 3, v0
    v_lshl_add_u32 v20, v20, 2, v21
    v_lshl_add_u32 v180, v20, 4, s6
    s_mul_i32 s6, s3, 5120
    v_add_u32 v13, s6, v2
    v_lshrrev_b32 v20, 5, v0
    v_bfe_u32 v21, v0, 3, 1
    v_and_b32 v22, 7, v0
    v_bfe_u32 v23, v0, 4, 1
    v_lshlrev_b32 v22, 5, v22
    v_lshl_add_u32 v22, v23, 4, v22
    v_lshl_add_u32 v22, v20, 8, v22
    s_lshl_b32 s6, s3, 9
    s_add_u32 s6, s6, 16384
    v_add_u32 v22, s6, v22
    v_add_u32 v23, 8, v22
    v_cmp_eq_u32 vcc, v20, v21
    s_nop 1
    v_cndmask_b32 v14, v23, v22, vcc
    s_mov_b64 s[58:59], vcc
    v_add_u32 v23, 2048, v22
    v_cndmask_b32 v182, v23, v22, vcc
    v_xor_b32 v183, 128, v13
    v_xor_b32 v4, 128, v181
    s_mul_i32 s61, s3, 2560
    v_and_b32 v22, 31, v0
    v_lshlrev_b32 v23, 3, v22
    v_add_u32 v15, 16384, v23
    s_lshl_b32 s6, s3, 11
    s_add_u32 s6, s6, 2048
    v_add_u32 v16, s6, v15
    v_lshlrev_b32 v22, 2, v0
    v_mov_b32 v23, 1073741824
    v_cmp_gt_u32 vcc, 32, v0
    s_nop 1
    v_cndmask_b32 v22, v23, v22, vcc
    s_mul_i32 s6, s5, 3277
    s_lshr_b32 s6, s6, 16
    s_mul_i32 s7, s6, 20
    s_sub_u32 s7, s5, s7
    s_lshl_b32 s6, s6, 14
    s_lshl_b32 s7, s7, 7
    s_add_u32 s6, s6, s7
    s_add_u32 s6, s6, 5120
    v_add_u32 v17, s6, v22
    s_lshl_b32 s6, s5, 9
    s_lshl_b32 s7, s3, 7
    s_add_u32 s6, s6, s7
    v_add_u32 v18, s6, v22
    s_lshr_b32 s33, s5, 4
    s_lshl_b32 s33, s33, 5
    s_lshl_b32 s6, s3, 2
    s_add_u32 s33, s33, s6
    s_add_u32 s33, s33, 16
    s_mul_i32 s34, s5, 332032
    s_mul_i32 s6, s3, 81920
    s_add_u32 s34, s34, s6
    s_add_u32 s34, s34, 16777216
    v_lshrrev_b32 v2, 4, v0
    v_bfe_u32 v3, v0, 3, 1
    v_lshl_add_u32 v2, v3, 2, v2
    v_and_b32 v3, 7, v0
    v_lshl_add_u32 v2, v2, 3, v3
    v_lshlrev_b32 v2, 4, v2
    v_mov_b32 v21, s33
PC_6:
    buffer_load_dword v20, v21, s[24:27], 0 offen sc1
    s_waitcnt vmcnt(0)
    v_readfirstlane_b32 s6, v20
    s_and_b32 s7, s6, 255
    s_cmp_ge_u32 s7, 2
    s_cbranch_scc1 PD_7
    s_sleep 3
    s_sub_u32 s32, s32, 1
    s_cbranch_scc0 PC_6
    s_endpgm
PD_7:
S2_W0:
    buffer_load_dwordx4 a[0:3], v2, s[8:11], s34 offen offset:0 sc1
    buffer_load_dwordx4 a[4:7], v2, s[8:11], s34 offen offset:1024 sc1
    buffer_load_dwordx4 a[8:11], v2, s[8:11], s34 offen offset:2048 sc1
    buffer_load_dwordx4 a[12:15], v2, s[8:11], s34 offen offset:3072 sc1
    s_add_u32 s34, s34, 4096
    buffer_load_dwordx4 a[16:19], v2, s[8:11], s34 offen offset:0 sc1
    buffer_load_dwordx4 a[20:23], v2, s[8:11], s34 offen offset:1024 sc1
    buffer_load_dwordx4 a[24:27], v2, s[8:11], s34 offen offset:2048 sc1
    buffer_load_dwordx4 a[28:31], v2, s[8:11], s34 offen offset:3072 sc1
    s_add_u32 s34, s34, 4096
    buffer_load_dwordx4 a[32:35], v2, s[8:11], s34 offen offset:0 sc1
    buffer_load_dwordx4 a[36:39], v2, s[8:11], s34 offen offset:1024 sc1
    buffer_load_dwordx4 a[40:43], v2, s[8:11], s34 offen offset:2048 sc1
    buffer_load_dwordx4 a[44:47], v2, s[8:11], s34 offen offset:3072 sc1
    s_add_u32 s34, s34, 4096
    buffer_load_dwordx4 a[48:51], v2, s[8:11], s34 offen offset:0 sc1
    buffer_load_dwordx4 a[52:55], v2, s[8:11], s34 offen offset:1024 sc1
    buffer_load_dwordx4 a[56:59], v2, s[8:11], s34 offen offset:2048 sc1
    buffer_load_dwordx4 a[60:63], v2, s[8:11], s34 offen offset:3072 sc1
    s_add_u32 s34, s34, 4096
    buffer_load_dwordx4 a[64:67], v2, s[8:11], s34 offen offset:0 sc1
    buffer_load_dwordx4 a[68:71], v2, s[8:11], s34 offen offset:1024 sc1
    buffer_load_dwordx4 a[72:75], v2, s[8:11], s34 offen offset:2048 sc1
    buffer_load_dwordx4 a[76:79], v2, s[8:11], s34 offen offset:3072 sc1
    s_add_u32 s34, s34, 4096
    s_and_b32 s7, s6, 65280
    s_cmp_ge_u32 s7, 512
    s_cbranch_scc1 S2_W1
    v_mov_b32 v21, s33
PC_8:
    buffer_load_dword v20, v21, s[24:27], 0 offen sc1
    s_waitcnt vmcnt(0)
    v_readfirstlane_b32 s6, v20
    s_and_b32 s7, s6, 65280
    s_cmp_ge_u32 s7, 512
    s_cbranch_scc1 PD_9
    s_sleep 3
    s_sub_u32 s32, s32, 1
    s_cbranch_scc0 PC_8
    s_endpgm
PD_9:
S2_W1:
    buffer_load_dwordx4 a[80:83], v2, s[8:11], s34 offen offset:0 sc1
    buffer_load_dwordx4 a[84:87], v2, s[8:11], s34 offen offset:1024 sc1
    buffer_load_dwordx4 a[88:91], v2, s[8:11], s34 offen offset:2048 sc1
    buffer_load_dwordx4 a[92:95], v2, s[8:11], s34 offen offset:3072 sc1
    s_add_u32 s34, s34, 4096
    buffer_load_dwordx4 a[96:99], v2, s[8:11], s34 offen offset:0 sc1
    buffer_load_dwordx4 a[100:103], v2, s[8:11], s34 offen offset:1024 sc1
    buffer_load_dwordx4 a[104:107], v2, s[8:11], s34 offen offset:2048 sc1
    buffer_load_dwordx4 a[108:111], v2, s[8:11], s34 offen offset:3072 sc1
    s_add_u32 s34, s34, 4096
    buffer_load_dwordx4 a[112:115], v2, s[8:11], s34 offen offset:0 sc1
    buffer_load_dwordx4 a[116:119], v2, s[8:11], s34 offen offset:1024 sc1
    buffer_load_dwordx4 a[120:123], v2, s[8:11], s34 offen offset:2048 sc1
    buffer_load_dwordx4 a[124:127], v2, s[8:11], s34 offen offset:3072 sc1
    s_add_u32 s34, s34, 4096
    buffer_load_dwordx4 a[128:131], v2, s[8:11], s34 offen offset:0 sc1
    buffer_load_dwordx4 a[132:135], v2, s[8:11], s34 offen offset:1024 sc1
    buffer_load_dwordx4 a[136:139], v2, s[8:11], s34 offen offset:2048 sc1
    buffer_load_dwordx4 a[140:143], v2, s[8:11], s34 offen offset:3072 sc1
    s_add_u32 s34, s34, 4096
    buffer_load_dwordx4 a[144:147], v2, s[8:11], s34 offen offset:0 sc1
    buffer_load_dwordx4 a[148:151], v2, s[8:11], s34 offen offset:1024 sc1
    buffer_load_dwordx4 a[152:155], v2, s[8:11], s34 offen offset:2048 sc1
    buffer_load_dwordx4 a[156:159], v2, s[8:11], s34 offen offset:3072 sc1
    s_add_u32 s34, s34, 4096
    s_and_b32 s7, s6, 16711680
    s_cmp_ge_u32 s7, 131072
    s_cbranch_scc1 S2_W2
    v_mov_b32 v21, s33
PC_10:
    buffer_load_dword v20, v21, s[24:27], 0 offen sc1
    s_waitcnt vmcnt(0)
    v_readfirstlane_b32 s6, v20
    s_and_b32 s7, s6, 16711680
    s_cmp_ge_u32 s7, 131072
    s_cbranch_scc1 PD_11
    s_sleep 3
    s_sub_u32 s32, s32, 1
    s_cbranch_scc0 PC_10
    s_endpgm
PD_11:
S2_W2:
    buffer_load_dwordx4 a[160:163], v2, s[8:11], s34 offen offset:0 sc1
    buffer_load_dwordx4 a[164:167], v2, s[8:11], s34 offen offset:1024 sc1
    buffer_load_dwordx4 a[168:171], v2, s[8:11], s34 offen offset:2048 sc1
    buffer_load_dwordx4 a[172:175], v2, s[8:11], s34 offen offset:3072 sc1
    s_add_u32 s34, s34, 4096
    buffer_load_dwordx4 a[176:179], v2, s[8:11], s34 offen offset:0 sc1
    buffer_load_dwordx4 a[180:183], v2, s[8:11], s34 offen offset:1024 sc1
    buffer_load_dwordx4 a[184:187], v2, s[8:11], s34 offen offset:2048 sc1
    buffer_load_dwordx4 a[188:191], v2, s[8:11], s34 offen offset:3072 sc1
    s_add_u32 s34, s34, 4096
    buffer_load_dwordx4 a[192:195], v2, s[8:11], s34 offen offset:0 sc1
    buffer_load_dwordx4 a[196:199], v2, s[8:11], s34 offen offset:1024 sc1
    buffer_load_dwordx4 a[200:203], v2, s[8:11], s34 offen offset:2048 sc1
    buffer_load_dwordx4 a[204:207], v2, s[8:11], s34 offen offset:3072 sc1
    s_add_u32 s34, s34, 4096
    buffer_load_dwordx4 a[208:211], v2, s[8:11], s34 offen offset:0 sc1
    buffer_load_dwordx4 a[212:215], v2, s[8:11], s34 offen offset:1024 sc1
    buffer_load_dwordx4 a[216:219], v2, s[8:11], s34 offen offset:2048 sc1
    buffer_load_dwordx4 a[220:223], v2, s[8:11], s34 offen offset:3072 sc1
    s_add_u32 s34, s34, 4096
    s_waitcnt vmcnt(30)
    buffer_load_dwordx4 a[224:227], v2, s[8:11], s34 offen offset:0 sc1
    buffer_load_dwordx4 a[228:231], v2, s[8:11], s34 offen offset:1024 sc1
    buffer_load_dwordx4 a[232:235], v2, s[8:11], s34 offen offset:2048 sc1
    buffer_load_dwordx4 a[236:239], v2, s[8:11], s34 offen offset:3072 sc1
    s_add_u32 s34, s34, 4096
    s_and_b32 s7, s6, 4278190080
    s_cmp_ge_u32 s7, 33554432
    s_cbranch_scc1 S2_W3
    v_mov_b32 v21, s33
PC_12:
    buffer_load_dword v20, v21, s[24:27], 0 offen sc1
    s_waitcnt vmcnt(0)
    v_readfirstlane_b32 s6, v20
    s_and_b32 s7, s6, 4278190080
    s_cmp_ge_u32 s7, 33554432
    s_cbranch_scc1 PD_13
    s_sleep 3
    s_sub_u32 s32, s32, 1
    s_cbranch_scc0 PC_12
    s_endpgm
PD_13:
S2_W3:
    buffer_load_dwordx4 a[240:243], v2, s[8:11], s34 offen offset:0 sc1
    buffer_load_dwordx4 a[244:247], v2, s[8:11], s34 offen offset:1024 sc1
    buffer_load_dwordx4 a[248:251], v2, s[8:11], s34 offen offset:2048 sc1
    buffer_load_dwordx4 a[252:255], v2, s[8:11], s34 offen offset:3072 sc1
    s_add_u32 s34, s34, 4096
    buffer_load_dwordx4 v[192:195], v2, s[8:11], s34 offen offset:0 sc1
    buffer_load_dwordx4 v[196:199], v2, s[8:11], s34 offen offset:1024 sc1
    buffer_load_dwordx4 v[200:203], v2, s[8:11], s34 offen offset:2048 sc1
    buffer_load_dwordx4 v[204:207], v2, s[8:11], s34 offen offset:3072 sc1
    s_add_u32 s34, s34, 4096
    buffer_load_dwordx4 v[208:211], v2, s[8:11], s34 offen offset:0 sc1
    buffer_load_dwordx4 v[212:215], v2, s[8:11], s34 offen offset:1024 sc1
    buffer_load_dwordx4 v[216:219], v2, s[8:11], s34 offen offset:2048 sc1
    buffer_load_dwordx4 v[220:223], v2, s[8:11], s34 offen offset:3072 sc1
    s_add_u32 s34, s34, 4096
    buffer_load_dwordx4 v[224:227], v2, s[8:11], s34 offen offset:0 sc1
    buffer_load_dwordx4 v[228:231], v2, s[8:11], s34 offen offset:1024 sc1
    buffer_load_dwordx4 v[232:235], v2, s[8:11], s34 offen offset:2048 sc1
    buffer_load_dwordx4 v[236:239], v2, s[8:11], s34 offen offset:3072 sc1
    s_add_u32 s34, s34, 4096
    buffer_load_dwordx4 v[240:243], v2, s[8:11], s34 offen offset:0 sc1
    buffer_load_dwordx4 v[244:247], v2, s[8:11], s34 offen offset:1024 sc1
    buffer_load_dwordx4 v[248:251], v2, s[8:11], s34 offen offset:2048 sc1
    buffer_load_dwordx4 v[252:255], v2, s[8:11], s34 offen offset:3072 sc1
    s_add_u32 s34, s34, 4096
    v_mov_b32 v3, 236
PC_14:
    buffer_load_dword v2, v3, s[24:27], 0 offen sc1
    s_waitcnt vmcnt(0)
    v_readfirstlane_b32 s6, v2
    s_and_b32 s7, s6, 255
    s_cmp_ge_u32 s7, 65
    s_cbranch_scc1 PD_15
    s_sleep 3
    s_sub_u32 s32, s32, 1
    s_cbranch_scc0 PC_14
    s_endpgm
PD_15:
    s_mov_b32 s65, s6
    s_mov_b32 s64, -1
    s_mov_b32 s67, 4194304
    s_mov_b32 s68, 9601024
    s_mov_b32 s72, 0
    s_lshr_b32 s6, s72, 5
    s_add_u32 s6, s6, 8
    s_lshr_b32 s6, s65, s6
    s_and_b32 s6, s6, 1
    s_lshl_b32 s6, s6, 13
    s_lshl_b32 s74, s72, 16
    s_add_u32 s74, s74, s6
    s_barrier
    ds_read_b128 v[72:75], v11 offset:0
    ds_read_b128 v[76:79], v11 offset:20480
    ds_read_b128 v[80:83], v10 offset:0
    ds_read_b128 v[84:87], v10 offset:20480
    s_waitcnt lgkmcnt(0)
    s_cmp_eq_u32 s3, s3
    s_branch S2_UX2
S2_POLL:
    buffer_load_dwordx4 v[108:111], v180, s[8:11], s66 offen offset:0 sc1
    buffer_load_dwordx4 v[112:115], v180, s[8:11], s66 offen offset:1024 sc1
    buffer_load_dwordx4 v[116:119], v180, s[8:11], s66 offen offset:2048 sc1
    buffer_load_dwordx4 v[120:123], v180, s[8:11], s66 offen offset:3072 sc1
    buffer_load_dwordx4 v[124:127], v12, s[8:11], s73 offen sc1
    s_waitcnt vmcnt(9)
    v_mfma_f32_16x16x32_bf16 v[148:151], v[20:23], v[128:131], 0
    v_max3_u32 v19, v128, v128, v129
    v_max3_u32 v19, v19, v130, v131
    s_waitcnt vmcnt(8)
    v_mfma_f32_16x16x32_bf16 v[148:151], v[24:27], v[132:135], v[148:151]
    v_max3_u32 v19, v19, v132, v133
    v_max3_u32 v19, v19, v134, v135
    s_waitcnt vmcnt(7)
    v_mfma_f32_16x16x32_bf16 v[148:151], v[28:31], v[136:139], v[148:151]
    v_max3_u32 v19, v19, v136, v137
    v_max3_u32 v19, v19, v138, v139
    s_waitcnt vmcnt(6)
    v_mfma_f32_16x16x32_bf16 v[148:151], v[32:35], v[140:143], v[148:151]
    v_max3_u32 v19, v19, v140, v141
    v_max3_u32 v19, v19, v142, v143
    s_waitcnt vmcnt(5)
    v_mfma_f32_16x16x32_bf16 v[148:151], v[36:39], v[144:147], v[148:151]
    v_max3_u32 v19, v19, v144, v145
    v_max3_u32 v19, v19, v146, v147
    v_cmp_eq_u32 vcc, -1, v19
    s_cbranch_vccz S2_GOT
    buffer_load_dwordx4 v[128:131], v180, s[8:11], s66 offen offset:0 sc1
    buffer_load_dwordx4 v[132:135], v180, s[8:11], s66 offen offset:1024 sc1
    buffer_load_dwordx4 v[136:139], v180, s[8:11], s66 offen offset:2048 sc1
    buffer_load_dwordx4 v[140:143], v180, s[8:11], s66 offen offset:3072 sc1
    buffer_load_dwordx4 v[144:147], v12, s[8:11], s73 offen sc1
S2_CHK:
    s_waitcnt vmcnt(9)
    v_mfma_f32_16x16x32_bf16 v[148:151], v[20:23], v[108:111], 0
    v_max3_u32 v19, v108, v108, v109
    v_max3_u32 v19, v19, v110, v111
    s_waitcnt vmcnt(8)
    v_mfma_f32_16x16x32_bf16 v[148:151], v[24:27], v[112:115], v[148:151]
    v_max3_u32 v19, v19, v112, v113
    v_max3_u32 v19, v19, v114, v115
    s_waitcnt vmcnt(7)
    v_mfma_f32_16x16x32_bf16 v[148:151], v[28:31], v[116:119], v[148:151]
    v_max3_u32 v19, v19, v116, v117
    v_max3_u32 v19, v19, v118, v119
    s_waitcnt vmcnt(6)
    v_mfma_f32_16x16x32_bf16 v[148:151], v[32:35], v[120:123], v[148:151]
    v_max3_u32 v19, v19, v120, v121
    v_max3_u32 v19, v19, v122, v123
    s_waitcnt vmcnt(5)
    v_mfma_f32_16x16x32_bf16 v[148:151], v[36:39], v[124:127], v[148:151]
    v_max3_u32 v19, v19, v124, v125
    v_max3_u32 v19, v19, v126, v127
    v_cmp_eq_u32 vcc, -1, v19
    s_cbranch_vccz S2_GOT
    s_sub_u32 s32, s32, 1
    s_cbranch_scc0 S2_POLL
    s_endpgm
S2_GOT:
    s_nop 3
    v_mov_b32_dpp v148, v150 row_ror:8 row_mask:0x3 bank_mask:0xc
    v_mov_b32_dpp v149, v151 row_ror:8 row_mask:0x3 bank_mask:0xc
    s_nop 0
    v_mov_b32_dpp v148, v150 row_ror:8 row_mask:0xc bank_mask:0x3
    v_mov_b32_dpp v149, v151 row_ror:8 row_mask:0xc bank_mask:0x3
    ds_write_b64 v14, v[148:149]
    s_cmp_lg_u32 s3, 0
    s_waitcnt lgkmcnt(0)
    s_barrier
    s_cbranch_scc1 S2_UX2
    ds_read_b64 v[164:165], v15 offset:0
    ds_read_b64 v[166:167], v15 offset:256
    ds_read_b64 v[168:169], v15 offset:512
    ds_read_b64 v[170:171], v15 offset:768
    ds_read_b64 v[172:173], v15 offset:1024
    ds_read_b64 v[174:175], v15 offset:1280
    ds_read_b64 v[176:177], v15 offset:1536
    ds_read_b64 v[178:179], v15 offset:1792
S2_UX2:
    v_mfma_f32_16x16x32_bf16 v[40:43], v[72:75], a[0:3], 0
    v_mfma_f32_16x16x32_bf16 v[44:47], v[76:79], a[0:3], 0
    v_mfma_f32_16x16x32_bf16 v[48:51], v[72:75], a[80:83], 0
    s_cbranch_scc1 S2_C2
    s_waitcnt lgkmcnt(4)
    v_pk_add_f32 v[164:165], v[164:165], v[166:167]
    v_pk_add_f32 v[168:169], v[168:169], v[170:171]
    s_waitcnt lgkmcnt(0)
    v_pk_add_f32 v[172:173], v[172:173], v[174:175]
    v_pk_add_f32 v[176:177], v[176:177], v[178:179]
    v_pk_add_f32 v[164:165], v[164:165], v[168:169]
    v_pk_add_f32 v[172:173], v[172:173], v[176:177]
    v_pk_add_f32 v[164:165], v[164:165], v[172:173]
    v_cvt_pk_bf16_f32 v164, v164, v165
    v_min_u32 v164, -2, v164
    buffer_store_dword v164, v17, s[8:11], s74 offen sc1
S2_C2:
    v_mfma_f32_16x16x32_bf16 v[52:55], v[76:79], a[80:83], 0
    v_mfma_f32_16x16x32_bf16 v[56:59], v[72:75], a[160:163], 0
    v_mfma_f32_16x16x32_bf16 v[60:63], v[76:79], a[160:163], 0
    v_mfma_f32_16x16x32_bf16 v[64:67], v[72:75], a[240:243], 0
    s_add_u32 s75, s67, 0
    v_mfma_f32_16x16x32_bf16 v[68:71], v[76:79], a[240:243], 0
    buffer_load_dwordx4 v[108:111], v13, s[8:11], s75 offen offset:0 sc1
    v_mfma_f32_16x16x32_bf16 v[40:43], v[80:83], a[4:7], v[40:43]
    ds_read_b128 v[72:75], v11 offset:1024
    v_mfma_f32_16x16x32_bf16 v[44:47], v[84:87], a[4:7], v[44:47]
    ds_read_b128 v[76:79], v11 offset:21504
    v_mfma_f32_16x16x32_bf16 v[48:51], v[80:83], a[84:87], v[48:51]
    ds_read_b64 v[164:165], v16 offset:0
    ds_read_b64 v[166:167], v16 offset:256
    v_mfma_f32_16x16x32_bf16 v[52:55], v[84:87], a[84:87], v[52:55]
    ds_read_b64 v[168:169], v16 offset:512
    ds_read_b64 v[170:171], v16 offset:768
    v_mfma_f32_16x16x32_bf16 v[56:59], v[80:83], a[164:167], v[56:59]
    ds_read_b64 v[172:173], v16 offset:1024
    ds_read_b64 v[174:175], v16 offset:1280
    buffer_load_dwordx4 v[112:115], v13, s[8:11], s75 offen offset:1024 sc1
    v_mfma_f32_16x16x32_bf16 v[60:63], v[84:87], a[164:167], v[60:63]
    ds_read_b64 v[176:177], v16 offset:1536
    ds_read_b64 v[178:179], v16 offset:1792
    v_mfma_f32_16x16x32_bf16 v[64:67], v[80:83], a[244:247], v[64:67]
    v_mfma_f32_16x16x32_bf16 v[68:71], v[84:87], a[244:247], v[68:71]
    s_waitcnt lgkmcnt(8)
    v_mfma_f32_16x16x32_bf16 v[40:43], v[72:75], a[8:11], v[40:43]
    ds_read_b128 v[80:83], v10 offset:1024
    v_mfma_f32_16x16x32_bf16 v[44:47], v[76:79], a[8:11], v[44:47]
    ds_read_b128 v[84:87], v10 offset:21504
    buffer_load_dwordx4 v[116:119], v13, s[8:11], s75 offen offset:2048 sc1
    v_mfma_f32_16x16x32_bf16 v[48:51], v[72:75], a[88:91], v[48:51]
    s_waitcnt lgkmcnt(6)
    v_mfma_f32_16x16x32_bf16 v[52:55], v[76:79], a[88:91], v[52:55]
    v_add_f32 v164, v164, v166
    v_mfma_f32_16x16x32_bf16 v[56:59], v[72:75], a[168:171], v[56:59]
    v_add_f32 v165, v165, v167
    v_mfma_f32_16x16x32_bf16 v[60:63], v[76:79], a[168:171], v[60:63]
    v_add_f32 v168, v168, v170
    v_mfma_f32_16x16x32_bf16 v[64:67], v[72:75], a[248:251], v[64:67]
    v_add_f32 v169, v169, v171
    buffer_load_dwordx4 v[120:123], v13, s[8:11], s75 offen offset:3072 sc1
    v_mfma_f32_16x16x32_bf16 v[68:71], v[76:79], a[248:251], v[68:71]
    s_waitcnt lgkmcnt(2)
    s_waitcnt lgkmcnt(0)
    v_mfma_f32_16x16x32_bf16 v[40:43], v[80:83], a[12:15], v[40:43]
    ds_read_b128 v[72:75], v11 offset:2048
    v_add_f32 v172, v172, v174
    v_mfma_f32_16x16x32_bf16 v[44:47], v[84:87], a[12:15], v[44:47]
    ds_read_b128 v[76:79], v11 offset:22528
    v_add_f32 v173, v173, v175
    v_mfma_f32_16x16x32_bf16 v[48:51], v[80:83], a[92:95], v[48:51]
    v_add_f32 v176, v176, v178
    s_add_u32 s75, s67, 4096
    v_mfma_f32_16x16x32_bf16 v[52:55], v[84:87], a[92:95], v[52:55]
    v_add_f32 v177, v177, v179
    buffer_load_dwordx4 v[124:127], v13, s[8:11], s75 offen offset:0 sc1
    v_mfma_f32_16x16x32_bf16 v[56:59], v[80:83], a[172:175], v[56:59]
    v_add_f32 v164, v164, v168
    v_mfma_f32_16x16x32_bf16 v[60:63], v[84:87], a[172:175], v[60:63]
    v_add_f32 v165, v165, v169
    v_mfma_f32_16x16x32_bf16 v[64:67], v[80:83], a[252:255], v[64:67]
    v_add_f32 v172, v172, v176
    v_mfma_f32_16x16x32_bf16 v[68:71], v[84:87], a[252:255], v[68:71]
    v_add_f32 v173, v173, v177
    s_add_u32 s75, s67, 20480
    s_waitcnt lgkmcnt(0)
    v_mfma_f32_16x16x32_bf16 v[40:43], v[72:75], a[16:19], v[40:43]
    ds_read_b128 v[80:83], v10 offset:2048
    v_add_f32 v164, v164, v172
    buffer_load_dwordx4 v[128:131], v183, s[8:11], s75 offen offset:0 sc1
    v_mfma_f32_16x16x32_bf16 v[44:47], v[76:79], a[16:19], v[44:47]
    ds_read_b128 v[84:87], v10 offset:22528
    v_add_f32 v165, v165, v173
    v_mfma_f32_16x16x32_bf16 v[48:51], v[72:75], a[96:99], v[48:51]
    v_cvt_pk_bf16_f32 v164, v164, v165
    v_mfma_f32_16x16x32_bf16 v[52:55], v[76:79], a[96:99], v[52:55]
    v_min_u32 v164, -2, v164
    v_mfma_f32_16x16x32_bf16 v[56:59], v[72:75], a[176:179], v[56:59]
    buffer_store_dword v164, v18, s[8:11], s68 offen sc1
    v_mfma_f32_16x16x32_bf16 v[60:63], v[76:79], a[176:179], v[60:63]
    s_add_u32 s68, s68, 40960
    buffer_load_dwordx4 v[132:135], v183, s[8:11], s75 offen offset:1024 sc1
    v_mfma_f32_16x16x32_bf16 v[64:67], v[72:75], v[192:195], v[64:67]
    v_mfma_f32_16x16x32_bf16 v[68:71], v[76:79], v[192:195], v[68:71]
    s_add_u32 s69, s69, 40960
    s_waitcnt lgkmcnt(0)
    v_mfma_f32_16x16x32_bf16 v[40:43], v[80:83], a[20:23], v[40:43]
    ds_read_b128 v[72:75], v11 offset:3072
    s_add_u32 s64, s64, 1
    v_mfma_f32_16x16x32_bf16 v[44:47], v[84:87], a[20:23], v[44:47]
    ds_read_b128 v[76:79], v11 offset:23552
    s_mov_b32 s66, s74
    v_mfma_f32_16x16x32_bf16 v[48:51], v[80:83], a[100:103], v[48:51]
    buffer_load_dwordx4 v[136:139], v183, s[8:11], s75 offen offset:2048 sc1
    s_add_u32 s73, s66, 4096
    v_mfma_f32_16x16x32_bf16 v[52:55], v[84:87], a[100:103], v[52:55]
    s_add_u32 s72, s64, 1
    v_mfma_f32_16x16x32_bf16 v[56:59], v[80:83], a[180:183], v[56:59]
    s_lshr_b32 s6, s72, 5
    v_mfma_f32_16x16x32_bf16 v[60:63], v[84:87], a[180:183], v[60:63]
    s_add_u32 s6, s6, 8
    v_mfma_f32_16x16x32_bf16 v[64:67], v[80:83], v[196:199], v[64:67]
    s_lshr_b32 s6, s65, s6
    v_mfma_f32_16x16x32_bf16 v[68:71], v[84:87], v[196:199], v[68:71]
    buffer_load_dwordx4 v[140:143], v183, s[8:11], s75 offen offset:3072 sc1
    s_and_b32 s6, s6, 1
    s_waitcnt lgkmcnt(0)
    v_mfma_f32_16x16x32_bf16 v[40:43], v[72:75], a[24:27], v[40:43]
    ds_read_b128 v[80:83], v10 offset:3072
    s_lshl_b32 s6, s6, 13
    v_mfma_f32_16x16x32_bf16 v[44:47], v[76:79], a[24:27], v[44:47]
    ds_read_b128 v[84:87], v10 offset:23552
    s_lshl_b32 s34, s72, 16
    v_mfma_f32_16x16x32_bf16 v[48:51], v[72:75], a[104:107], v[48:51]
    s_add_u32 s34, s34, s6
    v_mfma_f32_16x16x32_bf16 v[52:55], v[76:79], a[104:107], v[52:55]
    s_add_u32 s75, s67, 24576
    v_mfma_f32_16x16x32_bf16 v[56:59], v[72:75], a[184:187], v[56:59]
    buffer_load_dwordx4 v[144:147], v183, s[8:11], s75 offen offset:0 sc1
    v_mfma_f32_16x16x32_bf16 v[60:63], v[76:79], a[184:187], v[60:63]
    v_mfma_f32_16x16x32_bf16 v[64:67], v[72:75], v[200:203], v[64:67]
    v_mfma_f32_16x16x32_bf16 v[68:71], v[76:79], v[200:203], v[68:71]
    s_add_u32 m0, s71, 0
    s_waitcnt lgkmcnt(0)
    v_mfma_f32_16x16x32_bf16 v[40:43], v[80:83], a[28:31], v[40:43]
    ds_read_b128 v[72:75], v11 offset:4096
    buffer_load_dwordx4 v9, s[12:15], s69 offen offset:0 lds
    v_mfma_f32_16x16x32_bf16 v[44:47], v[84:87], a[28:31], v[44:47]
    ds_read_b128 v[76:79], v11 offset:24576
    v_mfma_f32_16x16x32_bf16 v[48:51], v[80:83], a[108:111], v[48:51]
    v_mov_b64 v[148:149], 0
    v_mfma_f32_16x16x32_bf16 v[52:55], v[84:87], a[108:111], v[52:55]
    v_mfma_f32_16x16x32_bf16 v[56:59], v[80:83], a[188:191], v[56:59]
    s_add_u32 m0, s60, 0
    s_add_u32 s75, s67, 40960
    v_mov_b64 v[150:151], 0
    v_mfma_f32_16x16x32_bf16 v[60:63], v[84:87], a[188:191], v[60:63]
    buffer_load_dwordx4 v13, s[8:11], s75 offen offset:0 sc1 lds
    v_mfma_f32_16x16x32_bf16 v[64:67], v[80:83], v[204:207], v[64:67]
    v_mov_b64 v[152:153], 0
    v_mfma_f32_16x16x32_bf16 v[68:71], v[84:87], v[204:207], v[68:71]
    s_waitcnt lgkmcnt(0)
    v_mfma_f32_16x16x32_bf16 v[40:43], v[72:75], a[32:35], v[40:43]
    ds_read_b128 v[80:83], v10 offset:4096
    v_mov_b64 v[154:155], 0
    v_mfma_f32_16x16x32_bf16 v[44:47], v[76:79], a[32:35], v[44:47]
    ds_read_b128 v[84:87], v10 offset:24576
    buffer_load_dwordx4 v13, s[8:11], s75 offen offset:1024 sc1 lds
    v_mfma_f32_16x16x32_bf16 v[48:51], v[72:75], a[112:115], v[48:51]
    v_mov_b64 v[156:157], 0
    v_mfma_f32_16x16x32_bf16 v[52:55], v[76:79], a[112:115], v[52:55]
    v_mfma_f32_16x16x32_bf16 v[56:59], v[72:75], a[192:195], v[56:59]
    v_mov_b64 v[158:159], 0
    v_mfma_f32_16x16x32_bf16 v[60:63], v[76:79], a[192:195], v[60:63]
    buffer_load_dwordx4 v13, s[8:11], s75 offen offset:2048 sc1 lds
    v_mfma_f32_16x16x32_bf16 v[64:67], v[72:75], v[208:211], v[64:67]
    v_mov_b64 v[160:161], 0
    v_mfma_f32_16x16x32_bf16 v[68:71], v[76:79], v[208:211], v[68:71]
    s_waitcnt vmcnt(10)
    v_mfma_f32_16x16x32_bf16 v[184:187], v[88:91], v[108:111], 0
    v_mov_b64 v[162:163], 0
    v_mfma_f32_16x16x32_bf16 v[184:187], v[92:95], v[112:115], v[184:187]
    buffer_load_dwordx4 v13, s[8:11], s75 offen offset:3072 sc1 lds
    v_mfma_f32_16x16x32_bf16 v[184:187], v[96:99], v[116:119], v[184:187]
    v_mfma_f32_16x16x32_bf16 v[184:187], v[100:103], v[120:123], v[184:187]
    v_mfma_f32_16x16x32_bf16 v[184:187], v[104:107], v[124:127], v[184:187]
    s_add_u32 m0, s60, 4096
    s_add_u32 s75, s67, 45056
    s_waitcnt lgkmcnt(0)
    v_mfma_f32_16x16x32_bf16 v[40:43], v[80:83], a[36:39], v[40:43]
    ds_read_b128 v[72:75], v11 offset:5120
    buffer_load_dwordx4 v13, s[8:11], s75 offen offset:0 sc1 lds
    v_mfma_f32_16x16x32_bf16 v[44:47], v[84:87], a[36:39], v[44:47]
    ds_read_b128 v[76:79], v11 offset:25600
    v_mfma_f32_16x16x32_bf16 v[48:51], v[80:83], a[116:119], v[48:51]
    v_mfma_f32_16x16x32_bf16 v[52:55], v[84:87], a[116:119], v[52:55]
    v_mfma_f32_16x16x32_bf16 v[56:59], v[80:83], a[196:199], v[56:59]
    s_mov_b32 m0, s61
    v_mfma_f32_16x16x32_bf16 v[60:63], v[84:87], a[196:199], v[60:63]
    buffer_load_dwordx4 v1, s[8:11], s74 offen sc1 lds
    v_mfma_f32_16x16x32_bf16 v[64:67], v[80:83], v[212:215], v[64:67]
    v_mfma_f32_16x16x32_bf16 v[68:71], v[84:87], v[212:215], v[68:71]
    s_waitcnt lgkmcnt(0)
    v_mfma_f32_16x16x32_bf16 v[40:43], v[72:75], a[40:43], v[40:43]
    ds_read_b128 v[80:83], v10 offset:5120
    v_mfma_f32_16x16x32_bf16 v[44:47], v[76:79], a[40:43], v[44:47]
    ds_read_b128 v[84:87], v10 offset:25600
    v_mfma_f32_16x16x32_bf16 v[48:51], v[72:75], a[120:123], v[48:51]
    buffer_load_dwordx4 v1, s[8:11], s74 offen offset:1024 sc1 lds
    v_mfma_f32_16x16x32_bf16 v[52:55], v[76:79], a[120:123], v[52:55]
    v_mfma_f32_16x16x32_bf16 v[56:59], v[72:75], a[200:203], v[56:59]
    v_mfma_f32_16x16x32_bf16 v[60:63], v[76:79], a[200:203], v[60:63]
    v_mfma_f32_16x16x32_bf16 v[64:67], v[72:75], v[216:219], v[64:67]
    s_mov_b32 exec_hi, 0
    buffer_load_dwordx4 v1, s[8:11], s74 offen offset:2048 sc1 lds
    s_mov_b32 exec_hi, -1
    v_mfma_f32_16x16x32_bf16 v[68:71], v[76:79], v[216:219], v[68:71]
    s_waitcnt vmcnt(9)
    v_mfma_f32_16x16x32_bf16 v[188:191], v[88:91], v[128:131], 0
    v_mfma_f32_16x16x32_bf16 v[188:191], v[92:95], v[132:135], v[188:191]
    v_mfma_f32_16x16x32_bf16 v[188:191], v[96:99], v[136:139], v[188:191]
    s_add_u32 m0, s60, 5120
    s_add_u32 s75, s67, 61440
    v_mfma_f32_16x16x32_bf16 v[188:191], v[100:103], v[140:143], v[188:191]
    buffer_load_dwordx4 v13, s[8:11], s75 offen offset:0 sc1 lds
    v_mfma_f32_16x16x32_bf16 v[188:191], v[104:107], v[144:147], v[188:191]
    s_waitcnt lgkmcnt(0)
    v_mfma_f32_16x16x32_bf16 v[40:43], v[80:83], a[44:47], v[40:43]
    ds_read_b128 v[72:75], v11 offset:6144
    v_mfma_f32_16x16x32_bf16 v[44:47], v[84:87], a[44:47], v[44:47]
    ds_read_b128 v[76:79], v11 offset:26624
    v_mfma_f32_16x16x32_bf16 v[48:51], v[80:83], a[124:127], v[48:51]
    v_mfma_f32_16x16x32_bf16 v[52:55], v[84:87], a[124:127], v[52:55]
    buffer_load_dwordx4 v13, s[8:11], s75 offen offset:1024 sc1 lds
    v_mfma_f32_16x16x32_bf16 v[56:59], v[80:83], a[204:207], v[56:59]
    v_cndmask_b32 v184, v188, v184, s[58:59]
    v_mfma_f32_16x16x32_bf16 v[60:63], v[84:87], a[204:207], v[60:63]
    v_cndmask_b32 v185, v189, v185, s[58:59]
    v_mfma_f32_16x16x32_bf16 v[64:67], v[80:83], v[220:223], v[64:67]
    v_cndmask_b32 v186, v190, v186, s[58:59]
    v_mfma_f32_16x16x32_bf16 v[68:71], v[84:87], v[220:223], v[68:71]
    v_cndmask_b32 v187, v191, v187, s[58:59]
    s_waitcnt lgkmcnt(0)
    v_mfma_f32_16x16x32_bf16 v[40:43], v[72:75], a[48:51], v[40:43]
    ds_read_b128 v[80:83], v10 offset:6144
    buffer_load_dwordx4 v13, s[8:11], s75 offen offset:2048 sc1 lds
    v_mfma_f32_16x16x32_bf16 v[44:47], v[76:79], a[48:51], v[44:47]
    ds_read_b128 v[84:87], v10 offset:26624
    v_mfma_f32_16x16x32_bf16 v[48:51], v[72:75], a[128:131], v[48:51]
    s_waitcnt vmcnt(6)
    v_mfma_f32_16x16x32_bf16 v[52:55], v[76:79], a[128:131], v[52:55]
    ds_read_b128 v[108:111], v181 offset:0
    v_mfma_f32_16x16x32_bf16 v[56:59], v[72:75], a[208:211], v[56:59]
    ds_read_b128 v[112:115], v181 offset:1024
    v_mfma_f32_16x16x32_bf16 v[60:63], v[76:79], a[208:211], v[60:63]
    buffer_load_dwordx4 v13, s[8:11], s75 offen offset:3072 sc1 lds
    ds_read_b128 v[116:119], v181 offset:2048
    v_mfma_f32_16x16x32_bf16 v[64:67], v[72:75], v[224:227], v[64:67]
    ds_read_b128 v[120:123], v181 offset:3072
    v_mfma_f32_16x16x32_bf16 v[68:71], v[76:79], v[224:227], v[68:71]
    ds_read_b128 v[124:127], v181 offset:4096
    s_waitcnt lgkmcnt(5)
    v_mfma_f32_16x16x32_bf16 v[40:43], v[80:83], a[52:55], v[40:43]
    ds_read_b128 v[72:75], v11 offset:7168
    v_mfma_f32_16x16x32_bf16 v[44:47], v[84:87], a[52:55], v[44:47]
    ds_read_b128 v[76:79], v11 offset:27648
    s_add_u32 m0, s60, 9216
    s_add_u32 s75, s67, 65536
    v_mfma_f32_16x16x32_bf16 v[48:51], v[80:83], a[132:135], v[48:51]
    buffer_load_dwordx4 v13, s[8:11], s75 offen offset:0 sc1 lds
    v_mfma_f32_16x16x32_bf16 v[52:55], v[84:87], a[132:135], v[52:55]
    v_mfma_f32_16x16x32_bf16 v[56:59], v[80:83], a[212:215], v[56:59]
    s_add_u32 s67, s67, 81920
    v_mfma_f32_16x16x32_bf16 v[60:63], v[84:87], a[212:215], v[60:63]
    s_waitcnt vmcnt(5)
    ds_read_b128 v[164:167], v5
    v_mfma_f32_16x16x32_bf16 v[64:67], v[80:83], v[228:231], v[64:67]
    s_add_u32 m0, s71, 896
    ds_read_b128 v[168:171], v5 offset:1024
    ds_read_b128 v[172:175], v6
    v_mfma_f32_16x16x32_bf16 v[68:71], v[84:87], v[228:231], v[68:71]
    buffer_load_dwordx4 v9, s[12:15], s69 offen offset:128 lds
    s_waitcnt lgkmcnt(3)
    v_mfma_f32_16x16x32_bf16 v[40:43], v[72:75], a[56:59], v[40:43]
    ds_read_b128 v[80:83], v10 offset:7168
    v_mfma_f32_16x16x32_bf16 v[44:47], v[76:79], a[56:59], v[44:47]
    ds_read_b128 v[84:87], v10 offset:27648
    v_mfma_f32_16x16x32_bf16 v[48:51], v[72:75], a[136:139], v[48:51]
    s_waitcnt lgkmcnt(2)
    v_max3_u32 v19, v164, v165, v166
    v_mfma_f32_16x16x32_bf16 v[52:55], v[76:79], a[136:139], v[52:55]
    s_add_u32 m0, s71, 1792
    v_max3_u32 v19, v19, v167, v168
    v_max3_u32 v19, v19, v169, v170
    v_mfma_f32_16x16x32_bf16 v[56:59], v[72:75], a[216:219], v[56:59]
    buffer_load_dwordx4 v9, s[12:15], s69 offen offset:256 lds
    v_max3_u32 v19, v19, v171, v172
    v_max3_u32 v19, v19, v173, v174
    v_mfma_f32_16x16x32_bf16 v[60:63], v[76:79], a[216:219], v[60:63]
    v_max_u32 v19, v19, v175
    v_mfma_f32_16x16x32_bf16 v[64:67], v[72:75], v[232:235], v[64:67]
    v_mfma_f32_16x16x32_bf16 v[68:71], v[76:79], v[232:235], v[68:71]
    v_cmp_eq_u32 vcc, -1, v19
    s_cbranch_vccnz S2_MP
S2_MGOT:
    s_barrier
    ds_read_b128 v[164:167], v7 offset:0
    s_waitcnt lgkmcnt(1)
    v_mfma_f32_16x16x32_bf16 v[40:43], v[80:83], a[60:63], v[40:43]
    ds_read_b128 v[72:75], v11 offset:8192
    v_mfma_f32_16x16x32_bf16 v[44:47], v[84:87], a[60:63], v[44:47]
    ds_read_b128 v[76:79], v11 offset:28672
    s_add_u32 m0, s71, 2688
    v_mfma_f32_16x16x32_bf16 v[48:51], v[80:83], a[140:143], v[48:51]
    buffer_load_dwordx4 v9, s[12:15], s69 offen offset:384 lds
    ds_read_b128 v[168:171], v7 offset:1024
    v_mfma_f32_16x16x32_bf16 v[52:55], v[84:87], a[140:143], v[52:55]
    ds_read_b128 v[172:175], v7 offset:2048
    v_mfma_f32_16x16x32_bf16 v[56:59], v[80:83], a[220:223], v[56:59]
    ds_read_b128 v[176:179], v7 offset:3072
    v_mfma_f32_16x16x32_bf16 v[60:63], v[84:87], a[220:223], v[60:63]
    ds_write_b128 v182, v[184:187] offset:2048
    v_mfma_f32_16x16x32_bf16 v[64:67], v[80:83], v[236:239], v[64:67]
    s_add_u32 m0, s71, 3584
    s_mov_b32 s74, s34
    v_mfma_f32_16x16x32_bf16 v[68:71], v[84:87], v[236:239], v[68:71]
    buffer_load_dwordx4 v9, s[12:15], s69 offen offset:512 lds
    s_waitcnt lgkmcnt(6)
    v_smfmac_f32_16x16x64_bf16 v[148:151], v[164:167], a[0:7], v8
    v_smfmac_f32_16x16x64_bf16 v[152:155], v[164:167], a[80:87], v8
    s_waitcnt lgkmcnt(4)
    v_mfma_f32_16x16x32_bf16 v[40:43], v[72:75], a[64:67], v[40:43]
    ds_read_b128 v[80:83], v10 offset:8192
    ds_read_b128 v[84:87], v10 offset:28672
    v_smfmac_f32_16x16x64_bf16 v[156:159], v[164:167], a[160:167], v8
    v_mfma_f32_16x16x32_bf16 v[44:47], v[76:79], a[64:67], v[44:47]
    s_add_u32 m0, s71, 4480
    v_smfmac_f32_16x16x64_bf16 v[160:163], v[164:167], a[240:247], v8
    s_waitcnt lgkmcnt(5)
    v_smfmac_f32_16x16x64_bf16 v[148:151], v[168:171], a[8:15], v8
    v_mfma_f32_16x16x32_bf16 v[48:51], v[72:75], a[144:147], v[48:51]
    buffer_load_dwordx4 v9, s[12:15], s69 offen offset:640 lds
    ds_read_b128 v[164:167], v7 offset:4096
    v_smfmac_f32_16x16x64_bf16 v[152:155], v[168:171], a[88:95], v8
    v_mfma_f32_16x16x32_bf16 v[52:55], v[76:79], a[144:147], v[52:55]
    s_add_u32 m0, s71, 5376
    v_smfmac_f32_16x16x64_bf16 v[156:159], v[168:171], a[168:175], v8
    v_smfmac_f32_16x16x64_bf16 v[160:163], v[168:171], a[248:255], v8
    v_mfma_f32_16x16x32_bf16 v[56:59], v[72:75], a[224:227], v[56:59]
    buffer_load_dwordx4 v9, s[12:15], s69 offen offset:768 lds
    ds_read_b128 v[168:171], v7 offset:5120
    s_waitcnt vmcnt(6)
    s_waitcnt lgkmcnt(6)
    v_smfmac_f32_16x16x64_bf16 v[148:151], v[172:175], a[16:23], v8
    v_mfma_f32_16x16x32_bf16 v[60:63], v[76:79], a[224:227], v[60:63]
    s_add_u32 m0, s71, 6272
    ds_read_b128 v[128:131], v4 offset:5120
    v_smfmac_f32_16x16x64_bf16 v[152:155], v[172:175], a[96:103], v8
    v_smfmac_f32_16x16x64_bf16 v[156:159], v[172:175], a[176:183], v8
    v_mfma_f32_16x16x32_bf16 v[64:67], v[72:75], v[240:243], v[64:67]
    buffer_load_dwordx4 v9, s[12:15], s69 offen offset:896 lds
    ds_read_b128 v[132:135], v4 offset:6144
    v_smfmac_f32_16x16x64_bf16 v[160:163], v[172:175], v[192:199], v8
    v_mfma_f32_16x16x32_bf16 v[68:71], v[76:79], v[240:243], v[68:71]
    s_add_u32 m0, s71, 7168
    ds_read_b128 v[172:175], v7 offset:6144
    ds_read_b128 v[136:139], v4 offset:7168
    s_waitcnt lgkmcnt(9)
    v_smfmac_f32_16x16x64_bf16 v[148:151], v[176:179], a[24:31], v8
    v_smfmac_f32_16x16x64_bf16 v[152:155], v[176:179], a[104:111], v8
    v_mfma_f32_16x16x32_bf16 v[184:187], v[88:91], v[108:111], 0
    buffer_load_dwordx4 v9, s[12:15], s69 offen offset:1024 lds
    ds_read_b128 v[140:143], v4 offset:8192
    v_smfmac_f32_16x16x64_bf16 v[156:159], v[176:179], a[184:191], v8
    v_mfma_f32_16x16x32_bf16 v[184:187], v[92:95], v[112:115], v[184:187]
    ds_read_b128 v[72:75], v11 offset:9216
    ds_read_b128 v[76:79], v11 offset:29696
    s_add_u32 m0, s71, 8064
    ds_read_b128 v[144:147], v4 offset:9216
    v_smfmac_f32_16x16x64_bf16 v[160:163], v[176:179], v[200:207], v8
    s_waitcnt lgkmcnt(9)
    v_smfmac_f32_16x16x64_bf16 v[148:151], v[164:167], a[32:39], v8
    v_mfma_f32_16x16x32_bf16 v[184:187], v[96:99], v[116:119], v[184:187]
    buffer_load_dwordx4 v9, s[12:15], s69 offen offset:1152 lds
    ds_read_b128 v[176:179], v7 offset:7168
    v_smfmac_f32_16x16x64_bf16 v[152:155], v[164:167], a[112:119], v8
    v_mfma_f32_16x16x32_bf16 v[184:187], v[100:103], v[120:123], v[184:187]
    v_smfmac_f32_16x16x64_bf16 v[156:159], v[164:167], a[192:199], v8
    v_smfmac_f32_16x16x64_bf16 v[160:163], v[164:167], v[208:215], v8
    v_mfma_f32_16x16x32_bf16 v[184:187], v[104:107], v[124:127], v[184:187]
    ds_read_b128 v[164:167], v7 offset:8192
    s_waitcnt lgkmcnt(10)
    v_smfmac_f32_16x16x64_bf16 v[148:151], v[168:171], a[40:47], v8
    s_waitcnt lgkmcnt(2)
    v_mfma_f32_16x16x32_bf16 v[188:191], v[88:91], v[128:131], 0
    v_smfmac_f32_16x16x64_bf16 v[152:155], v[168:171], a[120:127], v8
    v_smfmac_f32_16x16x64_bf16 v[156:159], v[168:171], a[200:207], v8
    v_mfma_f32_16x16x32_bf16 v[188:191], v[92:95], v[132:135], v[188:191]
    v_smfmac_f32_16x16x64_bf16 v[160:163], v[168:171], v[216:223], v8
    v_mfma_f32_16x16x32_bf16 v[188:191], v[96:99], v[136:139], v[188:191]
    ds_read_b128 v[168:171], v7 offset:9216
    v_mov_b64 v[88:89], v[20:21]
    v_mov_b64 v[90:91], v[22:23]
    v_smfmac_f32_16x16x64_bf16 v[148:151], v[172:175], a[48:55], v8
    v_smfmac_f32_16x16x64_bf16 v[152:155], v[172:175], a[128:135], v8
    v_mfma_f32_16x16x32_bf16 v[188:191], v[100:103], v[140:143], v[188:191]
    v_mov_b64 v[92:93], v[24:25]
    v_mov_b64 v[94:95], v[26:27]
    v_smfmac_f32_16x16x64_bf16 v[156:159], v[172:175], a[208:215], v8
    v_mfma_f32_16x16x32_bf16 v[188:191], v[104:107], v[144:147], v[188:191]
    v_mov_b64 v[96:97], v[28:29]
    v_mov_b64 v[98:99], v[30:31]
    v_smfmac_f32_16x16x64_bf16 v[160:163], v[172:175], v[224:231], v8
    s_waitcnt lgkmcnt(2)
    v_smfmac_f32_16x16x64_bf16 v[148:151], v[176:179], a[56:63], v8
    v_mfma_f32_16x16x32_bf16 v[40:43], v[80:83], a[68:71], v[40:43]
    v_mov_b64 v[100:101], v[32:33]
    v_mov_b64 v[102:103], v[34:35]
    v_smfmac_f32_16x16x64_bf16 v[152:155], v[176:179], a[136:143], v8
    v_mfma_f32_16x16x32_bf16 v[44:47], v[84:87], a[68:71], v[44:47]
    v_mov_b64 v[104:105], v[36:37]
    v_mov_b64 v[106:107], v[38:39]
    v_smfmac_f32_16x16x64_bf16 v[156:159], v[176:179], a[216:223], v8
    v_smfmac_f32_16x16x64_bf16 v[160:163], v[176:179], v[232:239], v8
    v_mfma_f32_16x16x32_bf16 v[48:51], v[80:83], a[148:151], v[48:51]
    v_cndmask_b32 v184, v188, v184, s[58:59]
    v_cndmask_b32 v185, v189, v185, s[58:59]
    s_waitcnt lgkmcnt(1)
    v_smfmac_f32_16x16x64_bf16 v[148:151], v[164:167], a[64:71], v8
    v_mfma_f32_16x16x32_bf16 v[52:55], v[84:87], a[148:151], v[52:55]
    v_cndmask_b32 v186, v190, v186, s[58:59]
    v_cndmask_b32 v187, v191, v187, s[58:59]
    buffer_load_dwordx4 v[108:111], v180, s[8:11], s66 offen offset:0 sc1
    v_smfmac_f32_16x16x64_bf16 v[152:155], v[164:167], a[144:151], v8
    v_smfmac_f32_16x16x64_bf16 v[156:159], v[164:167], a[224:231], v8
    v_mfma_f32_16x16x32_bf16 v[56:59], v[80:83], a[228:231], v[56:59]
    ds_write_b128 v182, v[184:187] offset:6144
    buffer_load_dwordx4 v[112:115], v180, s[8:11], s66 offen offset:1024 sc1
    v_smfmac_f32_16x16x64_bf16 v[160:163], v[164:167], v[240:247], v8
    v_mfma_f32_16x16x32_bf16 v[60:63], v[84:87], a[228:231], v[60:63]
    buffer_load_dwordx4 v[116:119], v180, s[8:11], s66 offen offset:2048 sc1
    s_waitcnt lgkmcnt(1)
    v_smfmac_f32_16x16x64_bf16 v[148:151], v[168:171], a[72:79], v8
    v_smfmac_f32_16x16x64_bf16 v[152:155], v[168:171], a[152:159], v8
    v_mfma_f32_16x16x32_bf16 v[64:67], v[80:83], v[244:247], v[64:67]
    buffer_load_dwordx4 v[120:123], v180, s[8:11], s66 offen offset:3072 sc1
    v_smfmac_f32_16x16x64_bf16 v[156:159], v[168:171], a[232:239], v8
    v_smfmac_f32_16x16x64_bf16 v[160:163], v[168:171], v[248:255], v8
    v_mfma_f32_16x16x32_bf16 v[68:71], v[84:87], v[244:247], v[68:71]
    ds_read_b128 v[80:83], v10 offset:9216
    ds_read_b128 v[84:87], v10 offset:29696
    v_mfma_f32_16x16x32_bf16 v[40:43], v[72:75], a[72:75], v[40:43]
    buffer_load_dwordx4 v[124:127], v12, s[8:11], s73 offen sc1
    v_add_u32 v11, s35, v11
    v_add_u32 v10, s35, v10
    v_mfma_f32_16x16x32_bf16 v[44:47], v[76:79], a[72:75], v[44:47]
    s_sub_u32 s35, 0, s35
    s_add_u32 s71, s71, s35
    v_mfma_f32_16x16x32_bf16 v[48:51], v[72:75], a[152:155], v[48:51]
    v_permlane32_swap_b32 v148, v156
    v_permlane32_swap_b32 v149, v157
    v_mfma_f32_16x16x32_bf16 v[52:55], v[76:79], a[152:155], v[52:55]
    v_permlane32_swap_b32 v150, v158
    v_permlane32_swap_b32 v151, v159
    s_waitcnt lgkmcnt(0)
    v_mfma_f32_16x16x32_bf16 v[40:43], v[80:83], a[76:79], v[40:43]
    v_permlane32_swap_b32 v152, v160
    v_permlane32_swap_b32 v153, v161
    v_mfma_f32_16x16x32_bf16 v[44:47], v[84:87], a[76:79], v[44:47]
    buffer_load_dwordx4 v[128:131], v180, s[8:11], s66 offen offset:0 sc1
    v_permlane32_swap_b32 v154, v162
    v_permlane32_swap_b32 v155, v163
    v_mfma_f32_16x16x32_bf16 v[48:51], v[80:83], a[156:159], v[48:51]
    v_add_f32 v148, v148, v156
    v_add_f32 v149, v149, v157
    v_mfma_f32_16x16x32_bf16 v[52:55], v[84:87], a[156:159], v[52:55]
    v_add_f32 v150, v150, v158
    v_add_f32 v151, v151, v159
    v_mfma_f32_16x16x32_bf16 v[56:59], v[72:75], a[232:235], v[56:59]
    buffer_load_dwordx4 v[132:135], v180, s[8:11], s66 offen offset:1024 sc1
    v_add_f32 v152, v152, v160
    v_add_f32 v153, v153, v161
    v_mfma_f32_16x16x32_bf16 v[60:63], v[76:79], a[232:235], v[60:63]
    v_add_f32 v154, v154, v162
    v_add_f32 v155, v155, v163
    v_mfma_f32_16x16x32_bf16 v[64:67], v[72:75], v[248:251], v[64:67]
    v_cvt_pk_bf16_f32 v36, v148, v149
    v_cvt_pk_bf16_f32 v37, v150, v151
    v_mfma_f32_16x16x32_bf16 v[68:71], v[76:79], v[248:251], v[68:71]
    buffer_load_dwordx4 v[136:139], v180, s[8:11], s66 offen offset:2048 sc1
    v_cvt_pk_bf16_f32 v38, v152, v153
    v_cvt_pk_bf16_f32 v39, v154, v155
    v_mfma_f32_16x16x32_bf16 v[56:59], v[80:83], a[236:239], v[56:59]
    v_cvt_pk_bf16_f32 v20, v40, v41
    v_cvt_pk_bf16_f32 v21, v42, v43
    v_mfma_f32_16x16x32_bf16 v[60:63], v[84:87], a[236:239], v[60:63]
    buffer_load_dwordx4 v[140:143], v180, s[8:11], s66 offen offset:3072 sc1
    v_cvt_pk_bf16_f32 v22, v44, v45
    v_cvt_pk_bf16_f32 v23, v46, v47
    v_mfma_f32_16x16x32_bf16 v[64:67], v[80:83], v[252:255], v[64:67]
    v_cvt_pk_bf16_f32 v24, v48, v49
    v_cvt_pk_bf16_f32 v25, v50, v51
    v_mfma_f32_16x16x32_bf16 v[68:71], v[84:87], v[252:255], v[68:71]
    buffer_load_dwordx4 v[144:147], v12, s[8:11], s73 offen sc1
    v_cvt_pk_bf16_f32 v26, v52, v53
    v_cvt_pk_bf16_f32 v27, v54, v55
    ds_read_b128 v[72:75], v11 offset:0
    ds_read_b128 v[76:79], v11 offset:20480
    ds_read_b128 v[80:83], v10 offset:0
    ds_read_b128 v[84:87], v10 offset:20480
    v_permlane16_swap_b32 v36, v38
    v_permlane16_swap_b32 v37, v39
    v_cvt_pk_bf16_f32 v28, v56, v57
    v_cvt_pk_bf16_f32 v29, v58, v59
    v_cvt_pk_bf16_f32 v30, v60, v61
    v_cvt_pk_bf16_f32 v31, v62, v63
    v_cvt_pk_bf16_f32 v32, v64, v65
    v_cvt_pk_bf16_f32 v33, v66, v67
    v_cvt_pk_bf16_f32 v34, v68, v69
    v_cvt_pk_bf16_f32 v35, v70, v71
    s_cmp_lg_u32 s64, 63
    s_cbranch_scc1 S2_CHK
    s_waitcnt lgkmcnt(0)
    s_barrier
    s_nop 0
    ds_read_b64 v[164:165], v16 offset:0
    ds_read_b64 v[166:167], v16 offset:256
    ds_read_b64 v[168:169], v16 offset:512
    ds_read_b64 v[170:171], v16 offset:768
    ds_read_b64 v[172:173], v16 offset:1024
    ds_read_b64 v[174:175], v16 offset:1280
    ds_read_b64 v[176:177], v16 offset:1536
    ds_read_b64 v[178:179], v16 offset:1792
    s_waitcnt lgkmcnt(4)
    v_pk_add_f32 v[164:165], v[164:165], v[166:167]
    v_pk_add_f32 v[168:169], v[168:169], v[170:171]
    s_waitcnt lgkmcnt(0)
    v_pk_add_f32 v[172:173], v[172:173], v[174:175]
    v_pk_add_f32 v[176:177], v[176:177], v[178:179]
    v_pk_add_f32 v[164:165], v[164:165], v[168:169]
    v_pk_add_f32 v[172:173], v[172:173], v[176:177]
    v_pk_add_f32 v[164:165], v[164:165], v[172:173]
    v_cvt_pk_bf16_f32 v164, v164, v165
    v_min_u32 v164, -2, v164
    buffer_store_dword v164, v18, s[8:11], s68 offen sc1
    s_add_u32 s68, s68, 40960
S2_XP:
    s_add_u32 s75, s67, 0
    buffer_load_dwordx4 v[40:43], v13, s[8:11], s75 offen offset:0 sc1
    buffer_load_dwordx4 v[44:47], v13, s[8:11], s75 offen offset:1024 sc1
    buffer_load_dwordx4 v[48:51], v13, s[8:11], s75 offen offset:2048 sc1
    buffer_load_dwordx4 v[52:55], v13, s[8:11], s75 offen offset:3072 sc1
    s_add_u32 s75, s67, 4096
    buffer_load_dwordx4 v[56:59], v13, s[8:11], s75 offen offset:0 sc1
    s_add_u32 s75, s67, 20480
    buffer_load_dwordx4 v[60:63], v183, s[8:11], s75 offen offset:0 sc1
    buffer_load_dwordx4 v[64:67], v183, s[8:11], s75 offen offset:1024 sc1
    buffer_load_dwordx4 v[68:71], v183, s[8:11], s75 offen offset:2048 sc1
    buffer_load_dwordx4 v[72:75], v183, s[8:11], s75 offen offset:3072 sc1
    s_add_u32 s75, s67, 24576
    buffer_load_dwordx4 v[76:79], v183, s[8:11], s75 offen offset:0 sc1
    s_add_u32 s75, s67, 40960
    buffer_load_dwordx4 v[80:83], v13, s[8:11], s75 offen offset:0 sc1
    buffer_load_dwordx4 v[84:87], v13, s[8:11], s75 offen offset:1024 sc1
    buffer_load_dwordx4 v[108:111], v13, s[8:11], s75 offen offset:2048 sc1
    buffer_load_dwordx4 v[112:115], v13, s[8:11], s75 offen offset:3072 sc1
    s_add_u32 s75, s67, 45056
    buffer_load_dwordx4 v[116:119], v13, s[8:11], s75 offen offset:0 sc1
    s_add_u32 s75, s67, 61440
    buffer_load_dwordx4 v[120:123], v183, s[8:11], s75 offen offset:0 sc1
    buffer_load_dwordx4 v[124:127], v183, s[8:11], s75 offen offset:1024 sc1
    buffer_load_dwordx4 v[128:131], v183, s[8:11], s75 offen offset:2048 sc1
    buffer_load_dwordx4 v[132:135], v183, s[8:11], s75 offen offset:3072 sc1
    s_add_u32 s75, s67, 65536
    buffer_load_dwordx4 v[136:139], v183, s[8:11], s75 offen offset:0 sc1
    s_waitcnt vmcnt(0)
    v_mfma_f32_16x16x32_bf16 v[148:151], v[88:91], v[40:43], 0
    v_max3_u32 v19, v40, v41, v42
    v_max3_u32 v19, v19, v43, v44
    v_mfma_f32_16x16x32_bf16 v[152:155], v[88:91], v[60:63], 0
    v_max3_u32 v19, v19, v45, v46
    v_max3_u32 v19, v19, v47, v48
    v_mfma_f32_16x16x32_bf16 v[156:159], v[88:91], v[80:83], 0
    v_max3_u32 v19, v19, v49, v50
    v_max3_u32 v19, v19, v51, v52
    v_mfma_f32_16x16x32_bf16 v[160:163], v[88:91], v[120:123], 0
    v_max3_u32 v19, v19, v53, v54
    v_max3_u32 v19, v19, v55, v56
    v_mfma_f32_16x16x32_bf16 v[148:151], v[92:95], v[44:47], v[148:151]
    v_max3_u32 v19, v19, v57, v58
    v_max3_u32 v19, v19, v59, v60
    v_mfma_f32_16x16x32_bf16 v[152:155], v[92:95], v[64:67], v[152:155]
    v_max3_u32 v19, v19, v61, v62
    v_max3_u32 v19, v19, v63, v64
    v_mfma_f32_16x16x32_bf16 v[156:159], v[92:95], v[84:87], v[156:159]
    v_max3_u32 v19, v19, v65, v66
    v_max3_u32 v19, v19, v67, v68
    v_mfma_f32_16x16x32_bf16 v[160:163], v[92:95], v[124:127], v[160:163]
    v_max3_u32 v19, v19, v69, v70
    v_max3_u32 v19, v19, v71, v72
    v_mfma_f32_16x16x32_bf16 v[148:151], v[96:99], v[48:51], v[148:151]
    v_max3_u32 v19, v19, v73, v74
    v_max3_u32 v19, v19, v75, v76
    v_mfma_f32_16x16x32_bf16 v[152:155], v[96:99], v[68:71], v[152:155]
    v_max3_u32 v19, v19, v77, v78
    v_max3_u32 v19, v19, v79, v80
    v_mfma_f32_16x16x32_bf16 v[156:159], v[96:99], v[108:111], v[156:159]
    v_max3_u32 v19, v19, v81, v82
    v_max3_u32 v19, v19, v83, v84
    v_mfma_f32_16x16x32_bf16 v[160:163], v[96:99], v[128:131], v[160:163]
    v_max3_u32 v19, v19, v85, v86
    v_max3_u32 v19, v19, v87, v108
    v_mfma_f32_16x16x32_bf16 v[148:151], v[100:103], v[52:55], v[148:151]
    v_max3_u32 v19, v19, v109, v110
    v_max3_u32 v19, v19, v111, v112
    v_mfma_f32_16x16x32_bf16 v[152:155], v[100:103], v[72:75], v[152:155]
    v_max3_u32 v19, v19, v113, v114
    v_max3_u32 v19, v19, v115, v116
    v_mfma_f32_16x16x32_bf16 v[156:159], v[100:103], v[112:115], v[156:159]
    v_max3_u32 v19, v19, v117, v118
    v_max3_u32 v19, v19, v119, v120
    v_mfma_f32_16x16x32_bf16 v[160:163], v[100:103], v[132:135], v[160:163]
    v_max3_u32 v19, v19, v121, v122
    v_max3_u32 v19, v19, v123, v124
    v_mfma_f32_16x16x32_bf16 v[148:151], v[104:107], v[56:59], v[148:151]
    v_max3_u32 v19, v19, v125, v126
    v_max3_u32 v19, v19, v127, v128
    v_mfma_f32_16x16x32_bf16 v[152:155], v[104:107], v[76:79], v[152:155]
    v_max3_u32 v19, v19, v129, v130
    v_max3_u32 v19, v19, v131, v132
    v_mfma_f32_16x16x32_bf16 v[156:159], v[104:107], v[116:119], v[156:159]
    v_max3_u32 v19, v19, v133, v134
    v_max3_u32 v19, v19, v135, v136
    v_mfma_f32_16x16x32_bf16 v[160:163], v[104:107], v[136:139], v[160:163]
    v_max3_u32 v19, v19, v137, v138
    v_max_u32 v19, v19, v139
    v_cmp_eq_u32 vcc, -1, v19
    s_cbranch_vccz S2_XGOT
    s_sub_u32 s32, s32, 1
    s_cbranch_scc0 S2_XP
    s_endpgm
S2_XGOT:
    s_nop 3
    s_barrier
    v_cndmask_b32 v148, v152, v148, s[58:59]
    v_cndmask_b32 v149, v153, v149, s[58:59]
    v_cndmask_b32 v150, v154, v150, s[58:59]
    v_cndmask_b32 v151, v155, v151, s[58:59]
    ds_write_b128 v182, v[148:151] offset:2048
    v_cndmask_b32 v156, v160, v156, s[58:59]
    v_cndmask_b32 v157, v161, v157, s[58:59]
    v_cndmask_b32 v158, v162, v158, s[58:59]
    v_cndmask_b32 v159, v163, v159, s[58:59]
    ds_write_b128 v182, v[156:159] offset:6144
    s_waitcnt lgkmcnt(0)
    s_barrier
    s_nop 0
    ds_read_b64 v[164:165], v16 offset:0
    ds_read_b64 v[166:167], v16 offset:256
    ds_read_b64 v[168:169], v16 offset:512
    ds_read_b64 v[170:171], v16 offset:768
    ds_read_b64 v[172:173], v16 offset:1024
    ds_read_b64 v[174:175], v16 offset:1280
    ds_read_b64 v[176:177], v16 offset:1536
    ds_read_b64 v[178:179], v16 offset:1792
    s_waitcnt lgkmcnt(4)
    v_pk_add_f32 v[164:165], v[164:165], v[166:167]
    v_pk_add_f32 v[168:169], v[168:169], v[170:171]
    s_waitcnt lgkmcnt(0)
    v_pk_add_f32 v[172:173], v[172:173], v[174:175]
    v_pk_add_f32 v[176:177], v[176:177], v[178:179]
    v_pk_add_f32 v[164:165], v[164:165], v[168:169]
    v_pk_add_f32 v[172:173], v[172:173], v[176:177]
    v_pk_add_f32 v[164:165], v[164:165], v[172:173]
    v_cvt_pk_bf16_f32 v164, v164, v165
    v_min_u32 v164, -2, v164
    buffer_store_dword v164, v18, s[8:11], s68 offen sc1
    v_mov_b32 v88, v20
    v_mov_b32 v89, v21
    v_mov_b32 v90, v22
    v_mov_b32 v91, v23
    v_mov_b32 v92, v24
    v_mov_b32 v93, v25
    v_mov_b32 v94, v26
    v_mov_b32 v95, v27
    v_mov_b32 v96, v28
    v_mov_b32 v97, v29
    v_mov_b32 v98, v30
    v_mov_b32 v99, v31
    v_mov_b32 v100, v32
    v_mov_b32 v101, v33
    v_mov_b32 v102, v34
    v_mov_b32 v103, v35
    v_mov_b32 v104, v36
    v_mov_b32 v105, v37
    v_mov_b32 v106, v38
    v_mov_b32 v107, v39
    s_add_u32 s64, s64, 1
    s_add_u32 s67, s67, 81920
    s_add_u32 s68, s68, 40960
    s_cmp_eq_u32 s64, 64
    s_cbranch_scc1 S2_XP
    s_endpgm
S2_MP:
    s_mov_b32 m0, s61
    s_nop 0
    buffer_load_dwordx4 v1, s[8:11], s74 offen sc1 lds
    buffer_load_dwordx4 v1, s[8:11], s74 offen offset:1024 sc1 lds
    s_mov_b32 exec_hi, 0
    buffer_load_dwordx4 v1, s[8:11], s74 offen offset:2048 sc1 lds
    s_mov_b32 exec_hi, -1
    s_waitcnt vmcnt(0)
    ds_read_b128 v[164:167], v5
    ds_read_b128 v[168:171], v5 offset:1024
    ds_read_b128 v[172:175], v6
    s_waitcnt lgkmcnt(0)
    v_max3_u32 v19, v164, v165, v166
    v_max3_u32 v19, v19, v167, v168
    v_max3_u32 v19, v19, v169, v170
    v_max3_u32 v19, v19, v171, v172
    v_max3_u32 v19, v19, v173, v174
    v_max_u32 v19, v19, v175
    v_cmp_eq_u32 vcc, -1, v19
    s_cbranch_vccz S2_MGOT
    s_sub_u32 s32, s32, 1
    s_cbranch_scc0 S2_MP
    s_endpgm
L_A:
    s_sub_u32 s5, s4, 192
    s_and_b32 s64, s5, 7
    s_lshr_b32 s65, s5, 3
    s_lshl_b32 s66, s65, 8
    s_lshl_b32 s6, s3, 6
    s_add_u32 s66, s66, s6
    v_lshrrev_b32 v4, 4, v0
    v_and_b32 v5, 15, v0
    v_mul_u32_u24 v6, 1280, v5
    v_lshl_add_u32 v6, v4, 4, v6
    s_mov_b32 s16, s38
    s_and_b32 s17, s39, 0xffff
    s_mov_b32 s18, 2457600
    s_mov_b32 s19, 0x20000
    s_mov_b32 s20, s56
    s_and_b32 s21, s57, 0xffff
    s_mov_b32 s22, 1280
    s_mov_b32 s23, 0x20000
    s_mul_i32 s6, s66, 1280
    s_add_u32 s6, s6, 0
    buffer_load_dwordx4 a[0:3], v6, s[12:15], s6 offen offset:0
    buffer_load_dwordx4 a[4:7], v6, s[12:15], s6 offen offset:64
    buffer_load_dwordx4 a[8:11], v6, s[12:15], s6 offen offset:128
    buffer_load_dwordx4 a[12:15], v6, s[12:15], s6 offen offset:192
    buffer_load_dwordx4 a[16:19], v6, s[12:15], s6 offen offset:256
    buffer_load_dwordx4 a[20:23], v6, s[12:15], s6 offen offset:320
    buffer_load_dwordx4 a[24:27], v6, s[12:15], s6 offen offset:384
    buffer_load_dwordx4 a[28:31], v6, s[12:15], s6 offen offset:448
    buffer_load_dwordx4 a[32:35], v6, s[12:15], s6 offen offset:512
    buffer_load_dwordx4 a[36:39], v6, s[12:15], s6 offen offset:576
    buffer_load_dwordx4 a[40:43], v6, s[12:15], s6 offen offset:640
    buffer_load_dwordx4 a[44:47], v6, s[12:15], s6 offen offset:704
    buffer_load_dwordx4 a[48:51], v6, s[12:15], s6 offen offset:768
    buffer_load_dwordx4 a[52:55], v6, s[12:15], s6 offen offset:832
    buffer_load_dwordx4 a[56:59], v6, s[12:15], s6 offen offset:896
    buffer_load_dwordx4 a[60:63], v6, s[12:15], s6 offen offset:960
    buffer_load_dwordx4 a[64:67], v6, s[12:15], s6 offen offset:1024
    buffer_load_dwordx4 a[68:71], v6, s[12:15], s6 offen offset:1088
    buffer_load_dwordx4 a[72:75], v6, s[12:15], s6 offen offset:1152
    buffer_load_dwordx4 a[76:79], v6, s[12:15], s6 offen offset:1216
    s_add_u32 s6, s6, 20480
    buffer_load_dwordx4 a[80:83], v6, s[12:15], s6 offen offset:0
    buffer_load_dwordx4 a[84:87], v6, s[12:15], s6 offen offset:64
    buffer_load_dwordx4 a[88:91], v6, s[12:15], s6 offen offset:128
    buffer_load_dwordx4 a[92:95], v6, s[12:15], s6 offen offset:192
    buffer_load_dwordx4 a[96:99], v6, s[12:15], s6 offen offset:256
    buffer_load_dwordx4 a[100:103], v6, s[12:15], s6 offen offset:320
    buffer_load_dwordx4 a[104:107], v6, s[12:15], s6 offen offset:384
    buffer_load_dwordx4 a[108:111], v6, s[12:15], s6 offen offset:448
    buffer_load_dwordx4 a[112:115], v6, s[12:15], s6 offen offset:512
    buffer_load_dwordx4 a[116:119], v6, s[12:15], s6 offen offset:576
    buffer_load_dwordx4 a[120:123], v6, s[12:15], s6 offen offset:640
    buffer_load_dwordx4 a[124:127], v6, s[12:15], s6 offen offset:704
    buffer_load_dwordx4 a[128:131], v6, s[12:15], s6 offen offset:768
    buffer_load_dwordx4 a[132:135], v6, s[12:15], s6 offen offset:832
    buffer_load_dwordx4 a[136:139], v6, s[12:15], s6 offen offset:896
    buffer_load_dwordx4 a[140:143], v6, s[12:15], s6 offen offset:960
    buffer_load_dwordx4 a[144:147], v6, s[12:15], s6 offen offset:1024
    buffer_load_dwordx4 a[148:151], v6, s[12:15], s6 offen offset:1088
    buffer_load_dwordx4 a[152:155], v6, s[12:15], s6 offen offset:1152
    buffer_load_dwordx4 a[156:159], v6, s[12:15], s6 offen offset:1216
    s_add_u32 s6, s6, 20480
    buffer_load_dwordx4 a[160:163], v6, s[12:15], s6 offen offset:0
    buffer_load_dwordx4 a[164:167], v6, s[12:15], s6 offen offset:64
    buffer_load_dwordx4 a[168:171], v6, s[12:15], s6 offen offset:128
    buffer_load_dwordx4 a[172:175], v6, s[12:15], s6 offen offset:192
    buffer_load_dwordx4 a[176:179], v6, s[12:15], s6 offen offset:256
    buffer_load_dwordx4 a[180:183], v6, s[12:15], s6 offen offset:320
    buffer_load_dwordx4 a[184:187], v6, s[12:15], s6 offen offset:384
    buffer_load_dwordx4 a[188:191], v6, s[12:15], s6 offen offset:448
    buffer_load_dwordx4 a[192:195], v6, s[12:15], s6 offen offset:512
    buffer_load_dwordx4 a[196:199], v6, s[12:15], s6 offen offset:576
    buffer_load_dwordx4 a[200:203], v6, s[12:15], s6 offen offset:640
    buffer_load_dwordx4 a[204:207], v6, s[12:15], s6 offen offset:704
    buffer_load_dwordx4 a[208:211], v6, s[12:15], s6 offen offset:768
    buffer_load_dwordx4 a[212:215], v6, s[12:15], s6 offen offset:832
    buffer_load_dwordx4 a[216:219], v6, s[12:15], s6 offen offset:896
    buffer_load_dwordx4 a[220:223], v6, s[12:15], s6 offen offset:960
    buffer_load_dwordx4 a[224:227], v6, s[12:15], s6 offen offset:1024
    buffer_load_dwordx4 a[228:231], v6, s[12:15], s6 offen offset:1088
    buffer_load_dwordx4 a[232:235], v6, s[12:15], s6 offen offset:1152
    buffer_load_dwordx4 a[236:239], v6, s[12:15], s6 offen offset:1216
    s_add_u32 s6, s6, 20480
    s_waitcnt vmcnt(40)
    buffer_load_dwordx4 a[240:243], v6, s[12:15], s6 offen offset:0
    buffer_load_dwordx4 a[244:247], v6, s[12:15], s6 offen offset:64
    buffer_load_dwordx4 a[248:251], v6, s[12:15], s6 offen offset:128
    buffer_load_dwordx4 a[252:255], v6, s[12:15], s6 offen offset:192
    buffer_load_dwordx4 v[192:195], v6, s[12:15], s6 offen offset:256
    buffer_load_dwordx4 v[196:199], v6, s[12:15], s6 offen offset:320
    buffer_load_dwordx4 v[200:203], v6, s[12:15], s6 offen offset:384
    buffer_load_dwordx4 v[204:207], v6, s[12:15], s6 offen offset:448
    buffer_load_dwordx4 v[208:211], v6, s[12:15], s6 offen offset:512
    buffer_load_dwordx4 v[212:215], v6, s[12:15], s6 offen offset:576
    buffer_load_dwordx4 v[216:219], v6, s[12:15], s6 offen offset:640
    buffer_load_dwordx4 v[220:223], v6, s[12:15], s6 offen offset:704
    buffer_load_dwordx4 v[224:227], v6, s[12:15], s6 offen offset:768
    buffer_load_dwordx4 v[228:231], v6, s[12:15], s6 offen offset:832
    buffer_load_dwordx4 v[232:235], v6, s[12:15], s6 offen offset:896
    buffer_load_dwordx4 v[236:239], v6, s[12:15], s6 offen offset:960
    buffer_load_dwordx4 v[240:243], v6, s[12:15], s6 offen offset:1024
    buffer_load_dwordx4 v[244:247], v6, s[12:15], s6 offen offset:1088
    buffer_load_dwordx4 v[248:251], v6, s[12:15], s6 offen offset:1152
    buffer_load_dwordx4 v[252:255], v6, s[12:15], s6 offen offset:1216
    s_add_u32 s6, s6, 20480
    v_lshlrev_b32 v7, 4, v4
    s_waitcnt vmcnt(40)
    buffer_load_dwordx4 v[16:19], v7, s[20:23], 0 offen offset:0
    buffer_load_dwordx4 v[20:23], v7, s[20:23], 0 offen offset:64
    buffer_load_dwordx4 v[24:27], v7, s[20:23], 0 offen offset:128
    buffer_load_dwordx4 v[28:31], v7, s[20:23], 0 offen offset:192
    buffer_load_dwordx4 v[32:35], v7, s[20:23], 0 offen offset:256
    buffer_load_dwordx4 v[36:39], v7, s[20:23], 0 offen offset:320
    buffer_load_dwordx4 v[40:43], v7, s[20:23], 0 offen offset:384
    buffer_load_dwordx4 v[44:47], v7, s[20:23], 0 offen offset:448
    buffer_load_dwordx4 v[48:51], v7, s[20:23], 0 offen offset:512
    buffer_load_dwordx4 v[52:55], v7, s[20:23], 0 offen offset:576
    buffer_load_dwordx4 v[56:59], v7, s[20:23], 0 offen offset:640
    buffer_load_dwordx4 v[60:63], v7, s[20:23], 0 offen offset:704
    buffer_load_dwordx4 v[64:67], v7, s[20:23], 0 offen offset:768
    buffer_load_dwordx4 v[68:71], v7, s[20:23], 0 offen offset:832
    buffer_load_dwordx4 v[72:75], v7, s[20:23], 0 offen offset:896
    buffer_load_dwordx4 v[76:79], v7, s[20:23], 0 offen offset:960
    buffer_load_dwordx4 v[80:83], v7, s[20:23], 0 offen offset:1024
    buffer_load_dwordx4 v[84:87], v7, s[20:23], 0 offen offset:1088
    buffer_load_dwordx4 v[88:91], v7, s[20:23], 0 offen offset:1152
    buffer_load_dwordx4 v[92:95], v7, s[20:23], 0 offen offset:1216
    s_waitcnt vmcnt(0)
    v_mfma_f32_16x16x32_bf16 v[96:99], v[16:19], a[0:3], 0
    v_mfma_f32_16x16x32_bf16 v[100:103], v[16:19], a[80:83], 0
    v_mfma_f32_16x16x32_bf16 v[104:107], v[16:19], a[160:163], 0
    v_mfma_f32_16x16x32_bf16 v[108:111], v[16:19], a[240:243], 0
    v_mfma_f32_16x16x32_bf16 v[96:99], v[20:23], a[4:7], v[96:99]
    v_mfma_f32_16x16x32_bf16 v[100:103], v[20:23], a[84:87], v[100:103]
    v_mfma_f32_16x16x32_bf16 v[104:107], v[20:23], a[164:167], v[104:107]
    v_mfma_f32_16x16x32_bf16 v[108:111], v[20:23], a[244:247], v[108:111]
    v_mfma_f32_16x16x32_bf16 v[96:99], v[24:27], a[8:11], v[96:99]
    v_mfma_f32_16x16x32_bf16 v[100:103], v[24:27], a[88:91], v[100:103]
    v_mfma_f32_16x16x32_bf16 v[104:107], v[24:27], a[168:171], v[104:107]
    v_mfma_f32_16x16x32_bf16 v[108:111], v[24:27], a[248:251], v[108:111]
    v_mfma_f32_16x16x32_bf16 v[96:99], v[28:31], a[12:15], v[96:99]
    v_mfma_f32_16x16x32_bf16 v[100:103], v[28:31], a[92:95], v[100:103]
    v_mfma_f32_16x16x32_bf16 v[104:107], v[28:31], a[172:175], v[104:107]
    v_mfma_f32_16x16x32_bf16 v[108:111], v[28:31], a[252:255], v[108:111]
    v_mfma_f32_16x16x32_bf16 v[96:99], v[32:35], a[16:19], v[96:99]
    v_mfma_f32_16x16x32_bf16 v[100:103], v[32:35], a[96:99], v[100:103]
    v_mfma_f32_16x16x32_bf16 v[104:107], v[32:35], a[176:179], v[104:107]
    v_mfma_f32_16x16x32_bf16 v[108:111], v[32:35], v[192:195], v[108:111]
    v_mfma_f32_16x16x32_bf16 v[96:99], v[36:39], a[20:23], v[96:99]
    v_mfma_f32_16x16x32_bf16 v[100:103], v[36:39], a[100:103], v[100:103]
    v_mfma_f32_16x16x32_bf16 v[104:107], v[36:39], a[180:183], v[104:107]
    v_mfma_f32_16x16x32_bf16 v[108:111], v[36:39], v[196:199], v[108:111]
    v_mfma_f32_16x16x32_bf16 v[96:99], v[40:43], a[24:27], v[96:99]
    v_mfma_f32_16x16x32_bf16 v[100:103], v[40:43], a[104:107], v[100:103]
    v_mfma_f32_16x16x32_bf16 v[104:107], v[40:43], a[184:187], v[104:107]
    v_mfma_f32_16x16x32_bf16 v[108:111], v[40:43], v[200:203], v[108:111]
    v_mfma_f32_16x16x32_bf16 v[96:99], v[44:47], a[28:31], v[96:99]
    v_mfma_f32_16x16x32_bf16 v[100:103], v[44:47], a[108:111], v[100:103]
    v_mfma_f32_16x16x32_bf16 v[104:107], v[44:47], a[188:191], v[104:107]
    v_mfma_f32_16x16x32_bf16 v[108:111], v[44:47], v[204:207], v[108:111]
    v_mfma_f32_16x16x32_bf16 v[96:99], v[48:51], a[32:35], v[96:99]
    v_mfma_f32_16x16x32_bf16 v[100:103], v[48:51], a[112:115], v[100:103]
    v_mfma_f32_16x16x32_bf16 v[104:107], v[48:51], a[192:195], v[104:107]
    v_mfma_f32_16x16x32_bf16 v[108:111], v[48:51], v[208:211], v[108:111]
    v_mfma_f32_16x16x32_bf16 v[96:99], v[52:55], a[36:39], v[96:99]
    v_mfma_f32_16x16x32_bf16 v[100:103], v[52:55], a[116:119], v[100:103]
    v_mfma_f32_16x16x32_bf16 v[104:107], v[52:55], a[196:199], v[104:107]
    v_mfma_f32_16x16x32_bf16 v[108:111], v[52:55], v[212:215], v[108:111]
    v_mfma_f32_16x16x32_bf16 v[96:99], v[56:59], a[40:43], v[96:99]
    v_mfma_f32_16x16x32_bf16 v[100:103], v[56:59], a[120:123], v[100:103]
    v_mfma_f32_16x16x32_bf16 v[104:107], v[56:59], a[200:203], v[104:107]
    v_mfma_f32_16x16x32_bf16 v[108:111], v[56:59], v[216:219], v[108:111]
    v_mfma_f32_16x16x32_bf16 v[96:99], v[60:63], a[44:47], v[96:99]
    v_mfma_f32_16x16x32_bf16 v[100:103], v[60:63], a[124:127], v[100:103]
    v_mfma_f32_16x16x32_bf16 v[104:107], v[60:63], a[204:207], v[104:107]
    v_mfma_f32_16x16x32_bf16 v[108:111], v[60:63], v[220:223], v[108:111]
    v_mfma_f32_16x16x32_bf16 v[96:99], v[64:67], a[48:51], v[96:99]
    v_mfma_f32_16x16x32_bf16 v[100:103], v[64:67], a[128:131], v[100:103]
    v_mfma_f32_16x16x32_bf16 v[104:107], v[64:67], a[208:211], v[104:107]
    v_mfma_f32_16x16x32_bf16 v[108:111], v[64:67], v[224:227], v[108:111]
    v_mfma_f32_16x16x32_bf16 v[96:99], v[68:71], a[52:55], v[96:99]
    v_mfma_f32_16x16x32_bf16 v[100:103], v[68:71], a[132:135], v[100:103]
    v_mfma_f32_16x16x32_bf16 v[104:107], v[68:71], a[212:215], v[104:107]
    v_mfma_f32_16x16x32_bf16 v[108:111], v[68:71], v[228:231], v[108:111]
    v_mfma_f32_16x16x32_bf16 v[96:99], v[72:75], a[56:59], v[96:99]
    v_mfma_f32_16x16x32_bf16 v[100:103], v[72:75], a[136:139], v[100:103]
    v_mfma_f32_16x16x32_bf16 v[104:107], v[72:75], a[216:219], v[104:107]
    v_mfma_f32_16x16x32_bf16 v[108:111], v[72:75], v[232:235], v[108:111]
    v_mfma_f32_16x16x32_bf16 v[96:99], v[76:79], a[60:63], v[96:99]
    v_mfma_f32_16x16x32_bf16 v[100:103], v[76:79], a[140:143], v[100:103]
    v_mfma_f32_16x16x32_bf16 v[104:107], v[76:79], a[220:223], v[104:107]
    v_mfma_f32_16x16x32_bf16 v[108:111], v[76:79], v[236:239], v[108:111]
    v_mfma_f32_16x16x32_bf16 v[96:99], v[80:83], a[64:67], v[96:99]
    v_mfma_f32_16x16x32_bf16 v[100:103], v[80:83], a[144:147], v[100:103]
    v_mfma_f32_16x16x32_bf16 v[104:107], v[80:83], a[224:227], v[104:107]
    v_mfma_f32_16x16x32_bf16 v[108:111], v[80:83], v[240:243], v[108:111]
    v_mfma_f32_16x16x32_bf16 v[96:99], v[84:87], a[68:71], v[96:99]
    v_mfma_f32_16x16x32_bf16 v[100:103], v[84:87], a[148:151], v[100:103]
    v_mfma_f32_16x16x32_bf16 v[104:107], v[84:87], a[228:231], v[104:107]
    v_mfma_f32_16x16x32_bf16 v[108:111], v[84:87], v[244:247], v[108:111]
    v_mfma_f32_16x16x32_bf16 v[96:99], v[88:91], a[72:75], v[96:99]
    v_mfma_f32_16x16x32_bf16 v[100:103], v[88:91], a[152:155], v[100:103]
    v_mfma_f32_16x16x32_bf16 v[104:107], v[88:91], a[232:235], v[104:107]
    v_mfma_f32_16x16x32_bf16 v[108:111], v[88:91], v[248:251], v[108:111]
    v_mfma_f32_16x16x32_bf16 v[96:99], v[92:95], a[76:79], v[96:99]
    v_mfma_f32_16x16x32_bf16 v[100:103], v[92:95], a[156:159], v[100:103]
    v_mfma_f32_16x16x32_bf16 v[104:107], v[92:95], a[236:239], v[104:107]
    v_mfma_f32_16x16x32_bf16 v[108:111], v[92:95], v[252:255], v[108:111]
    s_nop 4
    v_mul_f32 v112, 3216550459, v96
    v_mul_f32 v113, 3216550459, v100
    v_mul_f32 v114, 3216550459, v104
    v_mul_f32 v115, 3216550459, v108
    v_exp_f32 v112, v112
    v_exp_f32 v113, v113
    v_exp_f32 v114, v114
    v_exp_f32 v115, v115
    v_add_f32 v112, 1.0, v112
    v_add_f32 v113, 1.0, v113
    v_add_f32 v114, 1.0, v114
    v_add_f32 v115, 1.0, v115
    v_rcp_f32 v112, v112
    v_rcp_f32 v113, v113
    v_rcp_f32 v114, v114
    v_rcp_f32 v115, v115
    v_add_u32 v2, 0, v4
    v_mul_u32_u24 v3, 52, v2
    v_lshrrev_b32 v3, 8, v3
    v_mul_u32_u24 v7, 5, v3
    v_sub_u32 v2, v2, v7
    s_lshl_b32 s6, s64, 2
    v_add_u32 v3, s6, v3
    v_lshlrev_b32 v3, 11, v3
    v_add_u32 v3, s66, v3
    v_add_u32 v3, v3, v5
    v_lshlrev_b32 v7, 5, v3
    v_lshl_add_u32 v7, v2, 3, v7
    v_lshlrev_b32 v3, 3, v3
    v_add_u32 v3, 2097152, v3
    v_cmp_eq_u32 vcc, 4, v2
    s_nop 1
    v_cndmask_b32 v116, v7, v3, vcc
    v_mov_b32 v3, 128
    v_mov_b32 v7, 512
    v_cndmask_b32 v121, v7, v3, vcc
    v_add_u32 v2, 4, v4
    v_mul_u32_u24 v3, 52, v2
    v_lshrrev_b32 v3, 8, v3
    v_mul_u32_u24 v7, 5, v3
    v_sub_u32 v2, v2, v7
    s_lshl_b32 s6, s64, 2
    v_add_u32 v3, s6, v3
    v_lshlrev_b32 v3, 11, v3
    v_add_u32 v3, s66, v3
    v_add_u32 v3, v3, v5
    v_lshlrev_b32 v7, 5, v3
    v_lshl_add_u32 v7, v2, 3, v7
    v_lshlrev_b32 v3, 3, v3
    v_add_u32 v3, 2097152, v3
    v_cmp_eq_u32 vcc, 4, v2
    s_nop 1
    v_cndmask_b32 v117, v7, v3, vcc
    v_mov_b32 v3, 128
    v_mov_b32 v7, 512
    v_cndmask_b32 v122, v7, v3, vcc
    v_add_u32 v2, 8, v4
    v_mul_u32_u24 v3, 52, v2
    v_lshrrev_b32 v3, 8, v3
    v_mul_u32_u24 v7, 5, v3
    v_sub_u32 v2, v2, v7
    s_lshl_b32 s6, s64, 2
    v_add_u32 v3, s6, v3
    v_lshlrev_b32 v3, 11, v3
    v_add_u32 v3, s66, v3
    v_add_u32 v3, v3, v5
    v_lshlrev_b32 v7, 5, v3
    v_lshl_add_u32 v7, v2, 3, v7
    v_lshlrev_b32 v3, 3, v3
    v_add_u32 v3, 2097152, v3
    v_cmp_eq_u32 vcc, 4, v2
    s_nop 1
    v_cndmask_b32 v118, v7, v3, vcc
    v_mov_b32 v3, 128
    v_mov_b32 v7, 512
    v_cndmask_b32 v123, v7, v3, vcc
    v_add_u32 v2, 12, v4
    v_mul_u32_u24 v3, 52, v2
    v_lshrrev_b32 v3, 8, v3
    v_mul_u32_u24 v7, 5, v3
    v_sub_u32 v2, v2, v7
    s_lshl_b32 s6, s64, 2
    v_add_u32 v3, s6, v3
    v_lshlrev_b32 v3, 11, v3
    v_add_u32 v3, s66, v3
    v_add_u32 v3, v3, v5
    v_lshlrev_b32 v7, 5, v3
    v_lshl_add_u32 v7, v2, 3, v7
    v_lshlrev_b32 v3, 3, v3
    v_add_u32 v3, 2097152, v3
    v_cmp_eq_u32 vcc, 4, v2
    s_nop 1
    v_cndmask_b32 v119, v7, v3, vcc
    v_mov_b32 v3, 128
    v_mov_b32 v7, 512
    v_cndmask_b32 v124, v7, v3, vcc
    v_add_u32 v2, 16, v4
    v_mul_u32_u24 v3, 52, v2
    v_lshrrev_b32 v3, 8, v3
    v_mul_u32_u24 v7, 5, v3
    v_sub_u32 v2, v2, v7
    s_lshl_b32 s6, s64, 2
    v_add_u32 v3, s6, v3
    v_lshlrev_b32 v3, 11, v3
    v_add_u32 v3, s66, v3
    v_add_u32 v3, v3, v5
    v_lshlrev_b32 v7, 5, v3
    v_lshl_add_u32 v7, v2, 3, v7
    v_lshlrev_b32 v3, 3, v3
    v_add_u32 v3, 2097152, v3
    v_cmp_eq_u32 vcc, 4, v2
    s_nop 1
    v_cndmask_b32 v120, v7, v3, vcc
    v_mov_b32 v3, 128
    v_mov_b32 v7, 512
    v_cndmask_b32 v125, v7, v3, vcc
    s_mul_i32 s67, s64, 160
    s_mov_b32 s68, 117440512
    s_mov_b32 s69, 1051011932
A_QK:
    s_barrier
    s_mov_b32 s7, 52429
    s_mov_b32 s33, 3840
    v_add_u32 v2, 0, v0
    v_mul_lo_u32 v3, v2, s7
    v_lshrrev_b32 v3, 19, v3
    v_mul_u32_u24 v8, 10, v3
    v_sub_u32 v2, v2, v8
    v_and_b32 v8, 0x13, v3
    v_and_b32 v7, 4, v3
    v_lshl_or_b32 v8, v7, 1, v8
    v_and_b32 v7, 8, v3
    v_lshrrev_b32 v7, 1, v7
    v_or_b32 v8, v8, v7
    v_mul_lo_u32 v8, v8, s33
    v_lshl_add_u32 v8, v2, 4, v8
    v_add_u32 v2, 64, v0
    v_mul_lo_u32 v3, v2, s7
    v_lshrrev_b32 v3, 19, v3
    v_mul_u32_u24 v9, 10, v3
    v_sub_u32 v2, v2, v9
    v_and_b32 v9, 0x13, v3
    v_and_b32 v7, 4, v3
    v_lshl_or_b32 v9, v7, 1, v9
    v_and_b32 v7, 8, v3
    v_lshrrev_b32 v7, 1, v7
    v_or_b32 v9, v9, v7
    v_mul_lo_u32 v9, v9, s33
    v_lshl_add_u32 v9, v2, 4, v9
    v_add_u32 v2, 128, v0
    v_mul_lo_u32 v3, v2, s7
    v_lshrrev_b32 v3, 19, v3
    v_mul_u32_u24 v10, 10, v3
    v_sub_u32 v2, v2, v10
    v_and_b32 v10, 0x13, v3
    v_and_b32 v7, 4, v3
    v_lshl_or_b32 v10, v7, 1, v10
    v_and_b32 v7, 8, v3
    v_lshrrev_b32 v7, 1, v7
    v_or_b32 v10, v10, v7
    v_mul_lo_u32 v10, v10, s33
    v_lshl_add_u32 v10, v2, 4, v10
    v_add_u32 v2, 192, v0
    v_mul_lo_u32 v3, v2, s7
    v_lshrrev_b32 v3, 19, v3
    v_mul_u32_u24 v11, 10, v3
    v_sub_u32 v2, v2, v11
    v_and_b32 v11, 0x13, v3
    v_and_b32 v7, 4, v3
    v_lshl_or_b32 v11, v7, 1, v11
    v_and_b32 v7, 8, v3
    v_lshrrev_b32 v7, 1, v7
    v_or_b32 v11, v11, v7
    v_mul_lo_u32 v11, v11, s33
    v_lshl_add_u32 v11, v2, 4, v11
    v_add_u32 v2, 256, v0
    v_mul_lo_u32 v3, v2, s7
    v_lshrrev_b32 v3, 19, v3
    v_mul_u32_u24 v12, 10, v3
    v_sub_u32 v2, v2, v12
    v_and_b32 v12, 0x13, v3
    v_and_b32 v7, 4, v3
    v_lshl_or_b32 v12, v7, 1, v12
    v_and_b32 v7, 8, v3
    v_lshrrev_b32 v7, 1, v7
    v_or_b32 v12, v12, v7
    v_mul_lo_u32 v12, v12, s33
    v_lshl_add_u32 v12, v2, 4, v12
    s_mul_i32 s6, s3, 614400
    s_add_u32 s6, s6, s67
    s_mul_i32 s34, s3, 25600
    s_add_u32 m0, s34, 0
    s_nop 0
    buffer_load_dwordx4 v8, s[16:19], s6 offen lds
    s_add_u32 m0, s34, 1024
    s_nop 0
    buffer_load_dwordx4 v9, s[16:19], s6 offen lds
    s_add_u32 m0, s34, 2048
    s_nop 0
    buffer_load_dwordx4 v10, s[16:19], s6 offen lds
    s_add_u32 m0, s34, 3072
    s_nop 0
    buffer_load_dwordx4 v11, s[16:19], s6 offen lds
    s_add_u32 m0, s34, 4096
    s_nop 0
    buffer_load_dwordx4 v12, s[16:19], s6 offen lds
    s_add_u32 s6, s6, 122880
    s_add_u32 m0, s34, 5120
    s_nop 0
    buffer_load_dwordx4 v8, s[16:19], s6 offen lds
    s_add_u32 m0, s34, 6144
    s_nop 0
    buffer_load_dwordx4 v9, s[16:19], s6 offen lds
    s_add_u32 m0, s34, 7168
    s_nop 0
    buffer_load_dwordx4 v10, s[16:19], s6 offen lds
    s_add_u32 m0, s34, 8192
    s_nop 0
    buffer_load_dwordx4 v11, s[16:19], s6 offen lds
    s_add_u32 m0, s34, 9216
    s_nop 0
    buffer_load_dwordx4 v12, s[16:19], s6 offen lds
    s_add_u32 s6, s6, 122880
    s_add_u32 m0, s34, 10240
    s_nop 0
    buffer_load_dwordx4 v8, s[16:19], s6 offen lds
    s_add_u32 m0, s34, 11264
    s_nop 0
    buffer_load_dwordx4 v9, s[16:19], s6 offen lds
    s_add_u32 m0, s34, 12288
    s_nop 0
    buffer_load_dwordx4 v10, s[16:19], s6 offen lds
    s_add_u32 m0, s34, 13312
    s_nop 0
    buffer_load_dwordx4 v11, s[16:19], s6 offen lds
    s_add_u32 m0, s34, 14336
    s_nop 0
    buffer_load_dwordx4 v12, s[16:19], s6 offen lds
    s_add_u32 s6, s6, 122880
    s_add_u32 m0, s34, 15360
    s_nop 0
    buffer_load_dwordx4 v8, s[16:19], s6 offen lds
    s_add_u32 m0, s34, 16384
    s_nop 0
    buffer_load_dwordx4 v9, s[16:19], s6 offen lds
    s_add_u32 m0, s34, 17408
    s_nop 0
    buffer_load_dwordx4 v10, s[16:19], s6 offen lds
    s_add_u32 m0, s34, 18432
    s_nop 0
    buffer_load_dwordx4 v11, s[16:19], s6 offen lds
    s_add_u32 m0, s34, 19456
    s_nop 0
    buffer_load_dwordx4 v12, s[16:19], s6 offen lds
    s_add_u32 s6, s6, 122880
    s_add_u32 m0, s34, 20480
    s_nop 0
    buffer_load_dwordx4 v8, s[16:19], s6 offen lds
    s_add_u32 m0, s34, 21504
    s_nop 0
    buffer_load_dwordx4 v9, s[16:19], s6 offen lds
    s_add_u32 m0, s34, 22528
    s_nop 0
    buffer_load_dwordx4 v10, s[16:19], s6 offen lds
    s_add_u32 m0, s34, 23552
    s_nop 0
    buffer_load_dwordx4 v11, s[16:19], s6 offen lds
    s_add_u32 m0, s34, 24576
    s_nop 0
    buffer_load_dwordx4 v12, s[16:19], s6 offen lds
    s_add_u32 s6, s6, 122880
    v_lshrrev_b32 v2, 5, v0
    v_lshlrev_b32 v2, 4, v2
    v_bfe_u32 v3, v0, 2, 3
    v_add_u32 v2, v2, v3
    v_mul_u32_u24 v2, 160, v2
    v_and_b32 v3, 3, v0
    v_lshl_add_u32 v13, v3, 3, v2
    v_add_u32 v14, 51200, v13
    s_waitcnt vmcnt(0)
    s_barrier
    ds_read_b64_tr_b16 v[96:97], v13 offset:0
    ds_read_b64_tr_b16 v[98:99], v13 offset:1280
    ds_read_b64_tr_b16 v[100:101], v13 offset:32
    ds_read_b64_tr_b16 v[102:103], v13 offset:1312
    ds_read_b64_tr_b16 v[104:105], v13 offset:64
    ds_read_b64_tr_b16 v[106:107], v13 offset:1344
    s_waitcnt lgkmcnt(4)
    v_mfma_f32_16x16x32_bf16 v[16:19], v[96:99], a[0:3], 0
    v_mfma_f32_16x16x32_bf16 v[36:39], v[96:99], a[80:83], 0
    ds_read_b64_tr_b16 v[108:109], v13 offset:96
    v_mfma_f32_16x16x32_bf16 v[56:59], v[96:99], a[160:163], 0
    ds_read_b64_tr_b16 v[110:111], v13 offset:1376
    v_mfma_f32_16x16x32_bf16 v[76:79], v[96:99], a[240:243], 0
    s_waitcnt lgkmcnt(4)
    v_mfma_f32_16x16x32_bf16 v[20:23], v[100:103], a[0:3], 0
    v_mfma_f32_16x16x32_bf16 v[40:43], v[100:103], a[80:83], 0
    ds_read_b64_tr_b16 v[96:97], v13 offset:128
    v_mfma_f32_16x16x32_bf16 v[60:63], v[100:103], a[160:163], 0
    ds_read_b64_tr_b16 v[98:99], v13 offset:1408
    v_mfma_f32_16x16x32_bf16 v[80:83], v[100:103], a[240:243], 0
    s_waitcnt lgkmcnt(4)
    v_mfma_f32_16x16x32_bf16 v[24:27], v[104:107], a[0:3], 0
    v_mfma_f32_16x16x32_bf16 v[44:47], v[104:107], a[80:83], 0
    ds_read_b64_tr_b16 v[100:101], v13 offset:5120
    v_mfma_f32_16x16x32_bf16 v[64:67], v[104:107], a[160:163], 0
    ds_read_b64_tr_b16 v[102:103], v13 offset:6400
    v_mfma_f32_16x16x32_bf16 v[84:87], v[104:107], a[240:243], 0
    s_waitcnt lgkmcnt(4)
    v_mfma_f32_16x16x32_bf16 v[28:31], v[108:111], a[0:3], 0
    v_mfma_f32_16x16x32_bf16 v[48:51], v[108:111], a[80:83], 0
    ds_read_b64_tr_b16 v[104:105], v13 offset:5152
    v_mfma_f32_16x16x32_bf16 v[68:71], v[108:111], a[160:163], 0
    ds_read_b64_tr_b16 v[106:107], v13 offset:6432
    v_mfma_f32_16x16x32_bf16 v[88:91], v[108:111], a[240:243], 0
    s_waitcnt lgkmcnt(4)
    v_mfma_f32_16x16x32_bf16 v[32:35], v[96:99], a[0:3], 0
    v_mfma_f32_16x16x32_bf16 v[52:55], v[96:99], a[80:83], 0
    ds_read_b64_tr_b16 v[108:109], v13 offset:5184
    v_mfma_f32_16x16x32_bf16 v[72:75], v[96:99], a[160:163], 0
    ds_read_b64_tr_b16 v[110:111], v13 offset:6464
    v_mfma_f32_16x16x32_bf16 v[92:95], v[96:99], a[240:243], 0
    s_waitcnt lgkmcnt(4)
    v_mfma_f32_16x16x32_bf16 v[16:19], v[100:103], a[4:7], v[16:19]
    v_mfma_f32_16x16x32_bf16 v[36:39], v[100:103], a[84:87], v[36:39]
    ds_read_b64_tr_b16 v[96:97], v13 offset:5216
    v_mfma_f32_16x16x32_bf16 v[56:59], v[100:103], a[164:167], v[56:59]
    ds_read_b64_tr_b16 v[98:99], v13 offset:6496
    v_mfma_f32_16x16x32_bf16 v[76:79], v[100:103], a[244:247], v[76:79]
    s_waitcnt lgkmcnt(4)
    v_mfma_f32_16x16x32_bf16 v[20:23], v[104:107], a[4:7], v[20:23]
    v_mfma_f32_16x16x32_bf16 v[40:43], v[104:107], a[84:87], v[40:43]
    ds_read_b64_tr_b16 v[100:101], v13 offset:5248
    v_mfma_f32_16x16x32_bf16 v[60:63], v[104:107], a[164:167], v[60:63]
    ds_read_b64_tr_b16 v[102:103], v13 offset:6528
    v_mfma_f32_16x16x32_bf16 v[80:83], v[104:107], a[244:247], v[80:83]
    s_waitcnt lgkmcnt(4)
    v_mfma_f32_16x16x32_bf16 v[24:27], v[108:111], a[4:7], v[24:27]
    v_mfma_f32_16x16x32_bf16 v[44:47], v[108:111], a[84:87], v[44:47]
    ds_read_b64_tr_b16 v[104:105], v13 offset:10240
    v_mfma_f32_16x16x32_bf16 v[64:67], v[108:111], a[164:167], v[64:67]
    ds_read_b64_tr_b16 v[106:107], v13 offset:11520
    v_mfma_f32_16x16x32_bf16 v[84:87], v[108:111], a[244:247], v[84:87]
    s_waitcnt lgkmcnt(4)
    v_mfma_f32_16x16x32_bf16 v[28:31], v[96:99], a[4:7], v[28:31]
    v_mfma_f32_16x16x32_bf16 v[48:51], v[96:99], a[84:87], v[48:51]
    ds_read_b64_tr_b16 v[108:109], v13 offset:10272
    v_mfma_f32_16x16x32_bf16 v[68:71], v[96:99], a[164:167], v[68:71]
    ds_read_b64_tr_b16 v[110:111], v13 offset:11552
    v_mfma_f32_16x16x32_bf16 v[88:91], v[96:99], a[244:247], v[88:91]
    s_waitcnt lgkmcnt(4)
    v_mfma_f32_16x16x32_bf16 v[32:35], v[100:103], a[4:7], v[32:35]
    v_mfma_f32_16x16x32_bf16 v[52:55], v[100:103], a[84:87], v[52:55]
    ds_read_b64_tr_b16 v[96:97], v13 offset:10304
    v_mfma_f32_16x16x32_bf16 v[72:75], v[100:103], a[164:167], v[72:75]
    ds_read_b64_tr_b16 v[98:99], v13 offset:11584
    v_mfma_f32_16x16x32_bf16 v[92:95], v[100:103], a[244:247], v[92:95]
    s_waitcnt lgkmcnt(4)
    v_mfma_f32_16x16x32_bf16 v[16:19], v[104:107], a[8:11], v[16:19]
    v_mfma_f32_16x16x32_bf16 v[36:39], v[104:107], a[88:91], v[36:39]
    ds_read_b64_tr_b16 v[100:101], v13 offset:10336
    v_mfma_f32_16x16x32_bf16 v[56:59], v[104:107], a[168:171], v[56:59]
    ds_read_b64_tr_b16 v[102:103], v13 offset:11616
    v_mfma_f32_16x16x32_bf16 v[76:79], v[104:107], a[248:251], v[76:79]
    s_waitcnt lgkmcnt(4)
    v_mfma_f32_16x16x32_bf16 v[20:23], v[108:111], a[8:11], v[20:23]
    v_mfma_f32_16x16x32_bf16 v[40:43], v[108:111], a[88:91], v[40:43]
    ds_read_b64_tr_b16 v[104:105], v13 offset:10368
    v_mfma_f32_16x16x32_bf16 v[60:63], v[108:111], a[168:171], v[60:63]
    ds_read_b64_tr_b16 v[106:107], v13 offset:11648
    v_mfma_f32_16x16x32_bf16 v[80:83], v[108:111], a[248:251], v[80:83]
    s_waitcnt lgkmcnt(4)
    v_mfma_f32_16x16x32_bf16 v[24:27], v[96:99], a[8:11], v[24:27]
    v_mfma_f32_16x16x32_bf16 v[44:47], v[96:99], a[88:91], v[44:47]
    ds_read_b64_tr_b16 v[108:109], v13 offset:15360
    v_mfma_f32_16x16x32_bf16 v[64:67], v[96:99], a[168:171], v[64:67]
    ds_read_b64_tr_b16 v[110:111], v13 offset:16640
    v_mfma_f32_16x16x32_bf16 v[84:87], v[96:99], a[248:251], v[84:87]
    s_waitcnt lgkmcnt(4)
    v_mfma_f32_16x16x32_bf16 v[28:31], v[100:103], a[8:11], v[28:31]
    v_mfma_f32_16x16x32_bf16 v[48:51], v[100:103], a[88:91], v[48:51]
    ds_read_b64_tr_b16 v[96:97], v13 offset:15392
    v_mfma_f32_16x16x32_bf16 v[68:71], v[100:103], a[168:171], v[68:71]
    ds_read_b64_tr_b16 v[98:99], v13 offset:16672
    v_mfma_f32_16x16x32_bf16 v[88:91], v[100:103], a[248:251], v[88:91]
    s_waitcnt lgkmcnt(4)
    v_mfma_f32_16x16x32_bf16 v[32:35], v[104:107], a[8:11], v[32:35]
    v_mfma_f32_16x16x32_bf16 v[52:55], v[104:107], a[88:91], v[52:55]
    ds_read_b64_tr_b16 v[100:101], v13 offset:15424
    v_mfma_f32_16x16x32_bf16 v[72:75], v[104:107], a[168:171], v[72:75]
    ds_read_b64_tr_b16 v[102:103], v13 offset:16704
    v_mfma_f32_16x16x32_bf16 v[92:95], v[104:107], a[248:251], v[92:95]
    s_waitcnt lgkmcnt(4)
    v_mfma_f32_16x16x32_bf16 v[16:19], v[108:111], a[12:15], v[16:19]
    v_mfma_f32_16x16x32_bf16 v[36:39], v[108:111], a[92:95], v[36:39]
    ds_read_b64_tr_b16 v[104:105], v13 offset:15456
    v_mfma_f32_16x16x32_bf16 v[56:59], v[108:111], a[172:175], v[56:59]
    ds_read_b64_tr_b16 v[106:107], v13 offset:16736
    v_mfma_f32_16x16x32_bf16 v[76:79], v[108:111], a[252:255], v[76:79]
    s_waitcnt lgkmcnt(4)
    v_mfma_f32_16x16x32_bf16 v[20:23], v[96:99], a[12:15], v[20:23]
    v_mfma_f32_16x16x32_bf16 v[40:43], v[96:99], a[92:95], v[40:43]
    ds_read_b64_tr_b16 v[108:109], v13 offset:15488
    v_mfma_f32_16x16x32_bf16 v[60:63], v[96:99], a[172:175], v[60:63]
    ds_read_b64_tr_b16 v[110:111], v13 offset:16768
    v_mfma_f32_16x16x32_bf16 v[80:83], v[96:99], a[252:255], v[80:83]
    s_waitcnt lgkmcnt(4)
    v_mfma_f32_16x16x32_bf16 v[24:27], v[100:103], a[12:15], v[24:27]
    v_mfma_f32_16x16x32_bf16 v[44:47], v[100:103], a[92:95], v[44:47]
    ds_read_b64_tr_b16 v[96:97], v13 offset:20480
    v_mfma_f32_16x16x32_bf16 v[64:67], v[100:103], a[172:175], v[64:67]
    ds_read_b64_tr_b16 v[98:99], v13 offset:21760
    v_mfma_f32_16x16x32_bf16 v[84:87], v[100:103], a[252:255], v[84:87]
    s_waitcnt lgkmcnt(4)
    v_mfma_f32_16x16x32_bf16 v[28:31], v[104:107], a[12:15], v[28:31]
    v_mfma_f32_16x16x32_bf16 v[48:51], v[104:107], a[92:95], v[48:51]
    ds_read_b64_tr_b16 v[100:101], v13 offset:20512
    v_mfma_f32_16x16x32_bf16 v[68:71], v[104:107], a[172:175], v[68:71]
    ds_read_b64_tr_b16 v[102:103], v13 offset:21792
    v_mfma_f32_16x16x32_bf16 v[88:91], v[104:107], a[252:255], v[88:91]
    s_waitcnt lgkmcnt(4)
    v_mfma_f32_16x16x32_bf16 v[32:35], v[108:111], a[12:15], v[32:35]
    v_mfma_f32_16x16x32_bf16 v[52:55], v[108:111], a[92:95], v[52:55]
    ds_read_b64_tr_b16 v[104:105], v13 offset:20544
    v_mfma_f32_16x16x32_bf16 v[72:75], v[108:111], a[172:175], v[72:75]
    ds_read_b64_tr_b16 v[106:107], v13 offset:21824
    v_mfma_f32_16x16x32_bf16 v[92:95], v[108:111], a[252:255], v[92:95]
    s_waitcnt lgkmcnt(4)
    v_mfma_f32_16x16x32_bf16 v[16:19], v[96:99], a[16:19], v[16:19]
    v_mfma_f32_16x16x32_bf16 v[36:39], v[96:99], a[96:99], v[36:39]
    ds_read_b64_tr_b16 v[108:109], v13 offset:20576
    v_mfma_f32_16x16x32_bf16 v[56:59], v[96:99], a[176:179], v[56:59]
    ds_read_b64_tr_b16 v[110:111], v13 offset:21856
    v_mfma_f32_16x16x32_bf16 v[76:79], v[96:99], v[192:195], v[76:79]
    s_waitcnt lgkmcnt(4)
    v_mfma_f32_16x16x32_bf16 v[20:23], v[100:103], a[16:19], v[20:23]
    v_mfma_f32_16x16x32_bf16 v[40:43], v[100:103], a[96:99], v[40:43]
    ds_read_b64_tr_b16 v[96:97], v13 offset:20608
    v_mfma_f32_16x16x32_bf16 v[60:63], v[100:103], a[176:179], v[60:63]
    ds_read_b64_tr_b16 v[98:99], v13 offset:21888
    v_mfma_f32_16x16x32_bf16 v[80:83], v[100:103], v[192:195], v[80:83]
    s_waitcnt lgkmcnt(4)
    v_mfma_f32_16x16x32_bf16 v[24:27], v[104:107], a[16:19], v[24:27]
    v_mfma_f32_16x16x32_bf16 v[44:47], v[104:107], a[96:99], v[44:47]
    ds_read_b64_tr_b16 v[100:101], v13 offset:25600
    v_mfma_f32_16x16x32_bf16 v[64:67], v[104:107], a[176:179], v[64:67]
    ds_read_b64_tr_b16 v[102:103], v13 offset:26880
    v_mfma_f32_16x16x32_bf16 v[84:87], v[104:107], v[192:195], v[84:87]
    s_waitcnt lgkmcnt(4)
    v_mfma_f32_16x16x32_bf16 v[28:31], v[108:111], a[16:19], v[28:31]
    v_mfma_f32_16x16x32_bf16 v[48:51], v[108:111], a[96:99], v[48:51]
    ds_read_b64_tr_b16 v[104:105], v13 offset:25632
    v_mfma_f32_16x16x32_bf16 v[68:71], v[108:111], a[176:179], v[68:71]
    ds_read_b64_tr_b16 v[106:107], v13 offset:26912
    v_mfma_f32_16x16x32_bf16 v[88:91], v[108:111], v[192:195], v[88:91]
    s_waitcnt lgkmcnt(4)
    v_mfma_f32_16x16x32_bf16 v[32:35], v[96:99], a[16:19], v[32:35]
    v_mfma_f32_16x16x32_bf16 v[52:55], v[96:99], a[96:99], v[52:55]
    ds_read_b64_tr_b16 v[108:109], v13 offset:25664
    v_mfma_f32_16x16x32_bf16 v[72:75], v[96:99], a[176:179], v[72:75]
    ds_read_b64_tr_b16 v[110:111], v13 offset:26944
    v_mfma_f32_16x16x32_bf16 v[92:95], v[96:99], v[192:195], v[92:95]
    s_waitcnt lgkmcnt(4)
    v_mfma_f32_16x16x32_bf16 v[16:19], v[100:103], a[20:23], v[16:19]
    v_mfma_f32_16x16x32_bf16 v[36:39], v[100:103], a[100:103], v[36:39]
    ds_read_b64_tr_b16 v[96:97], v13 offset:25696
    v_mfma_f32_16x16x32_bf16 v[56:59], v[100:103], a[180:183], v[56:59]
    ds_read_b64_tr_b16 v[98:99], v13 offset:26976
    v_mfma_f32_16x16x32_bf16 v[76:79], v[100:103], v[196:199], v[76:79]
    s_waitcnt lgkmcnt(4)
    v_mfma_f32_16x16x32_bf16 v[20:23], v[104:107], a[20:23], v[20:23]
    v_mfma_f32_16x16x32_bf16 v[40:43], v[104:107], a[100:103], v[40:43]
    ds_read_b64_tr_b16 v[100:101], v13 offset:25728
    v_mfma_f32_16x16x32_bf16 v[60:63], v[104:107], a[180:183], v[60:63]
    ds_read_b64_tr_b16 v[102:103], v13 offset:27008
    v_mfma_f32_16x16x32_bf16 v[80:83], v[104:107], v[196:199], v[80:83]
    s_waitcnt lgkmcnt(4)
    v_mfma_f32_16x16x32_bf16 v[24:27], v[108:111], a[20:23], v[24:27]
    v_mfma_f32_16x16x32_bf16 v[44:47], v[108:111], a[100:103], v[44:47]
    ds_read_b64_tr_b16 v[104:105], v13 offset:30720
    v_mfma_f32_16x16x32_bf16 v[64:67], v[108:111], a[180:183], v[64:67]
    ds_read_b64_tr_b16 v[106:107], v13 offset:32000
    v_mfma_f32_16x16x32_bf16 v[84:87], v[108:111], v[196:199], v[84:87]
    s_waitcnt lgkmcnt(4)
    v_mfma_f32_16x16x32_bf16 v[28:31], v[96:99], a[20:23], v[28:31]
    v_mfma_f32_16x16x32_bf16 v[48:51], v[96:99], a[100:103], v[48:51]
    ds_read_b64_tr_b16 v[108:109], v13 offset:30752
    v_mfma_f32_16x16x32_bf16 v[68:71], v[96:99], a[180:183], v[68:71]
    ds_read_b64_tr_b16 v[110:111], v13 offset:32032
    v_mfma_f32_16x16x32_bf16 v[88:91], v[96:99], v[196:199], v[88:91]
    s_waitcnt lgkmcnt(4)
    v_mfma_f32_16x16x32_bf16 v[32:35], v[100:103], a[20:23], v[32:35]
    v_mfma_f32_16x16x32_bf16 v[52:55], v[100:103], a[100:103], v[52:55]
    ds_read_b64_tr_b16 v[96:97], v13 offset:30784
    v_mfma_f32_16x16x32_bf16 v[72:75], v[100:103], a[180:183], v[72:75]
    ds_read_b64_tr_b16 v[98:99], v13 offset:32064
    v_mfma_f32_16x16x32_bf16 v[92:95], v[100:103], v[196:199], v[92:95]
    s_waitcnt lgkmcnt(4)
    v_mfma_f32_16x16x32_bf16 v[16:19], v[104:107], a[24:27], v[16:19]
    v_mfma_f32_16x16x32_bf16 v[36:39], v[104:107], a[104:107], v[36:39]
    ds_read_b64_tr_b16 v[100:101], v13 offset:30816
    v_mfma_f32_16x16x32_bf16 v[56:59], v[104:107], a[184:187], v[56:59]
    ds_read_b64_tr_b16 v[102:103], v13 offset:32096
    v_mfma_f32_16x16x32_bf16 v[76:79], v[104:107], v[200:203], v[76:79]
    s_waitcnt lgkmcnt(4)
    v_mfma_f32_16x16x32_bf16 v[20:23], v[108:111], a[24:27], v[20:23]
    v_mfma_f32_16x16x32_bf16 v[40:43], v[108:111], a[104:107], v[40:43]
    ds_read_b64_tr_b16 v[104:105], v13 offset:30848
    v_mfma_f32_16x16x32_bf16 v[60:63], v[108:111], a[184:187], v[60:63]
    ds_read_b64_tr_b16 v[106:107], v13 offset:32128
    v_mfma_f32_16x16x32_bf16 v[80:83], v[108:111], v[200:203], v[80:83]
    s_waitcnt lgkmcnt(4)
    v_mfma_f32_16x16x32_bf16 v[24:27], v[96:99], a[24:27], v[24:27]
    v_mfma_f32_16x16x32_bf16 v[44:47], v[96:99], a[104:107], v[44:47]
    ds_read_b64_tr_b16 v[108:109], v13 offset:35840
    v_mfma_f32_16x16x32_bf16 v[64:67], v[96:99], a[184:187], v[64:67]
    ds_read_b64_tr_b16 v[110:111], v13 offset:37120
    v_mfma_f32_16x16x32_bf16 v[84:87], v[96:99], v[200:203], v[84:87]
    s_waitcnt lgkmcnt(4)
    v_mfma_f32_16x16x32_bf16 v[28:31], v[100:103], a[24:27], v[28:31]
    v_mfma_f32_16x16x32_bf16 v[48:51], v[100:103], a[104:107], v[48:51]
    ds_read_b64_tr_b16 v[96:97], v13 offset:35872
    v_mfma_f32_16x16x32_bf16 v[68:71], v[100:103], a[184:187], v[68:71]
    ds_read_b64_tr_b16 v[98:99], v13 offset:37152
    v_mfma_f32_16x16x32_bf16 v[88:91], v[100:103], v[200:203], v[88:91]
    s_waitcnt lgkmcnt(4)
    v_mfma_f32_16x16x32_bf16 v[32:35], v[104:107], a[24:27], v[32:35]
    v_mfma_f32_16x16x32_bf16 v[52:55], v[104:107], a[104:107], v[52:55]
    ds_read_b64_tr_b16 v[100:101], v13 offset:35904
    v_mfma_f32_16x16x32_bf16 v[72:75], v[104:107], a[184:187], v[72:75]
    ds_read_b64_tr_b16 v[102:103], v13 offset:37184
    v_mfma_f32_16x16x32_bf16 v[92:95], v[104:107], v[200:203], v[92:95]
    s_waitcnt lgkmcnt(4)
    v_mfma_f32_16x16x32_bf16 v[16:19], v[108:111], a[28:31], v[16:19]
    v_mfma_f32_16x16x32_bf16 v[36:39], v[108:111], a[108:111], v[36:39]
    ds_read_b64_tr_b16 v[104:105], v13 offset:35936
    v_mfma_f32_16x16x32_bf16 v[56:59], v[108:111], a[188:191], v[56:59]
    ds_read_b64_tr_b16 v[106:107], v13 offset:37216
    v_mfma_f32_16x16x32_bf16 v[76:79], v[108:111], v[204:207], v[76:79]
    s_waitcnt lgkmcnt(4)
    v_mfma_f32_16x16x32_bf16 v[20:23], v[96:99], a[28:31], v[20:23]
    v_mfma_f32_16x16x32_bf16 v[40:43], v[96:99], a[108:111], v[40:43]
    ds_read_b64_tr_b16 v[108:109], v13 offset:35968
    v_mfma_f32_16x16x32_bf16 v[60:63], v[96:99], a[188:191], v[60:63]
    ds_read_b64_tr_b16 v[110:111], v13 offset:37248
    v_mfma_f32_16x16x32_bf16 v[80:83], v[96:99], v[204:207], v[80:83]
    s_waitcnt lgkmcnt(4)
    v_mfma_f32_16x16x32_bf16 v[24:27], v[100:103], a[28:31], v[24:27]
    v_mfma_f32_16x16x32_bf16 v[44:47], v[100:103], a[108:111], v[44:47]
    ds_read_b64_tr_b16 v[96:97], v13 offset:40960
    v_mfma_f32_16x16x32_bf16 v[64:67], v[100:103], a[188:191], v[64:67]
    ds_read_b64_tr_b16 v[98:99], v13 offset:42240
    v_mfma_f32_16x16x32_bf16 v[84:87], v[100:103], v[204:207], v[84:87]
    s_waitcnt lgkmcnt(4)
    v_mfma_f32_16x16x32_bf16 v[28:31], v[104:107], a[28:31], v[28:31]
    v_mfma_f32_16x16x32_bf16 v[48:51], v[104:107], a[108:111], v[48:51]
    ds_read_b64_tr_b16 v[100:101], v13 offset:40992
    v_mfma_f32_16x16x32_bf16 v[68:71], v[104:107], a[188:191], v[68:71]
    ds_read_b64_tr_b16 v[102:103], v13 offset:42272
    v_mfma_f32_16x16x32_bf16 v[88:91], v[104:107], v[204:207], v[88:91]
    s_waitcnt lgkmcnt(4)
    v_mfma_f32_16x16x32_bf16 v[32:35], v[108:111], a[28:31], v[32:35]
    v_mfma_f32_16x16x32_bf16 v[52:55], v[108:111], a[108:111], v[52:55]
    ds_read_b64_tr_b16 v[104:105], v13 offset:41024
    v_mfma_f32_16x16x32_bf16 v[72:75], v[108:111], a[188:191], v[72:75]
    ds_read_b64_tr_b16 v[106:107], v13 offset:42304
    v_mfma_f32_16x16x32_bf16 v[92:95], v[108:111], v[204:207], v[92:95]
    s_waitcnt lgkmcnt(4)
    v_mfma_f32_16x16x32_bf16 v[16:19], v[96:99], a[32:35], v[16:19]
    v_mfma_f32_16x16x32_bf16 v[36:39], v[96:99], a[112:115], v[36:39]
    ds_read_b64_tr_b16 v[108:109], v13 offset:41056
    v_mfma_f32_16x16x32_bf16 v[56:59], v[96:99], a[192:195], v[56:59]
    ds_read_b64_tr_b16 v[110:111], v13 offset:42336
    v_mfma_f32_16x16x32_bf16 v[76:79], v[96:99], v[208:211], v[76:79]
    s_waitcnt lgkmcnt(4)
    v_mfma_f32_16x16x32_bf16 v[20:23], v[100:103], a[32:35], v[20:23]
    v_mfma_f32_16x16x32_bf16 v[40:43], v[100:103], a[112:115], v[40:43]
    ds_read_b64_tr_b16 v[96:97], v13 offset:41088
    v_mfma_f32_16x16x32_bf16 v[60:63], v[100:103], a[192:195], v[60:63]
    ds_read_b64_tr_b16 v[98:99], v13 offset:42368
    v_mfma_f32_16x16x32_bf16 v[80:83], v[100:103], v[208:211], v[80:83]
    s_waitcnt lgkmcnt(4)
    v_mfma_f32_16x16x32_bf16 v[24:27], v[104:107], a[32:35], v[24:27]
    v_mfma_f32_16x16x32_bf16 v[44:47], v[104:107], a[112:115], v[44:47]
    ds_read_b64_tr_b16 v[100:101], v13 offset:46080
    v_mfma_f32_16x16x32_bf16 v[64:67], v[104:107], a[192:195], v[64:67]
    ds_read_b64_tr_b16 v[102:103], v13 offset:47360
    v_mfma_f32_16x16x32_bf16 v[84:87], v[104:107], v[208:211], v[84:87]
    s_waitcnt lgkmcnt(4)
    v_mfma_f32_16x16x32_bf16 v[28:31], v[108:111], a[32:35], v[28:31]
    v_mfma_f32_16x16x32_bf16 v[48:51], v[108:111], a[112:115], v[48:51]
    ds_read_b64_tr_b16 v[104:105], v13 offset:46112
    v_mfma_f32_16x16x32_bf16 v[68:71], v[108:111], a[192:195], v[68:71]
    ds_read_b64_tr_b16 v[106:107], v13 offset:47392
    v_mfma_f32_16x16x32_bf16 v[88:91], v[108:111], v[208:211], v[88:91]
    s_waitcnt lgkmcnt(4)
    v_mfma_f32_16x16x32_bf16 v[32:35], v[96:99], a[32:35], v[32:35]
    v_mfma_f32_16x16x32_bf16 v[52:55], v[96:99], a[112:115], v[52:55]
    ds_read_b64_tr_b16 v[108:109], v13 offset:46144
    v_mfma_f32_16x16x32_bf16 v[72:75], v[96:99], a[192:195], v[72:75]
    ds_read_b64_tr_b16 v[110:111], v13 offset:47424
    v_mfma_f32_16x16x32_bf16 v[92:95], v[96:99], v[208:211], v[92:95]
    s_waitcnt lgkmcnt(4)
    v_mfma_f32_16x16x32_bf16 v[16:19], v[100:103], a[36:39], v[16:19]
    v_mfma_f32_16x16x32_bf16 v[36:39], v[100:103], a[116:119], v[36:39]
    ds_read_b64_tr_b16 v[96:97], v13 offset:46176
    v_mfma_f32_16x16x32_bf16 v[56:59], v[100:103], a[196:199], v[56:59]
    ds_read_b64_tr_b16 v[98:99], v13 offset:47456
    v_mfma_f32_16x16x32_bf16 v[76:79], v[100:103], v[212:215], v[76:79]
    s_waitcnt lgkmcnt(4)
    v_mfma_f32_16x16x32_bf16 v[20:23], v[104:107], a[36:39], v[20:23]
    v_mfma_f32_16x16x32_bf16 v[40:43], v[104:107], a[116:119], v[40:43]
    ds_read_b64_tr_b16 v[100:101], v13 offset:46208
    v_mfma_f32_16x16x32_bf16 v[60:63], v[104:107], a[196:199], v[60:63]
    ds_read_b64_tr_b16 v[102:103], v13 offset:47488
    v_mfma_f32_16x16x32_bf16 v[80:83], v[104:107], v[212:215], v[80:83]
    s_waitcnt lgkmcnt(4)
    v_mfma_f32_16x16x32_bf16 v[24:27], v[108:111], a[36:39], v[24:27]
    v_mfma_f32_16x16x32_bf16 v[44:47], v[108:111], a[116:119], v[44:47]
    ds_read_b64_tr_b16 v[104:105], v14 offset:0
    v_mfma_f32_16x16x32_bf16 v[64:67], v[108:111], a[196:199], v[64:67]
    ds_read_b64_tr_b16 v[106:107], v14 offset:1280
    v_mfma_f32_16x16x32_bf16 v[84:87], v[108:111], v[212:215], v[84:87]
    s_waitcnt lgkmcnt(4)
    v_mfma_f32_16x16x32_bf16 v[28:31], v[96:99], a[36:39], v[28:31]
    v_mfma_f32_16x16x32_bf16 v[48:51], v[96:99], a[116:119], v[48:51]
    ds_read_b64_tr_b16 v[108:109], v14 offset:32
    v_mfma_f32_16x16x32_bf16 v[68:71], v[96:99], a[196:199], v[68:71]
    ds_read_b64_tr_b16 v[110:111], v14 offset:1312
    v_mfma_f32_16x16x32_bf16 v[88:91], v[96:99], v[212:215], v[88:91]
    s_waitcnt lgkmcnt(4)
    v_mfma_f32_16x16x32_bf16 v[32:35], v[100:103], a[36:39], v[32:35]
    v_mfma_f32_16x16x32_bf16 v[52:55], v[100:103], a[116:119], v[52:55]
    ds_read_b64_tr_b16 v[96:97], v14 offset:64
    v_mfma_f32_16x16x32_bf16 v[72:75], v[100:103], a[196:199], v[72:75]
    ds_read_b64_tr_b16 v[98:99], v14 offset:1344
    v_mfma_f32_16x16x32_bf16 v[92:95], v[100:103], v[212:215], v[92:95]
    s_waitcnt lgkmcnt(4)
    v_mfma_f32_16x16x32_bf16 v[16:19], v[104:107], a[40:43], v[16:19]
    v_mfma_f32_16x16x32_bf16 v[36:39], v[104:107], a[120:123], v[36:39]
    ds_read_b64_tr_b16 v[100:101], v14 offset:96
    v_mfma_f32_16x16x32_bf16 v[56:59], v[104:107], a[200:203], v[56:59]
    ds_read_b64_tr_b16 v[102:103], v14 offset:1376
    v_mfma_f32_16x16x32_bf16 v[76:79], v[104:107], v[216:219], v[76:79]
    s_waitcnt lgkmcnt(4)
    v_mfma_f32_16x16x32_bf16 v[20:23], v[108:111], a[40:43], v[20:23]
    v_mfma_f32_16x16x32_bf16 v[40:43], v[108:111], a[120:123], v[40:43]
    ds_read_b64_tr_b16 v[104:105], v14 offset:128
    v_mfma_f32_16x16x32_bf16 v[60:63], v[108:111], a[200:203], v[60:63]
    ds_read_b64_tr_b16 v[106:107], v14 offset:1408
    v_mfma_f32_16x16x32_bf16 v[80:83], v[108:111], v[216:219], v[80:83]
    s_waitcnt lgkmcnt(4)
    v_mfma_f32_16x16x32_bf16 v[24:27], v[96:99], a[40:43], v[24:27]
    v_mfma_f32_16x16x32_bf16 v[44:47], v[96:99], a[120:123], v[44:47]
    ds_read_b64_tr_b16 v[108:109], v14 offset:5120
    v_mfma_f32_16x16x32_bf16 v[64:67], v[96:99], a[200:203], v[64:67]
    ds_read_b64_tr_b16 v[110:111], v14 offset:6400
    v_mfma_f32_16x16x32_bf16 v[84:87], v[96:99], v[216:219], v[84:87]
    s_waitcnt lgkmcnt(4)
    v_mfma_f32_16x16x32_bf16 v[28:31], v[100:103], a[40:43], v[28:31]
    v_mfma_f32_16x16x32_bf16 v[48:51], v[100:103], a[120:123], v[48:51]
    ds_read_b64_tr_b16 v[96:97], v14 offset:5152
    v_mfma_f32_16x16x32_bf16 v[68:71], v[100:103], a[200:203], v[68:71]
    ds_read_b64_tr_b16 v[98:99], v14 offset:6432
    v_mfma_f32_16x16x32_bf16 v[88:91], v[100:103], v[216:219], v[88:91]
    s_waitcnt lgkmcnt(4)
    v_mfma_f32_16x16x32_bf16 v[32:35], v[104:107], a[40:43], v[32:35]
    v_mfma_f32_16x16x32_bf16 v[52:55], v[104:107], a[120:123], v[52:55]
    ds_read_b64_tr_b16 v[100:101], v14 offset:5184
    v_mfma_f32_16x16x32_bf16 v[72:75], v[104:107], a[200:203], v[72:75]
    ds_read_b64_tr_b16 v[102:103], v14 offset:6464
    v_mfma_f32_16x16x32_bf16 v[92:95], v[104:107], v[216:219], v[92:95]
    s_waitcnt lgkmcnt(4)
    v_mfma_f32_16x16x32_bf16 v[16:19], v[108:111], a[44:47], v[16:19]
    v_mfma_f32_16x16x32_bf16 v[36:39], v[108:111], a[124:127], v[36:39]
    ds_read_b64_tr_b16 v[104:105], v14 offset:5216
    v_mfma_f32_16x16x32_bf16 v[56:59], v[108:111], a[204:207], v[56:59]
    ds_read_b64_tr_b16 v[106:107], v14 offset:6496
    v_mfma_f32_16x16x32_bf16 v[76:79], v[108:111], v[220:223], v[76:79]
    s_waitcnt lgkmcnt(4)
    v_mfma_f32_16x16x32_bf16 v[20:23], v[96:99], a[44:47], v[20:23]
    v_mfma_f32_16x16x32_bf16 v[40:43], v[96:99], a[124:127], v[40:43]
    ds_read_b64_tr_b16 v[108:109], v14 offset:5248
    v_mfma_f32_16x16x32_bf16 v[60:63], v[96:99], a[204:207], v[60:63]
    ds_read_b64_tr_b16 v[110:111], v14 offset:6528
    v_mfma_f32_16x16x32_bf16 v[80:83], v[96:99], v[220:223], v[80:83]
    s_waitcnt lgkmcnt(4)
    v_mfma_f32_16x16x32_bf16 v[24:27], v[100:103], a[44:47], v[24:27]
    v_mfma_f32_16x16x32_bf16 v[44:47], v[100:103], a[124:127], v[44:47]
    ds_read_b64_tr_b16 v[96:97], v14 offset:10240
    v_mfma_f32_16x16x32_bf16 v[64:67], v[100:103], a[204:207], v[64:67]
    ds_read_b64_tr_b16 v[98:99], v14 offset:11520
    v_mfma_f32_16x16x32_bf16 v[84:87], v[100:103], v[220:223], v[84:87]
    s_waitcnt lgkmcnt(4)
    v_mfma_f32_16x16x32_bf16 v[28:31], v[104:107], a[44:47], v[28:31]
    v_mfma_f32_16x16x32_bf16 v[48:51], v[104:107], a[124:127], v[48:51]
    ds_read_b64_tr_b16 v[100:101], v14 offset:10272
    v_mfma_f32_16x16x32_bf16 v[68:71], v[104:107], a[204:207], v[68:71]
    ds_read_b64_tr_b16 v[102:103], v14 offset:11552
    v_mfma_f32_16x16x32_bf16 v[88:91], v[104:107], v[220:223], v[88:91]
    s_waitcnt lgkmcnt(4)
    v_mfma_f32_16x16x32_bf16 v[32:35], v[108:111], a[44:47], v[32:35]
    v_mfma_f32_16x16x32_bf16 v[52:55], v[108:111], a[124:127], v[52:55]
    ds_read_b64_tr_b16 v[104:105], v14 offset:10304
    v_mfma_f32_16x16x32_bf16 v[72:75], v[108:111], a[204:207], v[72:75]
    ds_read_b64_tr_b16 v[106:107], v14 offset:11584
    v_mfma_f32_16x16x32_bf16 v[92:95], v[108:111], v[220:223], v[92:95]
    s_waitcnt lgkmcnt(4)
    v_mfma_f32_16x16x32_bf16 v[16:19], v[96:99], a[48:51], v[16:19]
    v_mfma_f32_16x16x32_bf16 v[36:39], v[96:99], a[128:131], v[36:39]
    ds_read_b64_tr_b16 v[108:109], v14 offset:10336
    v_mfma_f32_16x16x32_bf16 v[56:59], v[96:99], a[208:211], v[56:59]
    ds_read_b64_tr_b16 v[110:111], v14 offset:11616
    v_mfma_f32_16x16x32_bf16 v[76:79], v[96:99], v[224:227], v[76:79]
    s_waitcnt lgkmcnt(4)
    v_mfma_f32_16x16x32_bf16 v[20:23], v[100:103], a[48:51], v[20:23]
    v_mfma_f32_16x16x32_bf16 v[40:43], v[100:103], a[128:131], v[40:43]
    ds_read_b64_tr_b16 v[96:97], v14 offset:10368
    v_mfma_f32_16x16x32_bf16 v[60:63], v[100:103], a[208:211], v[60:63]
    ds_read_b64_tr_b16 v[98:99], v14 offset:11648
    v_mfma_f32_16x16x32_bf16 v[80:83], v[100:103], v[224:227], v[80:83]
    s_waitcnt lgkmcnt(4)
    v_mfma_f32_16x16x32_bf16 v[24:27], v[104:107], a[48:51], v[24:27]
    v_mfma_f32_16x16x32_bf16 v[44:47], v[104:107], a[128:131], v[44:47]
    ds_read_b64_tr_b16 v[100:101], v14 offset:15360
    v_mfma_f32_16x16x32_bf16 v[64:67], v[104:107], a[208:211], v[64:67]
    ds_read_b64_tr_b16 v[102:103], v14 offset:16640
    v_mfma_f32_16x16x32_bf16 v[84:87], v[104:107], v[224:227], v[84:87]
    s_waitcnt lgkmcnt(4)
    v_mfma_f32_16x16x32_bf16 v[28:31], v[108:111], a[48:51], v[28:31]
    v_mfma_f32_16x16x32_bf16 v[48:51], v[108:111], a[128:131], v[48:51]
    ds_read_b64_tr_b16 v[104:105], v14 offset:15392
    v_mfma_f32_16x16x32_bf16 v[68:71], v[108:111], a[208:211], v[68:71]
    ds_read_b64_tr_b16 v[106:107], v14 offset:16672
    v_mfma_f32_16x16x32_bf16 v[88:91], v[108:111], v[224:227], v[88:91]
    s_waitcnt lgkmcnt(4)
    v_mfma_f32_16x16x32_bf16 v[32:35], v[96:99], a[48:51], v[32:35]
    v_mfma_f32_16x16x32_bf16 v[52:55], v[96:99], a[128:131], v[52:55]
    ds_read_b64_tr_b16 v[108:109], v14 offset:15424
    v_mfma_f32_16x16x32_bf16 v[72:75], v[96:99], a[208:211], v[72:75]
    ds_read_b64_tr_b16 v[110:111], v14 offset:16704
    v_mfma_f32_16x16x32_bf16 v[92:95], v[96:99], v[224:227], v[92:95]
    s_waitcnt lgkmcnt(4)
    v_mfma_f32_16x16x32_bf16 v[16:19], v[100:103], a[52:55], v[16:19]
    v_mfma_f32_16x16x32_bf16 v[36:39], v[100:103], a[132:135], v[36:39]
    ds_read_b64_tr_b16 v[96:97], v14 offset:15456
    v_mfma_f32_16x16x32_bf16 v[56:59], v[100:103], a[212:215], v[56:59]
    ds_read_b64_tr_b16 v[98:99], v14 offset:16736
    v_mfma_f32_16x16x32_bf16 v[76:79], v[100:103], v[228:231], v[76:79]
    s_waitcnt lgkmcnt(4)
    v_mfma_f32_16x16x32_bf16 v[20:23], v[104:107], a[52:55], v[20:23]
    v_mfma_f32_16x16x32_bf16 v[40:43], v[104:107], a[132:135], v[40:43]
    ds_read_b64_tr_b16 v[100:101], v14 offset:15488
    v_mfma_f32_16x16x32_bf16 v[60:63], v[104:107], a[212:215], v[60:63]
    ds_read_b64_tr_b16 v[102:103], v14 offset:16768
    v_mfma_f32_16x16x32_bf16 v[80:83], v[104:107], v[228:231], v[80:83]
    s_waitcnt lgkmcnt(4)
    v_mfma_f32_16x16x32_bf16 v[24:27], v[108:111], a[52:55], v[24:27]
    v_mfma_f32_16x16x32_bf16 v[44:47], v[108:111], a[132:135], v[44:47]
    ds_read_b64_tr_b16 v[104:105], v14 offset:20480
    v_mfma_f32_16x16x32_bf16 v[64:67], v[108:111], a[212:215], v[64:67]
    ds_read_b64_tr_b16 v[106:107], v14 offset:21760
    v_mfma_f32_16x16x32_bf16 v[84:87], v[108:111], v[228:231], v[84:87]
    s_waitcnt lgkmcnt(4)
    v_mfma_f32_16x16x32_bf16 v[28:31], v[96:99], a[52:55], v[28:31]
    v_mfma_f32_16x16x32_bf16 v[48:51], v[96:99], a[132:135], v[48:51]
    ds_read_b64_tr_b16 v[108:109], v14 offset:20512
    v_mfma_f32_16x16x32_bf16 v[68:71], v[96:99], a[212:215], v[68:71]
    ds_read_b64_tr_b16 v[110:111], v14 offset:21792
    v_mfma_f32_16x16x32_bf16 v[88:91], v[96:99], v[228:231], v[88:91]
    s_waitcnt lgkmcnt(4)
    v_mfma_f32_16x16x32_bf16 v[32:35], v[100:103], a[52:55], v[32:35]
    v_mfma_f32_16x16x32_bf16 v[52:55], v[100:103], a[132:135], v[52:55]
    ds_read_b64_tr_b16 v[96:97], v14 offset:20544
    v_mfma_f32_16x16x32_bf16 v[72:75], v[100:103], a[212:215], v[72:75]
    ds_read_b64_tr_b16 v[98:99], v14 offset:21824
    v_mfma_f32_16x16x32_bf16 v[92:95], v[100:103], v[228:231], v[92:95]
    s_waitcnt lgkmcnt(4)
    v_mfma_f32_16x16x32_bf16 v[16:19], v[104:107], a[56:59], v[16:19]
    v_mfma_f32_16x16x32_bf16 v[36:39], v[104:107], a[136:139], v[36:39]
    ds_read_b64_tr_b16 v[100:101], v14 offset:20576
    v_mfma_f32_16x16x32_bf16 v[56:59], v[104:107], a[216:219], v[56:59]
    ds_read_b64_tr_b16 v[102:103], v14 offset:21856
    v_mfma_f32_16x16x32_bf16 v[76:79], v[104:107], v[232:235], v[76:79]
    s_waitcnt lgkmcnt(4)
    v_mfma_f32_16x16x32_bf16 v[20:23], v[108:111], a[56:59], v[20:23]
    v_mfma_f32_16x16x32_bf16 v[40:43], v[108:111], a[136:139], v[40:43]
    ds_read_b64_tr_b16 v[104:105], v14 offset:20608
    v_mfma_f32_16x16x32_bf16 v[60:63], v[108:111], a[216:219], v[60:63]
    ds_read_b64_tr_b16 v[106:107], v14 offset:21888
    v_mfma_f32_16x16x32_bf16 v[80:83], v[108:111], v[232:235], v[80:83]
    s_waitcnt lgkmcnt(4)
    v_mfma_f32_16x16x32_bf16 v[24:27], v[96:99], a[56:59], v[24:27]
    v_mfma_f32_16x16x32_bf16 v[44:47], v[96:99], a[136:139], v[44:47]
    ds_read_b64_tr_b16 v[108:109], v14 offset:25600
    v_mfma_f32_16x16x32_bf16 v[64:67], v[96:99], a[216:219], v[64:67]
    ds_read_b64_tr_b16 v[110:111], v14 offset:26880
    v_mfma_f32_16x16x32_bf16 v[84:87], v[96:99], v[232:235], v[84:87]
    s_waitcnt lgkmcnt(4)
    v_mfma_f32_16x16x32_bf16 v[28:31], v[100:103], a[56:59], v[28:31]
    v_mfma_f32_16x16x32_bf16 v[48:51], v[100:103], a[136:139], v[48:51]
    ds_read_b64_tr_b16 v[96:97], v14 offset:25632
    v_mfma_f32_16x16x32_bf16 v[68:71], v[100:103], a[216:219], v[68:71]
    ds_read_b64_tr_b16 v[98:99], v14 offset:26912
    v_mfma_f32_16x16x32_bf16 v[88:91], v[100:103], v[232:235], v[88:91]
    s_waitcnt lgkmcnt(4)
    v_mfma_f32_16x16x32_bf16 v[32:35], v[104:107], a[56:59], v[32:35]
    v_mfma_f32_16x16x32_bf16 v[52:55], v[104:107], a[136:139], v[52:55]
    ds_read_b64_tr_b16 v[100:101], v14 offset:25664
    v_mfma_f32_16x16x32_bf16 v[72:75], v[104:107], a[216:219], v[72:75]
    ds_read_b64_tr_b16 v[102:103], v14 offset:26944
    v_mfma_f32_16x16x32_bf16 v[92:95], v[104:107], v[232:235], v[92:95]
    s_waitcnt lgkmcnt(4)
    v_mfma_f32_16x16x32_bf16 v[16:19], v[108:111], a[60:63], v[16:19]
    v_mfma_f32_16x16x32_bf16 v[36:39], v[108:111], a[140:143], v[36:39]
    ds_read_b64_tr_b16 v[104:105], v14 offset:25696
    v_mfma_f32_16x16x32_bf16 v[56:59], v[108:111], a[220:223], v[56:59]
    ds_read_b64_tr_b16 v[106:107], v14 offset:26976
    v_mfma_f32_16x16x32_bf16 v[76:79], v[108:111], v[236:239], v[76:79]
    s_waitcnt lgkmcnt(4)
    v_mfma_f32_16x16x32_bf16 v[20:23], v[96:99], a[60:63], v[20:23]
    v_mfma_f32_16x16x32_bf16 v[40:43], v[96:99], a[140:143], v[40:43]
    ds_read_b64_tr_b16 v[108:109], v14 offset:25728
    v_mfma_f32_16x16x32_bf16 v[60:63], v[96:99], a[220:223], v[60:63]
    ds_read_b64_tr_b16 v[110:111], v14 offset:27008
    v_mfma_f32_16x16x32_bf16 v[80:83], v[96:99], v[236:239], v[80:83]
    s_waitcnt lgkmcnt(4)
    v_mfma_f32_16x16x32_bf16 v[24:27], v[100:103], a[60:63], v[24:27]
    v_mfma_f32_16x16x32_bf16 v[44:47], v[100:103], a[140:143], v[44:47]
    ds_read_b64_tr_b16 v[96:97], v14 offset:30720
    v_mfma_f32_16x16x32_bf16 v[64:67], v[100:103], a[220:223], v[64:67]
    ds_read_b64_tr_b16 v[98:99], v14 offset:32000
    v_mfma_f32_16x16x32_bf16 v[84:87], v[100:103], v[236:239], v[84:87]
    s_waitcnt lgkmcnt(4)
    v_mfma_f32_16x16x32_bf16 v[28:31], v[104:107], a[60:63], v[28:31]
    v_mfma_f32_16x16x32_bf16 v[48:51], v[104:107], a[140:143], v[48:51]
    ds_read_b64_tr_b16 v[100:101], v14 offset:30752
    v_mfma_f32_16x16x32_bf16 v[68:71], v[104:107], a[220:223], v[68:71]
    ds_read_b64_tr_b16 v[102:103], v14 offset:32032
    v_mfma_f32_16x16x32_bf16 v[88:91], v[104:107], v[236:239], v[88:91]
    s_waitcnt lgkmcnt(4)
    v_mfma_f32_16x16x32_bf16 v[32:35], v[108:111], a[60:63], v[32:35]
    v_mfma_f32_16x16x32_bf16 v[52:55], v[108:111], a[140:143], v[52:55]
    ds_read_b64_tr_b16 v[104:105], v14 offset:30784
    v_mfma_f32_16x16x32_bf16 v[72:75], v[108:111], a[220:223], v[72:75]
    ds_read_b64_tr_b16 v[106:107], v14 offset:32064
    v_mfma_f32_16x16x32_bf16 v[92:95], v[108:111], v[236:239], v[92:95]
    s_waitcnt lgkmcnt(4)
    v_mfma_f32_16x16x32_bf16 v[16:19], v[96:99], a[64:67], v[16:19]
    v_mfma_f32_16x16x32_bf16 v[36:39], v[96:99], a[144:147], v[36:39]
    ds_read_b64_tr_b16 v[108:109], v14 offset:30816
    v_mfma_f32_16x16x32_bf16 v[56:59], v[96:99], a[224:227], v[56:59]
    ds_read_b64_tr_b16 v[110:111], v14 offset:32096
    v_mfma_f32_16x16x32_bf16 v[76:79], v[96:99], v[240:243], v[76:79]
    s_waitcnt lgkmcnt(4)
    v_mfma_f32_16x16x32_bf16 v[20:23], v[100:103], a[64:67], v[20:23]
    v_mfma_f32_16x16x32_bf16 v[40:43], v[100:103], a[144:147], v[40:43]
    ds_read_b64_tr_b16 v[96:97], v14 offset:30848
    v_mfma_f32_16x16x32_bf16 v[60:63], v[100:103], a[224:227], v[60:63]
    ds_read_b64_tr_b16 v[98:99], v14 offset:32128
    v_mfma_f32_16x16x32_bf16 v[80:83], v[100:103], v[240:243], v[80:83]
    s_waitcnt lgkmcnt(4)
    v_mfma_f32_16x16x32_bf16 v[24:27], v[104:107], a[64:67], v[24:27]
    v_mfma_f32_16x16x32_bf16 v[44:47], v[104:107], a[144:147], v[44:47]
    ds_read_b64_tr_b16 v[100:101], v14 offset:35840
    v_mfma_f32_16x16x32_bf16 v[64:67], v[104:107], a[224:227], v[64:67]
    ds_read_b64_tr_b16 v[102:103], v14 offset:37120
    v_mfma_f32_16x16x32_bf16 v[84:87], v[104:107], v[240:243], v[84:87]
    s_waitcnt lgkmcnt(4)
    v_mfma_f32_16x16x32_bf16 v[28:31], v[108:111], a[64:67], v[28:31]
    v_mfma_f32_16x16x32_bf16 v[48:51], v[108:111], a[144:147], v[48:51]
    ds_read_b64_tr_b16 v[104:105], v14 offset:35872
    v_mfma_f32_16x16x32_bf16 v[68:71], v[108:111], a[224:227], v[68:71]
    ds_read_b64_tr_b16 v[106:107], v14 offset:37152
    v_mfma_f32_16x16x32_bf16 v[88:91], v[108:111], v[240:243], v[88:91]
    s_waitcnt lgkmcnt(4)
    v_mfma_f32_16x16x32_bf16 v[32:35], v[96:99], a[64:67], v[32:35]
    v_mfma_f32_16x16x32_bf16 v[52:55], v[96:99], a[144:147], v[52:55]
    ds_read_b64_tr_b16 v[108:109], v14 offset:35904
    v_mfma_f32_16x16x32_bf16 v[72:75], v[96:99], a[224:227], v[72:75]
    ds_read_b64_tr_b16 v[110:111], v14 offset:37184
    v_mfma_f32_16x16x32_bf16 v[92:95], v[96:99], v[240:243], v[92:95]
    s_waitcnt lgkmcnt(4)
    v_mfma_f32_16x16x32_bf16 v[16:19], v[100:103], a[68:71], v[16:19]
    v_mfma_f32_16x16x32_bf16 v[36:39], v[100:103], a[148:151], v[36:39]
    ds_read_b64_tr_b16 v[96:97], v14 offset:35936
    v_mfma_f32_16x16x32_bf16 v[56:59], v[100:103], a[228:231], v[56:59]
    ds_read_b64_tr_b16 v[98:99], v14 offset:37216
    v_mfma_f32_16x16x32_bf16 v[76:79], v[100:103], v[244:247], v[76:79]
    s_waitcnt lgkmcnt(4)
    v_mfma_f32_16x16x32_bf16 v[20:23], v[104:107], a[68:71], v[20:23]
    v_mfma_f32_16x16x32_bf16 v[40:43], v[104:107], a[148:151], v[40:43]
    ds_read_b64_tr_b16 v[100:101], v14 offset:35968
    v_mfma_f32_16x16x32_bf16 v[60:63], v[104:107], a[228:231], v[60:63]
    ds_read_b64_tr_b16 v[102:103], v14 offset:37248
    v_mfma_f32_16x16x32_bf16 v[80:83], v[104:107], v[244:247], v[80:83]
    s_waitcnt lgkmcnt(4)
    v_mfma_f32_16x16x32_bf16 v[24:27], v[108:111], a[68:71], v[24:27]
    v_mfma_f32_16x16x32_bf16 v[44:47], v[108:111], a[148:151], v[44:47]
    ds_read_b64_tr_b16 v[104:105], v14 offset:40960
    v_mfma_f32_16x16x32_bf16 v[64:67], v[108:111], a[228:231], v[64:67]
    ds_read_b64_tr_b16 v[106:107], v14 offset:42240
    v_mfma_f32_16x16x32_bf16 v[84:87], v[108:111], v[244:247], v[84:87]
    s_waitcnt lgkmcnt(4)
    v_mfma_f32_16x16x32_bf16 v[28:31], v[96:99], a[68:71], v[28:31]
    v_mfma_f32_16x16x32_bf16 v[48:51], v[96:99], a[148:151], v[48:51]
    ds_read_b64_tr_b16 v[108:109], v14 offset:40992
    v_mfma_f32_16x16x32_bf16 v[68:71], v[96:99], a[228:231], v[68:71]
    ds_read_b64_tr_b16 v[110:111], v14 offset:42272
    v_mfma_f32_16x16x32_bf16 v[88:91], v[96:99], v[244:247], v[88:91]
    s_waitcnt lgkmcnt(4)
    v_mfma_f32_16x16x32_bf16 v[32:35], v[100:103], a[68:71], v[32:35]
    v_mfma_f32_16x16x32_bf16 v[52:55], v[100:103], a[148:151], v[52:55]
    ds_read_b64_tr_b16 v[96:97], v14 offset:41024
    v_mfma_f32_16x16x32_bf16 v[72:75], v[100:103], a[228:231], v[72:75]
    ds_read_b64_tr_b16 v[98:99], v14 offset:42304
    v_mfma_f32_16x16x32_bf16 v[92:95], v[100:103], v[244:247], v[92:95]
    s_waitcnt lgkmcnt(4)
    v_mfma_f32_16x16x32_bf16 v[16:19], v[104:107], a[72:75], v[16:19]
    v_mfma_f32_16x16x32_bf16 v[36:39], v[104:107], a[152:155], v[36:39]
    ds_read_b64_tr_b16 v[100:101], v14 offset:41056
    v_mfma_f32_16x16x32_bf16 v[56:59], v[104:107], a[232:235], v[56:59]
    ds_read_b64_tr_b16 v[102:103], v14 offset:42336
    v_mfma_f32_16x16x32_bf16 v[76:79], v[104:107], v[248:251], v[76:79]
    s_waitcnt lgkmcnt(4)
    v_mfma_f32_16x16x32_bf16 v[20:23], v[108:111], a[72:75], v[20:23]
    v_mfma_f32_16x16x32_bf16 v[40:43], v[108:111], a[152:155], v[40:43]
    ds_read_b64_tr_b16 v[104:105], v14 offset:41088
    v_mfma_f32_16x16x32_bf16 v[60:63], v[108:111], a[232:235], v[60:63]
    ds_read_b64_tr_b16 v[106:107], v14 offset:42368
    v_mfma_f32_16x16x32_bf16 v[80:83], v[108:111], v[248:251], v[80:83]
    s_waitcnt lgkmcnt(4)
    v_mfma_f32_16x16x32_bf16 v[24:27], v[96:99], a[72:75], v[24:27]
    v_mfma_f32_16x16x32_bf16 v[44:47], v[96:99], a[152:155], v[44:47]
    ds_read_b64_tr_b16 v[108:109], v14 offset:46080
    v_mfma_f32_16x16x32_bf16 v[64:67], v[96:99], a[232:235], v[64:67]
    ds_read_b64_tr_b16 v[110:111], v14 offset:47360
    v_mfma_f32_16x16x32_bf16 v[84:87], v[96:99], v[248:251], v[84:87]
    s_waitcnt lgkmcnt(4)
    v_mfma_f32_16x16x32_bf16 v[28:31], v[100:103], a[72:75], v[28:31]
    v_mfma_f32_16x16x32_bf16 v[48:51], v[100:103], a[152:155], v[48:51]
    ds_read_b64_tr_b16 v[96:97], v14 offset:46112
    v_mfma_f32_16x16x32_bf16 v[68:71], v[100:103], a[232:235], v[68:71]
    ds_read_b64_tr_b16 v[98:99], v14 offset:47392
    v_mfma_f32_16x16x32_bf16 v[88:91], v[100:103], v[248:251], v[88:91]
    s_waitcnt lgkmcnt(4)
    v_mfma_f32_16x16x32_bf16 v[32:35], v[104:107], a[72:75], v[32:35]
    v_mfma_f32_16x16x32_bf16 v[52:55], v[104:107], a[152:155], v[52:55]
    ds_read_b64_tr_b16 v[100:101], v14 offset:46144
    v_mfma_f32_16x16x32_bf16 v[72:75], v[104:107], a[232:235], v[72:75]
    ds_read_b64_tr_b16 v[102:103], v14 offset:47424
    v_mfma_f32_16x16x32_bf16 v[92:95], v[104:107], v[248:251], v[92:95]
    s_waitcnt lgkmcnt(4)
    v_mfma_f32_16x16x32_bf16 v[16:19], v[108:111], a[76:79], v[16:19]
    v_mfma_f32_16x16x32_bf16 v[36:39], v[108:111], a[156:159], v[36:39]
    ds_read_b64_tr_b16 v[104:105], v14 offset:46176
    v_mfma_f32_16x16x32_bf16 v[56:59], v[108:111], a[236:239], v[56:59]
    ds_read_b64_tr_b16 v[106:107], v14 offset:47456
    v_mfma_f32_16x16x32_bf16 v[76:79], v[108:111], v[252:255], v[76:79]
    s_waitcnt lgkmcnt(4)
    v_mfma_f32_16x16x32_bf16 v[20:23], v[96:99], a[76:79], v[20:23]
    v_mfma_f32_16x16x32_bf16 v[40:43], v[96:99], a[156:159], v[40:43]
    ds_read_b64_tr_b16 v[108:109], v14 offset:46208
    v_mfma_f32_16x16x32_bf16 v[60:63], v[96:99], a[236:239], v[60:63]
    ds_read_b64_tr_b16 v[110:111], v14 offset:47488
    v_mfma_f32_16x16x32_bf16 v[80:83], v[96:99], v[252:255], v[80:83]
    s_waitcnt lgkmcnt(4)
    v_mfma_f32_16x16x32_bf16 v[24:27], v[100:103], a[76:79], v[24:27]
    v_mfma_f32_16x16x32_bf16 v[44:47], v[100:103], a[156:159], v[44:47]
    v_mfma_f32_16x16x32_bf16 v[64:67], v[100:103], a[236:239], v[64:67]
    v_mfma_f32_16x16x32_bf16 v[84:87], v[100:103], v[252:255], v[84:87]
    s_waitcnt lgkmcnt(2)
    v_mfma_f32_16x16x32_bf16 v[28:31], v[104:107], a[76:79], v[28:31]
    v_mfma_f32_16x16x32_bf16 v[48:51], v[104:107], a[156:159], v[48:51]
    v_mfma_f32_16x16x32_bf16 v[68:71], v[104:107], a[236:239], v[68:71]
    v_mfma_f32_16x16x32_bf16 v[88:91], v[104:107], v[252:255], v[88:91]
    s_waitcnt lgkmcnt(0)
    v_mfma_f32_16x16x32_bf16 v[32:35], v[108:111], a[76:79], v[32:35]
    v_mfma_f32_16x16x32_bf16 v[52:55], v[108:111], a[156:159], v[52:55]
    v_mfma_f32_16x16x32_bf16 v[72:75], v[108:111], a[236:239], v[72:75]
    v_mfma_f32_16x16x32_bf16 v[92:95], v[108:111], v[252:255], v[92:95]
    v_mov_b32 v7, v116
    v_mul_f32 v16, s69, v16
    v_mul_f32 v17, s69, v17
    v_mul_f32 v18, s69, v18
    v_mul_f32 v19, s69, v19
    v_cvt_pk_bf16_f32 v16, v16, v17
    v_cvt_pk_bf16_f32 v17, v18, v19
    buffer_store_dwordx2 v[16:17], v7, s[8:11], s68 offen sc1
    v_add_u32 v7, v7, v121
    v_mul_f32 v36, s69, v36
    v_mul_f32 v37, s69, v37
    v_mul_f32 v38, s69, v38
    v_mul_f32 v39, s69, v39
    v_cvt_pk_bf16_f32 v36, v36, v37
    v_cvt_pk_bf16_f32 v37, v38, v39
    buffer_store_dwordx2 v[36:37], v7, s[8:11], s68 offen sc1
    v_add_u32 v7, v7, v121
    v_mul_f32 v56, s69, v56
    v_mul_f32 v57, s69, v57
    v_mul_f32 v58, s69, v58
    v_mul_f32 v59, s69, v59
    v_cvt_pk_bf16_f32 v56, v56, v57
    v_cvt_pk_bf16_f32 v57, v58, v59
    buffer_store_dwordx2 v[56:57], v7, s[8:11], s68 offen sc1
    v_add_u32 v7, v7, v121
    v_mul_f32 v76, s69, v76
    v_mul_f32 v77, s69, v77
    v_mul_f32 v78, s69, v78
    v_mul_f32 v79, s69, v79
    v_cvt_pk_bf16_f32 v76, v76, v77
    v_cvt_pk_bf16_f32 v77, v78, v79
    buffer_store_dwordx2 v[76:77], v7, s[8:11], s68 offen sc1
    v_add_u32 v7, v7, v121
    v_mov_b32 v7, v117
    v_mul_f32 v20, s69, v20
    v_mul_f32 v21, s69, v21
    v_mul_f32 v22, s69, v22
    v_mul_f32 v23, s69, v23
    v_cvt_pk_bf16_f32 v20, v20, v21
    v_cvt_pk_bf16_f32 v21, v22, v23
    buffer_store_dwordx2 v[20:21], v7, s[8:11], s68 offen sc1
    v_add_u32 v7, v7, v122
    v_mul_f32 v40, s69, v40
    v_mul_f32 v41, s69, v41
    v_mul_f32 v42, s69, v42
    v_mul_f32 v43, s69, v43
    v_cvt_pk_bf16_f32 v40, v40, v41
    v_cvt_pk_bf16_f32 v41, v42, v43
    buffer_store_dwordx2 v[40:41], v7, s[8:11], s68 offen sc1
    v_add_u32 v7, v7, v122
    v_mul_f32 v60, s69, v60
    v_mul_f32 v61, s69, v61
    v_mul_f32 v62, s69, v62
    v_mul_f32 v63, s69, v63
    v_cvt_pk_bf16_f32 v60, v60, v61
    v_cvt_pk_bf16_f32 v61, v62, v63
    buffer_store_dwordx2 v[60:61], v7, s[8:11], s68 offen sc1
    v_add_u32 v7, v7, v122
    v_mul_f32 v80, s69, v80
    v_mul_f32 v81, s69, v81
    v_mul_f32 v82, s69, v82
    v_mul_f32 v83, s69, v83
    v_cvt_pk_bf16_f32 v80, v80, v81
    v_cvt_pk_bf16_f32 v81, v82, v83
    buffer_store_dwordx2 v[80:81], v7, s[8:11], s68 offen sc1
    v_add_u32 v7, v7, v122
    v_mov_b32 v7, v118
    v_mul_f32 v24, s69, v24
    v_mul_f32 v25, s69, v25
    v_mul_f32 v26, s69, v26
    v_mul_f32 v27, s69, v27
    v_cvt_pk_bf16_f32 v24, v24, v25
    v_cvt_pk_bf16_f32 v25, v26, v27
    buffer_store_dwordx2 v[24:25], v7, s[8:11], s68 offen sc1
    v_add_u32 v7, v7, v123
    v_mul_f32 v44, s69, v44
    v_mul_f32 v45, s69, v45
    v_mul_f32 v46, s69, v46
    v_mul_f32 v47, s69, v47
    v_cvt_pk_bf16_f32 v44, v44, v45
    v_cvt_pk_bf16_f32 v45, v46, v47
    buffer_store_dwordx2 v[44:45], v7, s[8:11], s68 offen sc1
    v_add_u32 v7, v7, v123
    v_mul_f32 v64, s69, v64
    v_mul_f32 v65, s69, v65
    v_mul_f32 v66, s69, v66
    v_mul_f32 v67, s69, v67
    v_cvt_pk_bf16_f32 v64, v64, v65
    v_cvt_pk_bf16_f32 v65, v66, v67
    buffer_store_dwordx2 v[64:65], v7, s[8:11], s68 offen sc1
    v_add_u32 v7, v7, v123
    v_mul_f32 v84, s69, v84
    v_mul_f32 v85, s69, v85
    v_mul_f32 v86, s69, v86
    v_mul_f32 v87, s69, v87
    v_cvt_pk_bf16_f32 v84, v84, v85
    v_cvt_pk_bf16_f32 v85, v86, v87
    buffer_store_dwordx2 v[84:85], v7, s[8:11], s68 offen sc1
    v_add_u32 v7, v7, v123
    v_mov_b32 v7, v119
    v_mul_f32 v28, s69, v28
    v_mul_f32 v29, s69, v29
    v_mul_f32 v30, s69, v30
    v_mul_f32 v31, s69, v31
    v_cvt_pk_bf16_f32 v28, v28, v29
    v_cvt_pk_bf16_f32 v29, v30, v31
    buffer_store_dwordx2 v[28:29], v7, s[8:11], s68 offen sc1
    v_add_u32 v7, v7, v124
    v_mul_f32 v48, s69, v48
    v_mul_f32 v49, s69, v49
    v_mul_f32 v50, s69, v50
    v_mul_f32 v51, s69, v51
    v_cvt_pk_bf16_f32 v48, v48, v49
    v_cvt_pk_bf16_f32 v49, v50, v51
    buffer_store_dwordx2 v[48:49], v7, s[8:11], s68 offen sc1
    v_add_u32 v7, v7, v124
    v_mul_f32 v68, s69, v68
    v_mul_f32 v69, s69, v69
    v_mul_f32 v70, s69, v70
    v_mul_f32 v71, s69, v71
    v_cvt_pk_bf16_f32 v68, v68, v69
    v_cvt_pk_bf16_f32 v69, v70, v71
    buffer_store_dwordx2 v[68:69], v7, s[8:11], s68 offen sc1
    v_add_u32 v7, v7, v124
    v_mul_f32 v88, s69, v88
    v_mul_f32 v89, s69, v89
    v_mul_f32 v90, s69, v90
    v_mul_f32 v91, s69, v91
    v_cvt_pk_bf16_f32 v88, v88, v89
    v_cvt_pk_bf16_f32 v89, v90, v91
    buffer_store_dwordx2 v[88:89], v7, s[8:11], s68 offen sc1
    v_add_u32 v7, v7, v124
    v_mov_b32 v7, v120
    v_mul_f32 v32, s69, v32
    v_mul_f32 v33, s69, v33
    v_mul_f32 v34, s69, v34
    v_mul_f32 v35, s69, v35
    v_cvt_pk_bf16_f32 v32, v32, v33
    v_cvt_pk_bf16_f32 v33, v34, v35
    buffer_store_dwordx2 v[32:33], v7, s[8:11], s68 offen sc1
    v_add_u32 v7, v7, v125
    v_mul_f32 v52, s69, v52
    v_mul_f32 v53, s69, v53
    v_mul_f32 v54, s69, v54
    v_mul_f32 v55, s69, v55
    v_cvt_pk_bf16_f32 v52, v52, v53
    v_cvt_pk_bf16_f32 v53, v54, v55
    buffer_store_dwordx2 v[52:53], v7, s[8:11], s68 offen sc1
    v_add_u32 v7, v7, v125
    v_mul_f32 v72, s69, v72
    v_mul_f32 v73, s69, v73
    v_mul_f32 v74, s69, v74
    v_mul_f32 v75, s69, v75
    v_cvt_pk_bf16_f32 v72, v72, v73
    v_cvt_pk_bf16_f32 v73, v74, v75
    buffer_store_dwordx2 v[72:73], v7, s[8:11], s68 offen sc1
    v_add_u32 v7, v7, v125
    v_mul_f32 v92, s69, v92
    v_mul_f32 v93, s69, v93
    v_mul_f32 v94, s69, v94
    v_mul_f32 v95, s69, v95
    v_cvt_pk_bf16_f32 v92, v92, v93
    v_cvt_pk_bf16_f32 v93, v94, v95
    buffer_store_dwordx2 v[92:93], v7, s[8:11], s68 offen sc1
    v_add_u32 v7, v7, v125
    s_add_u32 s67, s67, 1280
    s_mov_b32 s69, 1.0
    s_cmp_eq_u32 s68, 117440512
    s_mov_b32 s68, 121634816
    s_cbranch_scc1 A_QK
    s_barrier
    s_mov_b32 s7, 52429
    s_mov_b32 s33, 3840
    v_add_u32 v2, 0, v0
    v_mul_lo_u32 v3, v2, s7
    v_lshrrev_b32 v3, 19, v3
    v_mul_u32_u24 v8, 10, v3
    v_sub_u32 v2, v2, v8
    v_and_b32 v8, 0x13, v3
    v_and_b32 v7, 4, v3
    v_lshl_or_b32 v8, v7, 1, v8
    v_and_b32 v7, 8, v3
    v_lshrrev_b32 v7, 1, v7
    v_or_b32 v8, v8, v7
    v_mul_lo_u32 v8, v8, s33
    v_lshl_add_u32 v8, v2, 4, v8
    v_add_u32 v2, 64, v0
    v_mul_lo_u32 v3, v2, s7
    v_lshrrev_b32 v3, 19, v3
    v_mul_u32_u24 v9, 10, v3
    v_sub_u32 v2, v2, v9
    v_and_b32 v9, 0x13, v3
    v_and_b32 v7, 4, v3
    v_lshl_or_b32 v9, v7, 1, v9
    v_and_b32 v7, 8, v3
    v_lshrrev_b32 v7, 1, v7
    v_or_b32 v9, v9, v7
    v_mul_lo_u32 v9, v9, s33
    v_lshl_add_u32 v9, v2, 4, v9
    v_add_u32 v2, 128, v0
    v_mul_lo_u32 v3, v2, s7
    v_lshrrev_b32 v3, 19, v3
    v_mul_u32_u24 v10, 10, v3
    v_sub_u32 v2, v2, v10
    v_and_b32 v10, 0x13, v3
    v_and_b32 v7, 4, v3
    v_lshl_or_b32 v10, v7, 1, v10
    v_and_b32 v7, 8, v3
    v_lshrrev_b32 v7, 1, v7
    v_or_b32 v10, v10, v7
    v_mul_lo_u32 v10, v10, s33
    v_lshl_add_u32 v10, v2, 4, v10
    v_add_u32 v2, 192, v0
    v_mul_lo_u32 v3, v2, s7
    v_lshrrev_b32 v3, 19, v3
    v_mul_u32_u24 v11, 10, v3
    v_sub_u32 v2, v2, v11
    v_and_b32 v11, 0x13, v3
    v_and_b32 v7, 4, v3
    v_lshl_or_b32 v11, v7, 1, v11
    v_and_b32 v7, 8, v3
    v_lshrrev_b32 v7, 1, v7
    v_or_b32 v11, v11, v7
    v_mul_lo_u32 v11, v11, s33
    v_lshl_add_u32 v11, v2, 4, v11
    v_add_u32 v2, 256, v0
    v_mul_lo_u32 v3, v2, s7
    v_lshrrev_b32 v3, 19, v3
    v_mul_u32_u24 v12, 10, v3
    v_sub_u32 v2, v2, v12
    v_and_b32 v12, 0x13, v3
    v_and_b32 v7, 4, v3
    v_lshl_or_b32 v12, v7, 1, v12
    v_and_b32 v7, 8, v3
    v_lshrrev_b32 v7, 1, v7
    v_or_b32 v12, v12, v7
    v_mul_lo_u32 v12, v12, s33
    v_lshl_add_u32 v12, v2, 4, v12
    s_mul_i32 s6, s3, 614400
    s_add_u32 s6, s6, s67
    s_mul_i32 s34, s3, 25600
    s_add_u32 m0, s34, 0
    s_nop 0
    buffer_load_dwordx4 v8, s[16:19], s6 offen lds
    s_add_u32 m0, s34, 1024
    s_nop 0
    buffer_load_dwordx4 v9, s[16:19], s6 offen lds
    s_add_u32 m0, s34, 2048
    s_nop 0
    buffer_load_dwordx4 v10, s[16:19], s6 offen lds
    s_add_u32 m0, s34, 3072
    s_nop 0
    buffer_load_dwordx4 v11, s[16:19], s6 offen lds
    s_add_u32 m0, s34, 4096
    s_nop 0
    buffer_load_dwordx4 v12, s[16:19], s6 offen lds
    s_add_u32 s6, s6, 122880
    s_add_u32 m0, s34, 5120
    s_nop 0
    buffer_load_dwordx4 v8, s[16:19], s6 offen lds
    s_add_u32 m0, s34, 6144
    s_nop 0
    buffer_load_dwordx4 v9, s[16:19], s6 offen lds
    s_add_u32 m0, s34, 7168
    s_nop 0
    buffer_load_dwordx4 v10, s[16:19], s6 offen lds
    s_add_u32 m0, s34, 8192
    s_nop 0
    buffer_load_dwordx4 v11, s[16:19], s6 offen lds
    s_add_u32 m0, s34, 9216
    s_nop 0
    buffer_load_dwordx4 v12, s[16:19], s6 offen lds
    s_add_u32 s6, s6, 122880
    s_add_u32 m0, s34, 10240
    s_nop 0
    buffer_load_dwordx4 v8, s[16:19], s6 offen lds
    s_add_u32 m0, s34, 11264
    s_nop 0
    buffer_load_dwordx4 v9, s[16:19], s6 offen lds
    s_add_u32 m0, s34, 12288
    s_nop 0
    buffer_load_dwordx4 v10, s[16:19], s6 offen lds
    s_add_u32 m0, s34, 13312
    s_nop 0
    buffer_load_dwordx4 v11, s[16:19], s6 offen lds
    s_add_u32 m0, s34, 14336
    s_nop 0
    buffer_load_dwordx4 v12, s[16:19], s6 offen lds
    s_add_u32 s6, s6, 122880
    s_add_u32 m0, s34, 15360
    s_nop 0
    buffer_load_dwordx4 v8, s[16:19], s6 offen lds
    s_add_u32 m0, s34, 16384
    s_nop 0
    buffer_load_dwordx4 v9, s[16:19], s6 offen lds
    s_add_u32 m0, s34, 17408
    s_nop 0
    buffer_load_dwordx4 v10, s[16:19], s6 offen lds
    s_add_u32 m0, s34, 18432
    s_nop 0
    buffer_load_dwordx4 v11, s[16:19], s6 offen lds
    s_add_u32 m0, s34, 19456
    s_nop 0
    buffer_load_dwordx4 v12, s[16:19], s6 offen lds
    s_add_u32 s6, s6, 122880
    s_add_u32 m0, s34, 20480
    s_nop 0
    buffer_load_dwordx4 v8, s[16:19], s6 offen lds
    s_add_u32 m0, s34, 21504
    s_nop 0
    buffer_load_dwordx4 v9, s[16:19], s6 offen lds
    s_add_u32 m0, s34, 22528
    s_nop 0
    buffer_load_dwordx4 v10, s[16:19], s6 offen lds
    s_add_u32 m0, s34, 23552
    s_nop 0
    buffer_load_dwordx4 v11, s[16:19], s6 offen lds
    s_add_u32 m0, s34, 24576
    s_nop 0
    buffer_load_dwordx4 v12, s[16:19], s6 offen lds
    s_add_u32 s6, s6, 122880
    v_lshrrev_b32 v2, 5, v0
    v_lshlrev_b32 v2, 4, v2
    v_bfe_u32 v3, v0, 2, 3
    v_add_u32 v2, v2, v3
    v_mul_u32_u24 v2, 160, v2
    v_and_b32 v3, 3, v0
    v_lshl_add_u32 v13, v3, 3, v2
    v_add_u32 v14, 51200, v13
    s_waitcnt vmcnt(0)
    s_barrier
    ds_read_b64_tr_b16 v[96:97], v13 offset:0
    ds_read_b64_tr_b16 v[98:99], v13 offset:1280
    ds_read_b64_tr_b16 v[100:101], v13 offset:32
    ds_read_b64_tr_b16 v[102:103], v13 offset:1312
    ds_read_b64_tr_b16 v[104:105], v13 offset:64
    ds_read_b64_tr_b16 v[106:107], v13 offset:1344
    s_waitcnt lgkmcnt(4)
    v_mfma_f32_16x16x32_bf16 v[16:19], a[0:3], v[96:99], 0
    v_mfma_f32_16x16x32_bf16 v[36:39], a[80:83], v[96:99], 0
    ds_read_b64_tr_b16 v[108:109], v13 offset:96
    v_mfma_f32_16x16x32_bf16 v[56:59], a[160:163], v[96:99], 0
    ds_read_b64_tr_b16 v[110:111], v13 offset:1376
    v_mfma_f32_16x16x32_bf16 v[76:79], a[240:243], v[96:99], 0
    s_waitcnt lgkmcnt(4)
    v_mfma_f32_16x16x32_bf16 v[20:23], a[0:3], v[100:103], 0
    v_mfma_f32_16x16x32_bf16 v[40:43], a[80:83], v[100:103], 0
    ds_read_b64_tr_b16 v[96:97], v13 offset:128
    v_mfma_f32_16x16x32_bf16 v[60:63], a[160:163], v[100:103], 0
    ds_read_b64_tr_b16 v[98:99], v13 offset:1408
    v_mfma_f32_16x16x32_bf16 v[80:83], a[240:243], v[100:103], 0
    s_waitcnt lgkmcnt(4)
    v_mfma_f32_16x16x32_bf16 v[24:27], a[0:3], v[104:107], 0
    v_mfma_f32_16x16x32_bf16 v[44:47], a[80:83], v[104:107], 0
    ds_read_b64_tr_b16 v[100:101], v13 offset:5120
    v_mfma_f32_16x16x32_bf16 v[64:67], a[160:163], v[104:107], 0
    ds_read_b64_tr_b16 v[102:103], v13 offset:6400
    v_mfma_f32_16x16x32_bf16 v[84:87], a[240:243], v[104:107], 0
    s_waitcnt lgkmcnt(4)
    v_mfma_f32_16x16x32_bf16 v[28:31], a[0:3], v[108:111], 0
    v_mfma_f32_16x16x32_bf16 v[48:51], a[80:83], v[108:111], 0
    ds_read_b64_tr_b16 v[104:105], v13 offset:5152
    v_mfma_f32_16x16x32_bf16 v[68:71], a[160:163], v[108:111], 0
    ds_read_b64_tr_b16 v[106:107], v13 offset:6432
    v_mfma_f32_16x16x32_bf16 v[88:91], a[240:243], v[108:111], 0
    s_waitcnt lgkmcnt(4)
    v_mfma_f32_16x16x32_bf16 v[32:35], a[0:3], v[96:99], 0
    v_mfma_f32_16x16x32_bf16 v[52:55], a[80:83], v[96:99], 0
    ds_read_b64_tr_b16 v[108:109], v13 offset:5184
    v_mfma_f32_16x16x32_bf16 v[72:75], a[160:163], v[96:99], 0
    ds_read_b64_tr_b16 v[110:111], v13 offset:6464
    v_mfma_f32_16x16x32_bf16 v[92:95], a[240:243], v[96:99], 0
    s_waitcnt lgkmcnt(4)
    v_mfma_f32_16x16x32_bf16 v[16:19], a[4:7], v[100:103], v[16:19]
    v_mfma_f32_16x16x32_bf16 v[36:39], a[84:87], v[100:103], v[36:39]
    ds_read_b64_tr_b16 v[96:97], v13 offset:5216
    v_mfma_f32_16x16x32_bf16 v[56:59], a[164:167], v[100:103], v[56:59]
    ds_read_b64_tr_b16 v[98:99], v13 offset:6496
    v_mfma_f32_16x16x32_bf16 v[76:79], a[244:247], v[100:103], v[76:79]
    s_waitcnt lgkmcnt(4)
    v_mfma_f32_16x16x32_bf16 v[20:23], a[4:7], v[104:107], v[20:23]
    v_mfma_f32_16x16x32_bf16 v[40:43], a[84:87], v[104:107], v[40:43]
    ds_read_b64_tr_b16 v[100:101], v13 offset:5248
    v_mfma_f32_16x16x32_bf16 v[60:63], a[164:167], v[104:107], v[60:63]
    ds_read_b64_tr_b16 v[102:103], v13 offset:6528
    v_mfma_f32_16x16x32_bf16 v[80:83], a[244:247], v[104:107], v[80:83]
    s_waitcnt lgkmcnt(4)
    v_mfma_f32_16x16x32_bf16 v[24:27], a[4:7], v[108:111], v[24:27]
    v_mfma_f32_16x16x32_bf16 v[44:47], a[84:87], v[108:111], v[44:47]
    ds_read_b64_tr_b16 v[104:105], v13 offset:10240
    v_mfma_f32_16x16x32_bf16 v[64:67], a[164:167], v[108:111], v[64:67]
    ds_read_b64_tr_b16 v[106:107], v13 offset:11520
    v_mfma_f32_16x16x32_bf16 v[84:87], a[244:247], v[108:111], v[84:87]
    s_waitcnt lgkmcnt(4)
    v_mfma_f32_16x16x32_bf16 v[28:31], a[4:7], v[96:99], v[28:31]
    v_mfma_f32_16x16x32_bf16 v[48:51], a[84:87], v[96:99], v[48:51]
    ds_read_b64_tr_b16 v[108:109], v13 offset:10272
    v_mfma_f32_16x16x32_bf16 v[68:71], a[164:167], v[96:99], v[68:71]
    ds_read_b64_tr_b16 v[110:111], v13 offset:11552
    v_mfma_f32_16x16x32_bf16 v[88:91], a[244:247], v[96:99], v[88:91]
    s_waitcnt lgkmcnt(4)
    v_mfma_f32_16x16x32_bf16 v[32:35], a[4:7], v[100:103], v[32:35]
    v_mfma_f32_16x16x32_bf16 v[52:55], a[84:87], v[100:103], v[52:55]
    ds_read_b64_tr_b16 v[96:97], v13 offset:10304
    v_mfma_f32_16x16x32_bf16 v[72:75], a[164:167], v[100:103], v[72:75]
    ds_read_b64_tr_b16 v[98:99], v13 offset:11584
    v_mfma_f32_16x16x32_bf16 v[92:95], a[244:247], v[100:103], v[92:95]
    s_waitcnt lgkmcnt(4)
    v_mfma_f32_16x16x32_bf16 v[16:19], a[8:11], v[104:107], v[16:19]
    v_mfma_f32_16x16x32_bf16 v[36:39], a[88:91], v[104:107], v[36:39]
    ds_read_b64_tr_b16 v[100:101], v13 offset:10336
    v_mfma_f32_16x16x32_bf16 v[56:59], a[168:171], v[104:107], v[56:59]
    ds_read_b64_tr_b16 v[102:103], v13 offset:11616
    v_mfma_f32_16x16x32_bf16 v[76:79], a[248:251], v[104:107], v[76:79]
    s_waitcnt lgkmcnt(4)
    v_mfma_f32_16x16x32_bf16 v[20:23], a[8:11], v[108:111], v[20:23]
    v_mfma_f32_16x16x32_bf16 v[40:43], a[88:91], v[108:111], v[40:43]
    ds_read_b64_tr_b16 v[104:105], v13 offset:10368
    v_mfma_f32_16x16x32_bf16 v[60:63], a[168:171], v[108:111], v[60:63]
    ds_read_b64_tr_b16 v[106:107], v13 offset:11648
    v_mfma_f32_16x16x32_bf16 v[80:83], a[248:251], v[108:111], v[80:83]
    s_waitcnt lgkmcnt(4)
    v_mfma_f32_16x16x32_bf16 v[24:27], a[8:11], v[96:99], v[24:27]
    v_mfma_f32_16x16x32_bf16 v[44:47], a[88:91], v[96:99], v[44:47]
    ds_read_b64_tr_b16 v[108:109], v13 offset:15360
    v_mfma_f32_16x16x32_bf16 v[64:67], a[168:171], v[96:99], v[64:67]
    ds_read_b64_tr_b16 v[110:111], v13 offset:16640
    v_mfma_f32_16x16x32_bf16 v[84:87], a[248:251], v[96:99], v[84:87]
    s_waitcnt lgkmcnt(4)
    v_mfma_f32_16x16x32_bf16 v[28:31], a[8:11], v[100:103], v[28:31]
    v_mfma_f32_16x16x32_bf16 v[48:51], a[88:91], v[100:103], v[48:51]
    ds_read_b64_tr_b16 v[96:97], v13 offset:15392
    v_mfma_f32_16x16x32_bf16 v[68:71], a[168:171], v[100:103], v[68:71]
    ds_read_b64_tr_b16 v[98:99], v13 offset:16672
    v_mfma_f32_16x16x32_bf16 v[88:91], a[248:251], v[100:103], v[88:91]
    s_waitcnt lgkmcnt(4)
    v_mfma_f32_16x16x32_bf16 v[32:35], a[8:11], v[104:107], v[32:35]
    v_mfma_f32_16x16x32_bf16 v[52:55], a[88:91], v[104:107], v[52:55]
    ds_read_b64_tr_b16 v[100:101], v13 offset:15424
    v_mfma_f32_16x16x32_bf16 v[72:75], a[168:171], v[104:107], v[72:75]
    ds_read_b64_tr_b16 v[102:103], v13 offset:16704
    v_mfma_f32_16x16x32_bf16 v[92:95], a[248:251], v[104:107], v[92:95]
    s_waitcnt lgkmcnt(4)
    v_mfma_f32_16x16x32_bf16 v[16:19], a[12:15], v[108:111], v[16:19]
    v_mfma_f32_16x16x32_bf16 v[36:39], a[92:95], v[108:111], v[36:39]
    ds_read_b64_tr_b16 v[104:105], v13 offset:15456
    v_mfma_f32_16x16x32_bf16 v[56:59], a[172:175], v[108:111], v[56:59]
    ds_read_b64_tr_b16 v[106:107], v13 offset:16736
    v_mfma_f32_16x16x32_bf16 v[76:79], a[252:255], v[108:111], v[76:79]
    s_waitcnt lgkmcnt(4)
    v_mfma_f32_16x16x32_bf16 v[20:23], a[12:15], v[96:99], v[20:23]
    v_mfma_f32_16x16x32_bf16 v[40:43], a[92:95], v[96:99], v[40:43]
    ds_read_b64_tr_b16 v[108:109], v13 offset:15488
    v_mfma_f32_16x16x32_bf16 v[60:63], a[172:175], v[96:99], v[60:63]
    ds_read_b64_tr_b16 v[110:111], v13 offset:16768
    v_mfma_f32_16x16x32_bf16 v[80:83], a[252:255], v[96:99], v[80:83]
    s_waitcnt lgkmcnt(4)
    v_mfma_f32_16x16x32_bf16 v[24:27], a[12:15], v[100:103], v[24:27]
    v_mfma_f32_16x16x32_bf16 v[44:47], a[92:95], v[100:103], v[44:47]
    ds_read_b64_tr_b16 v[96:97], v13 offset:20480
    v_mfma_f32_16x16x32_bf16 v[64:67], a[172:175], v[100:103], v[64:67]
    ds_read_b64_tr_b16 v[98:99], v13 offset:21760
    v_mfma_f32_16x16x32_bf16 v[84:87], a[252:255], v[100:103], v[84:87]
    s_waitcnt lgkmcnt(4)
    v_mfma_f32_16x16x32_bf16 v[28:31], a[12:15], v[104:107], v[28:31]
    v_mfma_f32_16x16x32_bf16 v[48:51], a[92:95], v[104:107], v[48:51]
    ds_read_b64_tr_b16 v[100:101], v13 offset:20512
    v_mfma_f32_16x16x32_bf16 v[68:71], a[172:175], v[104:107], v[68:71]
    ds_read_b64_tr_b16 v[102:103], v13 offset:21792
    v_mfma_f32_16x16x32_bf16 v[88:91], a[252:255], v[104:107], v[88:91]
    s_waitcnt lgkmcnt(4)
    v_mfma_f32_16x16x32_bf16 v[32:35], a[12:15], v[108:111], v[32:35]
    v_mfma_f32_16x16x32_bf16 v[52:55], a[92:95], v[108:111], v[52:55]
    ds_read_b64_tr_b16 v[104:105], v13 offset:20544
    v_mfma_f32_16x16x32_bf16 v[72:75], a[172:175], v[108:111], v[72:75]
    ds_read_b64_tr_b16 v[106:107], v13 offset:21824
    v_mfma_f32_16x16x32_bf16 v[92:95], a[252:255], v[108:111], v[92:95]
    s_waitcnt lgkmcnt(4)
    v_mfma_f32_16x16x32_bf16 v[16:19], a[16:19], v[96:99], v[16:19]
    v_mfma_f32_16x16x32_bf16 v[36:39], a[96:99], v[96:99], v[36:39]
    ds_read_b64_tr_b16 v[108:109], v13 offset:20576
    v_mfma_f32_16x16x32_bf16 v[56:59], a[176:179], v[96:99], v[56:59]
    ds_read_b64_tr_b16 v[110:111], v13 offset:21856
    v_mfma_f32_16x16x32_bf16 v[76:79], v[192:195], v[96:99], v[76:79]
    s_waitcnt lgkmcnt(4)
    v_mfma_f32_16x16x32_bf16 v[20:23], a[16:19], v[100:103], v[20:23]
    v_mfma_f32_16x16x32_bf16 v[40:43], a[96:99], v[100:103], v[40:43]
    ds_read_b64_tr_b16 v[96:97], v13 offset:20608
    v_mfma_f32_16x16x32_bf16 v[60:63], a[176:179], v[100:103], v[60:63]
    ds_read_b64_tr_b16 v[98:99], v13 offset:21888
    v_mfma_f32_16x16x32_bf16 v[80:83], v[192:195], v[100:103], v[80:83]
    s_waitcnt lgkmcnt(4)
    v_mfma_f32_16x16x32_bf16 v[24:27], a[16:19], v[104:107], v[24:27]
    v_mfma_f32_16x16x32_bf16 v[44:47], a[96:99], v[104:107], v[44:47]
    ds_read_b64_tr_b16 v[100:101], v13 offset:25600
    v_mfma_f32_16x16x32_bf16 v[64:67], a[176:179], v[104:107], v[64:67]
    ds_read_b64_tr_b16 v[102:103], v13 offset:26880
    v_mfma_f32_16x16x32_bf16 v[84:87], v[192:195], v[104:107], v[84:87]
    s_waitcnt lgkmcnt(4)
    v_mfma_f32_16x16x32_bf16 v[28:31], a[16:19], v[108:111], v[28:31]
    v_mfma_f32_16x16x32_bf16 v[48:51], a[96:99], v[108:111], v[48:51]
    ds_read_b64_tr_b16 v[104:105], v13 offset:25632
    v_mfma_f32_16x16x32_bf16 v[68:71], a[176:179], v[108:111], v[68:71]
    ds_read_b64_tr_b16 v[106:107], v13 offset:26912
    v_mfma_f32_16x16x32_bf16 v[88:91], v[192:195], v[108:111], v[88:91]
    s_waitcnt lgkmcnt(4)
    v_mfma_f32_16x16x32_bf16 v[32:35], a[16:19], v[96:99], v[32:35]
    v_mfma_f32_16x16x32_bf16 v[52:55], a[96:99], v[96:99], v[52:55]
    ds_read_b64_tr_b16 v[108:109], v13 offset:25664
    v_mfma_f32_16x16x32_bf16 v[72:75], a[176:179], v[96:99], v[72:75]
    ds_read_b64_tr_b16 v[110:111], v13 offset:26944
    v_mfma_f32_16x16x32_bf16 v[92:95], v[192:195], v[96:99], v[92:95]
    s_waitcnt lgkmcnt(4)
    v_mfma_f32_16x16x32_bf16 v[16:19], a[20:23], v[100:103], v[16:19]
    v_mfma_f32_16x16x32_bf16 v[36:39], a[100:103], v[100:103], v[36:39]
    ds_read_b64_tr_b16 v[96:97], v13 offset:25696
    v_mfma_f32_16x16x32_bf16 v[56:59], a[180:183], v[100:103], v[56:59]
    ds_read_b64_tr_b16 v[98:99], v13 offset:26976
    v_mfma_f32_16x16x32_bf16 v[76:79], v[196:199], v[100:103], v[76:79]
    s_waitcnt lgkmcnt(4)
    v_mfma_f32_16x16x32_bf16 v[20:23], a[20:23], v[104:107], v[20:23]
    v_mfma_f32_16x16x32_bf16 v[40:43], a[100:103], v[104:107], v[40:43]
    ds_read_b64_tr_b16 v[100:101], v13 offset:25728
    v_mfma_f32_16x16x32_bf16 v[60:63], a[180:183], v[104:107], v[60:63]
    ds_read_b64_tr_b16 v[102:103], v13 offset:27008
    v_mfma_f32_16x16x32_bf16 v[80:83], v[196:199], v[104:107], v[80:83]
    s_waitcnt lgkmcnt(4)
    v_mfma_f32_16x16x32_bf16 v[24:27], a[20:23], v[108:111], v[24:27]
    v_mfma_f32_16x16x32_bf16 v[44:47], a[100:103], v[108:111], v[44:47]
    ds_read_b64_tr_b16 v[104:105], v13 offset:30720
    v_mfma_f32_16x16x32_bf16 v[64:67], a[180:183], v[108:111], v[64:67]
    ds_read_b64_tr_b16 v[106:107], v13 offset:32000
    v_mfma_f32_16x16x32_bf16 v[84:87], v[196:199], v[108:111], v[84:87]
    s_waitcnt lgkmcnt(4)
    v_mfma_f32_16x16x32_bf16 v[28:31], a[20:23], v[96:99], v[28:31]
    v_mfma_f32_16x16x32_bf16 v[48:51], a[100:103], v[96:99], v[48:51]
    ds_read_b64_tr_b16 v[108:109], v13 offset:30752
    v_mfma_f32_16x16x32_bf16 v[68:71], a[180:183], v[96:99], v[68:71]
    ds_read_b64_tr_b16 v[110:111], v13 offset:32032
    v_mfma_f32_16x16x32_bf16 v[88:91], v[196:199], v[96:99], v[88:91]
    s_waitcnt lgkmcnt(4)
    v_mfma_f32_16x16x32_bf16 v[32:35], a[20:23], v[100:103], v[32:35]
    v_mfma_f32_16x16x32_bf16 v[52:55], a[100:103], v[100:103], v[52:55]
    ds_read_b64_tr_b16 v[96:97], v13 offset:30784
    v_mfma_f32_16x16x32_bf16 v[72:75], a[180:183], v[100:103], v[72:75]
    ds_read_b64_tr_b16 v[98:99], v13 offset:32064
    v_mfma_f32_16x16x32_bf16 v[92:95], v[196:199], v[100:103], v[92:95]
    s_waitcnt lgkmcnt(4)
    v_mfma_f32_16x16x32_bf16 v[16:19], a[24:27], v[104:107], v[16:19]
    v_mfma_f32_16x16x32_bf16 v[36:39], a[104:107], v[104:107], v[36:39]
    ds_read_b64_tr_b16 v[100:101], v13 offset:30816
    v_mfma_f32_16x16x32_bf16 v[56:59], a[184:187], v[104:107], v[56:59]
    ds_read_b64_tr_b16 v[102:103], v13 offset:32096
    v_mfma_f32_16x16x32_bf16 v[76:79], v[200:203], v[104:107], v[76:79]
    s_waitcnt lgkmcnt(4)
    v_mfma_f32_16x16x32_bf16 v[20:23], a[24:27], v[108:111], v[20:23]
    v_mfma_f32_16x16x32_bf16 v[40:43], a[104:107], v[108:111], v[40:43]
    ds_read_b64_tr_b16 v[104:105], v13 offset:30848
    v_mfma_f32_16x16x32_bf16 v[60:63], a[184:187], v[108:111], v[60:63]
    ds_read_b64_tr_b16 v[106:107], v13 offset:32128
    v_mfma_f32_16x16x32_bf16 v[80:83], v[200:203], v[108:111], v[80:83]
    s_waitcnt lgkmcnt(4)
    v_mfma_f32_16x16x32_bf16 v[24:27], a[24:27], v[96:99], v[24:27]
    v_mfma_f32_16x16x32_bf16 v[44:47], a[104:107], v[96:99], v[44:47]
    ds_read_b64_tr_b16 v[108:109], v13 offset:35840
    v_mfma_f32_16x16x32_bf16 v[64:67], a[184:187], v[96:99], v[64:67]
    ds_read_b64_tr_b16 v[110:111], v13 offset:37120
    v_mfma_f32_16x16x32_bf16 v[84:87], v[200:203], v[96:99], v[84:87]
    s_waitcnt lgkmcnt(4)
    v_mfma_f32_16x16x32_bf16 v[28:31], a[24:27], v[100:103], v[28:31]
    v_mfma_f32_16x16x32_bf16 v[48:51], a[104:107], v[100:103], v[48:51]
    ds_read_b64_tr_b16 v[96:97], v13 offset:35872
    v_mfma_f32_16x16x32_bf16 v[68:71], a[184:187], v[100:103], v[68:71]
    ds_read_b64_tr_b16 v[98:99], v13 offset:37152
    v_mfma_f32_16x16x32_bf16 v[88:91], v[200:203], v[100:103], v[88:91]
    s_waitcnt lgkmcnt(4)
    v_mfma_f32_16x16x32_bf16 v[32:35], a[24:27], v[104:107], v[32:35]
    v_mfma_f32_16x16x32_bf16 v[52:55], a[104:107], v[104:107], v[52:55]
    ds_read_b64_tr_b16 v[100:101], v13 offset:35904
    v_mfma_f32_16x16x32_bf16 v[72:75], a[184:187], v[104:107], v[72:75]
    ds_read_b64_tr_b16 v[102:103], v13 offset:37184
    v_mfma_f32_16x16x32_bf16 v[92:95], v[200:203], v[104:107], v[92:95]
    s_waitcnt lgkmcnt(4)
    v_mfma_f32_16x16x32_bf16 v[16:19], a[28:31], v[108:111], v[16:19]
    v_mfma_f32_16x16x32_bf16 v[36:39], a[108:111], v[108:111], v[36:39]
    ds_read_b64_tr_b16 v[104:105], v13 offset:35936
    v_mfma_f32_16x16x32_bf16 v[56:59], a[188:191], v[108:111], v[56:59]
    ds_read_b64_tr_b16 v[106:107], v13 offset:37216
    v_mfma_f32_16x16x32_bf16 v[76:79], v[204:207], v[108:111], v[76:79]
    s_waitcnt lgkmcnt(4)
    v_mfma_f32_16x16x32_bf16 v[20:23], a[28:31], v[96:99], v[20:23]
    v_mfma_f32_16x16x32_bf16 v[40:43], a[108:111], v[96:99], v[40:43]
    ds_read_b64_tr_b16 v[108:109], v13 offset:35968
    v_mfma_f32_16x16x32_bf16 v[60:63], a[188:191], v[96:99], v[60:63]
    ds_read_b64_tr_b16 v[110:111], v13 offset:37248
    v_mfma_f32_16x16x32_bf16 v[80:83], v[204:207], v[96:99], v[80:83]
    s_waitcnt lgkmcnt(4)
    v_mfma_f32_16x16x32_bf16 v[24:27], a[28:31], v[100:103], v[24:27]
    v_mfma_f32_16x16x32_bf16 v[44:47], a[108:111], v[100:103], v[44:47]
    ds_read_b64_tr_b16 v[96:97], v13 offset:40960
    v_mfma_f32_16x16x32_bf16 v[64:67], a[188:191], v[100:103], v[64:67]
    ds_read_b64_tr_b16 v[98:99], v13 offset:42240
    v_mfma_f32_16x16x32_bf16 v[84:87], v[204:207], v[100:103], v[84:87]
    s_waitcnt lgkmcnt(4)
    v_mfma_f32_16x16x32_bf16 v[28:31], a[28:31], v[104:107], v[28:31]
    v_mfma_f32_16x16x32_bf16 v[48:51], a[108:111], v[104:107], v[48:51]
    ds_read_b64_tr_b16 v[100:101], v13 offset:40992
    v_mfma_f32_16x16x32_bf16 v[68:71], a[188:191], v[104:107], v[68:71]
    ds_read_b64_tr_b16 v[102:103], v13 offset:42272
    v_mfma_f32_16x16x32_bf16 v[88:91], v[204:207], v[104:107], v[88:91]
    s_waitcnt lgkmcnt(4)
    v_mfma_f32_16x16x32_bf16 v[32:35], a[28:31], v[108:111], v[32:35]
    v_mfma_f32_16x16x32_bf16 v[52:55], a[108:111], v[108:111], v[52:55]
    ds_read_b64_tr_b16 v[104:105], v13 offset:41024
    v_mfma_f32_16x16x32_bf16 v[72:75], a[188:191], v[108:111], v[72:75]
    ds_read_b64_tr_b16 v[106:107], v13 offset:42304
    v_mfma_f32_16x16x32_bf16 v[92:95], v[204:207], v[108:111], v[92:95]
    s_waitcnt lgkmcnt(4)
    v_mfma_f32_16x16x32_bf16 v[16:19], a[32:35], v[96:99], v[16:19]
    v_mfma_f32_16x16x32_bf16 v[36:39], a[112:115], v[96:99], v[36:39]
    ds_read_b64_tr_b16 v[108:109], v13 offset:41056
    v_mfma_f32_16x16x32_bf16 v[56:59], a[192:195], v[96:99], v[56:59]
    ds_read_b64_tr_b16 v[110:111], v13 offset:42336
    v_mfma_f32_16x16x32_bf16 v[76:79], v[208:211], v[96:99], v[76:79]
    s_waitcnt lgkmcnt(4)
    v_mfma_f32_16x16x32_bf16 v[20:23], a[32:35], v[100:103], v[20:23]
    v_mfma_f32_16x16x32_bf16 v[40:43], a[112:115], v[100:103], v[40:43]
    ds_read_b64_tr_b16 v[96:97], v13 offset:41088
    v_mfma_f32_16x16x32_bf16 v[60:63], a[192:195], v[100:103], v[60:63]
    ds_read_b64_tr_b16 v[98:99], v13 offset:42368
    v_mfma_f32_16x16x32_bf16 v[80:83], v[208:211], v[100:103], v[80:83]
    s_waitcnt lgkmcnt(4)
    v_mfma_f32_16x16x32_bf16 v[24:27], a[32:35], v[104:107], v[24:27]
    v_mfma_f32_16x16x32_bf16 v[44:47], a[112:115], v[104:107], v[44:47]
    ds_read_b64_tr_b16 v[100:101], v13 offset:46080
    v_mfma_f32_16x16x32_bf16 v[64:67], a[192:195], v[104:107], v[64:67]
    ds_read_b64_tr_b16 v[102:103], v13 offset:47360
    v_mfma_f32_16x16x32_bf16 v[84:87], v[208:211], v[104:107], v[84:87]
    s_waitcnt lgkmcnt(4)
    v_mfma_f32_16x16x32_bf16 v[28:31], a[32:35], v[108:111], v[28:31]
    v_mfma_f32_16x16x32_bf16 v[48:51], a[112:115], v[108:111], v[48:51]
    ds_read_b64_tr_b16 v[104:105], v13 offset:46112
    v_mfma_f32_16x16x32_bf16 v[68:71], a[192:195], v[108:111], v[68:71]
    ds_read_b64_tr_b16 v[106:107], v13 offset:47392
    v_mfma_f32_16x16x32_bf16 v[88:91], v[208:211], v[108:111], v[88:91]
    s_waitcnt lgkmcnt(4)
    v_mfma_f32_16x16x32_bf16 v[32:35], a[32:35], v[96:99], v[32:35]
    v_mfma_f32_16x16x32_bf16 v[52:55], a[112:115], v[96:99], v[52:55]
    ds_read_b64_tr_b16 v[108:109], v13 offset:46144
    v_mfma_f32_16x16x32_bf16 v[72:75], a[192:195], v[96:99], v[72:75]
    ds_read_b64_tr_b16 v[110:111], v13 offset:47424
    v_mfma_f32_16x16x32_bf16 v[92:95], v[208:211], v[96:99], v[92:95]
    s_waitcnt lgkmcnt(4)
    v_mfma_f32_16x16x32_bf16 v[16:19], a[36:39], v[100:103], v[16:19]
    v_mfma_f32_16x16x32_bf16 v[36:39], a[116:119], v[100:103], v[36:39]
    ds_read_b64_tr_b16 v[96:97], v13 offset:46176
    v_mfma_f32_16x16x32_bf16 v[56:59], a[196:199], v[100:103], v[56:59]
    ds_read_b64_tr_b16 v[98:99], v13 offset:47456
    v_mfma_f32_16x16x32_bf16 v[76:79], v[212:215], v[100:103], v[76:79]
    s_waitcnt lgkmcnt(4)
    v_mfma_f32_16x16x32_bf16 v[20:23], a[36:39], v[104:107], v[20:23]
    v_mfma_f32_16x16x32_bf16 v[40:43], a[116:119], v[104:107], v[40:43]
    ds_read_b64_tr_b16 v[100:101], v13 offset:46208
    v_mfma_f32_16x16x32_bf16 v[60:63], a[196:199], v[104:107], v[60:63]
    ds_read_b64_tr_b16 v[102:103], v13 offset:47488
    v_mfma_f32_16x16x32_bf16 v[80:83], v[212:215], v[104:107], v[80:83]
    s_waitcnt lgkmcnt(4)
    v_mfma_f32_16x16x32_bf16 v[24:27], a[36:39], v[108:111], v[24:27]
    v_mfma_f32_16x16x32_bf16 v[44:47], a[116:119], v[108:111], v[44:47]
    ds_read_b64_tr_b16 v[104:105], v14 offset:0
    v_mfma_f32_16x16x32_bf16 v[64:67], a[196:199], v[108:111], v[64:67]
    ds_read_b64_tr_b16 v[106:107], v14 offset:1280
    v_mfma_f32_16x16x32_bf16 v[84:87], v[212:215], v[108:111], v[84:87]
    s_waitcnt lgkmcnt(4)
    v_mfma_f32_16x16x32_bf16 v[28:31], a[36:39], v[96:99], v[28:31]
    v_mfma_f32_16x16x32_bf16 v[48:51], a[116:119], v[96:99], v[48:51]
    ds_read_b64_tr_b16 v[108:109], v14 offset:32
    v_mfma_f32_16x16x32_bf16 v[68:71], a[196:199], v[96:99], v[68:71]
    ds_read_b64_tr_b16 v[110:111], v14 offset:1312
    v_mfma_f32_16x16x32_bf16 v[88:91], v[212:215], v[96:99], v[88:91]
    s_waitcnt lgkmcnt(4)
    v_mfma_f32_16x16x32_bf16 v[32:35], a[36:39], v[100:103], v[32:35]
    v_mfma_f32_16x16x32_bf16 v[52:55], a[116:119], v[100:103], v[52:55]
    ds_read_b64_tr_b16 v[96:97], v14 offset:64
    v_mfma_f32_16x16x32_bf16 v[72:75], a[196:199], v[100:103], v[72:75]
    ds_read_b64_tr_b16 v[98:99], v14 offset:1344
    v_mfma_f32_16x16x32_bf16 v[92:95], v[212:215], v[100:103], v[92:95]
    s_waitcnt lgkmcnt(4)
    v_mfma_f32_16x16x32_bf16 v[16:19], a[40:43], v[104:107], v[16:19]
    v_mfma_f32_16x16x32_bf16 v[36:39], a[120:123], v[104:107], v[36:39]
    ds_read_b64_tr_b16 v[100:101], v14 offset:96
    v_mfma_f32_16x16x32_bf16 v[56:59], a[200:203], v[104:107], v[56:59]
    ds_read_b64_tr_b16 v[102:103], v14 offset:1376
    v_mfma_f32_16x16x32_bf16 v[76:79], v[216:219], v[104:107], v[76:79]
    s_waitcnt lgkmcnt(4)
    v_mfma_f32_16x16x32_bf16 v[20:23], a[40:43], v[108:111], v[20:23]
    v_mfma_f32_16x16x32_bf16 v[40:43], a[120:123], v[108:111], v[40:43]
    ds_read_b64_tr_b16 v[104:105], v14 offset:128
    v_mfma_f32_16x16x32_bf16 v[60:63], a[200:203], v[108:111], v[60:63]
    ds_read_b64_tr_b16 v[106:107], v14 offset:1408
    v_mfma_f32_16x16x32_bf16 v[80:83], v[216:219], v[108:111], v[80:83]
    s_waitcnt lgkmcnt(4)
    v_mfma_f32_16x16x32_bf16 v[24:27], a[40:43], v[96:99], v[24:27]
    v_mfma_f32_16x16x32_bf16 v[44:47], a[120:123], v[96:99], v[44:47]
    ds_read_b64_tr_b16 v[108:109], v14 offset:5120
    v_mfma_f32_16x16x32_bf16 v[64:67], a[200:203], v[96:99], v[64:67]
    ds_read_b64_tr_b16 v[110:111], v14 offset:6400
    v_mfma_f32_16x16x32_bf16 v[84:87], v[216:219], v[96:99], v[84:87]
    s_waitcnt lgkmcnt(4)
    v_mfma_f32_16x16x32_bf16 v[28:31], a[40:43], v[100:103], v[28:31]
    v_mfma_f32_16x16x32_bf16 v[48:51], a[120:123], v[100:103], v[48:51]
    ds_read_b64_tr_b16 v[96:97], v14 offset:5152
    v_mfma_f32_16x16x32_bf16 v[68:71], a[200:203], v[100:103], v[68:71]
    ds_read_b64_tr_b16 v[98:99], v14 offset:6432
    v_mfma_f32_16x16x32_bf16 v[88:91], v[216:219], v[100:103], v[88:91]
    s_waitcnt lgkmcnt(4)
    v_mfma_f32_16x16x32_bf16 v[32:35], a[40:43], v[104:107], v[32:35]
    v_mfma_f32_16x16x32_bf16 v[52:55], a[120:123], v[104:107], v[52:55]
    ds_read_b64_tr_b16 v[100:101], v14 offset:5184
    v_mfma_f32_16x16x32_bf16 v[72:75], a[200:203], v[104:107], v[72:75]
    ds_read_b64_tr_b16 v[102:103], v14 offset:6464
    v_mfma_f32_16x16x32_bf16 v[92:95], v[216:219], v[104:107], v[92:95]
    s_waitcnt lgkmcnt(4)
    v_mfma_f32_16x16x32_bf16 v[16:19], a[44:47], v[108:111], v[16:19]
    v_mfma_f32_16x16x32_bf16 v[36:39], a[124:127], v[108:111], v[36:39]
    ds_read_b64_tr_b16 v[104:105], v14 offset:5216
    v_mfma_f32_16x16x32_bf16 v[56:59], a[204:207], v[108:111], v[56:59]
    ds_read_b64_tr_b16 v[106:107], v14 offset:6496
    v_mfma_f32_16x16x32_bf16 v[76:79], v[220:223], v[108:111], v[76:79]
    s_waitcnt lgkmcnt(4)
    v_mfma_f32_16x16x32_bf16 v[20:23], a[44:47], v[96:99], v[20:23]
    v_mfma_f32_16x16x32_bf16 v[40:43], a[124:127], v[96:99], v[40:43]
    ds_read_b64_tr_b16 v[108:109], v14 offset:5248
    v_mfma_f32_16x16x32_bf16 v[60:63], a[204:207], v[96:99], v[60:63]
    ds_read_b64_tr_b16 v[110:111], v14 offset:6528
    v_mfma_f32_16x16x32_bf16 v[80:83], v[220:223], v[96:99], v[80:83]
    s_waitcnt lgkmcnt(4)
    v_mfma_f32_16x16x32_bf16 v[24:27], a[44:47], v[100:103], v[24:27]
    v_mfma_f32_16x16x32_bf16 v[44:47], a[124:127], v[100:103], v[44:47]
    ds_read_b64_tr_b16 v[96:97], v14 offset:10240
    v_mfma_f32_16x16x32_bf16 v[64:67], a[204:207], v[100:103], v[64:67]
    ds_read_b64_tr_b16 v[98:99], v14 offset:11520
    v_mfma_f32_16x16x32_bf16 v[84:87], v[220:223], v[100:103], v[84:87]
    s_waitcnt lgkmcnt(4)
    v_mfma_f32_16x16x32_bf16 v[28:31], a[44:47], v[104:107], v[28:31]
    v_mfma_f32_16x16x32_bf16 v[48:51], a[124:127], v[104:107], v[48:51]
    ds_read_b64_tr_b16 v[100:101], v14 offset:10272
    v_mfma_f32_16x16x32_bf16 v[68:71], a[204:207], v[104:107], v[68:71]
    ds_read_b64_tr_b16 v[102:103], v14 offset:11552
    v_mfma_f32_16x16x32_bf16 v[88:91], v[220:223], v[104:107], v[88:91]
    s_waitcnt lgkmcnt(4)
    v_mfma_f32_16x16x32_bf16 v[32:35], a[44:47], v[108:111], v[32:35]
    v_mfma_f32_16x16x32_bf16 v[52:55], a[124:127], v[108:111], v[52:55]
    ds_read_b64_tr_b16 v[104:105], v14 offset:10304
    v_mfma_f32_16x16x32_bf16 v[72:75], a[204:207], v[108:111], v[72:75]
    ds_read_b64_tr_b16 v[106:107], v14 offset:11584
    v_mfma_f32_16x16x32_bf16 v[92:95], v[220:223], v[108:111], v[92:95]
    s_waitcnt lgkmcnt(4)
    v_mfma_f32_16x16x32_bf16 v[16:19], a[48:51], v[96:99], v[16:19]
    v_mfma_f32_16x16x32_bf16 v[36:39], a[128:131], v[96:99], v[36:39]
    ds_read_b64_tr_b16 v[108:109], v14 offset:10336
    v_mfma_f32_16x16x32_bf16 v[56:59], a[208:211], v[96:99], v[56:59]
    ds_read_b64_tr_b16 v[110:111], v14 offset:11616
    v_mfma_f32_16x16x32_bf16 v[76:79], v[224:227], v[96:99], v[76:79]
    s_waitcnt lgkmcnt(4)
    v_mfma_f32_16x16x32_bf16 v[20:23], a[48:51], v[100:103], v[20:23]
    v_mfma_f32_16x16x32_bf16 v[40:43], a[128:131], v[100:103], v[40:43]
    ds_read_b64_tr_b16 v[96:97], v14 offset:10368
    v_mfma_f32_16x16x32_bf16 v[60:63], a[208:211], v[100:103], v[60:63]
    ds_read_b64_tr_b16 v[98:99], v14 offset:11648
    v_mfma_f32_16x16x32_bf16 v[80:83], v[224:227], v[100:103], v[80:83]
    s_waitcnt lgkmcnt(4)
    v_mfma_f32_16x16x32_bf16 v[24:27], a[48:51], v[104:107], v[24:27]
    v_mfma_f32_16x16x32_bf16 v[44:47], a[128:131], v[104:107], v[44:47]
    ds_read_b64_tr_b16 v[100:101], v14 offset:15360
    v_mfma_f32_16x16x32_bf16 v[64:67], a[208:211], v[104:107], v[64:67]
    ds_read_b64_tr_b16 v[102:103], v14 offset:16640
    v_mfma_f32_16x16x32_bf16 v[84:87], v[224:227], v[104:107], v[84:87]
    s_waitcnt lgkmcnt(4)
    v_mfma_f32_16x16x32_bf16 v[28:31], a[48:51], v[108:111], v[28:31]
    v_mfma_f32_16x16x32_bf16 v[48:51], a[128:131], v[108:111], v[48:51]
    ds_read_b64_tr_b16 v[104:105], v14 offset:15392
    v_mfma_f32_16x16x32_bf16 v[68:71], a[208:211], v[108:111], v[68:71]
    ds_read_b64_tr_b16 v[106:107], v14 offset:16672
    v_mfma_f32_16x16x32_bf16 v[88:91], v[224:227], v[108:111], v[88:91]
    s_waitcnt lgkmcnt(4)
    v_mfma_f32_16x16x32_bf16 v[32:35], a[48:51], v[96:99], v[32:35]
    v_mfma_f32_16x16x32_bf16 v[52:55], a[128:131], v[96:99], v[52:55]
    ds_read_b64_tr_b16 v[108:109], v14 offset:15424
    v_mfma_f32_16x16x32_bf16 v[72:75], a[208:211], v[96:99], v[72:75]
    ds_read_b64_tr_b16 v[110:111], v14 offset:16704
    v_mfma_f32_16x16x32_bf16 v[92:95], v[224:227], v[96:99], v[92:95]
    s_waitcnt lgkmcnt(4)
    v_mfma_f32_16x16x32_bf16 v[16:19], a[52:55], v[100:103], v[16:19]
    v_mfma_f32_16x16x32_bf16 v[36:39], a[132:135], v[100:103], v[36:39]
    ds_read_b64_tr_b16 v[96:97], v14 offset:15456
    v_mfma_f32_16x16x32_bf16 v[56:59], a[212:215], v[100:103], v[56:59]
    ds_read_b64_tr_b16 v[98:99], v14 offset:16736
    v_mfma_f32_16x16x32_bf16 v[76:79], v[228:231], v[100:103], v[76:79]
    s_waitcnt lgkmcnt(4)
    v_mfma_f32_16x16x32_bf16 v[20:23], a[52:55], v[104:107], v[20:23]
    v_mfma_f32_16x16x32_bf16 v[40:43], a[132:135], v[104:107], v[40:43]
    ds_read_b64_tr_b16 v[100:101], v14 offset:15488
    v_mfma_f32_16x16x32_bf16 v[60:63], a[212:215], v[104:107], v[60:63]
    ds_read_b64_tr_b16 v[102:103], v14 offset:16768
    v_mfma_f32_16x16x32_bf16 v[80:83], v[228:231], v[104:107], v[80:83]
    s_waitcnt lgkmcnt(4)
    v_mfma_f32_16x16x32_bf16 v[24:27], a[52:55], v[108:111], v[24:27]
    v_mfma_f32_16x16x32_bf16 v[44:47], a[132:135], v[108:111], v[44:47]
    ds_read_b64_tr_b16 v[104:105], v14 offset:20480
    v_mfma_f32_16x16x32_bf16 v[64:67], a[212:215], v[108:111], v[64:67]
    ds_read_b64_tr_b16 v[106:107], v14 offset:21760
    v_mfma_f32_16x16x32_bf16 v[84:87], v[228:231], v[108:111], v[84:87]
    s_waitcnt lgkmcnt(4)
    v_mfma_f32_16x16x32_bf16 v[28:31], a[52:55], v[96:99], v[28:31]
    v_mfma_f32_16x16x32_bf16 v[48:51], a[132:135], v[96:99], v[48:51]
    ds_read_b64_tr_b16 v[108:109], v14 offset:20512
    v_mfma_f32_16x16x32_bf16 v[68:71], a[212:215], v[96:99], v[68:71]
    ds_read_b64_tr_b16 v[110:111], v14 offset:21792
    v_mfma_f32_16x16x32_bf16 v[88:91], v[228:231], v[96:99], v[88:91]
    s_waitcnt lgkmcnt(4)
    v_mfma_f32_16x16x32_bf16 v[32:35], a[52:55], v[100:103], v[32:35]
    v_mfma_f32_16x16x32_bf16 v[52:55], a[132:135], v[100:103], v[52:55]
    ds_read_b64_tr_b16 v[96:97], v14 offset:20544
    v_mfma_f32_16x16x32_bf16 v[72:75], a[212:215], v[100:103], v[72:75]
    ds_read_b64_tr_b16 v[98:99], v14 offset:21824
    v_mfma_f32_16x16x32_bf16 v[92:95], v[228:231], v[100:103], v[92:95]
    s_waitcnt lgkmcnt(4)
    v_mfma_f32_16x16x32_bf16 v[16:19], a[56:59], v[104:107], v[16:19]
    v_mfma_f32_16x16x32_bf16 v[36:39], a[136:139], v[104:107], v[36:39]
    ds_read_b64_tr_b16 v[100:101], v14 offset:20576
    v_mfma_f32_16x16x32_bf16 v[56:59], a[216:219], v[104:107], v[56:59]
    ds_read_b64_tr_b16 v[102:103], v14 offset:21856
    v_mfma_f32_16x16x32_bf16 v[76:79], v[232:235], v[104:107], v[76:79]
    s_waitcnt lgkmcnt(4)
    v_mfma_f32_16x16x32_bf16 v[20:23], a[56:59], v[108:111], v[20:23]
    v_mfma_f32_16x16x32_bf16 v[40:43], a[136:139], v[108:111], v[40:43]
    ds_read_b64_tr_b16 v[104:105], v14 offset:20608
    v_mfma_f32_16x16x32_bf16 v[60:63], a[216:219], v[108:111], v[60:63]
    ds_read_b64_tr_b16 v[106:107], v14 offset:21888
    v_mfma_f32_16x16x32_bf16 v[80:83], v[232:235], v[108:111], v[80:83]
    s_waitcnt lgkmcnt(4)
    v_mfma_f32_16x16x32_bf16 v[24:27], a[56:59], v[96:99], v[24:27]
    v_mfma_f32_16x16x32_bf16 v[44:47], a[136:139], v[96:99], v[44:47]
    ds_read_b64_tr_b16 v[108:109], v14 offset:25600
    v_mfma_f32_16x16x32_bf16 v[64:67], a[216:219], v[96:99], v[64:67]
    ds_read_b64_tr_b16 v[110:111], v14 offset:26880
    v_mfma_f32_16x16x32_bf16 v[84:87], v[232:235], v[96:99], v[84:87]
    s_waitcnt lgkmcnt(4)
    v_mfma_f32_16x16x32_bf16 v[28:31], a[56:59], v[100:103], v[28:31]
    v_mfma_f32_16x16x32_bf16 v[48:51], a[136:139], v[100:103], v[48:51]
    ds_read_b64_tr_b16 v[96:97], v14 offset:25632
    v_mfma_f32_16x16x32_bf16 v[68:71], a[216:219], v[100:103], v[68:71]
    ds_read_b64_tr_b16 v[98:99], v14 offset:26912
    v_mfma_f32_16x16x32_bf16 v[88:91], v[232:235], v[100:103], v[88:91]
    s_waitcnt lgkmcnt(4)
    v_mfma_f32_16x16x32_bf16 v[32:35], a[56:59], v[104:107], v[32:35]
    v_mfma_f32_16x16x32_bf16 v[52:55], a[136:139], v[104:107], v[52:55]
    ds_read_b64_tr_b16 v[100:101], v14 offset:25664
    v_mfma_f32_16x16x32_bf16 v[72:75], a[216:219], v[104:107], v[72:75]
    ds_read_b64_tr_b16 v[102:103], v14 offset:26944
    v_mfma_f32_16x16x32_bf16 v[92:95], v[232:235], v[104:107], v[92:95]
    s_waitcnt lgkmcnt(4)
    v_mfma_f32_16x16x32_bf16 v[16:19], a[60:63], v[108:111], v[16:19]
    v_mfma_f32_16x16x32_bf16 v[36:39], a[140:143], v[108:111], v[36:39]
    ds_read_b64_tr_b16 v[104:105], v14 offset:25696
    v_mfma_f32_16x16x32_bf16 v[56:59], a[220:223], v[108:111], v[56:59]
    ds_read_b64_tr_b16 v[106:107], v14 offset:26976
    v_mfma_f32_16x16x32_bf16 v[76:79], v[236:239], v[108:111], v[76:79]
    s_waitcnt lgkmcnt(4)
    v_mfma_f32_16x16x32_bf16 v[20:23], a[60:63], v[96:99], v[20:23]
    v_mfma_f32_16x16x32_bf16 v[40:43], a[140:143], v[96:99], v[40:43]
    ds_read_b64_tr_b16 v[108:109], v14 offset:25728
    v_mfma_f32_16x16x32_bf16 v[60:63], a[220:223], v[96:99], v[60:63]
    ds_read_b64_tr_b16 v[110:111], v14 offset:27008
    v_mfma_f32_16x16x32_bf16 v[80:83], v[236:239], v[96:99], v[80:83]
    s_waitcnt lgkmcnt(4)
    v_mfma_f32_16x16x32_bf16 v[24:27], a[60:63], v[100:103], v[24:27]
    v_mfma_f32_16x16x32_bf16 v[44:47], a[140:143], v[100:103], v[44:47]
    ds_read_b64_tr_b16 v[96:97], v14 offset:30720
    v_mfma_f32_16x16x32_bf16 v[64:67], a[220:223], v[100:103], v[64:67]
    ds_read_b64_tr_b16 v[98:99], v14 offset:32000
    v_mfma_f32_16x16x32_bf16 v[84:87], v[236:239], v[100:103], v[84:87]
    s_waitcnt lgkmcnt(4)
    v_mfma_f32_16x16x32_bf16 v[28:31], a[60:63], v[104:107], v[28:31]
    v_mfma_f32_16x16x32_bf16 v[48:51], a[140:143], v[104:107], v[48:51]
    ds_read_b64_tr_b16 v[100:101], v14 offset:30752
    v_mfma_f32_16x16x32_bf16 v[68:71], a[220:223], v[104:107], v[68:71]
    ds_read_b64_tr_b16 v[102:103], v14 offset:32032
    v_mfma_f32_16x16x32_bf16 v[88:91], v[236:239], v[104:107], v[88:91]
    s_waitcnt lgkmcnt(4)
    v_mfma_f32_16x16x32_bf16 v[32:35], a[60:63], v[108:111], v[32:35]
    v_mfma_f32_16x16x32_bf16 v[52:55], a[140:143], v[108:111], v[52:55]
    ds_read_b64_tr_b16 v[104:105], v14 offset:30784
    v_mfma_f32_16x16x32_bf16 v[72:75], a[220:223], v[108:111], v[72:75]
    ds_read_b64_tr_b16 v[106:107], v14 offset:32064
    v_mfma_f32_16x16x32_bf16 v[92:95], v[236:239], v[108:111], v[92:95]
    s_waitcnt lgkmcnt(4)
    v_mfma_f32_16x16x32_bf16 v[16:19], a[64:67], v[96:99], v[16:19]
    v_mfma_f32_16x16x32_bf16 v[36:39], a[144:147], v[96:99], v[36:39]
    ds_read_b64_tr_b16 v[108:109], v14 offset:30816
    v_mfma_f32_16x16x32_bf16 v[56:59], a[224:227], v[96:99], v[56:59]
    ds_read_b64_tr_b16 v[110:111], v14 offset:32096
    v_mfma_f32_16x16x32_bf16 v[76:79], v[240:243], v[96:99], v[76:79]
    s_waitcnt lgkmcnt(4)
    v_mfma_f32_16x16x32_bf16 v[20:23], a[64:67], v[100:103], v[20:23]
    v_mfma_f32_16x16x32_bf16 v[40:43], a[144:147], v[100:103], v[40:43]
    ds_read_b64_tr_b16 v[96:97], v14 offset:30848
    v_mfma_f32_16x16x32_bf16 v[60:63], a[224:227], v[100:103], v[60:63]
    ds_read_b64_tr_b16 v[98:99], v14 offset:32128
    v_mfma_f32_16x16x32_bf16 v[80:83], v[240:243], v[100:103], v[80:83]
    s_waitcnt lgkmcnt(4)
    v_mfma_f32_16x16x32_bf16 v[24:27], a[64:67], v[104:107], v[24:27]
    v_mfma_f32_16x16x32_bf16 v[44:47], a[144:147], v[104:107], v[44:47]
    ds_read_b64_tr_b16 v[100:101], v14 offset:35840
    v_mfma_f32_16x16x32_bf16 v[64:67], a[224:227], v[104:107], v[64:67]
    ds_read_b64_tr_b16 v[102:103], v14 offset:37120
    v_mfma_f32_16x16x32_bf16 v[84:87], v[240:243], v[104:107], v[84:87]
    s_waitcnt lgkmcnt(4)
    v_mfma_f32_16x16x32_bf16 v[28:31], a[64:67], v[108:111], v[28:31]
    v_mfma_f32_16x16x32_bf16 v[48:51], a[144:147], v[108:111], v[48:51]
    ds_read_b64_tr_b16 v[104:105], v14 offset:35872
    v_mfma_f32_16x16x32_bf16 v[68:71], a[224:227], v[108:111], v[68:71]
    ds_read_b64_tr_b16 v[106:107], v14 offset:37152
    v_mfma_f32_16x16x32_bf16 v[88:91], v[240:243], v[108:111], v[88:91]
    s_waitcnt lgkmcnt(4)
    v_mfma_f32_16x16x32_bf16 v[32:35], a[64:67], v[96:99], v[32:35]
    v_mfma_f32_16x16x32_bf16 v[52:55], a[144:147], v[96:99], v[52:55]
    ds_read_b64_tr_b16 v[108:109], v14 offset:35904
    v_mfma_f32_16x16x32_bf16 v[72:75], a[224:227], v[96:99], v[72:75]
    ds_read_b64_tr_b16 v[110:111], v14 offset:37184
    v_mfma_f32_16x16x32_bf16 v[92:95], v[240:243], v[96:99], v[92:95]
    s_waitcnt lgkmcnt(4)
    v_mfma_f32_16x16x32_bf16 v[16:19], a[68:71], v[100:103], v[16:19]
    v_mfma_f32_16x16x32_bf16 v[36:39], a[148:151], v[100:103], v[36:39]
    ds_read_b64_tr_b16 v[96:97], v14 offset:35936
    v_mfma_f32_16x16x32_bf16 v[56:59], a[228:231], v[100:103], v[56:59]
    ds_read_b64_tr_b16 v[98:99], v14 offset:37216
    v_mfma_f32_16x16x32_bf16 v[76:79], v[244:247], v[100:103], v[76:79]
    s_waitcnt lgkmcnt(4)
    v_mfma_f32_16x16x32_bf16 v[20:23], a[68:71], v[104:107], v[20:23]
    v_mfma_f32_16x16x32_bf16 v[40:43], a[148:151], v[104:107], v[40:43]
    ds_read_b64_tr_b16 v[100:101], v14 offset:35968
    v_mfma_f32_16x16x32_bf16 v[60:63], a[228:231], v[104:107], v[60:63]
    ds_read_b64_tr_b16 v[102:103], v14 offset:37248
    v_mfma_f32_16x16x32_bf16 v[80:83], v[244:247], v[104:107], v[80:83]
    s_waitcnt lgkmcnt(4)
    v_mfma_f32_16x16x32_bf16 v[24:27], a[68:71], v[108:111], v[24:27]
    v_mfma_f32_16x16x32_bf16 v[44:47], a[148:151], v[108:111], v[44:47]
    ds_read_b64_tr_b16 v[104:105], v14 offset:40960
    v_mfma_f32_16x16x32_bf16 v[64:67], a[228:231], v[108:111], v[64:67]
    ds_read_b64_tr_b16 v[106:107], v14 offset:42240
    v_mfma_f32_16x16x32_bf16 v[84:87], v[244:247], v[108:111], v[84:87]
    s_waitcnt lgkmcnt(4)
    v_mfma_f32_16x16x32_bf16 v[28:31], a[68:71], v[96:99], v[28:31]
    v_mfma_f32_16x16x32_bf16 v[48:51], a[148:151], v[96:99], v[48:51]
    ds_read_b64_tr_b16 v[108:109], v14 offset:40992
    v_mfma_f32_16x16x32_bf16 v[68:71], a[228:231], v[96:99], v[68:71]
    ds_read_b64_tr_b16 v[110:111], v14 offset:42272
    v_mfma_f32_16x16x32_bf16 v[88:91], v[244:247], v[96:99], v[88:91]
    s_waitcnt lgkmcnt(4)
    v_mfma_f32_16x16x32_bf16 v[32:35], a[68:71], v[100:103], v[32:35]
    v_mfma_f32_16x16x32_bf16 v[52:55], a[148:151], v[100:103], v[52:55]
    ds_read_b64_tr_b16 v[96:97], v14 offset:41024
    v_mfma_f32_16x16x32_bf16 v[72:75], a[228:231], v[100:103], v[72:75]
    ds_read_b64_tr_b16 v[98:99], v14 offset:42304
    v_mfma_f32_16x16x32_bf16 v[92:95], v[244:247], v[100:103], v[92:95]
    s_waitcnt lgkmcnt(4)
    v_mfma_f32_16x16x32_bf16 v[16:19], a[72:75], v[104:107], v[16:19]
    v_mfma_f32_16x16x32_bf16 v[36:39], a[152:155], v[104:107], v[36:39]
    ds_read_b64_tr_b16 v[100:101], v14 offset:41056
    v_mfma_f32_16x16x32_bf16 v[56:59], a[232:235], v[104:107], v[56:59]
    ds_read_b64_tr_b16 v[102:103], v14 offset:42336
    v_mfma_f32_16x16x32_bf16 v[76:79], v[248:251], v[104:107], v[76:79]
    s_waitcnt lgkmcnt(4)
    v_mfma_f32_16x16x32_bf16 v[20:23], a[72:75], v[108:111], v[20:23]
    v_mfma_f32_16x16x32_bf16 v[40:43], a[152:155], v[108:111], v[40:43]
    ds_read_b64_tr_b16 v[104:105], v14 offset:41088
    v_mfma_f32_16x16x32_bf16 v[60:63], a[232:235], v[108:111], v[60:63]
    ds_read_b64_tr_b16 v[106:107], v14 offset:42368
    v_mfma_f32_16x16x32_bf16 v[80:83], v[248:251], v[108:111], v[80:83]
    s_waitcnt lgkmcnt(4)
    v_mfma_f32_16x16x32_bf16 v[24:27], a[72:75], v[96:99], v[24:27]
    v_mfma_f32_16x16x32_bf16 v[44:47], a[152:155], v[96:99], v[44:47]
    ds_read_b64_tr_b16 v[108:109], v14 offset:46080
    v_mfma_f32_16x16x32_bf16 v[64:67], a[232:235], v[96:99], v[64:67]
    ds_read_b64_tr_b16 v[110:111], v14 offset:47360
    v_mfma_f32_16x16x32_bf16 v[84:87], v[248:251], v[96:99], v[84:87]
    s_waitcnt lgkmcnt(4)
    v_mfma_f32_16x16x32_bf16 v[28:31], a[72:75], v[100:103], v[28:31]
    v_mfma_f32_16x16x32_bf16 v[48:51], a[152:155], v[100:103], v[48:51]
    ds_read_b64_tr_b16 v[96:97], v14 offset:46112
    v_mfma_f32_16x16x32_bf16 v[68:71], a[232:235], v[100:103], v[68:71]
    ds_read_b64_tr_b16 v[98:99], v14 offset:47392
    v_mfma_f32_16x16x32_bf16 v[88:91], v[248:251], v[100:103], v[88:91]
    s_waitcnt lgkmcnt(4)
    v_mfma_f32_16x16x32_bf16 v[32:35], a[72:75], v[104:107], v[32:35]
    v_mfma_f32_16x16x32_bf16 v[52:55], a[152:155], v[104:107], v[52:55]
    ds_read_b64_tr_b16 v[100:101], v14 offset:46144
    v_mfma_f32_16x16x32_bf16 v[72:75], a[232:235], v[104:107], v[72:75]
    ds_read_b64_tr_b16 v[102:103], v14 offset:47424
    v_mfma_f32_16x16x32_bf16 v[92:95], v[248:251], v[104:107], v[92:95]
    s_waitcnt lgkmcnt(4)
    v_mfma_f32_16x16x32_bf16 v[16:19], a[76:79], v[108:111], v[16:19]
    v_mfma_f32_16x16x32_bf16 v[36:39], a[156:159], v[108:111], v[36:39]
    ds_read_b64_tr_b16 v[104:105], v14 offset:46176
    v_mfma_f32_16x16x32_bf16 v[56:59], a[236:239], v[108:111], v[56:59]
    ds_read_b64_tr_b16 v[106:107], v14 offset:47456
    v_mfma_f32_16x16x32_bf16 v[76:79], v[252:255], v[108:111], v[76:79]
    s_waitcnt lgkmcnt(4)
    v_mfma_f32_16x16x32_bf16 v[20:23], a[76:79], v[96:99], v[20:23]
    v_mfma_f32_16x16x32_bf16 v[40:43], a[156:159], v[96:99], v[40:43]
    ds_read_b64_tr_b16 v[108:109], v14 offset:46208
    v_mfma_f32_16x16x32_bf16 v[60:63], a[236:239], v[96:99], v[60:63]
    ds_read_b64_tr_b16 v[110:111], v14 offset:47488
    v_mfma_f32_16x16x32_bf16 v[80:83], v[252:255], v[96:99], v[80:83]
    s_waitcnt lgkmcnt(4)
    v_mfma_f32_16x16x32_bf16 v[24:27], a[76:79], v[100:103], v[24:27]
    v_mfma_f32_16x16x32_bf16 v[44:47], a[156:159], v[100:103], v[44:47]
    v_mfma_f32_16x16x32_bf16 v[64:67], a[236:239], v[100:103], v[64:67]
    v_mfma_f32_16x16x32_bf16 v[84:87], v[252:255], v[100:103], v[84:87]
    s_waitcnt lgkmcnt(2)
    v_mfma_f32_16x16x32_bf16 v[28:31], a[76:79], v[104:107], v[28:31]
    v_mfma_f32_16x16x32_bf16 v[48:51], a[156:159], v[104:107], v[48:51]
    v_mfma_f32_16x16x32_bf16 v[68:71], a[236:239], v[104:107], v[68:71]
    v_mfma_f32_16x16x32_bf16 v[88:91], v[252:255], v[104:107], v[88:91]
    s_waitcnt lgkmcnt(0)
    v_mfma_f32_16x16x32_bf16 v[32:35], a[76:79], v[108:111], v[32:35]
    v_mfma_f32_16x16x32_bf16 v[52:55], a[156:159], v[108:111], v[52:55]
    v_mfma_f32_16x16x32_bf16 v[72:75], a[236:239], v[108:111], v[72:75]
    v_mfma_f32_16x16x32_bf16 v[92:95], v[252:255], v[108:111], v[92:95]
    s_lshl_b32 s68, s66, 6
    s_lshl_b32 s6, s64, 19
    s_add_u32 s68, s68, s6
    s_add_u32 s68, s68, 125829120
    v_add_u32 v2, 0, v5
    v_mul_u32_u24 v3, 205, v2
    v_lshrrev_b32 v3, 12, v3
    v_mul_u32_u24 v7, 20, v3
    v_sub_u32 v2, v2, v7
    v_lshlrev_b32 v3, 17, v3
    v_lshl_add_u32 v3, v2, 4, v3
    v_and_b32 v2, 1, v4
    v_lshl_add_u32 v3, v2, 9, v3
    v_lshrrev_b32 v2, 1, v4
    v_lshl_add_u32 v7, v2, 3, v3
    v_cvt_pk_bf16_f32 v16, v16, v17
    v_cvt_pk_bf16_f32 v17, v18, v19
    buffer_store_dwordx2 v[16:17], v7, s[8:11], s68 offen offset:0 sc1
    v_cvt_pk_bf16_f32 v36, v36, v37
    v_cvt_pk_bf16_f32 v37, v38, v39
    buffer_store_dwordx2 v[36:37], v7, s[8:11], s68 offen offset:1024 sc1
    v_cvt_pk_bf16_f32 v56, v56, v57
    v_cvt_pk_bf16_f32 v57, v58, v59
    buffer_store_dwordx2 v[56:57], v7, s[8:11], s68 offen offset:2048 sc1
    v_cvt_pk_bf16_f32 v76, v76, v77
    v_cvt_pk_bf16_f32 v77, v78, v79
    buffer_store_dwordx2 v[76:77], v7, s[8:11], s68 offen offset:3072 sc1
    v_add_u32 v2, 16, v5
    v_mul_u32_u24 v3, 205, v2
    v_lshrrev_b32 v3, 12, v3
    v_mul_u32_u24 v7, 20, v3
    v_sub_u32 v2, v2, v7
    v_lshlrev_b32 v3, 17, v3
    v_lshl_add_u32 v3, v2, 4, v3
    v_and_b32 v2, 1, v4
    v_lshl_add_u32 v3, v2, 9, v3
    v_lshrrev_b32 v2, 1, v4
    v_lshl_add_u32 v7, v2, 3, v3
    v_cvt_pk_bf16_f32 v20, v20, v21
    v_cvt_pk_bf16_f32 v21, v22, v23
    buffer_store_dwordx2 v[20:21], v7, s[8:11], s68 offen offset:0 sc1
    v_cvt_pk_bf16_f32 v40, v40, v41
    v_cvt_pk_bf16_f32 v41, v42, v43
    buffer_store_dwordx2 v[40:41], v7, s[8:11], s68 offen offset:1024 sc1
    v_cvt_pk_bf16_f32 v60, v60, v61
    v_cvt_pk_bf16_f32 v61, v62, v63
    buffer_store_dwordx2 v[60:61], v7, s[8:11], s68 offen offset:2048 sc1
    v_cvt_pk_bf16_f32 v80, v80, v81
    v_cvt_pk_bf16_f32 v81, v82, v83
    buffer_store_dwordx2 v[80:81], v7, s[8:11], s68 offen offset:3072 sc1
    v_add_u32 v2, 32, v5
    v_mul_u32_u24 v3, 205, v2
    v_lshrrev_b32 v3, 12, v3
    v_mul_u32_u24 v7, 20, v3
    v_sub_u32 v2, v2, v7
    v_lshlrev_b32 v3, 17, v3
    v_lshl_add_u32 v3, v2, 4, v3
    v_and_b32 v2, 1, v4
    v_lshl_add_u32 v3, v2, 9, v3
    v_lshrrev_b32 v2, 1, v4
    v_lshl_add_u32 v7, v2, 3, v3
    v_cvt_pk_bf16_f32 v24, v24, v25
    v_cvt_pk_bf16_f32 v25, v26, v27
    buffer_store_dwordx2 v[24:25], v7, s[8:11], s68 offen offset:0 sc1
    v_cvt_pk_bf16_f32 v44, v44, v45
    v_cvt_pk_bf16_f32 v45, v46, v47
    buffer_store_dwordx2 v[44:45], v7, s[8:11], s68 offen offset:1024 sc1
    v_cvt_pk_bf16_f32 v64, v64, v65
    v_cvt_pk_bf16_f32 v65, v66, v67
    buffer_store_dwordx2 v[64:65], v7, s[8:11], s68 offen offset:2048 sc1
    v_cvt_pk_bf16_f32 v84, v84, v85
    v_cvt_pk_bf16_f32 v85, v86, v87
    buffer_store_dwordx2 v[84:85], v7, s[8:11], s68 offen offset:3072 sc1
    v_add_u32 v2, 48, v5
    v_mul_u32_u24 v3, 205, v2
    v_lshrrev_b32 v3, 12, v3
    v_mul_u32_u24 v7, 20, v3
    v_sub_u32 v2, v2, v7
    v_lshlrev_b32 v3, 17, v3
    v_lshl_add_u32 v3, v2, 4, v3
    v_and_b32 v2, 1, v4
    v_lshl_add_u32 v3, v2, 9, v3
    v_lshrrev_b32 v2, 1, v4
    v_lshl_add_u32 v7, v2, 3, v3
    v_cvt_pk_bf16_f32 v28, v28, v29
    v_cvt_pk_bf16_f32 v29, v30, v31
    buffer_store_dwordx2 v[28:29], v7, s[8:11], s68 offen offset:0 sc1
    v_cvt_pk_bf16_f32 v48, v48, v49
    v_cvt_pk_bf16_f32 v49, v50, v51
    buffer_store_dwordx2 v[48:49], v7, s[8:11], s68 offen offset:1024 sc1
    v_cvt_pk_bf16_f32 v68, v68, v69
    v_cvt_pk_bf16_f32 v69, v70, v71
    buffer_store_dwordx2 v[68:69], v7, s[8:11], s68 offen offset:2048 sc1
    v_cvt_pk_bf16_f32 v88, v88, v89
    v_cvt_pk_bf16_f32 v89, v90, v91
    buffer_store_dwordx2 v[88:89], v7, s[8:11], s68 offen offset:3072 sc1
    v_add_u32 v2, 64, v5
    v_mul_u32_u24 v3, 205, v2
    v_lshrrev_b32 v3, 12, v3
    v_mul_u32_u24 v7, 20, v3
    v_sub_u32 v2, v2, v7
    v_lshlrev_b32 v3, 17, v3
    v_lshl_add_u32 v3, v2, 4, v3
    v_and_b32 v2, 1, v4
    v_lshl_add_u32 v3, v2, 9, v3
    v_lshrrev_b32 v2, 1, v4
    v_lshl_add_u32 v7, v2, 3, v3
    v_cvt_pk_bf16_f32 v32, v32, v33
    v_cvt_pk_bf16_f32 v33, v34, v35
    buffer_store_dwordx2 v[32:33], v7, s[8:11], s68 offen offset:0 sc1
    v_cvt_pk_bf16_f32 v52, v52, v53
    v_cvt_pk_bf16_f32 v53, v54, v55
    buffer_store_dwordx2 v[52:53], v7, s[8:11], s68 offen offset:1024 sc1
    v_cvt_pk_bf16_f32 v72, v72, v73
    v_cvt_pk_bf16_f32 v73, v74, v75
    buffer_store_dwordx2 v[72:73], v7, s[8:11], s68 offen offset:2048 sc1
    v_cvt_pk_bf16_f32 v92, v92, v93
    v_cvt_pk_bf16_f32 v93, v94, v95
    buffer_store_dwordx2 v[92:93], v7, s[8:11], s68 offen offset:3072 sc1
    s_lshl_b32 s33, s64, 5
    s_add_u32 s33, s33, 4
    s_waitcnt vmcnt(0)
    s_barrier
    s_cmp_lg_u32 s3, 0
    s_cbranch_scc1 SG_16
    v_mov_b32 v3, s33
    v_mov_b32 v2, 1
    s_mov_b64 exec, 1
    buffer_atomic_add v2, v3, s[24:27], 0 offen sc1
    s_mov_b64 exec, -1
SG_16:
    s_lshr_b32 s70, s5, 1
    s_and_b32 s71, s5, 1
    s_lshl_b32 s71, s71, 2
    s_add_u32 s71, s71, s3
    s_lshr_b32 s33, s70, 2
    s_lshl_b32 s33, s33, 5
    s_add_u32 s33, s33, 4
    v_mov_b32 v3, s33
PC_17:
    buffer_load_dword v2, v3, s[24:27], 0 offen sc1
    s_waitcnt vmcnt(0)
    v_readfirstlane_b32 s6, v2
    s_and_b32 s7, s6, 255
    s_cmp_ge_u32 s7, 8
    s_cbranch_scc1 PD_18
    s_sleep 3
    s_sub_u32 s32, s32, 1
    s_cbranch_scc0 PC_17
    s_endpgm
PD_18:
    v_and_b32 v1, 31, v0
    v_lshrrev_b32 v7, 5, v0
    v_lshlrev_b32 v2, 5, v1
    v_lshl_add_u32 v2, v7, 4, v2
    v_lshlrev_b32 v3, 3, v1
    v_lshlrev_b32 v116, 4, v0
    v_cmp_gt_u32 s[74:75], 20, v1
    v_cmp_gt_u32 s[76:77], 32, v0
    s_lshl_b32 s6, s70, 16
    s_add_u32 s72, s6, 121634816
    s_lshl_b32 s7, s71, 13
    s_add_u32 s6, s6, s7
    s_add_u32 s6, s6, 117440512
    s_lshl_b32 s7, s70, 14
    s_add_u32 s73, s7, 123731968
    s_lshl_b32 s33, s71, 11
    s_add_u32 s7, s7, s33
    s_add_u32 s7, s7, 119537664
    s_add_u32 s33, s6, 4096
    buffer_load_dwordx4 v[128:131], v2, s[8:11], s6 offen offset:0 sc1
    buffer_load_dwordx2 v[132:133], v3, s[8:11], s7 offen offset:0 sc1
    buffer_load_dwordx4 v[136:139], v2, s[8:11], s6 offen offset:1024 sc1
    buffer_load_dwordx2 v[140:141], v3, s[8:11], s7 offen offset:256 sc1
    buffer_load_dwordx4 v[144:147], v2, s[8:11], s6 offen offset:2048 sc1
    buffer_load_dwordx2 v[148:149], v3, s[8:11], s7 offen offset:512 sc1
    buffer_load_dwordx4 v[152:155], v2, s[8:11], s6 offen offset:3072 sc1
    buffer_load_dwordx2 v[156:157], v3, s[8:11], s7 offen offset:768 sc1
    buffer_load_dwordx4 v[160:163], v2, s[8:11], s33 offen offset:0 sc1
    buffer_load_dwordx2 v[164:165], v3, s[8:11], s7 offen offset:1024 sc1
    buffer_load_dwordx4 v[168:171], v2, s[8:11], s33 offen offset:1024 sc1
    buffer_load_dwordx2 v[172:173], v3, s[8:11], s7 offen offset:1280 sc1
    buffer_load_dwordx4 v[176:179], v2, s[8:11], s33 offen offset:2048 sc1
    buffer_load_dwordx2 v[180:181], v3, s[8:11], s7 offen offset:1536 sc1
    buffer_load_dwordx4 v[184:187], v2, s[8:11], s33 offen offset:3072 sc1
    buffer_load_dwordx2 v[188:189], v3, s[8:11], s7 offen offset:1792 sc1
    s_mov_b32 s78, s72
    s_mov_b32 s79, s73
    buffer_load_dwordx4 v[80:83], v2, s[8:11], s78 offen sc1
    buffer_load_dwordx2 v[84:85], v3, s[8:11], s79 offen sc1
    s_add_u32 s78, s78, 1024
    s_add_u32 s79, s79, 256
    buffer_load_dwordx4 v[88:91], v2, s[8:11], s78 offen sc1
    buffer_load_dwordx2 v[92:93], v3, s[8:11], s79 offen sc1
    s_add_u32 s78, s78, 1024
    s_add_u32 s79, s79, 256
    buffer_load_dwordx4 v[96:99], v2, s[8:11], s78 offen sc1
    buffer_load_dwordx2 v[100:101], v3, s[8:11], s79 offen sc1
    s_add_u32 s78, s78, 1024
    s_add_u32 s79, s79, 256
    v_mov_b32 v86, 0x3f803f80
    v_mov_b32 v87, 0
    v_mov_b32 v94, 0x3f803f80
    v_mov_b32 v95, 0
    v_mov_b32 v102, 0x3f803f80
    v_mov_b32 v103, 0
    v_mov_b32 v110, 0x3f803f80
    v_mov_b32 v111, 0
    v_mov_b32 v192, 0x3f803f80
    v_mov_b32 v193, 0x3f803f80
    v_mov_b32 v194, 0x3f803f80
    v_mov_b32 v195, 0x3f803f80
    v_mov_b32 v196, 0x3f803f80
    v_mov_b32 v197, 0x3f803f80
    v_mov_b32 v198, 0x3f803f80
    v_mov_b32 v199, 0x3f803f80
    v_mov_b32 v200, 0x3f803f80
    v_mov_b32 v201, 0x3f803f80
    v_mov_b32 v202, 0x3f803f80
    v_mov_b32 v203, 0x3f803f80
    v_mov_b32 v204, 0x3f803f80
    v_mov_b32 v205, 0x3f803f80
    v_mov_b32 v206, 0x3f803f80
    v_mov_b32 v207, 0x3f803f80
    v_accvgpr_write_b32 a0, 0
    v_accvgpr_write_b32 a1, 0
    v_accvgpr_write_b32 a2, 0
    v_accvgpr_write_b32 a3, 0
    v_accvgpr_write_b32 a4, 0
    v_accvgpr_write_b32 a5, 0
    v_accvgpr_write_b32 a6, 0
    v_accvgpr_write_b32 a7, 0
    v_accvgpr_write_b32 a8, 0
    v_accvgpr_write_b32 a9, 0
    v_accvgpr_write_b32 a10, 0
    v_accvgpr_write_b32 a11, 0
    v_accvgpr_write_b32 a12, 0
    v_accvgpr_write_b32 a13, 0
    v_accvgpr_write_b32 a14, 0
    v_accvgpr_write_b32 a15, 0
    v_accvgpr_write_b32 a16, 0
    v_accvgpr_write_b32 a17, 0
    v_accvgpr_write_b32 a18, 0
    v_accvgpr_write_b32 a19, 0
    v_accvgpr_write_b32 a20, 0
    v_accvgpr_write_b32 a21, 0
    v_accvgpr_write_b32 a22, 0
    v_accvgpr_write_b32 a23, 0
    v_accvgpr_write_b32 a24, 0
    v_accvgpr_write_b32 a25, 0
    v_accvgpr_write_b32 a26, 0
    v_accvgpr_write_b32 a27, 0
    v_accvgpr_write_b32 a28, 0
    v_accvgpr_write_b32 a29, 0
    v_accvgpr_write_b32 a30, 0
    v_accvgpr_write_b32 a31, 0
    v_accvgpr_write_b32 a32, 0
    v_accvgpr_write_b32 a33, 0
    v_accvgpr_write_b32 a34, 0
    v_accvgpr_write_b32 a35, 0
    v_accvgpr_write_b32 a36, 0
    v_accvgpr_write_b32 a37, 0
    v_accvgpr_write_b32 a38, 0
    v_accvgpr_write_b32 a39, 0
    v_accvgpr_write_b32 a40, 0
    v_accvgpr_write_b32 a41, 0
    v_accvgpr_write_b32 a42, 0
    v_accvgpr_write_b32 a43, 0
    v_accvgpr_write_b32 a44, 0
    v_accvgpr_write_b32 a45, 0
    v_accvgpr_write_b32 a46, 0
    v_accvgpr_write_b32 a47, 0
    v_accvgpr_write_b32 a48, 0
    v_accvgpr_write_b32 a49, 0
    v_accvgpr_write_b32 a50, 0
    v_accvgpr_write_b32 a51, 0
    v_accvgpr_write_b32 a52, 0
    v_accvgpr_write_b32 a53, 0
    v_accvgpr_write_b32 a54, 0
    v_accvgpr_write_b32 a55, 0
    v_accvgpr_write_b32 a56, 0
    v_accvgpr_write_b32 a57, 0
    v_accvgpr_write_b32 a58, 0
    v_accvgpr_write_b32 a59, 0
    v_accvgpr_write_b32 a60, 0
    v_accvgpr_write_b32 a61, 0
    v_accvgpr_write_b32 a62, 0
    v_accvgpr_write_b32 a63, 0
    v_accvgpr_write_b32 a64, 0
    v_accvgpr_write_b32 a65, 0
    v_accvgpr_write_b32 a66, 0
    v_accvgpr_write_b32 a67, 0
    v_accvgpr_write_b32 a68, 0
    v_accvgpr_write_b32 a69, 0
    v_accvgpr_write_b32 a70, 0
    v_accvgpr_write_b32 a71, 0
    v_accvgpr_write_b32 a72, 0
    v_accvgpr_write_b32 a73, 0
    v_accvgpr_write_b32 a74, 0
    v_accvgpr_write_b32 a75, 0
    v_accvgpr_write_b32 a76, 0
    v_accvgpr_write_b32 a77, 0
    v_accvgpr_write_b32 a78, 0
    v_accvgpr_write_b32 a79, 0
    v_accvgpr_write_b32 a80, 0
    v_accvgpr_write_b32 a81, 0
    v_accvgpr_write_b32 a82, 0
    v_accvgpr_write_b32 a83, 0
    v_accvgpr_write_b32 a84, 0
    v_accvgpr_write_b32 a85, 0
    v_accvgpr_write_b32 a86, 0
    v_accvgpr_write_b32 a87, 0
    v_accvgpr_write_b32 a88, 0
    v_accvgpr_write_b32 a89, 0
    v_accvgpr_write_b32 a90, 0
    v_accvgpr_write_b32 a91, 0
    v_accvgpr_write_b32 a92, 0
    v_accvgpr_write_b32 a93, 0
    v_accvgpr_write_b32 a94, 0
    v_accvgpr_write_b32 a95, 0
    v_accvgpr_write_b32 a96, 0
    v_accvgpr_write_b32 a97, 0
    v_accvgpr_write_b32 a98, 0
    v_accvgpr_write_b32 a99, 0
    v_accvgpr_write_b32 a100, 0
    v_accvgpr_write_b32 a101, 0
    v_accvgpr_write_b32 a102, 0
    v_accvgpr_write_b32 a103, 0
    v_accvgpr_write_b32 a104, 0
    v_accvgpr_write_b32 a105, 0
    v_accvgpr_write_b32 a106, 0
    v_accvgpr_write_b32 a107, 0
    v_accvgpr_write_b32 a108, 0
    v_accvgpr_write_b32 a109, 0
    v_accvgpr_write_b32 a110, 0
    v_accvgpr_write_b32 a111, 0
    v_accvgpr_write_b32 a112, 0
    v_accvgpr_write_b32 a113, 0
    v_accvgpr_write_b32 a114, 0
    v_accvgpr_write_b32 a115, 0
    v_accvgpr_write_b32 a116, 0
    v_accvgpr_write_b32 a117, 0
    v_accvgpr_write_b32 a118, 0
    v_accvgpr_write_b32 a119, 0
    v_accvgpr_write_b32 a120, 0
    v_accvgpr_write_b32 a121, 0
    v_accvgpr_write_b32 a122, 0
    v_accvgpr_write_b32 a123, 0
    v_accvgpr_write_b32 a124, 0
    v_accvgpr_write_b32 a125, 0
    v_accvgpr_write_b32 a126, 0
    v_accvgpr_write_b32 a127, 0
    s_waitcnt vmcnt(6)
    v_cndmask_b32 v132, 0, v132, s[76:77]
    v_cndmask_b32 v133, 0, v133, s[76:77]
    v_mov_b32 v134, 0
    v_mov_b32 v135, 0
    v_mov_b32 v8, 0xff800000
    v_cndmask_b32 v140, 0, v140, s[76:77]
    v_cndmask_b32 v141, 0, v141, s[76:77]
    v_mov_b32 v142, 0
    v_mov_b32 v143, 0
    v_mov_b32 v9, 0xff800000
    v_cndmask_b32 v148, 0, v148, s[76:77]
    v_cndmask_b32 v149, 0, v149, s[76:77]
    v_mov_b32 v150, 0
    v_mov_b32 v151, 0
    v_mov_b32 v10, 0xff800000
    v_cndmask_b32 v156, 0, v156, s[76:77]
    v_cndmask_b32 v157, 0, v157, s[76:77]
    v_mov_b32 v158, 0
    v_mov_b32 v159, 0
    v_mov_b32 v11, 0xff800000
    v_cndmask_b32 v164, 0, v164, s[76:77]
    v_cndmask_b32 v165, 0, v165, s[76:77]
    v_mov_b32 v166, 0
    v_mov_b32 v167, 0
    v_mov_b32 v12, 0xff800000
    v_cndmask_b32 v172, 0, v172, s[76:77]
    v_cndmask_b32 v173, 0, v173, s[76:77]
    v_mov_b32 v174, 0
    v_mov_b32 v175, 0
    v_mov_b32 v13, 0xff800000
    v_cndmask_b32 v180, 0, v180, s[76:77]
    v_cndmask_b32 v181, 0, v181, s[76:77]
    v_mov_b32 v182, 0
    v_mov_b32 v183, 0
    v_mov_b32 v14, 0xff800000
    v_cndmask_b32 v188, 0, v188, s[76:77]
    v_cndmask_b32 v189, 0, v189, s[76:77]
    v_mov_b32 v190, 0
    v_mov_b32 v191, 0
    v_mov_b32 v15, 0xff800000
    v_mov_b32 v32, 0xff800000
    v_mov_b32 v33, 0xff800000
    v_mov_b32 v34, 0xff800000
    v_mov_b32 v35, 0xff800000
    v_mov_b32 v36, 0xff800000
    v_mov_b32 v37, 0xff800000
    v_mov_b32 v38, 0xff800000
    v_mov_b32 v39, 0xff800000
    v_mov_b32 v40, 0xff800000
    v_mov_b32 v41, 0xff800000
    v_mov_b32 v42, 0xff800000
    v_mov_b32 v43, 0xff800000
    v_mov_b32 v44, 0xff800000
    v_mov_b32 v45, 0xff800000
    v_mov_b32 v46, 0xff800000
    v_mov_b32 v47, 0xff800000
    v_mov_b32 v48, 0xff800000
    v_mov_b32 v49, 0xff800000
    v_mov_b32 v50, 0xff800000
    v_mov_b32 v51, 0xff800000
    v_mov_b32 v52, 0xff800000
    v_mov_b32 v53, 0xff800000
    v_mov_b32 v54, 0xff800000
    v_mov_b32 v55, 0xff800000
    v_mov_b32 v56, 0xff800000
    v_mov_b32 v57, 0xff800000
    v_mov_b32 v58, 0xff800000
    v_mov_b32 v59, 0xff800000
    v_mov_b32 v60, 0xff800000
    v_mov_b32 v61, 0xff800000
    v_mov_b32 v62, 0xff800000
    v_mov_b32 v63, 0xff800000
    s_mov_b32 s80, 0
A_P1:
    s_waitcnt vmcnt(4)
    v_mfma_f32_32x32x16_bf16 v[16:31], v[80:83], v[128:131], 0
    v_max3_f32 v14, v14, v32, v33
    v_max3_f32 v14, v14, v34, v35
    v_max3_f32 v14, v14, v36, v37
    v_max3_f32 v14, v14, v38, v39
    v_mfma_f32_32x32x16_bf16 v[16:31], v[84:87], v[132:135], v[16:31]
    v_max3_f32 v14, v14, v40, v41
    v_max3_f32 v14, v14, v42, v43
    v_max3_f32 v14, v14, v44, v45
    v_max3_f32 v14, v14, v46, v47
    v_mfma_f32_32x32x16_bf16 v[32:47], v[80:83], v[136:139], 0
    v_max3_f32 v15, v15, v48, v49
    v_max3_f32 v15, v15, v50, v51
    v_max3_f32 v15, v15, v52, v53
    v_max3_f32 v15, v15, v54, v55
    v_mfma_f32_32x32x16_bf16 v[32:47], v[84:87], v[140:143], v[32:47]
    v_max3_f32 v15, v15, v56, v57
    v_max3_f32 v15, v15, v58, v59
    v_max3_f32 v15, v15, v60, v61
    v_max3_f32 v15, v15, v62, v63
    v_mfma_f32_32x32x16_bf16 v[48:63], v[80:83], v[144:147], 0
    v_max3_f32 v8, v8, v16, v17
    v_max3_f32 v8, v8, v18, v19
    v_max3_f32 v8, v8, v20, v21
    v_max3_f32 v8, v8, v22, v23
    v_mfma_f32_32x32x16_bf16 v[48:63], v[84:87], v[148:151], v[48:63]
    v_max3_f32 v8, v8, v24, v25
    v_max3_f32 v8, v8, v26, v27
    v_max3_f32 v8, v8, v28, v29
    v_max3_f32 v8, v8, v30, v31
    v_mfma_f32_32x32x16_bf16 v[16:31], v[80:83], v[152:155], 0
    v_max3_f32 v9, v9, v32, v33
    v_max3_f32 v9, v9, v34, v35
    v_max3_f32 v9, v9, v36, v37
    v_max3_f32 v9, v9, v38, v39
    v_mfma_f32_32x32x16_bf16 v[16:31], v[84:87], v[156:159], v[16:31]
    v_max3_f32 v9, v9, v40, v41
    v_max3_f32 v9, v9, v42, v43
    v_max3_f32 v9, v9, v44, v45
    v_max3_f32 v9, v9, v46, v47
    v_mfma_f32_32x32x16_bf16 v[32:47], v[80:83], v[160:163], 0
    v_max3_f32 v10, v10, v48, v49
    v_max3_f32 v10, v10, v50, v51
    v_max3_f32 v10, v10, v52, v53
    v_max3_f32 v10, v10, v54, v55
    v_mfma_f32_32x32x16_bf16 v[32:47], v[84:87], v[164:167], v[32:47]
    v_max3_f32 v10, v10, v56, v57
    v_max3_f32 v10, v10, v58, v59
    v_max3_f32 v10, v10, v60, v61
    v_max3_f32 v10, v10, v62, v63
    v_mfma_f32_32x32x16_bf16 v[48:63], v[80:83], v[168:171], 0
    v_max3_f32 v11, v11, v16, v17
    v_max3_f32 v11, v11, v18, v19
    v_max3_f32 v11, v11, v20, v21
    v_max3_f32 v11, v11, v22, v23
    v_mfma_f32_32x32x16_bf16 v[48:63], v[84:87], v[172:175], v[48:63]
    v_max3_f32 v11, v11, v24, v25
    v_max3_f32 v11, v11, v26, v27
    v_max3_f32 v11, v11, v28, v29
    v_max3_f32 v11, v11, v30, v31
    v_mfma_f32_32x32x16_bf16 v[16:31], v[80:83], v[176:179], 0
    v_max3_f32 v12, v12, v32, v33
    v_max3_f32 v12, v12, v34, v35
    v_max3_f32 v12, v12, v36, v37
    v_max3_f32 v12, v12, v38, v39
    v_mfma_f32_32x32x16_bf16 v[16:31], v[84:87], v[180:183], v[16:31]
    v_max3_f32 v12, v12, v40, v41
    v_max3_f32 v12, v12, v42, v43
    v_max3_f32 v12, v12, v44, v45
    v_max3_f32 v12, v12, v46, v47
    v_mfma_f32_32x32x16_bf16 v[32:47], v[80:83], v[184:187], 0
    v_max3_f32 v13, v13, v48, v49
    v_max3_f32 v13, v13, v50, v51
    v_max3_f32 v13, v13, v52, v53
    v_max3_f32 v13, v13, v54, v55
    v_mfma_f32_32x32x16_bf16 v[32:47], v[84:87], v[188:191], v[32:47]
    v_max3_f32 v13, v13, v56, v57
    v_max3_f32 v13, v13, v58, v59
    v_max3_f32 v13, v13, v60, v61
    v_max3_f32 v13, v13, v62, v63
    s_add_u32 s80, s80, 1
    s_cmp_eq_u32 s80, 62
    s_cselect_b32 s78, s72, s78
    s_cselect_b32 s79, s73, s79
    buffer_load_dwordx4 v[80:83], v2, s[8:11], s78 offen sc1
    buffer_load_dwordx2 v[84:85], v3, s[8:11], s79 offen sc1
    s_add_u32 s78, s78, 1024
    s_add_u32 s79, s79, 256
    s_waitcnt vmcnt(4)
    v_mfma_f32_32x32x16_bf16 v[48:63], v[88:91], v[128:131], 0
    v_max3_f32 v14, v14, v16, v17
    v_max3_f32 v14, v14, v18, v19
    v_max3_f32 v14, v14, v20, v21
    v_max3_f32 v14, v14, v22, v23
    v_mfma_f32_32x32x16_bf16 v[48:63], v[92:95], v[132:135], v[48:63]
    v_max3_f32 v14, v14, v24, v25
    v_max3_f32 v14, v14, v26, v27
    v_max3_f32 v14, v14, v28, v29
    v_max3_f32 v14, v14, v30, v31
    v_mfma_f32_32x32x16_bf16 v[16:31], v[88:91], v[136:139], 0
    v_max3_f32 v15, v15, v32, v33
    v_max3_f32 v15, v15, v34, v35
    v_max3_f32 v15, v15, v36, v37
    v_max3_f32 v15, v15, v38, v39
    v_mfma_f32_32x32x16_bf16 v[16:31], v[92:95], v[140:143], v[16:31]
    v_max3_f32 v15, v15, v40, v41
    v_max3_f32 v15, v15, v42, v43
    v_max3_f32 v15, v15, v44, v45
    v_max3_f32 v15, v15, v46, v47
    v_mfma_f32_32x32x16_bf16 v[32:47], v[88:91], v[144:147], 0
    v_max3_f32 v8, v8, v48, v49
    v_max3_f32 v8, v8, v50, v51
    v_max3_f32 v8, v8, v52, v53
    v_max3_f32 v8, v8, v54, v55
    v_mfma_f32_32x32x16_bf16 v[32:47], v[92:95], v[148:151], v[32:47]
    v_max3_f32 v8, v8, v56, v57
    v_max3_f32 v8, v8, v58, v59
    v_max3_f32 v8, v8, v60, v61
    v_max3_f32 v8, v8, v62, v63
    v_mfma_f32_32x32x16_bf16 v[48:63], v[88:91], v[152:155], 0
    v_max3_f32 v9, v9, v16, v17
    v_max3_f32 v9, v9, v18, v19
    v_max3_f32 v9, v9, v20, v21
    v_max3_f32 v9, v9, v22, v23
    v_mfma_f32_32x32x16_bf16 v[48:63], v[92:95], v[156:159], v[48:63]
    v_max3_f32 v9, v9, v24, v25
    v_max3_f32 v9, v9, v26, v27
    v_max3_f32 v9, v9, v28, v29
    v_max3_f32 v9, v9, v30, v31
    v_mfma_f32_32x32x16_bf16 v[16:31], v[88:91], v[160:163], 0
    v_max3_f32 v10, v10, v32, v33
    v_max3_f32 v10, v10, v34, v35
    v_max3_f32 v10, v10, v36, v37
    v_max3_f32 v10, v10, v38, v39
    v_mfma_f32_32x32x16_bf16 v[16:31], v[92:95], v[164:167], v[16:31]
    v_max3_f32 v10, v10, v40, v41
    v_max3_f32 v10, v10, v42, v43
    v_max3_f32 v10, v10, v44, v45
    v_max3_f32 v10, v10, v46, v47
    v_mfma_f32_32x32x16_bf16 v[32:47], v[88:91], v[168:171], 0
    v_max3_f32 v11, v11, v48, v49
    v_max3_f32 v11, v11, v50, v51
    v_max3_f32 v11, v11, v52, v53
    v_max3_f32 v11, v11, v54, v55
    v_mfma_f32_32x32x16_bf16 v[32:47], v[92:95], v[172:175], v[32:47]
    v_max3_f32 v11, v11, v56, v57
    v_max3_f32 v11, v11, v58, v59
    v_max3_f32 v11, v11, v60, v61
    v_max3_f32 v11, v11, v62, v63
    v_mfma_f32_32x32x16_bf16 v[48:63], v[88:91], v[176:179], 0
    v_max3_f32 v12, v12, v16, v17
    v_max3_f32 v12, v12, v18, v19
    v_max3_f32 v12, v12, v20, v21
    v_max3_f32 v12, v12, v22, v23
    v_mfma_f32_32x32x16_bf16 v[48:63], v[92:95], v[180:183], v[48:63]
    v_max3_f32 v12, v12, v24, v25
    v_max3_f32 v12, v12, v26, v27
    v_max3_f32 v12, v12, v28, v29
    v_max3_f32 v12, v12, v30, v31
    v_mfma_f32_32x32x16_bf16 v[16:31], v[88:91], v[184:187], 0
    v_max3_f32 v13, v13, v32, v33
    v_max3_f32 v13, v13, v34, v35
    v_max3_f32 v13, v13, v36, v37
    v_max3_f32 v13, v13, v38, v39
    v_mfma_f32_32x32x16_bf16 v[16:31], v[92:95], v[188:191], v[16:31]
    v_max3_f32 v13, v13, v40, v41
    v_max3_f32 v13, v13, v42, v43
    v_max3_f32 v13, v13, v44, v45
    v_max3_f32 v13, v13, v46, v47
    s_add_u32 s80, s80, 1
    s_cmp_eq_u32 s80, 62
    s_cselect_b32 s78, s72, s78
    s_cselect_b32 s79, s73, s79
    buffer_load_dwordx4 v[88:91], v2, s[8:11], s78 offen sc1
    buffer_load_dwordx2 v[92:93], v3, s[8:11], s79 offen sc1
    s_add_u32 s78, s78, 1024
    s_add_u32 s79, s79, 256
    s_waitcnt vmcnt(4)
    v_mfma_f32_32x32x16_bf16 v[32:47], v[96:99], v[128:131], 0
    v_max3_f32 v14, v14, v48, v49
    v_max3_f32 v14, v14, v50, v51
    v_max3_f32 v14, v14, v52, v53
    v_max3_f32 v14, v14, v54, v55
    v_mfma_f32_32x32x16_bf16 v[32:47], v[100:103], v[132:135], v[32:47]
    v_max3_f32 v14, v14, v56, v57
    v_max3_f32 v14, v14, v58, v59
    v_max3_f32 v14, v14, v60, v61
    v_max3_f32 v14, v14, v62, v63
    v_mfma_f32_32x32x16_bf16 v[48:63], v[96:99], v[136:139], 0
    v_max3_f32 v15, v15, v16, v17
    v_max3_f32 v15, v15, v18, v19
    v_max3_f32 v15, v15, v20, v21
    v_max3_f32 v15, v15, v22, v23
    v_mfma_f32_32x32x16_bf16 v[48:63], v[100:103], v[140:143], v[48:63]
    v_max3_f32 v15, v15, v24, v25
    v_max3_f32 v15, v15, v26, v27
    v_max3_f32 v15, v15, v28, v29
    v_max3_f32 v15, v15, v30, v31
    v_mfma_f32_32x32x16_bf16 v[16:31], v[96:99], v[144:147], 0
    v_max3_f32 v8, v8, v32, v33
    v_max3_f32 v8, v8, v34, v35
    v_max3_f32 v8, v8, v36, v37
    v_max3_f32 v8, v8, v38, v39
    v_mfma_f32_32x32x16_bf16 v[16:31], v[100:103], v[148:151], v[16:31]
    v_max3_f32 v8, v8, v40, v41
    v_max3_f32 v8, v8, v42, v43
    v_max3_f32 v8, v8, v44, v45
    v_max3_f32 v8, v8, v46, v47
    v_mfma_f32_32x32x16_bf16 v[32:47], v[96:99], v[152:155], 0
    v_max3_f32 v9, v9, v48, v49
    v_max3_f32 v9, v9, v50, v51
    v_max3_f32 v9, v9, v52, v53
    v_max3_f32 v9, v9, v54, v55
    v_mfma_f32_32x32x16_bf16 v[32:47], v[100:103], v[156:159], v[32:47]
    v_max3_f32 v9, v9, v56, v57
    v_max3_f32 v9, v9, v58, v59
    v_max3_f32 v9, v9, v60, v61
    v_max3_f32 v9, v9, v62, v63
    v_mfma_f32_32x32x16_bf16 v[48:63], v[96:99], v[160:163], 0
    v_max3_f32 v10, v10, v16, v17
    v_max3_f32 v10, v10, v18, v19
    v_max3_f32 v10, v10, v20, v21
    v_max3_f32 v10, v10, v22, v23
    v_mfma_f32_32x32x16_bf16 v[48:63], v[100:103], v[164:167], v[48:63]
    v_max3_f32 v10, v10, v24, v25
    v_max3_f32 v10, v10, v26, v27
    v_max3_f32 v10, v10, v28, v29
    v_max3_f32 v10, v10, v30, v31
    v_mfma_f32_32x32x16_bf16 v[16:31], v[96:99], v[168:171], 0
    v_max3_f32 v11, v11, v32, v33
    v_max3_f32 v11, v11, v34, v35
    v_max3_f32 v11, v11, v36, v37
    v_max3_f32 v11, v11, v38, v39
    v_mfma_f32_32x32x16_bf16 v[16:31], v[100:103], v[172:175], v[16:31]
    v_max3_f32 v11, v11, v40, v41
    v_max3_f32 v11, v11, v42, v43
    v_max3_f32 v11, v11, v44, v45
    v_max3_f32 v11, v11, v46, v47
    v_mfma_f32_32x32x16_bf16 v[32:47], v[96:99], v[176:179], 0
    v_max3_f32 v12, v12, v48, v49
    v_max3_f32 v12, v12, v50, v51
    v_max3_f32 v12, v12, v52, v53
    v_max3_f32 v12, v12, v54, v55
    v_mfma_f32_32x32x16_bf16 v[32:47], v[100:103], v[180:183], v[32:47]
    v_max3_f32 v12, v12, v56, v57
    v_max3_f32 v12, v12, v58, v59
    v_max3_f32 v12, v12, v60, v61
    v_max3_f32 v12, v12, v62, v63
    v_mfma_f32_32x32x16_bf16 v[48:63], v[96:99], v[184:187], 0
    v_max3_f32 v13, v13, v16, v17
    v_max3_f32 v13, v13, v18, v19
    v_max3_f32 v13, v13, v20, v21
    v_max3_f32 v13, v13, v22, v23
    v_mfma_f32_32x32x16_bf16 v[48:63], v[100:103], v[188:191], v[48:63]
    v_max3_f32 v13, v13, v24, v25
    v_max3_f32 v13, v13, v26, v27
    v_max3_f32 v13, v13, v28, v29
    v_max3_f32 v13, v13, v30, v31
    s_add_u32 s80, s80, 1
    s_cmp_eq_u32 s80, 62
    s_cselect_b32 s78, s72, s78
    s_cselect_b32 s79, s73, s79
    buffer_load_dwordx4 v[96:99], v2, s[8:11], s78 offen sc1
    buffer_load_dwordx2 v[100:101], v3, s[8:11], s79 offen sc1
    s_add_u32 s78, s78, 1024
    s_add_u32 s79, s79, 256
    s_cmp_lt_u32 s80, 66
    s_cbranch_scc1 A_P1
    s_nop 7
    v_max3_f32 v14, v14, v32, v33
    v_max3_f32 v14, v14, v34, v35
    v_max3_f32 v14, v14, v36, v37
    v_max3_f32 v14, v14, v38, v39
    v_max3_f32 v14, v14, v40, v41
    v_max3_f32 v14, v14, v42, v43
    v_max3_f32 v14, v14, v44, v45
    v_max3_f32 v14, v14, v46, v47
    v_max3_f32 v15, v15, v48, v49
    v_max3_f32 v15, v15, v50, v51
    v_max3_f32 v15, v15, v52, v53
    v_max3_f32 v15, v15, v54, v55
    v_max3_f32 v15, v15, v56, v57
    v_max3_f32 v15, v15, v58, v59
    v_max3_f32 v15, v15, v60, v61
    v_max3_f32 v15, v15, v62, v63
    s_waitcnt vmcnt(0)
    s_mov_b32 s78, s72
    s_mov_b32 s79, s73
    s_lshl_b32 s81, s70, 17
    s_add_u32 s81, s81, 125829120
    buffer_load_dwordx4 v[80:83], v2, s[8:11], s78 offen sc1
    buffer_load_dwordx2 v[84:85], v3, s[8:11], s79 offen sc1
    s_add_u32 s78, s78, 1024
    s_add_u32 s79, s79, 256
    s_mov_b64 exec, s[74:75]
    buffer_load_dwordx4 v[192:195], v116, s[8:11], s81 offen sc1
    buffer_load_dwordx4 v[196:199], v116, s[8:11], s81 offen offset:1024 sc1
    s_mov_b64 exec, -1
    s_add_u32 s81, s81, 2048
    buffer_load_dwordx4 v[88:91], v2, s[8:11], s78 offen sc1
    buffer_load_dwordx2 v[92:93], v3, s[8:11], s79 offen sc1
    s_add_u32 s78, s78, 1024
    s_add_u32 s79, s79, 256
    v_mov_b32 v7, v8
    s_nop 1
    v_permlane32_swap_b32 v7, v8
    v_max_f32 v8, v8, v7
    v_cvt_pk_bf16_f32 v7, -v8, -v8
    v_lshlrev_b32 v7, 16, v7
    v_sub_f32 v8, -v8, v7
    v_cvt_pk_bf16_f32 v7, v7, v8
    v_cndmask_b32 v134, 0, v7, s[76:77]
    v_mov_b32 v7, v9
    s_nop 1
    v_permlane32_swap_b32 v7, v9
    v_max_f32 v9, v9, v7
    v_cvt_pk_bf16_f32 v7, -v9, -v9
    v_lshlrev_b32 v7, 16, v7
    v_sub_f32 v9, -v9, v7
    v_cvt_pk_bf16_f32 v7, v7, v9
    v_cndmask_b32 v142, 0, v7, s[76:77]
    v_mov_b32 v7, v10
    s_nop 1
    v_permlane32_swap_b32 v7, v10
    v_max_f32 v10, v10, v7
    v_cvt_pk_bf16_f32 v7, -v10, -v10
    v_lshlrev_b32 v7, 16, v7
    v_sub_f32 v10, -v10, v7
    v_cvt_pk_bf16_f32 v7, v7, v10
    v_cndmask_b32 v150, 0, v7, s[76:77]
    v_mov_b32 v7, v11
    s_nop 1
    v_permlane32_swap_b32 v7, v11
    v_max_f32 v11, v11, v7
    v_cvt_pk_bf16_f32 v7, -v11, -v11
    v_lshlrev_b32 v7, 16, v7
    v_sub_f32 v11, -v11, v7
    v_cvt_pk_bf16_f32 v7, v7, v11
    v_cndmask_b32 v158, 0, v7, s[76:77]
    v_mov_b32 v7, v12
    s_nop 1
    v_permlane32_swap_b32 v7, v12
    v_max_f32 v12, v12, v7
    v_cvt_pk_bf16_f32 v7, -v12, -v12
    v_lshlrev_b32 v7, 16, v7
    v_sub_f32 v12, -v12, v7
    v_cvt_pk_bf16_f32 v7, v7, v12
    v_cndmask_b32 v166, 0, v7, s[76:77]
    v_mov_b32 v7, v13
    s_nop 1
    v_permlane32_swap_b32 v7, v13
    v_max_f32 v13, v13, v7
    v_cvt_pk_bf16_f32 v7, -v13, -v13
    v_lshlrev_b32 v7, 16, v7
    v_sub_f32 v13, -v13, v7
    v_cvt_pk_bf16_f32 v7, v7, v13
    v_cndmask_b32 v174, 0, v7, s[76:77]
    v_mov_b32 v7, v14
    s_nop 1
    v_permlane32_swap_b32 v7, v14
    v_max_f32 v14, v14, v7
    v_cvt_pk_bf16_f32 v7, -v14, -v14
    v_lshlrev_b32 v7, 16, v7
    v_sub_f32 v14, -v14, v7
    v_cvt_pk_bf16_f32 v7, v7, v14
    v_cndmask_b32 v182, 0, v7, s[76:77]
    v_mov_b32 v7, v15
    s_nop 1
    v_permlane32_swap_b32 v7, v15
    v_max_f32 v15, v15, v7
    v_cvt_pk_bf16_f32 v7, -v15, -v15
    v_lshlrev_b32 v7, 16, v7
    v_sub_f32 v15, -v15, v7
    v_cvt_pk_bf16_f32 v7, v7, v15
    v_cndmask_b32 v190, 0, v7, s[76:77]
    v_mov_b32 v72, 0
    v_mov_b32 v73, 0
    v_mov_b32 v74, 0
    v_mov_b32 v75, 0
    v_mov_b32 v76, 0
    v_mov_b32 v77, 0
    v_mov_b32 v78, 0
    v_mov_b32 v79, 0
    s_waitcnt vmcnt(4)
    v_mfma_f32_32x32x16_bf16 v[16:31], v[80:83], v[128:131], 0
    v_mfma_f32_32x32x16_bf16 v[16:31], v[84:87], v[132:135], v[16:31]
    s_mov_b32 s80, 0
    s_nop 7
A_P2:
    v_mfma_f32_32x32x16_bf16 v[32:47], v[80:83], v[136:139], 0
    s_nop 1
    v_exp_f32 v16, v16
    v_exp_f32 v17, v17
    v_exp_f32 v18, v18
    v_exp_f32 v19, v19
    v_mfma_f32_32x32x16_bf16 a[112:127], v[200:203], v[72:75], a[112:127]
    v_exp_f32 v20, v20
    v_exp_f32 v21, v21
    v_exp_f32 v22, v22
    v_exp_f32 v23, v23
    v_cvt_pk_bf16_f32 v64, v16, v17
    v_cvt_pk_bf16_f32 v65, v18, v19
    v_mfma_f32_32x32x16_bf16 v[32:47], v[84:87], v[140:143], v[32:47]
    v_exp_f32 v24, v24
    v_exp_f32 v25, v25
    v_exp_f32 v26, v26
    v_exp_f32 v27, v27
    v_cvt_pk_bf16_f32 v66, v20, v21
    v_cvt_pk_bf16_f32 v67, v22, v23
    v_mfma_f32_32x32x16_bf16 a[112:127], v[204:207], v[76:79], a[112:127]
    v_exp_f32 v28, v28
    v_exp_f32 v29, v29
    v_exp_f32 v30, v30
    v_exp_f32 v31, v31
    v_cvt_pk_bf16_f32 v68, v24, v25
    v_cvt_pk_bf16_f32 v69, v26, v27
    v_cvt_pk_bf16_f32 v70, v28, v29
    v_cvt_pk_bf16_f32 v71, v30, v31
    s_mov_b64 exec, s[74:75]
    buffer_load_dwordx4 v[200:203], v116, s[8:11], s81 offen sc1
    buffer_load_dwordx4 v[204:207], v116, s[8:11], s81 offen offset:1024 sc1
    s_mov_b64 exec, -1
    s_add_u32 s81, s81, 2048
    s_waitcnt vmcnt(2)
    v_mfma_f32_32x32x16_bf16 v[16:31], v[80:83], v[144:147], 0
    v_exp_f32 v32, v32
    v_exp_f32 v33, v33
    v_exp_f32 v34, v34
    v_exp_f32 v35, v35
    v_mfma_f32_32x32x16_bf16 a[0:15], v[192:195], v[64:67], a[0:15]
    v_exp_f32 v36, v36
    v_exp_f32 v37, v37
    v_exp_f32 v38, v38
    v_exp_f32 v39, v39
    v_cvt_pk_bf16_f32 v72, v32, v33
    v_cvt_pk_bf16_f32 v73, v34, v35
    v_mfma_f32_32x32x16_bf16 v[16:31], v[84:87], v[148:151], v[16:31]
    v_exp_f32 v40, v40
    v_exp_f32 v41, v41
    v_exp_f32 v42, v42
    v_exp_f32 v43, v43
    v_cvt_pk_bf16_f32 v74, v36, v37
    v_cvt_pk_bf16_f32 v75, v38, v39
    v_mfma_f32_32x32x16_bf16 a[0:15], v[196:199], v[68:71], a[0:15]
    v_exp_f32 v44, v44
    v_exp_f32 v45, v45
    v_exp_f32 v46, v46
    v_exp_f32 v47, v47
    v_cvt_pk_bf16_f32 v76, v40, v41
    v_cvt_pk_bf16_f32 v77, v42, v43
    v_cvt_pk_bf16_f32 v78, v44, v45
    v_cvt_pk_bf16_f32 v79, v46, v47
    v_mfma_f32_32x32x16_bf16 v[32:47], v[80:83], v[152:155], 0
    v_exp_f32 v16, v16
    v_exp_f32 v17, v17
    v_exp_f32 v18, v18
    v_exp_f32 v19, v19
    v_mfma_f32_32x32x16_bf16 a[16:31], v[192:195], v[72:75], a[16:31]
    v_exp_f32 v20, v20
    v_exp_f32 v21, v21
    v_exp_f32 v22, v22
    v_exp_f32 v23, v23
    v_cvt_pk_bf16_f32 v64, v16, v17
    v_cvt_pk_bf16_f32 v65, v18, v19
    v_mfma_f32_32x32x16_bf16 v[32:47], v[84:87], v[156:159], v[32:47]
    v_exp_f32 v24, v24
    v_exp_f32 v25, v25
    v_exp_f32 v26, v26
    v_exp_f32 v27, v27
    v_cvt_pk_bf16_f32 v66, v20, v21
    v_cvt_pk_bf16_f32 v67, v22, v23
    v_mfma_f32_32x32x16_bf16 a[16:31], v[196:199], v[76:79], a[16:31]
    v_exp_f32 v28, v28
    v_exp_f32 v29, v29
    v_exp_f32 v30, v30
    v_exp_f32 v31, v31
    v_cvt_pk_bf16_f32 v68, v24, v25
    v_cvt_pk_bf16_f32 v69, v26, v27
    v_cvt_pk_bf16_f32 v70, v28, v29
    v_cvt_pk_bf16_f32 v71, v30, v31
    v_mfma_f32_32x32x16_bf16 v[16:31], v[80:83], v[160:163], 0
    v_exp_f32 v32, v32
    v_exp_f32 v33, v33
    v_exp_f32 v34, v34
    v_exp_f32 v35, v35
    v_mfma_f32_32x32x16_bf16 a[32:47], v[192:195], v[64:67], a[32:47]
    v_exp_f32 v36, v36
    v_exp_f32 v37, v37
    v_exp_f32 v38, v38
    v_exp_f32 v39, v39
    v_cvt_pk_bf16_f32 v72, v32, v33
    v_cvt_pk_bf16_f32 v73, v34, v35
    v_mfma_f32_32x32x16_bf16 v[16:31], v[84:87], v[164:167], v[16:31]
    v_exp_f32 v40, v40
    v_exp_f32 v41, v41
    v_exp_f32 v42, v42
    v_exp_f32 v43, v43
    v_cvt_pk_bf16_f32 v74, v36, v37
    v_cvt_pk_bf16_f32 v75, v38, v39
    v_mfma_f32_32x32x16_bf16 a[32:47], v[196:199], v[68:71], a[32:47]
    v_exp_f32 v44, v44
    v_exp_f32 v45, v45
    v_exp_f32 v46, v46
    v_exp_f32 v47, v47
    v_cvt_pk_bf16_f32 v76, v40, v41
    v_cvt_pk_bf16_f32 v77, v42, v43
    v_cvt_pk_bf16_f32 v78, v44, v45
    v_cvt_pk_bf16_f32 v79, v46, v47
    v_mfma_f32_32x32x16_bf16 v[32:47], v[80:83], v[168:171], 0
    v_exp_f32 v16, v16
    v_exp_f32 v17, v17
    v_exp_f32 v18, v18
    v_exp_f32 v19, v19
    v_mfma_f32_32x32x16_bf16 a[48:63], v[192:195], v[72:75], a[48:63]
    v_exp_f32 v20, v20
    v_exp_f32 v21, v21
    v_exp_f32 v22, v22
    v_exp_f32 v23, v23
    v_cvt_pk_bf16_f32 v64, v16, v17
    v_cvt_pk_bf16_f32 v65, v18, v19
    v_mfma_f32_32x32x16_bf16 v[32:47], v[84:87], v[172:175], v[32:47]
    v_exp_f32 v24, v24
    v_exp_f32 v25, v25
    v_exp_f32 v26, v26
    v_exp_f32 v27, v27
    v_cvt_pk_bf16_f32 v66, v20, v21
    v_cvt_pk_bf16_f32 v67, v22, v23
    v_mfma_f32_32x32x16_bf16 a[48:63], v[196:199], v[76:79], a[48:63]
    v_exp_f32 v28, v28
    v_exp_f32 v29, v29
    v_exp_f32 v30, v30
    v_exp_f32 v31, v31
    v_cvt_pk_bf16_f32 v68, v24, v25
    v_cvt_pk_bf16_f32 v69, v26, v27
    v_cvt_pk_bf16_f32 v70, v28, v29
    v_cvt_pk_bf16_f32 v71, v30, v31
    v_mfma_f32_32x32x16_bf16 v[16:31], v[80:83], v[176:179], 0
    v_exp_f32 v32, v32
    v_exp_f32 v33, v33
    v_exp_f32 v34, v34
    v_exp_f32 v35, v35
    v_mfma_f32_32x32x16_bf16 a[64:79], v[192:195], v[64:67], a[64:79]
    v_exp_f32 v36, v36
    v_exp_f32 v37, v37
    v_exp_f32 v38, v38
    v_exp_f32 v39, v39
    v_cvt_pk_bf16_f32 v72, v32, v33
    v_cvt_pk_bf16_f32 v73, v34, v35
    v_mfma_f32_32x32x16_bf16 v[16:31], v[84:87], v[180:183], v[16:31]
    v_exp_f32 v40, v40
    v_exp_f32 v41, v41
    v_exp_f32 v42, v42
    v_exp_f32 v43, v43
    v_cvt_pk_bf16_f32 v74, v36, v37
    v_cvt_pk_bf16_f32 v75, v38, v39
    v_mfma_f32_32x32x16_bf16 a[64:79], v[196:199], v[68:71], a[64:79]
    v_exp_f32 v44, v44
    v_exp_f32 v45, v45
    v_exp_f32 v46, v46
    v_exp_f32 v47, v47
    v_cvt_pk_bf16_f32 v76, v40, v41
    v_cvt_pk_bf16_f32 v77, v42, v43
    v_cvt_pk_bf16_f32 v78, v44, v45
    v_cvt_pk_bf16_f32 v79, v46, v47
    v_mfma_f32_32x32x16_bf16 v[32:47], v[80:83], v[184:187], 0
    v_exp_f32 v16, v16
    v_exp_f32 v17, v17
    v_exp_f32 v18, v18
    v_exp_f32 v19, v19
    v_mfma_f32_32x32x16_bf16 a[80:95], v[192:195], v[72:75], a[80:95]
    v_exp_f32 v20, v20
    v_exp_f32 v21, v21
    v_exp_f32 v22, v22
    v_exp_f32 v23, v23
    v_cvt_pk_bf16_f32 v64, v16, v17
    v_cvt_pk_bf16_f32 v65, v18, v19
    v_mfma_f32_32x32x16_bf16 v[32:47], v[84:87], v[188:191], v[32:47]
    v_exp_f32 v24, v24
    v_exp_f32 v25, v25
    v_exp_f32 v26, v26
    v_exp_f32 v27, v27
    v_cvt_pk_bf16_f32 v66, v20, v21
    v_cvt_pk_bf16_f32 v67, v22, v23
    v_mfma_f32_32x32x16_bf16 a[80:95], v[196:199], v[76:79], a[80:95]
    v_exp_f32 v28, v28
    v_exp_f32 v29, v29
    v_exp_f32 v30, v30
    v_exp_f32 v31, v31
    v_cvt_pk_bf16_f32 v68, v24, v25
    v_cvt_pk_bf16_f32 v69, v26, v27
    v_cvt_pk_bf16_f32 v70, v28, v29
    v_cvt_pk_bf16_f32 v71, v30, v31
    buffer_load_dwordx4 v[80:83], v2, s[8:11], s78 offen sc1
    buffer_load_dwordx2 v[84:85], v3, s[8:11], s79 offen sc1
    s_add_u32 s78, s78, 1024
    s_add_u32 s79, s79, 256
    s_waitcnt vmcnt(2)
    v_mfma_f32_32x32x16_bf16 v[16:31], v[88:91], v[128:131], 0
    v_exp_f32 v32, v32
    v_exp_f32 v33, v33
    v_exp_f32 v34, v34
    v_exp_f32 v35, v35
    v_mfma_f32_32x32x16_bf16 a[96:111], v[192:195], v[64:67], a[96:111]
    v_exp_f32 v36, v36
    v_exp_f32 v37, v37
    v_exp_f32 v38, v38
    v_exp_f32 v39, v39
    v_cvt_pk_bf16_f32 v72, v32, v33
    v_cvt_pk_bf16_f32 v73, v34, v35
    v_mfma_f32_32x32x16_bf16 v[16:31], v[92:95], v[132:135], v[16:31]
    v_exp_f32 v40, v40
    v_exp_f32 v41, v41
    v_exp_f32 v42, v42
    v_exp_f32 v43, v43
    v_cvt_pk_bf16_f32 v74, v36, v37
    v_cvt_pk_bf16_f32 v75, v38, v39
    v_mfma_f32_32x32x16_bf16 a[96:111], v[196:199], v[68:71], a[96:111]
    v_exp_f32 v44, v44
    v_exp_f32 v45, v45
    v_exp_f32 v46, v46
    v_exp_f32 v47, v47
    v_cvt_pk_bf16_f32 v76, v40, v41
    v_cvt_pk_bf16_f32 v77, v42, v43
    v_cvt_pk_bf16_f32 v78, v44, v45
    v_cvt_pk_bf16_f32 v79, v46, v47
    v_mfma_f32_32x32x16_bf16 v[32:47], v[88:91], v[136:139], 0
    v_exp_f32 v16, v16
    v_exp_f32 v17, v17
    v_exp_f32 v18, v18
    v_exp_f32 v19, v19
    v_mfma_f32_32x32x16_bf16 a[112:127], v[192:195], v[72:75], a[112:127]
    v_exp_f32 v20, v20
    v_exp_f32 v21, v21
    v_exp_f32 v22, v22
    v_exp_f32 v23, v23
    v_cvt_pk_bf16_f32 v64, v16, v17
    v_cvt_pk_bf16_f32 v65, v18, v19
    v_mfma_f32_32x32x16_bf16 v[32:47], v[92:95], v[140:143], v[32:47]
    v_exp_f32 v24, v24
    v_exp_f32 v25, v25
    v_exp_f32 v26, v26
    v_exp_f32 v27, v27
    v_cvt_pk_bf16_f32 v66, v20, v21
    v_cvt_pk_bf16_f32 v67, v22, v23
    v_mfma_f32_32x32x16_bf16 a[112:127], v[196:199], v[76:79], a[112:127]
    v_exp_f32 v28, v28
    v_exp_f32 v29, v29
    v_exp_f32 v30, v30
    v_exp_f32 v31, v31
    v_cvt_pk_bf16_f32 v68, v24, v25
    v_cvt_pk_bf16_f32 v69, v26, v27
    v_cvt_pk_bf16_f32 v70, v28, v29
    v_cvt_pk_bf16_f32 v71, v30, v31
    s_mov_b64 exec, s[74:75]
    buffer_load_dwordx4 v[192:195], v116, s[8:11], s81 offen sc1
    buffer_load_dwordx4 v[196:199], v116, s[8:11], s81 offen offset:1024 sc1
    s_mov_b64 exec, -1
    s_add_u32 s81, s81, 2048
    s_waitcnt vmcnt(2)
    v_mfma_f32_32x32x16_bf16 v[16:31], v[88:91], v[144:147], 0
    v_exp_f32 v32, v32
    v_exp_f32 v33, v33
    v_exp_f32 v34, v34
    v_exp_f32 v35, v35
    v_mfma_f32_32x32x16_bf16 a[0:15], v[200:203], v[64:67], a[0:15]
    v_exp_f32 v36, v36
    v_exp_f32 v37, v37
    v_exp_f32 v38, v38
    v_exp_f32 v39, v39
    v_cvt_pk_bf16_f32 v72, v32, v33
    v_cvt_pk_bf16_f32 v73, v34, v35
    v_mfma_f32_32x32x16_bf16 v[16:31], v[92:95], v[148:151], v[16:31]
    v_exp_f32 v40, v40
    v_exp_f32 v41, v41
    v_exp_f32 v42, v42
    v_exp_f32 v43, v43
    v_cvt_pk_bf16_f32 v74, v36, v37
    v_cvt_pk_bf16_f32 v75, v38, v39
    v_mfma_f32_32x32x16_bf16 a[0:15], v[204:207], v[68:71], a[0:15]
    v_exp_f32 v44, v44
    v_exp_f32 v45, v45
    v_exp_f32 v46, v46
    v_exp_f32 v47, v47
    v_cvt_pk_bf16_f32 v76, v40, v41
    v_cvt_pk_bf16_f32 v77, v42, v43
    v_cvt_pk_bf16_f32 v78, v44, v45
    v_cvt_pk_bf16_f32 v79, v46, v47
    v_mfma_f32_32x32x16_bf16 v[32:47], v[88:91], v[152:155], 0
    v_exp_f32 v16, v16
    v_exp_f32 v17, v17
    v_exp_f32 v18, v18
    v_exp_f32 v19, v19
    v_mfma_f32_32x32x16_bf16 a[16:31], v[200:203], v[72:75], a[16:31]
    v_exp_f32 v20, v20
    v_exp_f32 v21, v21
    v_exp_f32 v22, v22
    v_exp_f32 v23, v23
    v_cvt_pk_bf16_f32 v64, v16, v17
    v_cvt_pk_bf16_f32 v65, v18, v19
    v_mfma_f32_32x32x16_bf16 v[32:47], v[92:95], v[156:159], v[32:47]
    v_exp_f32 v24, v24
    v_exp_f32 v25, v25
    v_exp_f32 v26, v26
    v_exp_f32 v27, v27
    v_cvt_pk_bf16_f32 v66, v20, v21
    v_cvt_pk_bf16_f32 v67, v22, v23
    v_mfma_f32_32x32x16_bf16 a[16:31], v[204:207], v[76:79], a[16:31]
    v_exp_f32 v28, v28
    v_exp_f32 v29, v29
    v_exp_f32 v30, v30
    v_exp_f32 v31, v31
    v_cvt_pk_bf16_f32 v68, v24, v25
    v_cvt_pk_bf16_f32 v69, v26, v27
    v_cvt_pk_bf16_f32 v70, v28, v29
    v_cvt_pk_bf16_f32 v71, v30, v31
    v_mfma_f32_32x32x16_bf16 v[16:31], v[88:91], v[160:163], 0
    v_exp_f32 v32, v32
    v_exp_f32 v33, v33
    v_exp_f32 v34, v34
    v_exp_f32 v35, v35
    v_mfma_f32_32x32x16_bf16 a[32:47], v[200:203], v[64:67], a[32:47]
    v_exp_f32 v36, v36
    v_exp_f32 v37, v37
    v_exp_f32 v38, v38
    v_exp_f32 v39, v39
    v_cvt_pk_bf16_f32 v72, v32, v33
    v_cvt_pk_bf16_f32 v73, v34, v35
    v_mfma_f32_32x32x16_bf16 v[16:31], v[92:95], v[164:167], v[16:31]
    v_exp_f32 v40, v40
    v_exp_f32 v41, v41
    v_exp_f32 v42, v42
    v_exp_f32 v43, v43
    v_cvt_pk_bf16_f32 v74, v36, v37
    v_cvt_pk_bf16_f32 v75, v38, v39
    v_mfma_f32_32x32x16_bf16 a[32:47], v[204:207], v[68:71], a[32:47]
    v_exp_f32 v44, v44
    v_exp_f32 v45, v45
    v_exp_f32 v46, v46
    v_exp_f32 v47, v47
    v_cvt_pk_bf16_f32 v76, v40, v41
    v_cvt_pk_bf16_f32 v77, v42, v43
    v_cvt_pk_bf16_f32 v78, v44, v45
    v_cvt_pk_bf16_f32 v79, v46, v47
    v_mfma_f32_32x32x16_bf16 v[32:47], v[88:91], v[168:171], 0
    v_exp_f32 v16, v16
    v_exp_f32 v17, v17
    v_exp_f32 v18, v18
    v_exp_f32 v19, v19
    v_mfma_f32_32x32x16_bf16 a[48:63], v[200:203], v[72:75], a[48:63]
    v_exp_f32 v20, v20
    v_exp_f32 v21, v21
    v_exp_f32 v22, v22
    v_exp_f32 v23, v23
    v_cvt_pk_bf16_f32 v64, v16, v17
    v_cvt_pk_bf16_f32 v65, v18, v19
    v_mfma_f32_32x32x16_bf16 v[32:47], v[92:95], v[172:175], v[32:47]
    v_exp_f32 v24, v24
    v_exp_f32 v25, v25
    v_exp_f32 v26, v26
    v_exp_f32 v27, v27
    v_cvt_pk_bf16_f32 v66, v20, v21
    v_cvt_pk_bf16_f32 v67, v22, v23
    v_mfma_f32_32x32x16_bf16 a[48:63], v[204:207], v[76:79], a[48:63]
    v_exp_f32 v28, v28
    v_exp_f32 v29, v29
    v_exp_f32 v30, v30
    v_exp_f32 v31, v31
    v_cvt_pk_bf16_f32 v68, v24, v25
    v_cvt_pk_bf16_f32 v69, v26, v27
    v_cvt_pk_bf16_f32 v70, v28, v29
    v_cvt_pk_bf16_f32 v71, v30, v31
    v_mfma_f32_32x32x16_bf16 v[16:31], v[88:91], v[176:179], 0
    v_exp_f32 v32, v32
    v_exp_f32 v33, v33
    v_exp_f32 v34, v34
    v_exp_f32 v35, v35
    v_mfma_f32_32x32x16_bf16 a[64:79], v[200:203], v[64:67], a[64:79]
    v_exp_f32 v36, v36
    v_exp_f32 v37, v37
    v_exp_f32 v38, v38
    v_exp_f32 v39, v39
    v_cvt_pk_bf16_f32 v72, v32, v33
    v_cvt_pk_bf16_f32 v73, v34, v35
    v_mfma_f32_32x32x16_bf16 v[16:31], v[92:95], v[180:183], v[16:31]
    v_exp_f32 v40, v40
    v_exp_f32 v41, v41
    v_exp_f32 v42, v42
    v_exp_f32 v43, v43
    v_cvt_pk_bf16_f32 v74, v36, v37
    v_cvt_pk_bf16_f32 v75, v38, v39
    v_mfma_f32_32x32x16_bf16 a[64:79], v[204:207], v[68:71], a[64:79]
    v_exp_f32 v44, v44
    v_exp_f32 v45, v45
    v_exp_f32 v46, v46
    v_exp_f32 v47, v47
    v_cvt_pk_bf16_f32 v76, v40, v41
    v_cvt_pk_bf16_f32 v77, v42, v43
    v_cvt_pk_bf16_f32 v78, v44, v45
    v_cvt_pk_bf16_f32 v79, v46, v47
    v_mfma_f32_32x32x16_bf16 v[32:47], v[88:91], v[184:187], 0
    v_exp_f32 v16, v16
    v_exp_f32 v17, v17
    v_exp_f32 v18, v18
    v_exp_f32 v19, v19
    v_mfma_f32_32x32x16_bf16 a[80:95], v[200:203], v[72:75], a[80:95]
    v_exp_f32 v20, v20
    v_exp_f32 v21, v21
    v_exp_f32 v22, v22
    v_exp_f32 v23, v23
    v_cvt_pk_bf16_f32 v64, v16, v17
    v_cvt_pk_bf16_f32 v65, v18, v19
    v_mfma_f32_32x32x16_bf16 v[32:47], v[92:95], v[188:191], v[32:47]
    v_exp_f32 v24, v24
    v_exp_f32 v25, v25
    v_exp_f32 v26, v26
    v_exp_f32 v27, v27
    v_cvt_pk_bf16_f32 v66, v20, v21
    v_cvt_pk_bf16_f32 v67, v22, v23
    v_mfma_f32_32x32x16_bf16 a[80:95], v[204:207], v[76:79], a[80:95]
    v_exp_f32 v28, v28
    v_exp_f32 v29, v29
    v_exp_f32 v30, v30
    v_exp_f32 v31, v31
    v_cvt_pk_bf16_f32 v68, v24, v25
    v_cvt_pk_bf16_f32 v69, v26, v27
    v_cvt_pk_bf16_f32 v70, v28, v29
    v_cvt_pk_bf16_f32 v71, v30, v31
    buffer_load_dwordx4 v[88:91], v2, s[8:11], s78 offen sc1
    buffer_load_dwordx2 v[92:93], v3, s[8:11], s79 offen sc1
    s_add_u32 s78, s78, 1024
    s_add_u32 s79, s79, 256
    s_waitcnt vmcnt(2)
    v_mfma_f32_32x32x16_bf16 v[16:31], v[80:83], v[128:131], 0
    v_exp_f32 v32, v32
    v_exp_f32 v33, v33
    v_exp_f32 v34, v34
    v_exp_f32 v35, v35
    v_mfma_f32_32x32x16_bf16 a[96:111], v[200:203], v[64:67], a[96:111]
    v_exp_f32 v36, v36
    v_exp_f32 v37, v37
    v_exp_f32 v38, v38
    v_exp_f32 v39, v39
    v_cvt_pk_bf16_f32 v72, v32, v33
    v_cvt_pk_bf16_f32 v73, v34, v35
    v_mfma_f32_32x32x16_bf16 v[16:31], v[84:87], v[132:135], v[16:31]
    v_exp_f32 v40, v40
    v_exp_f32 v41, v41
    v_exp_f32 v42, v42
    v_exp_f32 v43, v43
    v_cvt_pk_bf16_f32 v74, v36, v37
    v_cvt_pk_bf16_f32 v75, v38, v39
    v_mfma_f32_32x32x16_bf16 a[96:111], v[204:207], v[68:71], a[96:111]
    v_exp_f32 v44, v44
    v_exp_f32 v45, v45
    v_exp_f32 v46, v46
    v_exp_f32 v47, v47
    v_cvt_pk_bf16_f32 v76, v40, v41
    v_cvt_pk_bf16_f32 v77, v42, v43
    v_cvt_pk_bf16_f32 v78, v44, v45
    v_cvt_pk_bf16_f32 v79, v46, v47
    s_add_u32 s80, s80, 1
    s_cmp_lt_u32 s80, 32
    s_cbranch_scc1 A_P2
    v_mfma_f32_32x32x16_bf16 a[112:127], v[200:203], v[72:75], a[112:127]
    v_mfma_f32_32x32x16_bf16 a[112:127], v[204:207], v[76:79], a[112:127]
    s_waitcnt vmcnt(0)
    v_mul_u32_u24 v2, 1280, v1
    v_lshrrev_b32 v7, 5, v0
    v_lshl_add_u32 v2, v7, 3, v2
    v_mov_b32 v3, 1073741824
    v_cndmask_b32 v3, v3, v2, s[76:77]
    s_mul_i32 s6, s71, 327680
    s_mul_i32 s7, s70, 40
    s_add_u32 s6, s6, s7
    s_add_u32 s6, s6, 130023424
    v_accvgpr_read_b32 v16, a0
    v_accvgpr_read_b32 v17, a1
    v_accvgpr_read_b32 v18, a2
    v_accvgpr_read_b32 v19, a3
    v_accvgpr_read_b32 v20, a4
    v_accvgpr_read_b32 v21, a5
    v_accvgpr_read_b32 v22, a6
    v_accvgpr_read_b32 v23, a7
    v_accvgpr_read_b32 v24, a8
    v_accvgpr_read_b32 v25, a9
    v_accvgpr_read_b32 v26, a10
    v_accvgpr_read_b32 v27, a11
    v_mov_b32 v28, v24
    v_mov_b32 v29, v24
    s_nop 1
    v_permlane32_swap_b32 v28, v29
    v_rcp_f32 v29, v29
    s_nop 0
    v_mul_f32 v16, v29, v16
    v_mul_f32 v17, v29, v17
    v_mul_f32 v18, v29, v18
    v_mul_f32 v19, v29, v19
    v_mul_f32 v20, v29, v20
    v_mul_f32 v21, v29, v21
    v_mul_f32 v22, v29, v22
    v_mul_f32 v23, v29, v23
    v_mul_f32 v24, v29, v24
    v_mul_f32 v25, v29, v25
    v_mul_f32 v26, v29, v26
    v_mul_f32 v27, v29, v27
    v_cvt_pk_bf16_f32 v16, v16, v17
    v_cvt_pk_bf16_f32 v17, v18, v19
    v_cvt_pk_bf16_f32 v18, v20, v21
    v_cvt_pk_bf16_f32 v19, v22, v23
    v_cvt_pk_bf16_f32 v20, v24, v25
    v_cvt_pk_bf16_f32 v21, v26, v27
    buffer_store_dwordx2 v[16:17], v2, s[8:11], s6 offen sc1
    buffer_store_dwordx2 v[18:19], v2, s[8:11], s6 offen offset:16 sc1
    buffer_store_dwordx2 v[20:21], v3, s[8:11], s6 offen offset:32 sc1
    s_add_u32 s6, s6, 40960
    v_accvgpr_read_b32 v32, a16
    v_accvgpr_read_b32 v33, a17
    v_accvgpr_read_b32 v34, a18
    v_accvgpr_read_b32 v35, a19
    v_accvgpr_read_b32 v36, a20
    v_accvgpr_read_b32 v37, a21
    v_accvgpr_read_b32 v38, a22
    v_accvgpr_read_b32 v39, a23
    v_accvgpr_read_b32 v40, a24
    v_accvgpr_read_b32 v41, a25
    v_accvgpr_read_b32 v42, a26
    v_accvgpr_read_b32 v43, a27
    v_mov_b32 v44, v40
    v_mov_b32 v45, v40
    s_nop 1
    v_permlane32_swap_b32 v44, v45
    v_rcp_f32 v45, v45
    s_nop 0
    v_mul_f32 v32, v45, v32
    v_mul_f32 v33, v45, v33
    v_mul_f32 v34, v45, v34
    v_mul_f32 v35, v45, v35
    v_mul_f32 v36, v45, v36
    v_mul_f32 v37, v45, v37
    v_mul_f32 v38, v45, v38
    v_mul_f32 v39, v45, v39
    v_mul_f32 v40, v45, v40
    v_mul_f32 v41, v45, v41
    v_mul_f32 v42, v45, v42
    v_mul_f32 v43, v45, v43
    v_cvt_pk_bf16_f32 v32, v32, v33
    v_cvt_pk_bf16_f32 v33, v34, v35
    v_cvt_pk_bf16_f32 v34, v36, v37
    v_cvt_pk_bf16_f32 v35, v38, v39
    v_cvt_pk_bf16_f32 v36, v40, v41
    v_cvt_pk_bf16_f32 v37, v42, v43
    buffer_store_dwordx2 v[32:33], v2, s[8:11], s6 offen sc1
    buffer_store_dwordx2 v[34:35], v2, s[8:11], s6 offen offset:16 sc1
    buffer_store_dwordx2 v[36:37], v3, s[8:11], s6 offen offset:32 sc1
    s_add_u32 s6, s6, 40960
    v_accvgpr_read_b32 v16, a32
    v_accvgpr_read_b32 v17, a33
    v_accvgpr_read_b32 v18, a34
    v_accvgpr_read_b32 v19, a35
    v_accvgpr_read_b32 v20, a36
    v_accvgpr_read_b32 v21, a37
    v_accvgpr_read_b32 v22, a38
    v_accvgpr_read_b32 v23, a39
    v_accvgpr_read_b32 v24, a40
    v_accvgpr_read_b32 v25, a41
    v_accvgpr_read_b32 v26, a42
    v_accvgpr_read_b32 v27, a43
    v_mov_b32 v28, v24
    v_mov_b32 v29, v24
    s_nop 1
    v_permlane32_swap_b32 v28, v29
    v_rcp_f32 v29, v29
    s_nop 0
    v_mul_f32 v16, v29, v16
    v_mul_f32 v17, v29, v17
    v_mul_f32 v18, v29, v18
    v_mul_f32 v19, v29, v19
    v_mul_f32 v20, v29, v20
    v_mul_f32 v21, v29, v21
    v_mul_f32 v22, v29, v22
    v_mul_f32 v23, v29, v23
    v_mul_f32 v24, v29, v24
    v_mul_f32 v25, v29, v25
    v_mul_f32 v26, v29, v26
    v_mul_f32 v27, v29, v27
    v_cvt_pk_bf16_f32 v16, v16, v17
    v_cvt_pk_bf16_f32 v17, v18, v19
    v_cvt_pk_bf16_f32 v18, v20, v21
    v_cvt_pk_bf16_f32 v19, v22, v23
    v_cvt_pk_bf16_f32 v20, v24, v25
    v_cvt_pk_bf16_f32 v21, v26, v27
    buffer_store_dwordx2 v[16:17], v2, s[8:11], s6 offen sc1
    buffer_store_dwordx2 v[18:19], v2, s[8:11], s6 offen offset:16 sc1
    buffer_store_dwordx2 v[20:21], v3, s[8:11], s6 offen offset:32 sc1
    s_add_u32 s6, s6, 40960
    v_accvgpr_read_b32 v32, a48
    v_accvgpr_read_b32 v33, a49
    v_accvgpr_read_b32 v34, a50
    v_accvgpr_read_b32 v35, a51
    v_accvgpr_read_b32 v36, a52
    v_accvgpr_read_b32 v37, a53
    v_accvgpr_read_b32 v38, a54
    v_accvgpr_read_b32 v39, a55
    v_accvgpr_read_b32 v40, a56
    v_accvgpr_read_b32 v41, a57
    v_accvgpr_read_b32 v42, a58
    v_accvgpr_read_b32 v43, a59
    v_mov_b32 v44, v40
    v_mov_b32 v45, v40
    s_nop 1
    v_permlane32_swap_b32 v44, v45
    v_rcp_f32 v45, v45
    s_nop 0
    v_mul_f32 v32, v45, v32
    v_mul_f32 v33, v45, v33
    v_mul_f32 v34, v45, v34
    v_mul_f32 v35, v45, v35
    v_mul_f32 v36, v45, v36
    v_mul_f32 v37, v45, v37
    v_mul_f32 v38, v45, v38
    v_mul_f32 v39, v45, v39
    v_mul_f32 v40, v45, v40
    v_mul_f32 v41, v45, v41
    v_mul_f32 v42, v45, v42
    v_mul_f32 v43, v45, v43
    v_cvt_pk_bf16_f32 v32, v32, v33
    v_cvt_pk_bf16_f32 v33, v34, v35
    v_cvt_pk_bf16_f32 v34, v36, v37
    v_cvt_pk_bf16_f32 v35, v38, v39
    v_cvt_pk_bf16_f32 v36, v40, v41
    v_cvt_pk_bf16_f32 v37, v42, v43
    buffer_store_dwordx2 v[32:33], v2, s[8:11], s6 offen sc1
    buffer_store_dwordx2 v[34:35], v2, s[8:11], s6 offen offset:16 sc1
    buffer_store_dwordx2 v[36:37], v3, s[8:11], s6 offen offset:32 sc1
    s_add_u32 s6, s6, 40960
    v_accvgpr_read_b32 v16, a64
    v_accvgpr_read_b32 v17, a65
    v_accvgpr_read_b32 v18, a66
    v_accvgpr_read_b32 v19, a67
    v_accvgpr_read_b32 v20, a68
    v_accvgpr_read_b32 v21, a69
    v_accvgpr_read_b32 v22, a70
    v_accvgpr_read_b32 v23, a71
    v_accvgpr_read_b32 v24, a72
    v_accvgpr_read_b32 v25, a73
    v_accvgpr_read_b32 v26, a74
    v_accvgpr_read_b32 v27, a75
    v_mov_b32 v28, v24
    v_mov_b32 v29, v24
    s_nop 1
    v_permlane32_swap_b32 v28, v29
    v_rcp_f32 v29, v29
    s_nop 0
    v_mul_f32 v16, v29, v16
    v_mul_f32 v17, v29, v17
    v_mul_f32 v18, v29, v18
    v_mul_f32 v19, v29, v19
    v_mul_f32 v20, v29, v20
    v_mul_f32 v21, v29, v21
    v_mul_f32 v22, v29, v22
    v_mul_f32 v23, v29, v23
    v_mul_f32 v24, v29, v24
    v_mul_f32 v25, v29, v25
    v_mul_f32 v26, v29, v26
    v_mul_f32 v27, v29, v27
    v_cvt_pk_bf16_f32 v16, v16, v17
    v_cvt_pk_bf16_f32 v17, v18, v19
    v_cvt_pk_bf16_f32 v18, v20, v21
    v_cvt_pk_bf16_f32 v19, v22, v23
    v_cvt_pk_bf16_f32 v20, v24, v25
    v_cvt_pk_bf16_f32 v21, v26, v27
    buffer_store_dwordx2 v[16:17], v2, s[8:11], s6 offen sc1
    buffer_store_dwordx2 v[18:19], v2, s[8:11], s6 offen offset:16 sc1
    buffer_store_dwordx2 v[20:21], v3, s[8:11], s6 offen offset:32 sc1
    s_add_u32 s6, s6, 40960
    v_accvgpr_read_b32 v32, a80
    v_accvgpr_read_b32 v33, a81
    v_accvgpr_read_b32 v34, a82
    v_accvgpr_read_b32 v35, a83
    v_accvgpr_read_b32 v36, a84
    v_accvgpr_read_b32 v37, a85
    v_accvgpr_read_b32 v38, a86
    v_accvgpr_read_b32 v39, a87
    v_accvgpr_read_b32 v40, a88
    v_accvgpr_read_b32 v41, a89
    v_accvgpr_read_b32 v42, a90
    v_accvgpr_read_b32 v43, a91
    v_mov_b32 v44, v40
    v_mov_b32 v45, v40
    s_nop 1
    v_permlane32_swap_b32 v44, v45
    v_rcp_f32 v45, v45
    s_nop 0
    v_mul_f32 v32, v45, v32
    v_mul_f32 v33, v45, v33
    v_mul_f32 v34, v45, v34
    v_mul_f32 v35, v45, v35
    v_mul_f32 v36, v45, v36
    v_mul_f32 v37, v45, v37
    v_mul_f32 v38, v45, v38
    v_mul_f32 v39, v45, v39
    v_mul_f32 v40, v45, v40
    v_mul_f32 v41, v45, v41
    v_mul_f32 v42, v45, v42
    v_mul_f32 v43, v45, v43
    v_cvt_pk_bf16_f32 v32, v32, v33
    v_cvt_pk_bf16_f32 v33, v34, v35
    v_cvt_pk_bf16_f32 v34, v36, v37
    v_cvt_pk_bf16_f32 v35, v38, v39
    v_cvt_pk_bf16_f32 v36, v40, v41
    v_cvt_pk_bf16_f32 v37, v42, v43
    buffer_store_dwordx2 v[32:33], v2, s[8:11], s6 offen sc1
    buffer_store_dwordx2 v[34:35], v2, s[8:11], s6 offen offset:16 sc1
    buffer_store_dwordx2 v[36:37], v3, s[8:11], s6 offen offset:32 sc1
    s_add_u32 s6, s6, 40960
    v_accvgpr_read_b32 v16, a96
    v_accvgpr_read_b32 v17, a97
    v_accvgpr_read_b32 v18, a98
    v_accvgpr_read_b32 v19, a99
    v_accvgpr_read_b32 v20, a100
    v_accvgpr_read_b32 v21, a101
    v_accvgpr_read_b32 v22, a102
    v_accvgpr_read_b32 v23, a103
    v_accvgpr_read_b32 v24, a104
    v_accvgpr_read_b32 v25, a105
    v_accvgpr_read_b32 v26, a106
    v_accvgpr_read_b32 v27, a107
    v_mov_b32 v28, v24
    v_mov_b32 v29, v24
    s_nop 1
    v_permlane32_swap_b32 v28, v29
    v_rcp_f32 v29, v29
    s_nop 0
    v_mul_f32 v16, v29, v16
    v_mul_f32 v17, v29, v17
    v_mul_f32 v18, v29, v18
    v_mul_f32 v19, v29, v19
    v_mul_f32 v20, v29, v20
    v_mul_f32 v21, v29, v21
    v_mul_f32 v22, v29, v22
    v_mul_f32 v23, v29, v23
    v_mul_f32 v24, v29, v24
    v_mul_f32 v25, v29, v25
    v_mul_f32 v26, v29, v26
    v_mul_f32 v27, v29, v27
    v_cvt_pk_bf16_f32 v16, v16, v17
    v_cvt_pk_bf16_f32 v17, v18, v19
    v_cvt_pk_bf16_f32 v18, v20, v21
    v_cvt_pk_bf16_f32 v19, v22, v23
    v_cvt_pk_bf16_f32 v20, v24, v25
    v_cvt_pk_bf16_f32 v21, v26, v27
    buffer_store_dwordx2 v[16:17], v2, s[8:11], s6 offen sc1
    buffer_store_dwordx2 v[18:19], v2, s[8:11], s6 offen offset:16 sc1
    buffer_store_dwordx2 v[20:21], v3, s[8:11], s6 offen offset:32 sc1
    s_add_u32 s6, s6, 40960
    v_accvgpr_read_b32 v32, a112
    v_accvgpr_read_b32 v33, a113
    v_accvgpr_read_b32 v34, a114
    v_accvgpr_read_b32 v35, a115
    v_accvgpr_read_b32 v36, a116
    v_accvgpr_read_b32 v37, a117
    v_accvgpr_read_b32 v38, a118
    v_accvgpr_read_b32 v39, a119
    v_accvgpr_read_b32 v40, a120
    v_accvgpr_read_b32 v41, a121
    v_accvgpr_read_b32 v42, a122
    v_accvgpr_read_b32 v43, a123
    v_mov_b32 v44, v40
    v_mov_b32 v45, v40
    s_nop 1
    v_permlane32_swap_b32 v44, v45
    v_rcp_f32 v45, v45
    s_nop 0
    v_mul_f32 v32, v45, v32
    v_mul_f32 v33, v45, v33
    v_mul_f32 v34, v45, v34
    v_mul_f32 v35, v45, v35
    v_mul_f32 v36, v45, v36
    v_mul_f32 v37, v45, v37
    v_mul_f32 v38, v45, v38
    v_mul_f32 v39, v45, v39
    v_mul_f32 v40, v45, v40
    v_mul_f32 v41, v45, v41
    v_mul_f32 v42, v45, v42
    v_mul_f32 v43, v45, v43
    v_cvt_pk_bf16_f32 v32, v32, v33
    v_cvt_pk_bf16_f32 v33, v34, v35
    v_cvt_pk_bf16_f32 v34, v36, v37
    v_cvt_pk_bf16_f32 v35, v38, v39
    v_cvt_pk_bf16_f32 v36, v40, v41
    v_cvt_pk_bf16_f32 v37, v42, v43
    buffer_store_dwordx2 v[32:33], v2, s[8:11], s6 offen sc1
    buffer_store_dwordx2 v[34:35], v2, s[8:11], s6 offen offset:16 sc1
    buffer_store_dwordx2 v[36:37], v3, s[8:11], s6 offen offset:32 sc1
    s_add_u32 s6, s6, 40960
    s_waitcnt vmcnt(0)
    s_lshl_b32 s33, s71, 5
    s_add_u32 s33, s33, 8
    v_mov_b32 v3, s33
    v_mov_b32 v2, 1
    s_mov_b64 exec, 1
    buffer_atomic_add v2, v3, s[24:27], 0 offen sc1
    s_mov_b64 exec, -1
    s_mov_b32 s16, s40
    s_and_b32 s17, s41, 0xffff
    s_mov_b32 s18, 819200
    s_mov_b32 s19, 0x20000
    s_mul_i32 s67, s64, 160
    s_barrier
    s_mov_b32 s7, 52429
    s_mov_b32 s33, 1280
    v_add_u32 v2, 0, v0
    v_mul_lo_u32 v3, v2, s7
    v_lshrrev_b32 v3, 19, v3
    v_mul_u32_u24 v8, 10, v3
    v_sub_u32 v2, v2, v8
    v_and_b32 v8, 0x13, v3
    v_and_b32 v7, 4, v3
    v_lshl_or_b32 v8, v7, 1, v8
    v_and_b32 v7, 8, v3
    v_lshrrev_b32 v7, 1, v7
    v_or_b32 v8, v8, v7
    v_mul_lo_u32 v8, v8, s33
    v_lshl_add_u32 v8, v2, 4, v8
    v_add_u32 v2, 64, v0
    v_mul_lo_u32 v3, v2, s7
    v_lshrrev_b32 v3, 19, v3
    v_mul_u32_u24 v9, 10, v3
    v_sub_u32 v2, v2, v9
    v_and_b32 v9, 0x13, v3
    v_and_b32 v7, 4, v3
    v_lshl_or_b32 v9, v7, 1, v9
    v_and_b32 v7, 8, v3
    v_lshrrev_b32 v7, 1, v7
    v_or_b32 v9, v9, v7
    v_mul_lo_u32 v9, v9, s33
    v_lshl_add_u32 v9, v2, 4, v9
    v_add_u32 v2, 128, v0
    v_mul_lo_u32 v3, v2, s7
    v_lshrrev_b32 v3, 19, v3
    v_mul_u32_u24 v10, 10, v3
    v_sub_u32 v2, v2, v10
    v_and_b32 v10, 0x13, v3
    v_and_b32 v7, 4, v3
    v_lshl_or_b32 v10, v7, 1, v10
    v_and_b32 v7, 8, v3
    v_lshrrev_b32 v7, 1, v7
    v_or_b32 v10, v10, v7
    v_mul_lo_u32 v10, v10, s33
    v_lshl_add_u32 v10, v2, 4, v10
    v_add_u32 v2, 192, v0
    v_mul_lo_u32 v3, v2, s7
    v_lshrrev_b32 v3, 19, v3
    v_mul_u32_u24 v11, 10, v3
    v_sub_u32 v2, v2, v11
    v_and_b32 v11, 0x13, v3
    v_and_b32 v7, 4, v3
    v_lshl_or_b32 v11, v7, 1, v11
    v_and_b32 v7, 8, v3
    v_lshrrev_b32 v7, 1, v7
    v_or_b32 v11, v11, v7
    v_mul_lo_u32 v11, v11, s33
    v_lshl_add_u32 v11, v2, 4, v11
    v_add_u32 v2, 256, v0
    v_mul_lo_u32 v3, v2, s7
    v_lshrrev_b32 v3, 19, v3
    v_mul_u32_u24 v12, 10, v3
    v_sub_u32 v2, v2, v12
    v_and_b32 v12, 0x13, v3
    v_and_b32 v7, 4, v3
    v_lshl_or_b32 v12, v7, 1, v12
    v_and_b32 v7, 8, v3
    v_lshrrev_b32 v7, 1, v7
    v_or_b32 v12, v12, v7
    v_mul_lo_u32 v12, v12, s33
    v_lshl_add_u32 v12, v2, 4, v12
    s_mul_i32 s6, s3, 204800
    s_add_u32 s6, s6, s67
    s_mul_i32 s34, s3, 25600
    s_add_u32 m0, s34, 0
    s_nop 0
    buffer_load_dwordx4 v8, s[16:19], s6 offen lds
    s_add_u32 m0, s34, 1024
    s_nop 0
    buffer_load_dwordx4 v9, s[16:19], s6 offen lds
    s_add_u32 m0, s34, 2048
    s_nop 0
    buffer_load_dwordx4 v10, s[16:19], s6 offen lds
    s_add_u32 m0, s34, 3072
    s_nop 0
    buffer_load_dwordx4 v11, s[16:19], s6 offen lds
    s_add_u32 m0, s34, 4096
    s_nop 0
    buffer_load_dwordx4 v12, s[16:19], s6 offen lds
    s_add_u32 s6, s6, 40960
    s_add_u32 m0, s34, 5120
    s_nop 0
    buffer_load_dwordx4 v8, s[16:19], s6 offen lds
    s_add_u32 m0, s34, 6144
    s_nop 0
    buffer_load_dwordx4 v9, s[16:19], s6 offen lds
    s_add_u32 m0, s34, 7168
    s_nop 0
    buffer_load_dwordx4 v10, s[16:19], s6 offen lds
    s_add_u32 m0, s34, 8192
    s_nop 0
    buffer_load_dwordx4 v11, s[16:19], s6 offen lds
    s_add_u32 m0, s34, 9216
    s_nop 0
    buffer_load_dwordx4 v12, s[16:19], s6 offen lds
    s_add_u32 s6, s6, 40960
    s_add_u32 m0, s34, 10240
    s_nop 0
    buffer_load_dwordx4 v8, s[16:19], s6 offen lds
    s_add_u32 m0, s34, 11264
    s_nop 0
    buffer_load_dwordx4 v9, s[16:19], s6 offen lds
    s_add_u32 m0, s34, 12288
    s_nop 0
    buffer_load_dwordx4 v10, s[16:19], s6 offen lds
    s_add_u32 m0, s34, 13312
    s_nop 0
    buffer_load_dwordx4 v11, s[16:19], s6 offen lds
    s_add_u32 m0, s34, 14336
    s_nop 0
    buffer_load_dwordx4 v12, s[16:19], s6 offen lds
    s_add_u32 s6, s6, 40960
    s_add_u32 m0, s34, 15360
    s_nop 0
    buffer_load_dwordx4 v8, s[16:19], s6 offen lds
    s_add_u32 m0, s34, 16384
    s_nop 0
    buffer_load_dwordx4 v9, s[16:19], s6 offen lds
    s_add_u32 m0, s34, 17408
    s_nop 0
    buffer_load_dwordx4 v10, s[16:19], s6 offen lds
    s_add_u32 m0, s34, 18432
    s_nop 0
    buffer_load_dwordx4 v11, s[16:19], s6 offen lds
    s_add_u32 m0, s34, 19456
    s_nop 0
    buffer_load_dwordx4 v12, s[16:19], s6 offen lds
    s_add_u32 s6, s6, 40960
    s_add_u32 m0, s34, 20480
    s_nop 0
    buffer_load_dwordx4 v8, s[16:19], s6 offen lds
    s_add_u32 m0, s34, 21504
    s_nop 0
    buffer_load_dwordx4 v9, s[16:19], s6 offen lds
    s_add_u32 m0, s34, 22528
    s_nop 0
    buffer_load_dwordx4 v10, s[16:19], s6 offen lds
    s_add_u32 m0, s34, 23552
    s_nop 0
    buffer_load_dwordx4 v11, s[16:19], s6 offen lds
    s_add_u32 m0, s34, 24576
    s_nop 0
    buffer_load_dwordx4 v12, s[16:19], s6 offen lds
    s_add_u32 s6, s6, 40960
    v_lshrrev_b32 v2, 5, v0
    v_lshlrev_b32 v2, 4, v2
    v_bfe_u32 v3, v0, 2, 3
    v_add_u32 v2, v2, v3
    v_mul_u32_u24 v2, 160, v2
    v_and_b32 v3, 3, v0
    v_lshl_add_u32 v13, v3, 3, v2
    v_add_u32 v14, 51200, v13
    s_waitcnt vmcnt(0)
    s_barrier
    v_mov_b32 v3, 204
PC_19:
    buffer_load_dword v2, v3, s[24:27], 0 offen sc1
    s_waitcnt vmcnt(0)
    v_readfirstlane_b32 s6, v2
    s_and_b32 s7, s6, 255
    s_cmp_ge_u32 s7, 64
    s_cbranch_scc1 PD_20
    s_sleep 3
    s_sub_u32 s32, s32, 1
    s_cbranch_scc0 PC_19
    s_endpgm
PD_20:
    s_lshl_b32 s33, s65, 5
    s_add_u32 s33, s33, 8
    v_mov_b32 v3, s33
PC_21:
    buffer_load_dword v2, v3, s[24:27], 0 offen sc1
    s_waitcnt vmcnt(0)
    v_readfirstlane_b32 s6, v2
    s_and_b32 s7, s6, 255
    s_cmp_ge_u32 s7, 32
    s_cbranch_scc1 PD_22
    s_sleep 3
    s_sub_u32 s32, s32, 1
    s_cbranch_scc0 PC_21
    s_endpgm
PD_22:
    s_mul_i32 s6, s66, 1280
    s_add_u32 s6, s6, 130023424
    buffer_load_dwordx4 a[0:3], v6, s[8:11], s6 offen offset:0 sc1
    buffer_load_dwordx4 a[4:7], v6, s[8:11], s6 offen offset:64 sc1
    buffer_load_dwordx4 a[8:11], v6, s[8:11], s6 offen offset:128 sc1
    buffer_load_dwordx4 a[12:15], v6, s[8:11], s6 offen offset:192 sc1
    buffer_load_dwordx4 a[16:19], v6, s[8:11], s6 offen offset:256 sc1
    buffer_load_dwordx4 a[20:23], v6, s[8:11], s6 offen offset:320 sc1
    buffer_load_dwordx4 a[24:27], v6, s[8:11], s6 offen offset:384 sc1
    buffer_load_dwordx4 a[28:31], v6, s[8:11], s6 offen offset:448 sc1
    buffer_load_dwordx4 a[32:35], v6, s[8:11], s6 offen offset:512 sc1
    buffer_load_dwordx4 a[36:39], v6, s[8:11], s6 offen offset:576 sc1
    buffer_load_dwordx4 a[40:43], v6, s[8:11], s6 offen offset:640 sc1
    buffer_load_dwordx4 a[44:47], v6, s[8:11], s6 offen offset:704 sc1
    buffer_load_dwordx4 a[48:51], v6, s[8:11], s6 offen offset:768 sc1
    buffer_load_dwordx4 a[52:55], v6, s[8:11], s6 offen offset:832 sc1
    buffer_load_dwordx4 a[56:59], v6, s[8:11], s6 offen offset:896 sc1
    buffer_load_dwordx4 a[60:63], v6, s[8:11], s6 offen offset:960 sc1
    buffer_load_dwordx4 a[64:67], v6, s[8:11], s6 offen offset:1024 sc1
    buffer_load_dwordx4 a[68:71], v6, s[8:11], s6 offen offset:1088 sc1
    buffer_load_dwordx4 a[72:75], v6, s[8:11], s6 offen offset:1152 sc1
    buffer_load_dwordx4 a[76:79], v6, s[8:11], s6 offen offset:1216 sc1
    s_add_u32 s6, s6, 20480
    buffer_load_dwordx4 a[80:83], v6, s[8:11], s6 offen offset:0 sc1
    buffer_load_dwordx4 a[84:87], v6, s[8:11], s6 offen offset:64 sc1
    buffer_load_dwordx4 a[88:91], v6, s[8:11], s6 offen offset:128 sc1
    buffer_load_dwordx4 a[92:95], v6, s[8:11], s6 offen offset:192 sc1
    buffer_load_dwordx4 a[96:99], v6, s[8:11], s6 offen offset:256 sc1
    buffer_load_dwordx4 a[100:103], v6, s[8:11], s6 offen offset:320 sc1
    buffer_load_dwordx4 a[104:107], v6, s[8:11], s6 offen offset:384 sc1
    buffer_load_dwordx4 a[108:111], v6, s[8:11], s6 offen offset:448 sc1
    buffer_load_dwordx4 a[112:115], v6, s[8:11], s6 offen offset:512 sc1
    buffer_load_dwordx4 a[116:119], v6, s[8:11], s6 offen offset:576 sc1
    buffer_load_dwordx4 a[120:123], v6, s[8:11], s6 offen offset:640 sc1
    buffer_load_dwordx4 a[124:127], v6, s[8:11], s6 offen offset:704 sc1
    buffer_load_dwordx4 a[128:131], v6, s[8:11], s6 offen offset:768 sc1
    buffer_load_dwordx4 a[132:135], v6, s[8:11], s6 offen offset:832 sc1
    buffer_load_dwordx4 a[136:139], v6, s[8:11], s6 offen offset:896 sc1
    buffer_load_dwordx4 a[140:143], v6, s[8:11], s6 offen offset:960 sc1
    buffer_load_dwordx4 a[144:147], v6, s[8:11], s6 offen offset:1024 sc1
    buffer_load_dwordx4 a[148:151], v6, s[8:11], s6 offen offset:1088 sc1
    buffer_load_dwordx4 a[152:155], v6, s[8:11], s6 offen offset:1152 sc1
    buffer_load_dwordx4 a[156:159], v6, s[8:11], s6 offen offset:1216 sc1
    s_add_u32 s6, s6, 20480
    buffer_load_dwordx4 a[160:163], v6, s[8:11], s6 offen offset:0 sc1
    buffer_load_dwordx4 a[164:167], v6, s[8:11], s6 offen offset:64 sc1
    buffer_load_dwordx4 a[168:171], v6, s[8:11], s6 offen offset:128 sc1
    buffer_load_dwordx4 a[172:175], v6, s[8:11], s6 offen offset:192 sc1
    buffer_load_dwordx4 a[176:179], v6, s[8:11], s6 offen offset:256 sc1
    buffer_load_dwordx4 a[180:183], v6, s[8:11], s6 offen offset:320 sc1
    buffer_load_dwordx4 a[184:187], v6, s[8:11], s6 offen offset:384 sc1
    buffer_load_dwordx4 a[188:191], v6, s[8:11], s6 offen offset:448 sc1
    buffer_load_dwordx4 a[192:195], v6, s[8:11], s6 offen offset:512 sc1
    buffer_load_dwordx4 a[196:199], v6, s[8:11], s6 offen offset:576 sc1
    buffer_load_dwordx4 a[200:203], v6, s[8:11], s6 offen offset:640 sc1
    buffer_load_dwordx4 a[204:207], v6, s[8:11], s6 offen offset:704 sc1
    buffer_load_dwordx4 a[208:211], v6, s[8:11], s6 offen offset:768 sc1
    buffer_load_dwordx4 a[212:215], v6, s[8:11], s6 offen offset:832 sc1
    buffer_load_dwordx4 a[216:219], v6, s[8:11], s6 offen offset:896 sc1
    buffer_load_dwordx4 a[220:223], v6, s[8:11], s6 offen offset:960 sc1
    buffer_load_dwordx4 a[224:227], v6, s[8:11], s6 offen offset:1024 sc1
    buffer_load_dwordx4 a[228:231], v6, s[8:11], s6 offen offset:1088 sc1
    buffer_load_dwordx4 a[232:235], v6, s[8:11], s6 offen offset:1152 sc1
    buffer_load_dwordx4 a[236:239], v6, s[8:11], s6 offen offset:1216 sc1
    s_add_u32 s6, s6, 20480
    s_waitcnt vmcnt(40)
    buffer_load_dwordx4 a[240:243], v6, s[8:11], s6 offen offset:0 sc1
    buffer_load_dwordx4 a[244:247], v6, s[8:11], s6 offen offset:64 sc1
    buffer_load_dwordx4 a[248:251], v6, s[8:11], s6 offen offset:128 sc1
    buffer_load_dwordx4 a[252:255], v6, s[8:11], s6 offen offset:192 sc1
    buffer_load_dwordx4 v[192:195], v6, s[8:11], s6 offen offset:256 sc1
    buffer_load_dwordx4 v[196:199], v6, s[8:11], s6 offen offset:320 sc1
    buffer_load_dwordx4 v[200:203], v6, s[8:11], s6 offen offset:384 sc1
    buffer_load_dwordx4 v[204:207], v6, s[8:11], s6 offen offset:448 sc1
    buffer_load_dwordx4 v[208:211], v6, s[8:11], s6 offen offset:512 sc1
    buffer_load_dwordx4 v[212:215], v6, s[8:11], s6 offen offset:576 sc1
    buffer_load_dwordx4 v[216:219], v6, s[8:11], s6 offen offset:640 sc1
    buffer_load_dwordx4 v[220:223], v6, s[8:11], s6 offen offset:704 sc1
    buffer_load_dwordx4 v[224:227], v6, s[8:11], s6 offen offset:768 sc1
    buffer_load_dwordx4 v[228:231], v6, s[8:11], s6 offen offset:832 sc1
    buffer_load_dwordx4 v[232:235], v6, s[8:11], s6 offen offset:896 sc1
    buffer_load_dwordx4 v[236:239], v6, s[8:11], s6 offen offset:960 sc1
    buffer_load_dwordx4 v[240:243], v6, s[8:11], s6 offen offset:1024 sc1
    buffer_load_dwordx4 v[244:247], v6, s[8:11], s6 offen offset:1088 sc1
    buffer_load_dwordx4 v[248:251], v6, s[8:11], s6 offen offset:1152 sc1
    buffer_load_dwordx4 v[252:255], v6, s[8:11], s6 offen offset:1216 sc1
    s_add_u32 s6, s6, 20480
    s_waitcnt vmcnt(0)
    ds_read_b64_tr_b16 v[96:97], v13 offset:0
    ds_read_b64_tr_b16 v[98:99], v13 offset:1280
    ds_read_b64_tr_b16 v[100:101], v13 offset:32
    ds_read_b64_tr_b16 v[102:103], v13 offset:1312
    ds_read_b64_tr_b16 v[104:105], v13 offset:64
    ds_read_b64_tr_b16 v[106:107], v13 offset:1344
    s_waitcnt lgkmcnt(4)
    v_mfma_f32_16x16x32_bf16 v[16:19], v[96:99], a[0:3], 0
    v_mfma_f32_16x16x32_bf16 v[36:39], v[96:99], a[80:83], 0
    ds_read_b64_tr_b16 v[108:109], v13 offset:96
    v_mfma_f32_16x16x32_bf16 v[56:59], v[96:99], a[160:163], 0
    ds_read_b64_tr_b16 v[110:111], v13 offset:1376
    v_mfma_f32_16x16x32_bf16 v[76:79], v[96:99], a[240:243], 0
    s_waitcnt lgkmcnt(4)
    v_mfma_f32_16x16x32_bf16 v[20:23], v[100:103], a[0:3], 0
    v_mfma_f32_16x16x32_bf16 v[40:43], v[100:103], a[80:83], 0
    ds_read_b64_tr_b16 v[96:97], v13 offset:128
    v_mfma_f32_16x16x32_bf16 v[60:63], v[100:103], a[160:163], 0
    ds_read_b64_tr_b16 v[98:99], v13 offset:1408
    v_mfma_f32_16x16x32_bf16 v[80:83], v[100:103], a[240:243], 0
    s_waitcnt lgkmcnt(4)
    v_mfma_f32_16x16x32_bf16 v[24:27], v[104:107], a[0:3], 0
    v_mfma_f32_16x16x32_bf16 v[44:47], v[104:107], a[80:83], 0
    ds_read_b64_tr_b16 v[100:101], v13 offset:5120
    v_mfma_f32_16x16x32_bf16 v[64:67], v[104:107], a[160:163], 0
    ds_read_b64_tr_b16 v[102:103], v13 offset:6400
    v_mfma_f32_16x16x32_bf16 v[84:87], v[104:107], a[240:243], 0
    s_waitcnt lgkmcnt(4)
    v_mfma_f32_16x16x32_bf16 v[28:31], v[108:111], a[0:3], 0
    v_mfma_f32_16x16x32_bf16 v[48:51], v[108:111], a[80:83], 0
    ds_read_b64_tr_b16 v[104:105], v13 offset:5152
    v_mfma_f32_16x16x32_bf16 v[68:71], v[108:111], a[160:163], 0
    ds_read_b64_tr_b16 v[106:107], v13 offset:6432
    v_mfma_f32_16x16x32_bf16 v[88:91], v[108:111], a[240:243], 0
    s_waitcnt lgkmcnt(4)
    v_mfma_f32_16x16x32_bf16 v[32:35], v[96:99], a[0:3], 0
    v_mfma_f32_16x16x32_bf16 v[52:55], v[96:99], a[80:83], 0
    ds_read_b64_tr_b16 v[108:109], v13 offset:5184
    v_mfma_f32_16x16x32_bf16 v[72:75], v[96:99], a[160:163], 0
    ds_read_b64_tr_b16 v[110:111], v13 offset:6464
    v_mfma_f32_16x16x32_bf16 v[92:95], v[96:99], a[240:243], 0
    s_waitcnt lgkmcnt(4)
    v_mfma_f32_16x16x32_bf16 v[16:19], v[100:103], a[4:7], v[16:19]
    v_mfma_f32_16x16x32_bf16 v[36:39], v[100:103], a[84:87], v[36:39]
    ds_read_b64_tr_b16 v[96:97], v13 offset:5216
    v_mfma_f32_16x16x32_bf16 v[56:59], v[100:103], a[164:167], v[56:59]
    ds_read_b64_tr_b16 v[98:99], v13 offset:6496
    v_mfma_f32_16x16x32_bf16 v[76:79], v[100:103], a[244:247], v[76:79]
    s_waitcnt lgkmcnt(4)
    v_mfma_f32_16x16x32_bf16 v[20:23], v[104:107], a[4:7], v[20:23]
    v_mfma_f32_16x16x32_bf16 v[40:43], v[104:107], a[84:87], v[40:43]
    ds_read_b64_tr_b16 v[100:101], v13 offset:5248
    v_mfma_f32_16x16x32_bf16 v[60:63], v[104:107], a[164:167], v[60:63]
    ds_read_b64_tr_b16 v[102:103], v13 offset:6528
    v_mfma_f32_16x16x32_bf16 v[80:83], v[104:107], a[244:247], v[80:83]
    s_waitcnt lgkmcnt(4)
    v_mfma_f32_16x16x32_bf16 v[24:27], v[108:111], a[4:7], v[24:27]
    v_mfma_f32_16x16x32_bf16 v[44:47], v[108:111], a[84:87], v[44:47]
    ds_read_b64_tr_b16 v[104:105], v13 offset:10240
    v_mfma_f32_16x16x32_bf16 v[64:67], v[108:111], a[164:167], v[64:67]
    ds_read_b64_tr_b16 v[106:107], v13 offset:11520
    v_mfma_f32_16x16x32_bf16 v[84:87], v[108:111], a[244:247], v[84:87]
    s_waitcnt lgkmcnt(4)
    v_mfma_f32_16x16x32_bf16 v[28:31], v[96:99], a[4:7], v[28:31]
    v_mfma_f32_16x16x32_bf16 v[48:51], v[96:99], a[84:87], v[48:51]
    ds_read_b64_tr_b16 v[108:109], v13 offset:10272
    v_mfma_f32_16x16x32_bf16 v[68:71], v[96:99], a[164:167], v[68:71]
    ds_read_b64_tr_b16 v[110:111], v13 offset:11552
    v_mfma_f32_16x16x32_bf16 v[88:91], v[96:99], a[244:247], v[88:91]
    s_waitcnt lgkmcnt(4)
    v_mfma_f32_16x16x32_bf16 v[32:35], v[100:103], a[4:7], v[32:35]
    v_mfma_f32_16x16x32_bf16 v[52:55], v[100:103], a[84:87], v[52:55]
    ds_read_b64_tr_b16 v[96:97], v13 offset:10304
    v_mfma_f32_16x16x32_bf16 v[72:75], v[100:103], a[164:167], v[72:75]
    ds_read_b64_tr_b16 v[98:99], v13 offset:11584
    v_mfma_f32_16x16x32_bf16 v[92:95], v[100:103], a[244:247], v[92:95]
    s_waitcnt lgkmcnt(4)
    v_mfma_f32_16x16x32_bf16 v[16:19], v[104:107], a[8:11], v[16:19]
    v_mfma_f32_16x16x32_bf16 v[36:39], v[104:107], a[88:91], v[36:39]
    ds_read_b64_tr_b16 v[100:101], v13 offset:10336
    v_mfma_f32_16x16x32_bf16 v[56:59], v[104:107], a[168:171], v[56:59]
    ds_read_b64_tr_b16 v[102:103], v13 offset:11616
    v_mfma_f32_16x16x32_bf16 v[76:79], v[104:107], a[248:251], v[76:79]
    s_waitcnt lgkmcnt(4)
    v_mfma_f32_16x16x32_bf16 v[20:23], v[108:111], a[8:11], v[20:23]
    v_mfma_f32_16x16x32_bf16 v[40:43], v[108:111], a[88:91], v[40:43]
    ds_read_b64_tr_b16 v[104:105], v13 offset:10368
    v_mfma_f32_16x16x32_bf16 v[60:63], v[108:111], a[168:171], v[60:63]
    ds_read_b64_tr_b16 v[106:107], v13 offset:11648
    v_mfma_f32_16x16x32_bf16 v[80:83], v[108:111], a[248:251], v[80:83]
    s_waitcnt lgkmcnt(4)
    v_mfma_f32_16x16x32_bf16 v[24:27], v[96:99], a[8:11], v[24:27]
    v_mfma_f32_16x16x32_bf16 v[44:47], v[96:99], a[88:91], v[44:47]
    ds_read_b64_tr_b16 v[108:109], v13 offset:15360
    v_mfma_f32_16x16x32_bf16 v[64:67], v[96:99], a[168:171], v[64:67]
    ds_read_b64_tr_b16 v[110:111], v13 offset:16640
    v_mfma_f32_16x16x32_bf16 v[84:87], v[96:99], a[248:251], v[84:87]
    s_waitcnt lgkmcnt(4)
    v_mfma_f32_16x16x32_bf16 v[28:31], v[100:103], a[8:11], v[28:31]
    v_mfma_f32_16x16x32_bf16 v[48:51], v[100:103], a[88:91], v[48:51]
    ds_read_b64_tr_b16 v[96:97], v13 offset:15392
    v_mfma_f32_16x16x32_bf16 v[68:71], v[100:103], a[168:171], v[68:71]
    ds_read_b64_tr_b16 v[98:99], v13 offset:16672
    v_mfma_f32_16x16x32_bf16 v[88:91], v[100:103], a[248:251], v[88:91]
    s_waitcnt lgkmcnt(4)
    v_mfma_f32_16x16x32_bf16 v[32:35], v[104:107], a[8:11], v[32:35]
    v_mfma_f32_16x16x32_bf16 v[52:55], v[104:107], a[88:91], v[52:55]
    ds_read_b64_tr_b16 v[100:101], v13 offset:15424
    v_mfma_f32_16x16x32_bf16 v[72:75], v[104:107], a[168:171], v[72:75]
    ds_read_b64_tr_b16 v[102:103], v13 offset:16704
    v_mfma_f32_16x16x32_bf16 v[92:95], v[104:107], a[248:251], v[92:95]
    s_waitcnt lgkmcnt(4)
    v_mfma_f32_16x16x32_bf16 v[16:19], v[108:111], a[12:15], v[16:19]
    v_mfma_f32_16x16x32_bf16 v[36:39], v[108:111], a[92:95], v[36:39]
    ds_read_b64_tr_b16 v[104:105], v13 offset:15456
    v_mfma_f32_16x16x32_bf16 v[56:59], v[108:111], a[172:175], v[56:59]
    ds_read_b64_tr_b16 v[106:107], v13 offset:16736
    v_mfma_f32_16x16x32_bf16 v[76:79], v[108:111], a[252:255], v[76:79]
    s_waitcnt lgkmcnt(4)
    v_mfma_f32_16x16x32_bf16 v[20:23], v[96:99], a[12:15], v[20:23]
    v_mfma_f32_16x16x32_bf16 v[40:43], v[96:99], a[92:95], v[40:43]
    ds_read_b64_tr_b16 v[108:109], v13 offset:15488
    v_mfma_f32_16x16x32_bf16 v[60:63], v[96:99], a[172:175], v[60:63]
    ds_read_b64_tr_b16 v[110:111], v13 offset:16768
    v_mfma_f32_16x16x32_bf16 v[80:83], v[96:99], a[252:255], v[80:83]
    s_waitcnt lgkmcnt(4)
    v_mfma_f32_16x16x32_bf16 v[24:27], v[100:103], a[12:15], v[24:27]
    v_mfma_f32_16x16x32_bf16 v[44:47], v[100:103], a[92:95], v[44:47]
    ds_read_b64_tr_b16 v[96:97], v13 offset:20480
    v_mfma_f32_16x16x32_bf16 v[64:67], v[100:103], a[172:175], v[64:67]
    ds_read_b64_tr_b16 v[98:99], v13 offset:21760
    v_mfma_f32_16x16x32_bf16 v[84:87], v[100:103], a[252:255], v[84:87]
    s_waitcnt lgkmcnt(4)
    v_mfma_f32_16x16x32_bf16 v[28:31], v[104:107], a[12:15], v[28:31]
    v_mfma_f32_16x16x32_bf16 v[48:51], v[104:107], a[92:95], v[48:51]
    ds_read_b64_tr_b16 v[100:101], v13 offset:20512
    v_mfma_f32_16x16x32_bf16 v[68:71], v[104:107], a[172:175], v[68:71]
    ds_read_b64_tr_b16 v[102:103], v13 offset:21792
    v_mfma_f32_16x16x32_bf16 v[88:91], v[104:107], a[252:255], v[88:91]
    s_waitcnt lgkmcnt(4)
    v_mfma_f32_16x16x32_bf16 v[32:35], v[108:111], a[12:15], v[32:35]
    v_mfma_f32_16x16x32_bf16 v[52:55], v[108:111], a[92:95], v[52:55]
    ds_read_b64_tr_b16 v[104:105], v13 offset:20544
    v_mfma_f32_16x16x32_bf16 v[72:75], v[108:111], a[172:175], v[72:75]
    ds_read_b64_tr_b16 v[106:107], v13 offset:21824
    v_mfma_f32_16x16x32_bf16 v[92:95], v[108:111], a[252:255], v[92:95]
    s_waitcnt lgkmcnt(4)
    v_mfma_f32_16x16x32_bf16 v[16:19], v[96:99], a[16:19], v[16:19]
    v_mfma_f32_16x16x32_bf16 v[36:39], v[96:99], a[96:99], v[36:39]
    ds_read_b64_tr_b16 v[108:109], v13 offset:20576
    v_mfma_f32_16x16x32_bf16 v[56:59], v[96:99], a[176:179], v[56:59]
    ds_read_b64_tr_b16 v[110:111], v13 offset:21856
    v_mfma_f32_16x16x32_bf16 v[76:79], v[96:99], v[192:195], v[76:79]
    s_waitcnt lgkmcnt(4)
    v_mfma_f32_16x16x32_bf16 v[20:23], v[100:103], a[16:19], v[20:23]
    v_mfma_f32_16x16x32_bf16 v[40:43], v[100:103], a[96:99], v[40:43]
    ds_read_b64_tr_b16 v[96:97], v13 offset:20608
    v_mfma_f32_16x16x32_bf16 v[60:63], v[100:103], a[176:179], v[60:63]
    ds_read_b64_tr_b16 v[98:99], v13 offset:21888
    v_mfma_f32_16x16x32_bf16 v[80:83], v[100:103], v[192:195], v[80:83]
    s_waitcnt lgkmcnt(4)
    v_mfma_f32_16x16x32_bf16 v[24:27], v[104:107], a[16:19], v[24:27]
    v_mfma_f32_16x16x32_bf16 v[44:47], v[104:107], a[96:99], v[44:47]
    ds_read_b64_tr_b16 v[100:101], v13 offset:25600
    v_mfma_f32_16x16x32_bf16 v[64:67], v[104:107], a[176:179], v[64:67]
    ds_read_b64_tr_b16 v[102:103], v13 offset:26880
    v_mfma_f32_16x16x32_bf16 v[84:87], v[104:107], v[192:195], v[84:87]
    s_waitcnt lgkmcnt(4)
    v_mfma_f32_16x16x32_bf16 v[28:31], v[108:111], a[16:19], v[28:31]
    v_mfma_f32_16x16x32_bf16 v[48:51], v[108:111], a[96:99], v[48:51]
    ds_read_b64_tr_b16 v[104:105], v13 offset:25632
    v_mfma_f32_16x16x32_bf16 v[68:71], v[108:111], a[176:179], v[68:71]
    ds_read_b64_tr_b16 v[106:107], v13 offset:26912
    v_mfma_f32_16x16x32_bf16 v[88:91], v[108:111], v[192:195], v[88:91]
    s_waitcnt lgkmcnt(4)
    v_mfma_f32_16x16x32_bf16 v[32:35], v[96:99], a[16:19], v[32:35]
    v_mfma_f32_16x16x32_bf16 v[52:55], v[96:99], a[96:99], v[52:55]
    ds_read_b64_tr_b16 v[108:109], v13 offset:25664
    v_mfma_f32_16x16x32_bf16 v[72:75], v[96:99], a[176:179], v[72:75]
    ds_read_b64_tr_b16 v[110:111], v13 offset:26944
    v_mfma_f32_16x16x32_bf16 v[92:95], v[96:99], v[192:195], v[92:95]
    s_waitcnt lgkmcnt(4)
    v_mfma_f32_16x16x32_bf16 v[16:19], v[100:103], a[20:23], v[16:19]
    v_mfma_f32_16x16x32_bf16 v[36:39], v[100:103], a[100:103], v[36:39]
    ds_read_b64_tr_b16 v[96:97], v13 offset:25696
    v_mfma_f32_16x16x32_bf16 v[56:59], v[100:103], a[180:183], v[56:59]
    ds_read_b64_tr_b16 v[98:99], v13 offset:26976
    v_mfma_f32_16x16x32_bf16 v[76:79], v[100:103], v[196:199], v[76:79]
    s_waitcnt lgkmcnt(4)
    v_mfma_f32_16x16x32_bf16 v[20:23], v[104:107], a[20:23], v[20:23]
    v_mfma_f32_16x16x32_bf16 v[40:43], v[104:107], a[100:103], v[40:43]
    ds_read_b64_tr_b16 v[100:101], v13 offset:25728
    v_mfma_f32_16x16x32_bf16 v[60:63], v[104:107], a[180:183], v[60:63]
    ds_read_b64_tr_b16 v[102:103], v13 offset:27008
    v_mfma_f32_16x16x32_bf16 v[80:83], v[104:107], v[196:199], v[80:83]
    s_waitcnt lgkmcnt(4)
    v_mfma_f32_16x16x32_bf16 v[24:27], v[108:111], a[20:23], v[24:27]
    v_mfma_f32_16x16x32_bf16 v[44:47], v[108:111], a[100:103], v[44:47]
    ds_read_b64_tr_b16 v[104:105], v13 offset:30720
    v_mfma_f32_16x16x32_bf16 v[64:67], v[108:111], a[180:183], v[64:67]
    ds_read_b64_tr_b16 v[106:107], v13 offset:32000
    v_mfma_f32_16x16x32_bf16 v[84:87], v[108:111], v[196:199], v[84:87]
    s_waitcnt lgkmcnt(4)
    v_mfma_f32_16x16x32_bf16 v[28:31], v[96:99], a[20:23], v[28:31]
    v_mfma_f32_16x16x32_bf16 v[48:51], v[96:99], a[100:103], v[48:51]
    ds_read_b64_tr_b16 v[108:109], v13 offset:30752
    v_mfma_f32_16x16x32_bf16 v[68:71], v[96:99], a[180:183], v[68:71]
    ds_read_b64_tr_b16 v[110:111], v13 offset:32032
    v_mfma_f32_16x16x32_bf16 v[88:91], v[96:99], v[196:199], v[88:91]
    s_waitcnt lgkmcnt(4)
    v_mfma_f32_16x16x32_bf16 v[32:35], v[100:103], a[20:23], v[32:35]
    v_mfma_f32_16x16x32_bf16 v[52:55], v[100:103], a[100:103], v[52:55]
    ds_read_b64_tr_b16 v[96:97], v13 offset:30784
    v_mfma_f32_16x16x32_bf16 v[72:75], v[100:103], a[180:183], v[72:75]
    ds_read_b64_tr_b16 v[98:99], v13 offset:32064
    v_mfma_f32_16x16x32_bf16 v[92:95], v[100:103], v[196:199], v[92:95]
    s_waitcnt lgkmcnt(4)
    v_mfma_f32_16x16x32_bf16 v[16:19], v[104:107], a[24:27], v[16:19]
    v_mfma_f32_16x16x32_bf16 v[36:39], v[104:107], a[104:107], v[36:39]
    ds_read_b64_tr_b16 v[100:101], v13 offset:30816
    v_mfma_f32_16x16x32_bf16 v[56:59], v[104:107], a[184:187], v[56:59]
    ds_read_b64_tr_b16 v[102:103], v13 offset:32096
    v_mfma_f32_16x16x32_bf16 v[76:79], v[104:107], v[200:203], v[76:79]
    s_waitcnt lgkmcnt(4)
    v_mfma_f32_16x16x32_bf16 v[20:23], v[108:111], a[24:27], v[20:23]
    v_mfma_f32_16x16x32_bf16 v[40:43], v[108:111], a[104:107], v[40:43]
    ds_read_b64_tr_b16 v[104:105], v13 offset:30848
    v_mfma_f32_16x16x32_bf16 v[60:63], v[108:111], a[184:187], v[60:63]
    ds_read_b64_tr_b16 v[106:107], v13 offset:32128
    v_mfma_f32_16x16x32_bf16 v[80:83], v[108:111], v[200:203], v[80:83]
    s_waitcnt lgkmcnt(4)
    v_mfma_f32_16x16x32_bf16 v[24:27], v[96:99], a[24:27], v[24:27]
    v_mfma_f32_16x16x32_bf16 v[44:47], v[96:99], a[104:107], v[44:47]
    ds_read_b64_tr_b16 v[108:109], v13 offset:35840
    v_mfma_f32_16x16x32_bf16 v[64:67], v[96:99], a[184:187], v[64:67]
    ds_read_b64_tr_b16 v[110:111], v13 offset:37120
    v_mfma_f32_16x16x32_bf16 v[84:87], v[96:99], v[200:203], v[84:87]
    s_waitcnt lgkmcnt(4)
    v_mfma_f32_16x16x32_bf16 v[28:31], v[100:103], a[24:27], v[28:31]
    v_mfma_f32_16x16x32_bf16 v[48:51], v[100:103], a[104:107], v[48:51]
    ds_read_b64_tr_b16 v[96:97], v13 offset:35872
    v_mfma_f32_16x16x32_bf16 v[68:71], v[100:103], a[184:187], v[68:71]
    ds_read_b64_tr_b16 v[98:99], v13 offset:37152
    v_mfma_f32_16x16x32_bf16 v[88:91], v[100:103], v[200:203], v[88:91]
    s_waitcnt lgkmcnt(4)
    v_mfma_f32_16x16x32_bf16 v[32:35], v[104:107], a[24:27], v[32:35]
    v_mfma_f32_16x16x32_bf16 v[52:55], v[104:107], a[104:107], v[52:55]
    ds_read_b64_tr_b16 v[100:101], v13 offset:35904
    v_mfma_f32_16x16x32_bf16 v[72:75], v[104:107], a[184:187], v[72:75]
    ds_read_b64_tr_b16 v[102:103], v13 offset:37184
    v_mfma_f32_16x16x32_bf16 v[92:95], v[104:107], v[200:203], v[92:95]
    s_waitcnt lgkmcnt(4)
    v_mfma_f32_16x16x32_bf16 v[16:19], v[108:111], a[28:31], v[16:19]
    v_mfma_f32_16x16x32_bf16 v[36:39], v[108:111], a[108:111], v[36:39]
    ds_read_b64_tr_b16 v[104:105], v13 offset:35936
    v_mfma_f32_16x16x32_bf16 v[56:59], v[108:111], a[188:191], v[56:59]
    ds_read_b64_tr_b16 v[106:107], v13 offset:37216
    v_mfma_f32_16x16x32_bf16 v[76:79], v[108:111], v[204:207], v[76:79]
    s_waitcnt lgkmcnt(4)
    v_mfma_f32_16x16x32_bf16 v[20:23], v[96:99], a[28:31], v[20:23]
    v_mfma_f32_16x16x32_bf16 v[40:43], v[96:99], a[108:111], v[40:43]
    ds_read_b64_tr_b16 v[108:109], v13 offset:35968
    v_mfma_f32_16x16x32_bf16 v[60:63], v[96:99], a[188:191], v[60:63]
    ds_read_b64_tr_b16 v[110:111], v13 offset:37248
    v_mfma_f32_16x16x32_bf16 v[80:83], v[96:99], v[204:207], v[80:83]
    s_waitcnt lgkmcnt(4)
    v_mfma_f32_16x16x32_bf16 v[24:27], v[100:103], a[28:31], v[24:27]
    v_mfma_f32_16x16x32_bf16 v[44:47], v[100:103], a[108:111], v[44:47]
    ds_read_b64_tr_b16 v[96:97], v13 offset:40960
    v_mfma_f32_16x16x32_bf16 v[64:67], v[100:103], a[188:191], v[64:67]
    ds_read_b64_tr_b16 v[98:99], v13 offset:42240
    v_mfma_f32_16x16x32_bf16 v[84:87], v[100:103], v[204:207], v[84:87]
    s_waitcnt lgkmcnt(4)
    v_mfma_f32_16x16x32_bf16 v[28:31], v[104:107], a[28:31], v[28:31]
    v_mfma_f32_16x16x32_bf16 v[48:51], v[104:107], a[108:111], v[48:51]
    ds_read_b64_tr_b16 v[100:101], v13 offset:40992
    v_mfma_f32_16x16x32_bf16 v[68:71], v[104:107], a[188:191], v[68:71]
    ds_read_b64_tr_b16 v[102:103], v13 offset:42272
    v_mfma_f32_16x16x32_bf16 v[88:91], v[104:107], v[204:207], v[88:91]
    s_waitcnt lgkmcnt(4)
    v_mfma_f32_16x16x32_bf16 v[32:35], v[108:111], a[28:31], v[32:35]
    v_mfma_f32_16x16x32_bf16 v[52:55], v[108:111], a[108:111], v[52:55]
    ds_read_b64_tr_b16 v[104:105], v13 offset:41024
    v_mfma_f32_16x16x32_bf16 v[72:75], v[108:111], a[188:191], v[72:75]
    ds_read_b64_tr_b16 v[106:107], v13 offset:42304
    v_mfma_f32_16x16x32_bf16 v[92:95], v[108:111], v[204:207], v[92:95]
    s_waitcnt lgkmcnt(4)
    v_mfma_f32_16x16x32_bf16 v[16:19], v[96:99], a[32:35], v[16:19]
    v_mfma_f32_16x16x32_bf16 v[36:39], v[96:99], a[112:115], v[36:39]
    ds_read_b64_tr_b16 v[108:109], v13 offset:41056
    v_mfma_f32_16x16x32_bf16 v[56:59], v[96:99], a[192:195], v[56:59]
    ds_read_b64_tr_b16 v[110:111], v13 offset:42336
    v_mfma_f32_16x16x32_bf16 v[76:79], v[96:99], v[208:211], v[76:79]
    s_waitcnt lgkmcnt(4)
    v_mfma_f32_16x16x32_bf16 v[20:23], v[100:103], a[32:35], v[20:23]
    v_mfma_f32_16x16x32_bf16 v[40:43], v[100:103], a[112:115], v[40:43]
    ds_read_b64_tr_b16 v[96:97], v13 offset:41088
    v_mfma_f32_16x16x32_bf16 v[60:63], v[100:103], a[192:195], v[60:63]
    ds_read_b64_tr_b16 v[98:99], v13 offset:42368
    v_mfma_f32_16x16x32_bf16 v[80:83], v[100:103], v[208:211], v[80:83]
    s_waitcnt lgkmcnt(4)
    v_mfma_f32_16x16x32_bf16 v[24:27], v[104:107], a[32:35], v[24:27]
    v_mfma_f32_16x16x32_bf16 v[44:47], v[104:107], a[112:115], v[44:47]
    ds_read_b64_tr_b16 v[100:101], v13 offset:46080
    v_mfma_f32_16x16x32_bf16 v[64:67], v[104:107], a[192:195], v[64:67]
    ds_read_b64_tr_b16 v[102:103], v13 offset:47360
    v_mfma_f32_16x16x32_bf16 v[84:87], v[104:107], v[208:211], v[84:87]
    s_waitcnt lgkmcnt(4)
    v_mfma_f32_16x16x32_bf16 v[28:31], v[108:111], a[32:35], v[28:31]
    v_mfma_f32_16x16x32_bf16 v[48:51], v[108:111], a[112:115], v[48:51]
    ds_read_b64_tr_b16 v[104:105], v13 offset:46112
    v_mfma_f32_16x16x32_bf16 v[68:71], v[108:111], a[192:195], v[68:71]
    ds_read_b64_tr_b16 v[106:107], v13 offset:47392
    v_mfma_f32_16x16x32_bf16 v[88:91], v[108:111], v[208:211], v[88:91]
    s_waitcnt lgkmcnt(4)
    v_mfma_f32_16x16x32_bf16 v[32:35], v[96:99], a[32:35], v[32:35]
    v_mfma_f32_16x16x32_bf16 v[52:55], v[96:99], a[112:115], v[52:55]
    ds_read_b64_tr_b16 v[108:109], v13 offset:46144
    v_mfma_f32_16x16x32_bf16 v[72:75], v[96:99], a[192:195], v[72:75]
    ds_read_b64_tr_b16 v[110:111], v13 offset:47424
    v_mfma_f32_16x16x32_bf16 v[92:95], v[96:99], v[208:211], v[92:95]
    s_waitcnt lgkmcnt(4)
    v_mfma_f32_16x16x32_bf16 v[16:19], v[100:103], a[36:39], v[16:19]
    v_mfma_f32_16x16x32_bf16 v[36:39], v[100:103], a[116:119], v[36:39]
    ds_read_b64_tr_b16 v[96:97], v13 offset:46176
    v_mfma_f32_16x16x32_bf16 v[56:59], v[100:103], a[196:199], v[56:59]
    ds_read_b64_tr_b16 v[98:99], v13 offset:47456
    v_mfma_f32_16x16x32_bf16 v[76:79], v[100:103], v[212:215], v[76:79]
    s_waitcnt lgkmcnt(4)
    v_mfma_f32_16x16x32_bf16 v[20:23], v[104:107], a[36:39], v[20:23]
    v_mfma_f32_16x16x32_bf16 v[40:43], v[104:107], a[116:119], v[40:43]
    ds_read_b64_tr_b16 v[100:101], v13 offset:46208
    v_mfma_f32_16x16x32_bf16 v[60:63], v[104:107], a[196:199], v[60:63]
    ds_read_b64_tr_b16 v[102:103], v13 offset:47488
    v_mfma_f32_16x16x32_bf16 v[80:83], v[104:107], v[212:215], v[80:83]
    s_waitcnt lgkmcnt(4)
    v_mfma_f32_16x16x32_bf16 v[24:27], v[108:111], a[36:39], v[24:27]
    v_mfma_f32_16x16x32_bf16 v[44:47], v[108:111], a[116:119], v[44:47]
    ds_read_b64_tr_b16 v[104:105], v14 offset:0
    v_mfma_f32_16x16x32_bf16 v[64:67], v[108:111], a[196:199], v[64:67]
    ds_read_b64_tr_b16 v[106:107], v14 offset:1280
    v_mfma_f32_16x16x32_bf16 v[84:87], v[108:111], v[212:215], v[84:87]
    s_waitcnt lgkmcnt(4)
    v_mfma_f32_16x16x32_bf16 v[28:31], v[96:99], a[36:39], v[28:31]
    v_mfma_f32_16x16x32_bf16 v[48:51], v[96:99], a[116:119], v[48:51]
    ds_read_b64_tr_b16 v[108:109], v14 offset:32
    v_mfma_f32_16x16x32_bf16 v[68:71], v[96:99], a[196:199], v[68:71]
    ds_read_b64_tr_b16 v[110:111], v14 offset:1312
    v_mfma_f32_16x16x32_bf16 v[88:91], v[96:99], v[212:215], v[88:91]
    s_waitcnt lgkmcnt(4)
    v_mfma_f32_16x16x32_bf16 v[32:35], v[100:103], a[36:39], v[32:35]
    v_mfma_f32_16x16x32_bf16 v[52:55], v[100:103], a[116:119], v[52:55]
    ds_read_b64_tr_b16 v[96:97], v14 offset:64
    v_mfma_f32_16x16x32_bf16 v[72:75], v[100:103], a[196:199], v[72:75]
    ds_read_b64_tr_b16 v[98:99], v14 offset:1344
    v_mfma_f32_16x16x32_bf16 v[92:95], v[100:103], v[212:215], v[92:95]
    s_waitcnt lgkmcnt(4)
    v_mfma_f32_16x16x32_bf16 v[16:19], v[104:107], a[40:43], v[16:19]
    v_mfma_f32_16x16x32_bf16 v[36:39], v[104:107], a[120:123], v[36:39]
    ds_read_b64_tr_b16 v[100:101], v14 offset:96
    v_mfma_f32_16x16x32_bf16 v[56:59], v[104:107], a[200:203], v[56:59]
    ds_read_b64_tr_b16 v[102:103], v14 offset:1376
    v_mfma_f32_16x16x32_bf16 v[76:79], v[104:107], v[216:219], v[76:79]
    s_waitcnt lgkmcnt(4)
    v_mfma_f32_16x16x32_bf16 v[20:23], v[108:111], a[40:43], v[20:23]
    v_mfma_f32_16x16x32_bf16 v[40:43], v[108:111], a[120:123], v[40:43]
    ds_read_b64_tr_b16 v[104:105], v14 offset:128
    v_mfma_f32_16x16x32_bf16 v[60:63], v[108:111], a[200:203], v[60:63]
    ds_read_b64_tr_b16 v[106:107], v14 offset:1408
    v_mfma_f32_16x16x32_bf16 v[80:83], v[108:111], v[216:219], v[80:83]
    s_waitcnt lgkmcnt(4)
    v_mfma_f32_16x16x32_bf16 v[24:27], v[96:99], a[40:43], v[24:27]
    v_mfma_f32_16x16x32_bf16 v[44:47], v[96:99], a[120:123], v[44:47]
    ds_read_b64_tr_b16 v[108:109], v14 offset:5120
    v_mfma_f32_16x16x32_bf16 v[64:67], v[96:99], a[200:203], v[64:67]
    ds_read_b64_tr_b16 v[110:111], v14 offset:6400
    v_mfma_f32_16x16x32_bf16 v[84:87], v[96:99], v[216:219], v[84:87]
    s_waitcnt lgkmcnt(4)
    v_mfma_f32_16x16x32_bf16 v[28:31], v[100:103], a[40:43], v[28:31]
    v_mfma_f32_16x16x32_bf16 v[48:51], v[100:103], a[120:123], v[48:51]
    ds_read_b64_tr_b16 v[96:97], v14 offset:5152
    v_mfma_f32_16x16x32_bf16 v[68:71], v[100:103], a[200:203], v[68:71]
    ds_read_b64_tr_b16 v[98:99], v14 offset:6432
    v_mfma_f32_16x16x32_bf16 v[88:91], v[100:103], v[216:219], v[88:91]
    s_waitcnt lgkmcnt(4)
    v_mfma_f32_16x16x32_bf16 v[32:35], v[104:107], a[40:43], v[32:35]
    v_mfma_f32_16x16x32_bf16 v[52:55], v[104:107], a[120:123], v[52:55]
    ds_read_b64_tr_b16 v[100:101], v14 offset:5184
    v_mfma_f32_16x16x32_bf16 v[72:75], v[104:107], a[200:203], v[72:75]
    ds_read_b64_tr_b16 v[102:103], v14 offset:6464
    v_mfma_f32_16x16x32_bf16 v[92:95], v[104:107], v[216:219], v[92:95]
    s_waitcnt lgkmcnt(4)
    v_mfma_f32_16x16x32_bf16 v[16:19], v[108:111], a[44:47], v[16:19]
    v_mfma_f32_16x16x32_bf16 v[36:39], v[108:111], a[124:127], v[36:39]
    ds_read_b64_tr_b16 v[104:105], v14 offset:5216
    v_mfma_f32_16x16x32_bf16 v[56:59], v[108:111], a[204:207], v[56:59]
    ds_read_b64_tr_b16 v[106:107], v14 offset:6496
    v_mfma_f32_16x16x32_bf16 v[76:79], v[108:111], v[220:223], v[76:79]
    s_waitcnt lgkmcnt(4)
    v_mfma_f32_16x16x32_bf16 v[20:23], v[96:99], a[44:47], v[20:23]
    v_mfma_f32_16x16x32_bf16 v[40:43], v[96:99], a[124:127], v[40:43]
    ds_read_b64_tr_b16 v[108:109], v14 offset:5248
    v_mfma_f32_16x16x32_bf16 v[60:63], v[96:99], a[204:207], v[60:63]
    ds_read_b64_tr_b16 v[110:111], v14 offset:6528
    v_mfma_f32_16x16x32_bf16 v[80:83], v[96:99], v[220:223], v[80:83]
    s_waitcnt lgkmcnt(4)
    v_mfma_f32_16x16x32_bf16 v[24:27], v[100:103], a[44:47], v[24:27]
    v_mfma_f32_16x16x32_bf16 v[44:47], v[100:103], a[124:127], v[44:47]
    ds_read_b64_tr_b16 v[96:97], v14 offset:10240
    v_mfma_f32_16x16x32_bf16 v[64:67], v[100:103], a[204:207], v[64:67]
    ds_read_b64_tr_b16 v[98:99], v14 offset:11520
    v_mfma_f32_16x16x32_bf16 v[84:87], v[100:103], v[220:223], v[84:87]
    s_waitcnt lgkmcnt(4)
    v_mfma_f32_16x16x32_bf16 v[28:31], v[104:107], a[44:47], v[28:31]
    v_mfma_f32_16x16x32_bf16 v[48:51], v[104:107], a[124:127], v[48:51]
    ds_read_b64_tr_b16 v[100:101], v14 offset:10272
    v_mfma_f32_16x16x32_bf16 v[68:71], v[104:107], a[204:207], v[68:71]
    ds_read_b64_tr_b16 v[102:103], v14 offset:11552
    v_mfma_f32_16x16x32_bf16 v[88:91], v[104:107], v[220:223], v[88:91]
    s_waitcnt lgkmcnt(4)
    v_mfma_f32_16x16x32_bf16 v[32:35], v[108:111], a[44:47], v[32:35]
    v_mfma_f32_16x16x32_bf16 v[52:55], v[108:111], a[124:127], v[52:55]
    ds_read_b64_tr_b16 v[104:105], v14 offset:10304
    v_mfma_f32_16x16x32_bf16 v[72:75], v[108:111], a[204:207], v[72:75]
    ds_read_b64_tr_b16 v[106:107], v14 offset:11584
    v_mfma_f32_16x16x32_bf16 v[92:95], v[108:111], v[220:223], v[92:95]
    s_waitcnt lgkmcnt(4)
    v_mfma_f32_16x16x32_bf16 v[16:19], v[96:99], a[48:51], v[16:19]
    v_mfma_f32_16x16x32_bf16 v[36:39], v[96:99], a[128:131], v[36:39]
    ds_read_b64_tr_b16 v[108:109], v14 offset:10336
    v_mfma_f32_16x16x32_bf16 v[56:59], v[96:99], a[208:211], v[56:59]
    ds_read_b64_tr_b16 v[110:111], v14 offset:11616
    v_mfma_f32_16x16x32_bf16 v[76:79], v[96:99], v[224:227], v[76:79]
    s_waitcnt lgkmcnt(4)
    v_mfma_f32_16x16x32_bf16 v[20:23], v[100:103], a[48:51], v[20:23]
    v_mfma_f32_16x16x32_bf16 v[40:43], v[100:103], a[128:131], v[40:43]
    ds_read_b64_tr_b16 v[96:97], v14 offset:10368
    v_mfma_f32_16x16x32_bf16 v[60:63], v[100:103], a[208:211], v[60:63]
    ds_read_b64_tr_b16 v[98:99], v14 offset:11648
    v_mfma_f32_16x16x32_bf16 v[80:83], v[100:103], v[224:227], v[80:83]
    s_waitcnt lgkmcnt(4)
    v_mfma_f32_16x16x32_bf16 v[24:27], v[104:107], a[48:51], v[24:27]
    v_mfma_f32_16x16x32_bf16 v[44:47], v[104:107], a[128:131], v[44:47]
    ds_read_b64_tr_b16 v[100:101], v14 offset:15360
    v_mfma_f32_16x16x32_bf16 v[64:67], v[104:107], a[208:211], v[64:67]
    ds_read_b64_tr_b16 v[102:103], v14 offset:16640
    v_mfma_f32_16x16x32_bf16 v[84:87], v[104:107], v[224:227], v[84:87]
    s_waitcnt lgkmcnt(4)
    v_mfma_f32_16x16x32_bf16 v[28:31], v[108:111], a[48:51], v[28:31]
    v_mfma_f32_16x16x32_bf16 v[48:51], v[108:111], a[128:131], v[48:51]
    ds_read_b64_tr_b16 v[104:105], v14 offset:15392
    v_mfma_f32_16x16x32_bf16 v[68:71], v[108:111], a[208:211], v[68:71]
    ds_read_b64_tr_b16 v[106:107], v14 offset:16672
    v_mfma_f32_16x16x32_bf16 v[88:91], v[108:111], v[224:227], v[88:91]
    s_waitcnt lgkmcnt(4)
    v_mfma_f32_16x16x32_bf16 v[32:35], v[96:99], a[48:51], v[32:35]
    v_mfma_f32_16x16x32_bf16 v[52:55], v[96:99], a[128:131], v[52:55]
    ds_read_b64_tr_b16 v[108:109], v14 offset:15424
    v_mfma_f32_16x16x32_bf16 v[72:75], v[96:99], a[208:211], v[72:75]
    ds_read_b64_tr_b16 v[110:111], v14 offset:16704
    v_mfma_f32_16x16x32_bf16 v[92:95], v[96:99], v[224:227], v[92:95]
    s_waitcnt lgkmcnt(4)
    v_mfma_f32_16x16x32_bf16 v[16:19], v[100:103], a[52:55], v[16:19]
    v_mfma_f32_16x16x32_bf16 v[36:39], v[100:103], a[132:135], v[36:39]
    ds_read_b64_tr_b16 v[96:97], v14 offset:15456
    v_mfma_f32_16x16x32_bf16 v[56:59], v[100:103], a[212:215], v[56:59]
    ds_read_b64_tr_b16 v[98:99], v14 offset:16736
    v_mfma_f32_16x16x32_bf16 v[76:79], v[100:103], v[228:231], v[76:79]
    s_waitcnt lgkmcnt(4)
    v_mfma_f32_16x16x32_bf16 v[20:23], v[104:107], a[52:55], v[20:23]
    v_mfma_f32_16x16x32_bf16 v[40:43], v[104:107], a[132:135], v[40:43]
    ds_read_b64_tr_b16 v[100:101], v14 offset:15488
    v_mfma_f32_16x16x32_bf16 v[60:63], v[104:107], a[212:215], v[60:63]
    ds_read_b64_tr_b16 v[102:103], v14 offset:16768
    v_mfma_f32_16x16x32_bf16 v[80:83], v[104:107], v[228:231], v[80:83]
    s_waitcnt lgkmcnt(4)
    v_mfma_f32_16x16x32_bf16 v[24:27], v[108:111], a[52:55], v[24:27]
    v_mfma_f32_16x16x32_bf16 v[44:47], v[108:111], a[132:135], v[44:47]
    ds_read_b64_tr_b16 v[104:105], v14 offset:20480
    v_mfma_f32_16x16x32_bf16 v[64:67], v[108:111], a[212:215], v[64:67]
    ds_read_b64_tr_b16 v[106:107], v14 offset:21760
    v_mfma_f32_16x16x32_bf16 v[84:87], v[108:111], v[228:231], v[84:87]
    s_waitcnt lgkmcnt(4)
    v_mfma_f32_16x16x32_bf16 v[28:31], v[96:99], a[52:55], v[28:31]
    v_mfma_f32_16x16x32_bf16 v[48:51], v[96:99], a[132:135], v[48:51]
    ds_read_b64_tr_b16 v[108:109], v14 offset:20512
    v_mfma_f32_16x16x32_bf16 v[68:71], v[96:99], a[212:215], v[68:71]
    ds_read_b64_tr_b16 v[110:111], v14 offset:21792
    v_mfma_f32_16x16x32_bf16 v[88:91], v[96:99], v[228:231], v[88:91]
    s_waitcnt lgkmcnt(4)
    v_mfma_f32_16x16x32_bf16 v[32:35], v[100:103], a[52:55], v[32:35]
    v_mfma_f32_16x16x32_bf16 v[52:55], v[100:103], a[132:135], v[52:55]
    ds_read_b64_tr_b16 v[96:97], v14 offset:20544
    v_mfma_f32_16x16x32_bf16 v[72:75], v[100:103], a[212:215], v[72:75]
    ds_read_b64_tr_b16 v[98:99], v14 offset:21824
    v_mfma_f32_16x16x32_bf16 v[92:95], v[100:103], v[228:231], v[92:95]
    s_waitcnt lgkmcnt(4)
    v_mfma_f32_16x16x32_bf16 v[16:19], v[104:107], a[56:59], v[16:19]
    v_mfma_f32_16x16x32_bf16 v[36:39], v[104:107], a[136:139], v[36:39]
    ds_read_b64_tr_b16 v[100:101], v14 offset:20576
    v_mfma_f32_16x16x32_bf16 v[56:59], v[104:107], a[216:219], v[56:59]
    ds_read_b64_tr_b16 v[102:103], v14 offset:21856
    v_mfma_f32_16x16x32_bf16 v[76:79], v[104:107], v[232:235], v[76:79]
    s_waitcnt lgkmcnt(4)
    v_mfma_f32_16x16x32_bf16 v[20:23], v[108:111], a[56:59], v[20:23]
    v_mfma_f32_16x16x32_bf16 v[40:43], v[108:111], a[136:139], v[40:43]
    ds_read_b64_tr_b16 v[104:105], v14 offset:20608
    v_mfma_f32_16x16x32_bf16 v[60:63], v[108:111], a[216:219], v[60:63]
    ds_read_b64_tr_b16 v[106:107], v14 offset:21888
    v_mfma_f32_16x16x32_bf16 v[80:83], v[108:111], v[232:235], v[80:83]
    s_waitcnt lgkmcnt(4)
    v_mfma_f32_16x16x32_bf16 v[24:27], v[96:99], a[56:59], v[24:27]
    v_mfma_f32_16x16x32_bf16 v[44:47], v[96:99], a[136:139], v[44:47]
    ds_read_b64_tr_b16 v[108:109], v14 offset:25600
    v_mfma_f32_16x16x32_bf16 v[64:67], v[96:99], a[216:219], v[64:67]
    ds_read_b64_tr_b16 v[110:111], v14 offset:26880
    v_mfma_f32_16x16x32_bf16 v[84:87], v[96:99], v[232:235], v[84:87]
    s_waitcnt lgkmcnt(4)
    v_mfma_f32_16x16x32_bf16 v[28:31], v[100:103], a[56:59], v[28:31]
    v_mfma_f32_16x16x32_bf16 v[48:51], v[100:103], a[136:139], v[48:51]
    ds_read_b64_tr_b16 v[96:97], v14 offset:25632
    v_mfma_f32_16x16x32_bf16 v[68:71], v[100:103], a[216:219], v[68:71]
    ds_read_b64_tr_b16 v[98:99], v14 offset:26912
    v_mfma_f32_16x16x32_bf16 v[88:91], v[100:103], v[232:235], v[88:91]
    s_waitcnt lgkmcnt(4)
    v_mfma_f32_16x16x32_bf16 v[32:35], v[104:107], a[56:59], v[32:35]
    v_mfma_f32_16x16x32_bf16 v[52:55], v[104:107], a[136:139], v[52:55]
    ds_read_b64_tr_b16 v[100:101], v14 offset:25664
    v_mfma_f32_16x16x32_bf16 v[72:75], v[104:107], a[216:219], v[72:75]
    ds_read_b64_tr_b16 v[102:103], v14 offset:26944
    v_mfma_f32_16x16x32_bf16 v[92:95], v[104:107], v[232:235], v[92:95]
    s_waitcnt lgkmcnt(4)
    v_mfma_f32_16x16x32_bf16 v[16:19], v[108:111], a[60:63], v[16:19]
    v_mfma_f32_16x16x32_bf16 v[36:39], v[108:111], a[140:143], v[36:39]
    ds_read_b64_tr_b16 v[104:105], v14 offset:25696
    v_mfma_f32_16x16x32_bf16 v[56:59], v[108:111], a[220:223], v[56:59]
    ds_read_b64_tr_b16 v[106:107], v14 offset:26976
    v_mfma_f32_16x16x32_bf16 v[76:79], v[108:111], v[236:239], v[76:79]
    s_waitcnt lgkmcnt(4)
    v_mfma_f32_16x16x32_bf16 v[20:23], v[96:99], a[60:63], v[20:23]
    v_mfma_f32_16x16x32_bf16 v[40:43], v[96:99], a[140:143], v[40:43]
    ds_read_b64_tr_b16 v[108:109], v14 offset:25728
    v_mfma_f32_16x16x32_bf16 v[60:63], v[96:99], a[220:223], v[60:63]
    ds_read_b64_tr_b16 v[110:111], v14 offset:27008
    v_mfma_f32_16x16x32_bf16 v[80:83], v[96:99], v[236:239], v[80:83]
    s_waitcnt lgkmcnt(4)
    v_mfma_f32_16x16x32_bf16 v[24:27], v[100:103], a[60:63], v[24:27]
    v_mfma_f32_16x16x32_bf16 v[44:47], v[100:103], a[140:143], v[44:47]
    ds_read_b64_tr_b16 v[96:97], v14 offset:30720
    v_mfma_f32_16x16x32_bf16 v[64:67], v[100:103], a[220:223], v[64:67]
    ds_read_b64_tr_b16 v[98:99], v14 offset:32000
    v_mfma_f32_16x16x32_bf16 v[84:87], v[100:103], v[236:239], v[84:87]
    s_waitcnt lgkmcnt(4)
    v_mfma_f32_16x16x32_bf16 v[28:31], v[104:107], a[60:63], v[28:31]
    v_mfma_f32_16x16x32_bf16 v[48:51], v[104:107], a[140:143], v[48:51]
    ds_read_b64_tr_b16 v[100:101], v14 offset:30752
    v_mfma_f32_16x16x32_bf16 v[68:71], v[104:107], a[220:223], v[68:71]
    ds_read_b64_tr_b16 v[102:103], v14 offset:32032
    v_mfma_f32_16x16x32_bf16 v[88:91], v[104:107], v[236:239], v[88:91]
    s_waitcnt lgkmcnt(4)
    v_mfma_f32_16x16x32_bf16 v[32:35], v[108:111], a[60:63], v[32:35]
    v_mfma_f32_16x16x32_bf16 v[52:55], v[108:111], a[140:143], v[52:55]
    ds_read_b64_tr_b16 v[104:105], v14 offset:30784
    v_mfma_f32_16x16x32_bf16 v[72:75], v[108:111], a[220:223], v[72:75]
    ds_read_b64_tr_b16 v[106:107], v14 offset:32064
    v_mfma_f32_16x16x32_bf16 v[92:95], v[108:111], v[236:239], v[92:95]
    s_waitcnt lgkmcnt(4)
    v_mfma_f32_16x16x32_bf16 v[16:19], v[96:99], a[64:67], v[16:19]
    v_mfma_f32_16x16x32_bf16 v[36:39], v[96:99], a[144:147], v[36:39]
    ds_read_b64_tr_b16 v[108:109], v14 offset:30816
    v_mfma_f32_16x16x32_bf16 v[56:59], v[96:99], a[224:227], v[56:59]
    ds_read_b64_tr_b16 v[110:111], v14 offset:32096
    v_mfma_f32_16x16x32_bf16 v[76:79], v[96:99], v[240:243], v[76:79]
    s_waitcnt lgkmcnt(4)
    v_mfma_f32_16x16x32_bf16 v[20:23], v[100:103], a[64:67], v[20:23]
    v_mfma_f32_16x16x32_bf16 v[40:43], v[100:103], a[144:147], v[40:43]
    ds_read_b64_tr_b16 v[96:97], v14 offset:30848
    v_mfma_f32_16x16x32_bf16 v[60:63], v[100:103], a[224:227], v[60:63]
    ds_read_b64_tr_b16 v[98:99], v14 offset:32128
    v_mfma_f32_16x16x32_bf16 v[80:83], v[100:103], v[240:243], v[80:83]
    s_waitcnt lgkmcnt(4)
    v_mfma_f32_16x16x32_bf16 v[24:27], v[104:107], a[64:67], v[24:27]
    v_mfma_f32_16x16x32_bf16 v[44:47], v[104:107], a[144:147], v[44:47]
    ds_read_b64_tr_b16 v[100:101], v14 offset:35840
    v_mfma_f32_16x16x32_bf16 v[64:67], v[104:107], a[224:227], v[64:67]
    ds_read_b64_tr_b16 v[102:103], v14 offset:37120
    v_mfma_f32_16x16x32_bf16 v[84:87], v[104:107], v[240:243], v[84:87]
    s_waitcnt lgkmcnt(4)
    v_mfma_f32_16x16x32_bf16 v[28:31], v[108:111], a[64:67], v[28:31]
    v_mfma_f32_16x16x32_bf16 v[48:51], v[108:111], a[144:147], v[48:51]
    ds_read_b64_tr_b16 v[104:105], v14 offset:35872
    v_mfma_f32_16x16x32_bf16 v[68:71], v[108:111], a[224:227], v[68:71]
    ds_read_b64_tr_b16 v[106:107], v14 offset:37152
    v_mfma_f32_16x16x32_bf16 v[88:91], v[108:111], v[240:243], v[88:91]
    s_waitcnt lgkmcnt(4)
    v_mfma_f32_16x16x32_bf16 v[32:35], v[96:99], a[64:67], v[32:35]
    v_mfma_f32_16x16x32_bf16 v[52:55], v[96:99], a[144:147], v[52:55]
    ds_read_b64_tr_b16 v[108:109], v14 offset:35904
    v_mfma_f32_16x16x32_bf16 v[72:75], v[96:99], a[224:227], v[72:75]
    ds_read_b64_tr_b16 v[110:111], v14 offset:37184
    v_mfma_f32_16x16x32_bf16 v[92:95], v[96:99], v[240:243], v[92:95]
    s_waitcnt lgkmcnt(4)
    v_mfma_f32_16x16x32_bf16 v[16:19], v[100:103], a[68:71], v[16:19]
    v_mfma_f32_16x16x32_bf16 v[36:39], v[100:103], a[148:151], v[36:39]
    ds_read_b64_tr_b16 v[96:97], v14 offset:35936
    v_mfma_f32_16x16x32_bf16 v[56:59], v[100:103], a[228:231], v[56:59]
    ds_read_b64_tr_b16 v[98:99], v14 offset:37216
    v_mfma_f32_16x16x32_bf16 v[76:79], v[100:103], v[244:247], v[76:79]
    s_waitcnt lgkmcnt(4)
    v_mfma_f32_16x16x32_bf16 v[20:23], v[104:107], a[68:71], v[20:23]
    v_mfma_f32_16x16x32_bf16 v[40:43], v[104:107], a[148:151], v[40:43]
    ds_read_b64_tr_b16 v[100:101], v14 offset:35968
    v_mfma_f32_16x16x32_bf16 v[60:63], v[104:107], a[228:231], v[60:63]
    ds_read_b64_tr_b16 v[102:103], v14 offset:37248
    v_mfma_f32_16x16x32_bf16 v[80:83], v[104:107], v[244:247], v[80:83]
    s_waitcnt lgkmcnt(4)
    v_mfma_f32_16x16x32_bf16 v[24:27], v[108:111], a[68:71], v[24:27]
    v_mfma_f32_16x16x32_bf16 v[44:47], v[108:111], a[148:151], v[44:47]
    ds_read_b64_tr_b16 v[104:105], v14 offset:40960
    v_mfma_f32_16x16x32_bf16 v[64:67], v[108:111], a[228:231], v[64:67]
    ds_read_b64_tr_b16 v[106:107], v14 offset:42240
    v_mfma_f32_16x16x32_bf16 v[84:87], v[108:111], v[244:247], v[84:87]
    s_waitcnt lgkmcnt(4)
    v_mfma_f32_16x16x32_bf16 v[28:31], v[96:99], a[68:71], v[28:31]
    v_mfma_f32_16x16x32_bf16 v[48:51], v[96:99], a[148:151], v[48:51]
    ds_read_b64_tr_b16 v[108:109], v14 offset:40992
    v_mfma_f32_16x16x32_bf16 v[68:71], v[96:99], a[228:231], v[68:71]
    ds_read_b64_tr_b16 v[110:111], v14 offset:42272
    v_mfma_f32_16x16x32_bf16 v[88:91], v[96:99], v[244:247], v[88:91]
    s_waitcnt lgkmcnt(4)
    v_mfma_f32_16x16x32_bf16 v[32:35], v[100:103], a[68:71], v[32:35]
    v_mfma_f32_16x16x32_bf16 v[52:55], v[100:103], a[148:151], v[52:55]
    ds_read_b64_tr_b16 v[96:97], v14 offset:41024
    v_mfma_f32_16x16x32_bf16 v[72:75], v[100:103], a[228:231], v[72:75]
    ds_read_b64_tr_b16 v[98:99], v14 offset:42304
    v_mfma_f32_16x16x32_bf16 v[92:95], v[100:103], v[244:247], v[92:95]
    s_waitcnt lgkmcnt(4)
    v_mfma_f32_16x16x32_bf16 v[16:19], v[104:107], a[72:75], v[16:19]
    v_mfma_f32_16x16x32_bf16 v[36:39], v[104:107], a[152:155], v[36:39]
    ds_read_b64_tr_b16 v[100:101], v14 offset:41056
    v_mfma_f32_16x16x32_bf16 v[56:59], v[104:107], a[232:235], v[56:59]
    ds_read_b64_tr_b16 v[102:103], v14 offset:42336
    v_mfma_f32_16x16x32_bf16 v[76:79], v[104:107], v[248:251], v[76:79]
    s_waitcnt lgkmcnt(4)
    v_mfma_f32_16x16x32_bf16 v[20:23], v[108:111], a[72:75], v[20:23]
    v_mfma_f32_16x16x32_bf16 v[40:43], v[108:111], a[152:155], v[40:43]
    ds_read_b64_tr_b16 v[104:105], v14 offset:41088
    v_mfma_f32_16x16x32_bf16 v[60:63], v[108:111], a[232:235], v[60:63]
    ds_read_b64_tr_b16 v[106:107], v14 offset:42368
    v_mfma_f32_16x16x32_bf16 v[80:83], v[108:111], v[248:251], v[80:83]
    s_waitcnt lgkmcnt(4)
    v_mfma_f32_16x16x32_bf16 v[24:27], v[96:99], a[72:75], v[24:27]
    v_mfma_f32_16x16x32_bf16 v[44:47], v[96:99], a[152:155], v[44:47]
    ds_read_b64_tr_b16 v[108:109], v14 offset:46080
    v_mfma_f32_16x16x32_bf16 v[64:67], v[96:99], a[232:235], v[64:67]
    ds_read_b64_tr_b16 v[110:111], v14 offset:47360
    v_mfma_f32_16x16x32_bf16 v[84:87], v[96:99], v[248:251], v[84:87]
    s_waitcnt lgkmcnt(4)
    v_mfma_f32_16x16x32_bf16 v[28:31], v[100:103], a[72:75], v[28:31]
    v_mfma_f32_16x16x32_bf16 v[48:51], v[100:103], a[152:155], v[48:51]
    ds_read_b64_tr_b16 v[96:97], v14 offset:46112
    v_mfma_f32_16x16x32_bf16 v[68:71], v[100:103], a[232:235], v[68:71]
    ds_read_b64_tr_b16 v[98:99], v14 offset:47392
    v_mfma_f32_16x16x32_bf16 v[88:91], v[100:103], v[248:251], v[88:91]
    s_waitcnt lgkmcnt(4)
    v_mfma_f32_16x16x32_bf16 v[32:35], v[104:107], a[72:75], v[32:35]
    v_mfma_f32_16x16x32_bf16 v[52:55], v[104:107], a[152:155], v[52:55]
    ds_read_b64_tr_b16 v[100:101], v14 offset:46144
    v_mfma_f32_16x16x32_bf16 v[72:75], v[104:107], a[232:235], v[72:75]
    ds_read_b64_tr_b16 v[102:103], v14 offset:47424
    v_mfma_f32_16x16x32_bf16 v[92:95], v[104:107], v[248:251], v[92:95]
    s_waitcnt lgkmcnt(4)
    v_mfma_f32_16x16x32_bf16 v[16:19], v[108:111], a[76:79], v[16:19]
    v_mfma_f32_16x16x32_bf16 v[36:39], v[108:111], a[156:159], v[36:39]
    ds_read_b64_tr_b16 v[104:105], v14 offset:46176
    v_mfma_f32_16x16x32_bf16 v[56:59], v[108:111], a[236:239], v[56:59]
    ds_read_b64_tr_b16 v[106:107], v14 offset:47456
    v_mfma_f32_16x16x32_bf16 v[76:79], v[108:111], v[252:255], v[76:79]
    s_waitcnt lgkmcnt(4)
    v_mfma_f32_16x16x32_bf16 v[20:23], v[96:99], a[76:79], v[20:23]
    v_mfma_f32_16x16x32_bf16 v[40:43], v[96:99], a[156:159], v[40:43]
    ds_read_b64_tr_b16 v[108:109], v14 offset:46208
    v_mfma_f32_16x16x32_bf16 v[60:63], v[96:99], a[236:239], v[60:63]
    ds_read_b64_tr_b16 v[110:111], v14 offset:47488
    v_mfma_f32_16x16x32_bf16 v[80:83], v[96:99], v[252:255], v[80:83]
    s_waitcnt lgkmcnt(4)
    v_mfma_f32_16x16x32_bf16 v[24:27], v[100:103], a[76:79], v[24:27]
    v_mfma_f32_16x16x32_bf16 v[44:47], v[100:103], a[156:159], v[44:47]
    v_mfma_f32_16x16x32_bf16 v[64:67], v[100:103], a[236:239], v[64:67]
    v_mfma_f32_16x16x32_bf16 v[84:87], v[100:103], v[252:255], v[84:87]
    s_waitcnt lgkmcnt(2)
    v_mfma_f32_16x16x32_bf16 v[28:31], v[104:107], a[76:79], v[28:31]
    v_mfma_f32_16x16x32_bf16 v[48:51], v[104:107], a[156:159], v[48:51]
    v_mfma_f32_16x16x32_bf16 v[68:71], v[104:107], a[236:239], v[68:71]
    v_mfma_f32_16x16x32_bf16 v[88:91], v[104:107], v[252:255], v[88:91]
    s_waitcnt lgkmcnt(0)
    v_mfma_f32_16x16x32_bf16 v[32:35], v[108:111], a[76:79], v[32:35]
    v_mfma_f32_16x16x32_bf16 v[52:55], v[108:111], a[156:159], v[52:55]
    v_mfma_f32_16x16x32_bf16 v[72:75], v[108:111], a[236:239], v[72:75]
    v_mfma_f32_16x16x32_bf16 v[92:95], v[108:111], v[252:255], v[92:95]
    v_lshlrev_b32 v2, 4, v5
    v_lshl_add_u32 v2, v4, 2, v2
    v_mul_u32_u24 v3, 1280, v5
    v_lshl_add_u32 v3, v4, 3, v3
    s_lshr_b32 s68, s66, 5
    s_mul_i32 s68, s68, 40960
    s_mul_i32 s6, s64, 5120
    s_add_u32 s68, s68, s6
    s_add_u32 s68, s68, 9723904
    s_mul_i32 s69, s66, 1280
    s_add_u32 s69, s69, s67
    s_add_u32 s33, s68, 4096
A_BP0:
    buffer_load_dword v128, v2, s[8:11], s68 offen offset:0 sc1
    buffer_load_dword v129, v2, s[8:11], s68 offen offset:512 sc1
    buffer_load_dword v130, v2, s[8:11], s68 offen offset:1024 sc1
    buffer_load_dword v131, v2, s[8:11], s68 offen offset:1536 sc1
    buffer_load_dword v132, v2, s[8:11], s68 offen offset:2048 sc1
    buffer_load_dword v133, v2, s[8:11], s68 offen offset:2560 sc1
    buffer_load_dword v134, v2, s[8:11], s68 offen offset:3072 sc1
    buffer_load_dword v135, v2, s[8:11], s68 offen offset:3584 sc1
    buffer_load_dword v136, v2, s[8:11], s33 offen offset:0 sc1
    buffer_load_dword v137, v2, s[8:11], s33 offen offset:512 sc1
    buffer_load_dword v138, v2, s[8:11], s68 offen offset:256 sc1
    buffer_load_dword v139, v2, s[8:11], s68 offen offset:768 sc1
    buffer_load_dword v140, v2, s[8:11], s68 offen offset:1280 sc1
    buffer_load_dword v141, v2, s[8:11], s68 offen offset:1792 sc1
    buffer_load_dword v142, v2, s[8:11], s68 offen offset:2304 sc1
    buffer_load_dword v143, v2, s[8:11], s68 offen offset:2816 sc1
    buffer_load_dword v144, v2, s[8:11], s68 offen offset:3328 sc1
    buffer_load_dword v145, v2, s[8:11], s68 offen offset:3840 sc1
    buffer_load_dword v146, v2, s[8:11], s33 offen offset:256 sc1
    buffer_load_dword v147, v2, s[8:11], s33 offen offset:768 sc1
    s_waitcnt vmcnt(0)
    v_max3_u32 v7, v128, v129, v130
    v_max3_u32 v7, v7, v131, v132
    v_max3_u32 v7, v7, v133, v134
    v_max3_u32 v7, v7, v135, v136
    v_max3_u32 v7, v7, v137, v138
    v_max3_u32 v7, v7, v139, v140
    v_max3_u32 v7, v7, v141, v142
    v_max3_u32 v7, v7, v143, v144
    v_max3_u32 v7, v7, v145, v146
    v_max_u32 v7, v7, v147
    v_cmp_eq_u32 vcc, -1, v7
    s_cbranch_vccz A_BD0
    s_sleep 3
    s_sub_u32 s32, s32, 1
    s_cbranch_scc0 A_BP0
    s_endpgm
A_BD0:
    v_lshlrev_b32 v8, 16, v128
    v_and_b32 v9, 0xffff0000, v128
    v_lshlrev_b32 v10, 16, v129
    v_and_b32 v11, 0xffff0000, v129
    v_sub_f32 v16, v16, v8
    v_sub_f32 v17, v17, v9
    v_sub_f32 v18, v18, v10
    v_sub_f32 v19, v19, v11
    v_fma_f32 v16, v16, v112, v8
    v_fma_f32 v17, v17, v112, v9
    v_fma_f32 v18, v18, v112, v10
    v_fma_f32 v19, v19, v112, v11
    v_cvt_pk_bf16_f32 v16, v16, v17
    v_cvt_pk_bf16_f32 v17, v18, v19
    buffer_store_dwordx2 v[16:17], v3, s[28:31], s69 offen offset:0
    v_lshlrev_b32 v8, 16, v130
    v_and_b32 v9, 0xffff0000, v130
    v_lshlrev_b32 v10, 16, v131
    v_and_b32 v11, 0xffff0000, v131
    v_sub_f32 v20, v20, v8
    v_sub_f32 v21, v21, v9
    v_sub_f32 v22, v22, v10
    v_sub_f32 v23, v23, v11
    v_fma_f32 v20, v20, v112, v8
    v_fma_f32 v21, v21, v112, v9
    v_fma_f32 v22, v22, v112, v10
    v_fma_f32 v23, v23, v112, v11
    v_cvt_pk_bf16_f32 v20, v20, v21
    v_cvt_pk_bf16_f32 v21, v22, v23
    buffer_store_dwordx2 v[20:21], v3, s[28:31], s69 offen offset:32
    v_lshlrev_b32 v8, 16, v132
    v_and_b32 v9, 0xffff0000, v132
    v_lshlrev_b32 v10, 16, v133
    v_and_b32 v11, 0xffff0000, v133
    v_sub_f32 v24, v24, v8
    v_sub_f32 v25, v25, v9
    v_sub_f32 v26, v26, v10
    v_sub_f32 v27, v27, v11
    v_fma_f32 v24, v24, v112, v8
    v_fma_f32 v25, v25, v112, v9
    v_fma_f32 v26, v26, v112, v10
    v_fma_f32 v27, v27, v112, v11
    v_cvt_pk_bf16_f32 v24, v24, v25
    v_cvt_pk_bf16_f32 v25, v26, v27
    buffer_store_dwordx2 v[24:25], v3, s[28:31], s69 offen offset:64
    v_lshlrev_b32 v8, 16, v134
    v_and_b32 v9, 0xffff0000, v134
    v_lshlrev_b32 v10, 16, v135
    v_and_b32 v11, 0xffff0000, v135
    v_sub_f32 v28, v28, v8
    v_sub_f32 v29, v29, v9
    v_sub_f32 v30, v30, v10
    v_sub_f32 v31, v31, v11
    v_fma_f32 v28, v28, v112, v8
    v_fma_f32 v29, v29, v112, v9
    v_fma_f32 v30, v30, v112, v10
    v_fma_f32 v31, v31, v112, v11
    v_cvt_pk_bf16_f32 v28, v28, v29
    v_cvt_pk_bf16_f32 v29, v30, v31
    buffer_store_dwordx2 v[28:29], v3, s[28:31], s69 offen offset:96
    v_lshlrev_b32 v8, 16, v136
    v_and_b32 v9, 0xffff0000, v136
    v_lshlrev_b32 v10, 16, v137
    v_and_b32 v11, 0xffff0000, v137
    v_sub_f32 v32, v32, v8
    v_sub_f32 v33, v33, v9
    v_sub_f32 v34, v34, v10
    v_sub_f32 v35, v35, v11
    v_fma_f32 v32, v32, v112, v8
    v_fma_f32 v33, v33, v112, v9
    v_fma_f32 v34, v34, v112, v10
    v_fma_f32 v35, v35, v112, v11
    v_cvt_pk_bf16_f32 v32, v32, v33
    v_cvt_pk_bf16_f32 v33, v34, v35
    buffer_store_dwordx2 v[32:33], v3, s[28:31], s69 offen offset:128
    s_add_u32 s69, s69, 20480
    v_lshlrev_b32 v8, 16, v138
    v_and_b32 v9, 0xffff0000, v138
    v_lshlrev_b32 v10, 16, v139
    v_and_b32 v11, 0xffff0000, v139
    v_sub_f32 v36, v36, v8
    v_sub_f32 v37, v37, v9
    v_sub_f32 v38, v38, v10
    v_sub_f32 v39, v39, v11
    v_fma_f32 v36, v36, v113, v8
    v_fma_f32 v37, v37, v113, v9
    v_fma_f32 v38, v38, v113, v10
    v_fma_f32 v39, v39, v113, v11
    v_cvt_pk_bf16_f32 v36, v36, v37
    v_cvt_pk_bf16_f32 v37, v38, v39
    buffer_store_dwordx2 v[36:37], v3, s[28:31], s69 offen offset:0
    v_lshlrev_b32 v8, 16, v140
    v_and_b32 v9, 0xffff0000, v140
    v_lshlrev_b32 v10, 16, v141
    v_and_b32 v11, 0xffff0000, v141
    v_sub_f32 v40, v40, v8
    v_sub_f32 v41, v41, v9
    v_sub_f32 v42, v42, v10
    v_sub_f32 v43, v43, v11
    v_fma_f32 v40, v40, v113, v8
    v_fma_f32 v41, v41, v113, v9
    v_fma_f32 v42, v42, v113, v10
    v_fma_f32 v43, v43, v113, v11
    v_cvt_pk_bf16_f32 v40, v40, v41
    v_cvt_pk_bf16_f32 v41, v42, v43
    buffer_store_dwordx2 v[40:41], v3, s[28:31], s69 offen offset:32
    v_lshlrev_b32 v8, 16, v142
    v_and_b32 v9, 0xffff0000, v142
    v_lshlrev_b32 v10, 16, v143
    v_and_b32 v11, 0xffff0000, v143
    v_sub_f32 v44, v44, v8
    v_sub_f32 v45, v45, v9
    v_sub_f32 v46, v46, v10
    v_sub_f32 v47, v47, v11
    v_fma_f32 v44, v44, v113, v8
    v_fma_f32 v45, v45, v113, v9
    v_fma_f32 v46, v46, v113, v10
    v_fma_f32 v47, v47, v113, v11
    v_cvt_pk_bf16_f32 v44, v44, v45
    v_cvt_pk_bf16_f32 v45, v46, v47
    buffer_store_dwordx2 v[44:45], v3, s[28:31], s69 offen offset:64
    v_lshlrev_b32 v8, 16, v144
    v_and_b32 v9, 0xffff0000, v144
    v_lshlrev_b32 v10, 16, v145
    v_and_b32 v11, 0xffff0000, v145
    v_sub_f32 v48, v48, v8
    v_sub_f32 v49, v49, v9
    v_sub_f32 v50, v50, v10
    v_sub_f32 v51, v51, v11
    v_fma_f32 v48, v48, v113, v8
    v_fma_f32 v49, v49, v113, v9
    v_fma_f32 v50, v50, v113, v10
    v_fma_f32 v51, v51, v113, v11
    v_cvt_pk_bf16_f32 v48, v48, v49
    v_cvt_pk_bf16_f32 v49, v50, v51
    buffer_store_dwordx2 v[48:49], v3, s[28:31], s69 offen offset:96
    v_lshlrev_b32 v8, 16, v146
    v_and_b32 v9, 0xffff0000, v146
    v_lshlrev_b32 v10, 16, v147
    v_and_b32 v11, 0xffff0000, v147
    v_sub_f32 v52, v52, v8
    v_sub_f32 v53, v53, v9
    v_sub_f32 v54, v54, v10
    v_sub_f32 v55, v55, v11
    v_fma_f32 v52, v52, v113, v8
    v_fma_f32 v53, v53, v113, v9
    v_fma_f32 v54, v54, v113, v10
    v_fma_f32 v55, v55, v113, v11
    v_cvt_pk_bf16_f32 v52, v52, v53
    v_cvt_pk_bf16_f32 v53, v54, v55
    buffer_store_dwordx2 v[52:53], v3, s[28:31], s69 offen offset:128
    s_add_u32 s69, s69, 20480
    s_add_u32 s68, s68, 40960
    s_add_u32 s33, s68, 4096
A_BP1:
    buffer_load_dword v128, v2, s[8:11], s68 offen offset:0 sc1
    buffer_load_dword v129, v2, s[8:11], s68 offen offset:512 sc1
    buffer_load_dword v130, v2, s[8:11], s68 offen offset:1024 sc1
    buffer_load_dword v131, v2, s[8:11], s68 offen offset:1536 sc1
    buffer_load_dword v132, v2, s[8:11], s68 offen offset:2048 sc1
    buffer_load_dword v133, v2, s[8:11], s68 offen offset:2560 sc1
    buffer_load_dword v134, v2, s[8:11], s68 offen offset:3072 sc1
    buffer_load_dword v135, v2, s[8:11], s68 offen offset:3584 sc1
    buffer_load_dword v136, v2, s[8:11], s33 offen offset:0 sc1
    buffer_load_dword v137, v2, s[8:11], s33 offen offset:512 sc1
    buffer_load_dword v138, v2, s[8:11], s68 offen offset:256 sc1
    buffer_load_dword v139, v2, s[8:11], s68 offen offset:768 sc1
    buffer_load_dword v140, v2, s[8:11], s68 offen offset:1280 sc1
    buffer_load_dword v141, v2, s[8:11], s68 offen offset:1792 sc1
    buffer_load_dword v142, v2, s[8:11], s68 offen offset:2304 sc1
    buffer_load_dword v143, v2, s[8:11], s68 offen offset:2816 sc1
    buffer_load_dword v144, v2, s[8:11], s68 offen offset:3328 sc1
    buffer_load_dword v145, v2, s[8:11], s68 offen offset:3840 sc1
    buffer_load_dword v146, v2, s[8:11], s33 offen offset:256 sc1
    buffer_load_dword v147, v2, s[8:11], s33 offen offset:768 sc1
    s_waitcnt vmcnt(0)
    v_max3_u32 v7, v128, v129, v130
    v_max3_u32 v7, v7, v131, v132
    v_max3_u32 v7, v7, v133, v134
    v_max3_u32 v7, v7, v135, v136
    v_max3_u32 v7, v7, v137, v138
    v_max3_u32 v7, v7, v139, v140
    v_max3_u32 v7, v7, v141, v142
    v_max3_u32 v7, v7, v143, v144
    v_max3_u32 v7, v7, v145, v146
    v_max_u32 v7, v7, v147
    v_cmp_eq_u32 vcc, -1, v7
    s_cbranch_vccz A_BD1
    s_sleep 3
    s_sub_u32 s32, s32, 1
    s_cbranch_scc0 A_BP1
    s_endpgm
A_BD1:
    v_lshlrev_b32 v8, 16, v128
    v_and_b32 v9, 0xffff0000, v128
    v_lshlrev_b32 v10, 16, v129
    v_and_b32 v11, 0xffff0000, v129
    v_sub_f32 v56, v56, v8
    v_sub_f32 v57, v57, v9
    v_sub_f32 v58, v58, v10
    v_sub_f32 v59, v59, v11
    v_fma_f32 v56, v56, v114, v8
    v_fma_f32 v57, v57, v114, v9
    v_fma_f32 v58, v58, v114, v10
    v_fma_f32 v59, v59, v114, v11
    v_cvt_pk_bf16_f32 v56, v56, v57
    v_cvt_pk_bf16_f32 v57, v58, v59
    buffer_store_dwordx2 v[56:57], v3, s[28:31], s69 offen offset:0
    v_lshlrev_b32 v8, 16, v130
    v_and_b32 v9, 0xffff0000, v130
    v_lshlrev_b32 v10, 16, v131
    v_and_b32 v11, 0xffff0000, v131
    v_sub_f32 v60, v60, v8
    v_sub_f32 v61, v61, v9
    v_sub_f32 v62, v62, v10
    v_sub_f32 v63, v63, v11
    v_fma_f32 v60, v60, v114, v8
    v_fma_f32 v61, v61, v114, v9
    v_fma_f32 v62, v62, v114, v10
    v_fma_f32 v63, v63, v114, v11
    v_cvt_pk_bf16_f32 v60, v60, v61
    v_cvt_pk_bf16_f32 v61, v62, v63
    buffer_store_dwordx2 v[60:61], v3, s[28:31], s69 offen offset:32
    v_lshlrev_b32 v8, 16, v132
    v_and_b32 v9, 0xffff0000, v132
    v_lshlrev_b32 v10, 16, v133
    v_and_b32 v11, 0xffff0000, v133
    v_sub_f32 v64, v64, v8
    v_sub_f32 v65, v65, v9
    v_sub_f32 v66, v66, v10
    v_sub_f32 v67, v67, v11
    v_fma_f32 v64, v64, v114, v8
    v_fma_f32 v65, v65, v114, v9
    v_fma_f32 v66, v66, v114, v10
    v_fma_f32 v67, v67, v114, v11
    v_cvt_pk_bf16_f32 v64, v64, v65
    v_cvt_pk_bf16_f32 v65, v66, v67
    buffer_store_dwordx2 v[64:65], v3, s[28:31], s69 offen offset:64
    v_lshlrev_b32 v8, 16, v134
    v_and_b32 v9, 0xffff0000, v134
    v_lshlrev_b32 v10, 16, v135
    v_and_b32 v11, 0xffff0000, v135
    v_sub_f32 v68, v68, v8
    v_sub_f32 v69, v69, v9
    v_sub_f32 v70, v70, v10
    v_sub_f32 v71, v71, v11
    v_fma_f32 v68, v68, v114, v8
    v_fma_f32 v69, v69, v114, v9
    v_fma_f32 v70, v70, v114, v10
    v_fma_f32 v71, v71, v114, v11
    v_cvt_pk_bf16_f32 v68, v68, v69
    v_cvt_pk_bf16_f32 v69, v70, v71
    buffer_store_dwordx2 v[68:69], v3, s[28:31], s69 offen offset:96
    v_lshlrev_b32 v8, 16, v136
    v_and_b32 v9, 0xffff0000, v136
    v_lshlrev_b32 v10, 16, v137
    v_and_b32 v11, 0xffff0000, v137
    v_sub_f32 v72, v72, v8
    v_sub_f32 v73, v73, v9
    v_sub_f32 v74, v74, v10
    v_sub_f32 v75, v75, v11
    v_fma_f32 v72, v72, v114, v8
    v_fma_f32 v73, v73, v114, v9
    v_fma_f32 v74, v74, v114, v10
    v_fma_f32 v75, v75, v114, v11
    v_cvt_pk_bf16_f32 v72, v72, v73
    v_cvt_pk_bf16_f32 v73, v74, v75
    buffer_store_dwordx2 v[72:73], v3, s[28:31], s69 offen offset:128
    s_add_u32 s69, s69, 20480
    v_lshlrev_b32 v8, 16, v138
    v_and_b32 v9, 0xffff0000, v138
    v_lshlrev_b32 v10, 16, v139
    v_and_b32 v11, 0xffff0000, v139
    v_sub_f32 v76, v76, v8
    v_sub_f32 v77, v77, v9
    v_sub_f32 v78, v78, v10
    v_sub_f32 v79, v79, v11
    v_fma_f32 v76, v76, v115, v8
    v_fma_f32 v77, v77, v115, v9
    v_fma_f32 v78, v78, v115, v10
    v_fma_f32 v79, v79, v115, v11
    v_cvt_pk_bf16_f32 v76, v76, v77
    v_cvt_pk_bf16_f32 v77, v78, v79
    buffer_store_dwordx2 v[76:77], v3, s[28:31], s69 offen offset:0
    v_lshlrev_b32 v8, 16, v140
    v_and_b32 v9, 0xffff0000, v140
    v_lshlrev_b32 v10, 16, v141
    v_and_b32 v11, 0xffff0000, v141
    v_sub_f32 v80, v80, v8
    v_sub_f32 v81, v81, v9
    v_sub_f32 v82, v82, v10
    v_sub_f32 v83, v83, v11
    v_fma_f32 v80, v80, v115, v8
    v_fma_f32 v81, v81, v115, v9
    v_fma_f32 v82, v82, v115, v10
    v_fma_f32 v83, v83, v115, v11
    v_cvt_pk_bf16_f32 v80, v80, v81
    v_cvt_pk_bf16_f32 v81, v82, v83
    buffer_store_dwordx2 v[80:81], v3, s[28:31], s69 offen offset:32
    v_lshlrev_b32 v8, 16, v142
    v_and_b32 v9, 0xffff0000, v142
    v_lshlrev_b32 v10, 16, v143
    v_and_b32 v11, 0xffff0000, v143
    v_sub_f32 v84, v84, v8
    v_sub_f32 v85, v85, v9
    v_sub_f32 v86, v86, v10
    v_sub_f32 v87, v87, v11
    v_fma_f32 v84, v84, v115, v8
    v_fma_f32 v85, v85, v115, v9
    v_fma_f32 v86, v86, v115, v10
    v_fma_f32 v87, v87, v115, v11
    v_cvt_pk_bf16_f32 v84, v84, v85
    v_cvt_pk_bf16_f32 v85, v86, v87
    buffer_store_dwordx2 v[84:85], v3, s[28:31], s69 offen offset:64
    v_lshlrev_b32 v8, 16, v144
    v_and_b32 v9, 0xffff0000, v144
    v_lshlrev_b32 v10, 16, v145
    v_and_b32 v11, 0xffff0000, v145
    v_sub_f32 v88, v88, v8
    v_sub_f32 v89, v89, v9
    v_sub_f32 v90, v90, v10
    v_sub_f32 v91, v91, v11
    v_fma_f32 v88, v88, v115, v8
    v_fma_f32 v89, v89, v115, v9
    v_fma_f32 v90, v90, v115, v10
    v_fma_f32 v91, v91, v115, v11
    v_cvt_pk_bf16_f32 v88, v88, v89
    v_cvt_pk_bf16_f32 v89, v90, v91
    buffer_store_dwordx2 v[88:89], v3, s[28:31], s69 offen offset:96
    v_lshlrev_b32 v8, 16, v146
    v_and_b32 v9, 0xffff0000, v146
    v_lshlrev_b32 v10, 16, v147
    v_and_b32 v11, 0xffff0000, v147
    v_sub_f32 v92, v92, v8
    v_sub_f32 v93, v93, v9
    v_sub_f32 v94, v94, v10
    v_sub_f32 v95, v95, v11
    v_fma_f32 v92, v92, v115, v8
    v_fma_f32 v93, v93, v115, v9
    v_fma_f32 v94, v94, v115, v10
    v_fma_f32 v95, v95, v115, v11
    v_cvt_pk_bf16_f32 v92, v92, v93
    v_cvt_pk_bf16_f32 v93, v94, v95
    buffer_store_dwordx2 v[92:93], v3, s[28:31], s69 offen offset:128
    s_add_u32 s69, s69, 20480
    s_add_u32 s68, s68, 40960
    s_endpgm
.section .rodata,"a"
.p2align 6
.amdhsa_kernel gated_mix__softmax_full_mha__memory_aug_recurrent_mem_tr__prompt_kernel
  .amdhsa_next_free_vgpr 512
  .amdhsa_next_free_sgpr 102
  .amdhsa_accum_offset 256
  .amdhsa_group_segment_fixed_size 0
  .amdhsa_kernarg_size 112
  .amdhsa_user_sgpr_count 2
  .amdhsa_user_sgpr_kernarg_segment_ptr 1
  .amdhsa_system_sgpr_workgroup_id_x 1
.end_amdhsa_kernel
```
